```python
import torch

def _softmax(x, axis=-1):
    return torch.softmax(x, dim=axis)

def _gelu(x):
    return torch.nn.functional.gelu(x, approximate='tanh')

def _silu(x):
    return torch.nn.functional.silu(x)

def _sigmoid(x):
    return torch.sigmoid(x)

def _layernorm(x, axis=-1, eps=1e-05):
    m = x.mean(dim=axis, keepdim=True)
    v = x.var(dim=axis, keepdim=True, unbiased=False)
    return (x - m) / torch.sqrt(v + eps)

def _scatter_add(tgt, idx, src, axis=0):
    return tgt.clone().index_add_(axis, idx, src)

def _segment_sum(src, seg, n):
    out = torch.zeros((n,) + src.shape[1:], dtype=src.dtype)
    return out.index_add_(0, seg, src)

def _pad(x, pw):
    flat = tuple((v for pair in reversed(pw) for v in pair))
    return torch.nn.functional.pad(x, flat)
kernel_name = 'concat_heads__ssm_conv_s4__memory_aug_recurrent_mem_tr__prompt'

def setup_inputs():

    _w = lambda a: (lambda t: t.to(torch.bfloat16) if t.is_floating_point() else t)(torch.as_tensor(a))

    def _A_setup():
        B, L, D, N = (1, 2048, 640, 128)
        A_re = -(lambda _x: torch.exp(torch.as_tensor(_x)))((lambda *s: torch.randn(*s, dtype=torch.bfloat16) * 6.4)(D, N))
        A_im = torch.pi * (lambda *s: torch.randn(*s, dtype=torch.bfloat16) * 0.05)(D, N)
        B_re = (lambda *s: torch.randn(*s, dtype=torch.bfloat16) * 0.1)(D, N)
        B_im = (lambda *s: torch.randn(*s, dtype=torch.bfloat16) * 0.1)(D, N)
        C_re = (lambda *s: torch.randn(*s, dtype=torch.bfloat16) * 0.1)(D, N)
        C_im = (lambda *s: torch.randn(*s, dtype=torch.bfloat16) * 0.1)(D, N)
        log_dt = (lambda *s: torch.randn(*s, dtype=torch.bfloat16) * 0.05)(D) * 0.5 - 4.0
        Dskip = (lambda *s: torch.randn(*s, dtype=torch.bfloat16) * 0.05)(D)
        return {'u': _w((lambda *s: torch.randn(*s, dtype=torch.bfloat16) * 0.05)(B, L, D)), 'A_re': _w(A_re), 'A_im': _w(A_im), 'B_re': _w(B_re), 'B_im': _w(B_im), 'C_re': _w(C_re), 'C_im': _w(C_im), 'log_dt': _w(log_dt), 'Dskip': _w(Dskip)}
    _A_in = _A_setup()

    def _B_setup():
        B, S, Dm = (1, 2048, 640)
        H, Dh = (32, 128)
        M, seg = (8, 32)
        seg = min(seg, S)
        S = S // seg * seg
        return {'x': _w((lambda *s: torch.randn(*s, dtype=torch.bfloat16) * 0.05)(B, S, Dm)), 'mem0': _w((lambda *s: torch.randn(*s, dtype=torch.bfloat16) * 0.4)(B, M, Dm)), 'Wq': _w((lambda *s: torch.randn(*s, dtype=torch.bfloat16) * 6.4)(Dm, H, Dh) * Dm ** (-0.5)), 'Wk': _w((lambda *s: torch.randn(*s, dtype=torch.bfloat16) * 6.4)(Dm, H, Dh) * Dm ** (-0.5)), 'Wv': _w((lambda *s: torch.randn(*s, dtype=torch.bfloat16) * 0.4)(Dm, H, Dh) * Dm ** (-0.5)), 'Wo': _w((lambda *s: torch.randn(*s, dtype=torch.bfloat16) * 0.4)(H, Dh, Dm) * (H * Dh) ** (-0.5)), 'seg_len': seg}
    _B_in = _B_setup()
    return {'A_u': _A_in['u'], 'A_A_re': _A_in['A_re'], 'A_A_im': _A_in['A_im'], 'A_B_re': _A_in['B_re'], 'A_B_im': _A_in['B_im'], 'A_C_re': _A_in['C_re'], 'A_C_im': _A_in['C_im'], 'A_log_dt': _A_in['log_dt'], 'A_Dskip': _A_in['Dskip'], 'B_x': _B_in['x'], 'B_mem0': _B_in['mem0'], 'B_Wq': _B_in['Wq'], 'B_Wk': _B_in['Wk'], 'B_Wv': _B_in['Wv'], 'B_Wo': _B_in['Wo'], 'B_seg_len': _B_in['seg_len']}

def reference(A_u, A_A_re, A_A_im, A_B_re, A_B_im, A_C_re, A_C_im, A_log_dt, A_Dskip, B_x, B_mem0, B_Wq, B_Wk, B_Wv, B_Wo, B_seg_len):

    def _A_ref(u, A_re, A_im, B_re, B_im, C_re, C_im, log_dt, Dskip):
        Bsz, L, D = u.shape
        dt = torch.exp(log_dt)[:, None]
        A = A_re + 1j * A_im
        Bc = B_re + 1j * B_im
        Cc = C_re + 1j * C_im
        logdA = dt * A
        dB = dt * Bc
        l = (lambda x, dt: x.to(dt))(torch.arange(L), A_re.dtype)
        P = torch.exp(logdA[:, :, None] * l[None, None, :])
        K = torch.einsum('dn,dnl,dn->dl', Cc, P, dB).real
        L2 = 2 * L
        Kp = _pad(K, ((0, 0), (0, L)))
        up = (lambda x, *d: x.permute(*d))(u, 0, 2, 1)
        up = _pad(up, ((0, 0), (0, 0), (0, L)))
        Kf = (lambda x, axes=(-2, -1): torch.fft.rfft2(x.float(), dim=axes))(Kp[:, None, :], axes=(-2, -1))
        Uf = (lambda x, axes=(-2, -1): torch.fft.rfft2(x.float(), dim=axes))(up[:, :, None, :], axes=(-2, -1))
        Yf = Uf * Kf[None, :, :, :]
        y = (lambda x, s, axes=(-2, -1): torch.fft.irfft2(x, s=s, dim=axes).to(torch.bfloat16))(Yf, (1, L2), axes=(-2, -1))[:, :, 0, :L]
        y = (lambda x, *d: x.permute(*d))(y, 0, 2, 1) + u * Dskip[None, None, :]
        return y

    def _B_ref(x, mem0, Wq, Wk, Wv, Wo, seg_len):
        B, S, Dm = x.shape
        H, Dh = (Wq.shape[1], Wq.shape[2])
        M = mem0.shape[1]
        scale = Dh ** (-0.5)
        n_seg = S // seg_len
        L = M + seg_len
        idx = torch.arange(L)
        mask = (idx[:, None] < M) | (idx[:, None] >= idx[None, :])
        mem = mem0
        outs = []
        for s in range(n_seg):
            xs = x[:, s * seg_len:(s + 1) * seg_len, :].clone()
            h = torch.concatenate([mem, xs], axis=1)
            q = torch.einsum('btd,dhe->bhte', h, Wq)
            k = torch.einsum('btd,dhe->bhte', h, Wk)
            v = torch.einsum('btd,dhe->bhte', h, Wv)
            scores = torch.einsum('bhqe,bhke->bhqk', q, k) * scale
            scores = torch.where(mask[None, None], scores, -1000000000.0)
            p = _softmax(scores, axis=-1)
            o = torch.einsum('bhqk,bhke->bhqe', p, v)
            o = torch.einsum('bhte,hed->btd', o, Wo)
            mem = o[:, :M, :].clone()
            outs.append(o[:, M:, :])
        return torch.concatenate(outs, axis=1)
    a = _A_ref(A_u, A_A_re, A_A_im, A_B_re, A_B_im, A_C_re, A_C_im, A_log_dt, A_Dskip)
    b = _B_ref(B_x, B_mem0, B_Wq, B_Wk, B_Wv, B_Wo, B_seg_len)
    return torch.concatenate([a, b], axis=-1)
```

```asm
; @launch grid=(256,1,1) block=(256,1,1) lds=163840
.amdgcn_target "amdgcn-amd-amdhsa--gfx950"
.text
.globl concat_heads__ssm_conv_s4__memory_aug_recurrent_mem_tr__prompt_kernel
.p2align 8
.type concat_heads__ssm_conv_s4__memory_aug_recurrent_mem_tr__prompt_kernel,@function
concat_heads__ssm_conv_s4__memory_aug_recurrent_mem_tr__prompt_kernel:

s_cmp_ge_u32 s2, 256
s_cbranch_scc1 L_exit
s_load_dwordx2 s[4:5], s[0:1], 144
s_load_dwordx2 s[6:7], s[0:1], 136
s_getreg_b32 s12, hwreg(HW_REG_XCC_ID, 0, 4)
v_and_b32 v1, 63, v0
v_lshrrev_b32 v30, 6, v0
s_nop 0
v_readfirstlane_b32 s3, v30
s_mov_b32 s101, 0
s_mov_b32 s100, 0
s_mov_b32 s99, 0
s_waitcnt lgkmcnt(0)
s_cmp_lg_u32 s3, 0
s_cbranch_scc1 L_tk
s_lshl_b32 s14, s12, 2
v_mov_b32 v30, s14
v_mov_b32 v31, 1
s_mov_b64 exec, 1
global_atomic_add v32, v30, v31, s[6:7] sc0
s_waitcnt vmcnt(0)
v_mov_b32 v30, 0
ds_write_b32 v30, v32
s_mov_b64 exec, -1
s_waitcnt lgkmcnt(0)
s_branch L_tk2
L_tk:
s_mul_i32 s40, s2, 7424
s_add_u32 s40, s40, 44040192
v_subrev_u32 v33, 64, v0
v_lshlrev_b32 v33, 4, v33
v_add_u32 v34, s40, v33
v_mov_b32 v36, -1
v_mov_b32 v37, -1
v_mov_b32 v38, -1
v_mov_b32 v39, -1
global_store_dwordx4 v34, v[36:39], s[4:5] sc1
global_store_dwordx4 v34, v[36:39], s[4:5] offset:3072 sc1
v_cmp_gt_u32 vcc, 1280, v33
s_and_saveexec_b64 s[42:43], vcc
s_nop 2
s_cbranch_execz L_i2
v_add_u32 v34, 6144, v34
global_store_dwordx4 v34, v[36:39], s[4:5] sc1
L_i2:
s_mov_b64 exec, s[42:43]
s_mul_i32 s40, s2, 208
s_add_u32 s40, s40, 46137344
v_add_u32 v34, s40, v33
v_mov_b32 v40, 0
v_mov_b32 v41, 0
v_mov_b32 v42, 0
v_mov_b32 v43, 0
v_cmp_gt_u32 vcc, 208, v33
s_and_saveexec_b64 s[42:43], vcc
s_nop 2
s_cbranch_execz L_i3
global_store_dwordx4 v34, v[40:43], s[4:5] sc1
L_i3:
s_mov_b64 exec, s[42:43]
L_tk2:
s_barrier
v_mov_b32 v30, 0
ds_read_b32 v32, v30
s_waitcnt lgkmcnt(0)
v_readfirstlane_b32 s17, v32
s_barrier
L_dispatch:
s_cmp_gt_u32 s12, 7
s_nop 1
s_cbranch_scc1 L_odd
s_cmp_lt_u32 s12, 2
s_cbranch_scc1 L_chain
s_cmp_lt_u32 s12, 4
s_cbranch_scc1 L_e1
s_cmp_lt_u32 s12, 6
s_cbranch_scc1 L_vu
s_sub_u32 s40, s12, 6
s_lshl_b32 s29, s40, 5
s_add_u32 s29, s29, s17
s_and_b32 s29, s29, 63
s_cmp_lg_u32 s101, 0
s_cbranch_scc1 arr_1
s_cmp_lg_u32 s99, 0
s_cbranch_scc1 arr_1
s_waitcnt vmcnt(0)
s_barrier
s_cmp_lg_u32 s3, 0
s_cbranch_scc1 arr_1
v_mov_b32 v30, 64
v_mov_b32 v31, 1
s_mov_b64 exec, 1
global_atomic_add v30, v31, s[6:7]
s_mov_b64 exec, -1
arr_1:
v_mov_b32 v30, 64
sc_2:
global_load_dword v31, v30, s[6:7] sc1
s_waitcnt vmcnt(0)
v_readfirstlane_b32 s40, v31
s_cmp_ge_u32 s40, 256
s_nop 2
s_cbranch_scc1 scg_4
s_sleep 4
s_add_u32 s100, s100, 64
s_cmp_lt_u32 s100, 0x1000000
s_cbranch_scc1 sc_2
s_endpgm
scg_4:
s_cmp_lg_u32 s101, 0
s_cbranch_scc1 sco_3
v_and_b32 v30, 7, v1
v_lshlrev_b32 v30, 2, v30
global_load_dword v31, v30, s[6:7] sc1
s_waitcnt vmcnt(0)
v_cmp_ne_u32 vcc, 32, v31
s_nop 3
s_cbranch_vccz sco_3
s_mov_b32 s101, 1
s_lshr_b32 s12, s2, 5
s_and_b32 s17, s2, 31
s_barrier
s_branch L_dispatch
sco_3:
s_mov_b32 s23, s29
s_load_dwordx2 s[46:47], s[0:1], 8
s_load_dwordx2 s[48:49], s[0:1], 16
s_load_dwordx2 s[50:51], s[0:1], 24
s_load_dwordx2 s[52:53], s[0:1], 32
s_load_dwordx2 s[54:55], s[0:1], 40
s_load_dwordx2 s[56:57], s[0:1], 48
s_load_dwordx2 s[58:59], s[0:1], 56
s_load_dwordx2 s[60:61], s[0:1], 64
s_load_dwordx2 s[62:63], s[0:1], 0
s_load_dwordx2 s[64:65], s[0:1], 128
s_mul_i32 s26, s3, 40960
v_and_b32 v30, 15, v1
v_lshrrev_b32 v31, 4, v1
v_lshlrev_b32 v2, 4, v31
v_add_u32 v2, s26, v2
v_lshlrev_b32 v22, 2, v1
v_add_u32 v32, 120, v30
v_cmp_gt_u32 vcc, 8, v30
s_nop 1
v_cndmask_b32 v32, v32, v30, vcc
v_cvt_f32_u32 v4, v32
v_lshrrev_b32 v32, 2, v30
v_lshlrev_b32 v32, 7, v32
v_and_b32 v33, 3, v30
v_lshl_add_u32 v32, v33, 1, v32
v_add_u32 v32, 256, v32
v_bfe_u32 v33, v30, 1, 2
v_lshlrev_b32 v33, 7, v33
v_and_b32 v34, 1, v30
v_lshl_add_u32 v33, v34, 2, v33
v_add_u32 v33, 512, v33
v_cndmask_b32 v32, v33, v32, vcc
v_cvt_f32_u32 v6, v32
v_lshlrev_b32 v32, 7, v30
v_add_u32 v32, 1024, v32
v_cmp_gt_u32 vcc, 9, v30
s_nop 1
v_cndmask_b32 v32, 0, v32, vcc
v_cvt_f32_u32 v8, v32
v_mov_b32 v5, v4
v_mov_b32 v7, v6
v_mov_b32 v9, v8
v_lshlrev_b32 v32, 3, v30
v_cvt_f32_u32 v10, v32
v_mov_b32 v11, v10
v_mov_b32 v12, 0
v_and_b32 v32, 1, v31
v_cmp_eq_u32 vcc, 1, v32
v_mov_b32 v33, 0xbe800000
s_nop 0
v_cndmask_b32 v13, 0, v33, vcc
v_lshlrev_b32 v32, 7, v31
v_lshl_add_u32 v32, v30, 1, v32
v_add_u32 v32, s26, v32
v_add_u32 v14, 39424, v32
v_and_b32 v32, 7, v1
v_mul_u32_u24 v32, 4160, v32
v_bfe_u32 v33, v1, 3, 2
v_lshlrev_b32 v33, 4, v33
v_sub_u32 v32, v32, v33
v_lshrrev_b32 v33, 5, v1
v_lshl_add_u32 v32, v33, 4, v32
v_add_u32 v32, s26, v32
v_add_u32 v15, 48, v32
v_and_b32 v32, 31, v1
v_lshlrev_b32 v32, 6, v32
v_lshl_add_u32 v32, v33, 4, v32
v_add_u32 v32, s26, v32
v_add_u32 v16, 33344, v32
v_and_b32 v32, 31, v1
v_lshlrev_b32 v32, 6, v32
v_lshl_add_u32 v32, v33, 3, v32
v_add_u32 v32, s26, v32
v_add_u32 v18, 35328, v32
v_and_b32 v32, 31, v1
v_lshlrev_b32 v32, 8, v32
v_lshl_add_u32 v32, v33, 5, v32
s_lshl_b32 s40, s3, 1
v_add_u32 v19, s40, v32
v_lshlrev_b32 v32, 1, v0
v_add_u32 v17, 35328, v32
v_lshlrev_b32 v32, 6, v1
v_add_u32 v21, s26, v32
v_lshlrev_b32 v20, 5, v1
v_sub_u32 v20, 2048, v20
v_subrev_u32 v104, 0, v20
v_max_i32 v105, 0, v104
v_min_i32 v105, 2047, v105
v_cvt_f32_u32 v105, v105
v_cvt_pk_bf16_f32 v105, v105, v105
v_lshlrev_b32 v105, 16, v105
v_cvt_u32_f32 v105, v105
v_bfe_u32 v108, v105, 3, 4
v_and_b32 v107, 7, v105
v_add_u32 v106, 8, v107
v_cmp_le_u32 vcc, 128, v105
s_nop 1
v_cndmask_b32 v107, v107, v106, vcc
v_bfe_u32 v106, v105, 7, 1
v_lshlrev_b32 v106, 2, v106
v_bfe_u32 v109, v105, 1, 2
v_add3_u32 v106, v106, v109, 16
v_cmp_le_u32 vcc, 256, v105
s_nop 1
v_cndmask_b32 v107, v107, v106, vcc
v_bfe_u32 v106, v105, 7, 2
v_lshlrev_b32 v106, 1, v106
v_bfe_u32 v109, v105, 2, 1
v_add3_u32 v106, v106, v109, 24
v_cmp_le_u32 vcc, 512, v105
s_nop 1
v_cndmask_b32 v107, v107, v106, vcc
v_subrev_u32 v106, 1024, v105
v_lshrrev_b32 v106, 7, v106
v_add_u32 v106, 32, v106
v_cmp_le_u32 vcc, 1024, v105
s_nop 1
v_cndmask_b32 v107, v107, v106, vcc
v_lshlrev_b32 v107, 5, v107
v_lshl_add_u32 v107, v108, 1, v107
v_add_u32 v107, 39424, v107
v_mov_b32 v106, 4096
v_cmp_gt_i32 vcc, 0, v104
s_nop 1
v_cndmask_b32 v107, v107, v106, vcc
v_add_u32 v36, s26, v107
v_subrev_u32 v104, 1, v20
v_max_i32 v105, 0, v104
v_min_i32 v105, 2047, v105
v_cvt_f32_u32 v105, v105
v_cvt_pk_bf16_f32 v105, v105, v105
v_lshlrev_b32 v105, 16, v105
v_cvt_u32_f32 v105, v105
v_bfe_u32 v108, v105, 3, 4
v_and_b32 v107, 7, v105
v_add_u32 v106, 8, v107
v_cmp_le_u32 vcc, 128, v105
s_nop 1
v_cndmask_b32 v107, v107, v106, vcc
v_bfe_u32 v106, v105, 7, 1
v_lshlrev_b32 v106, 2, v106
v_bfe_u32 v109, v105, 1, 2
v_add3_u32 v106, v106, v109, 16
v_cmp_le_u32 vcc, 256, v105
s_nop 1
v_cndmask_b32 v107, v107, v106, vcc
v_bfe_u32 v106, v105, 7, 2
v_lshlrev_b32 v106, 1, v106
v_bfe_u32 v109, v105, 2, 1
v_add3_u32 v106, v106, v109, 24
v_cmp_le_u32 vcc, 512, v105
s_nop 1
v_cndmask_b32 v107, v107, v106, vcc
v_subrev_u32 v106, 1024, v105
v_lshrrev_b32 v106, 7, v106
v_add_u32 v106, 32, v106
v_cmp_le_u32 vcc, 1024, v105
s_nop 1
v_cndmask_b32 v107, v107, v106, vcc
v_lshlrev_b32 v107, 5, v107
v_lshl_add_u32 v107, v108, 1, v107
v_add_u32 v107, 39424, v107
v_mov_b32 v106, 4096
v_cmp_gt_i32 vcc, 0, v104
s_nop 1
v_cndmask_b32 v107, v107, v106, vcc
v_add_u32 v37, s26, v107
v_subrev_u32 v104, 2, v20
v_max_i32 v105, 0, v104
v_min_i32 v105, 2047, v105
v_cvt_f32_u32 v105, v105
v_cvt_pk_bf16_f32 v105, v105, v105
v_lshlrev_b32 v105, 16, v105
v_cvt_u32_f32 v105, v105
v_bfe_u32 v108, v105, 3, 4
v_and_b32 v107, 7, v105
v_add_u32 v106, 8, v107
v_cmp_le_u32 vcc, 128, v105
s_nop 1
v_cndmask_b32 v107, v107, v106, vcc
v_bfe_u32 v106, v105, 7, 1
v_lshlrev_b32 v106, 2, v106
v_bfe_u32 v109, v105, 1, 2
v_add3_u32 v106, v106, v109, 16
v_cmp_le_u32 vcc, 256, v105
s_nop 1
v_cndmask_b32 v107, v107, v106, vcc
v_bfe_u32 v106, v105, 7, 2
v_lshlrev_b32 v106, 1, v106
v_bfe_u32 v109, v105, 2, 1
v_add3_u32 v106, v106, v109, 24
v_cmp_le_u32 vcc, 512, v105
s_nop 1
v_cndmask_b32 v107, v107, v106, vcc
v_subrev_u32 v106, 1024, v105
v_lshrrev_b32 v106, 7, v106
v_add_u32 v106, 32, v106
v_cmp_le_u32 vcc, 1024, v105
s_nop 1
v_cndmask_b32 v107, v107, v106, vcc
v_lshlrev_b32 v107, 5, v107
v_lshl_add_u32 v107, v108, 1, v107
v_add_u32 v107, 39424, v107
v_mov_b32 v106, 4096
v_cmp_gt_i32 vcc, 0, v104
s_nop 1
v_cndmask_b32 v107, v107, v106, vcc
v_add_u32 v38, s26, v107
v_subrev_u32 v104, 3, v20
v_max_i32 v105, 0, v104
v_min_i32 v105, 2047, v105
v_cvt_f32_u32 v105, v105
v_cvt_pk_bf16_f32 v105, v105, v105
v_lshlrev_b32 v105, 16, v105
v_cvt_u32_f32 v105, v105
v_bfe_u32 v108, v105, 3, 4
v_and_b32 v107, 7, v105
v_add_u32 v106, 8, v107
v_cmp_le_u32 vcc, 128, v105
s_nop 1
v_cndmask_b32 v107, v107, v106, vcc
v_bfe_u32 v106, v105, 7, 1
v_lshlrev_b32 v106, 2, v106
v_bfe_u32 v109, v105, 1, 2
v_add3_u32 v106, v106, v109, 16
v_cmp_le_u32 vcc, 256, v105
s_nop 1
v_cndmask_b32 v107, v107, v106, vcc
v_bfe_u32 v106, v105, 7, 2
v_lshlrev_b32 v106, 1, v106
v_bfe_u32 v109, v105, 2, 1
v_add3_u32 v106, v106, v109, 24
v_cmp_le_u32 vcc, 512, v105
s_nop 1
v_cndmask_b32 v107, v107, v106, vcc
v_subrev_u32 v106, 1024, v105
v_lshrrev_b32 v106, 7, v106
v_add_u32 v106, 32, v106
v_cmp_le_u32 vcc, 1024, v105
s_nop 1
v_cndmask_b32 v107, v107, v106, vcc
v_lshlrev_b32 v107, 5, v107
v_lshl_add_u32 v107, v108, 1, v107
v_add_u32 v107, 39424, v107
v_mov_b32 v106, 4096
v_cmp_gt_i32 vcc, 0, v104
s_nop 1
v_cndmask_b32 v107, v107, v106, vcc
v_add_u32 v39, s26, v107
v_subrev_u32 v104, 4, v20
v_max_i32 v105, 0, v104
v_min_i32 v105, 2047, v105
v_cvt_f32_u32 v105, v105
v_cvt_pk_bf16_f32 v105, v105, v105
v_lshlrev_b32 v105, 16, v105
v_cvt_u32_f32 v105, v105
v_bfe_u32 v108, v105, 3, 4
v_and_b32 v107, 7, v105
v_add_u32 v106, 8, v107
v_cmp_le_u32 vcc, 128, v105
s_nop 1
v_cndmask_b32 v107, v107, v106, vcc
v_bfe_u32 v106, v105, 7, 1
v_lshlrev_b32 v106, 2, v106
v_bfe_u32 v109, v105, 1, 2
v_add3_u32 v106, v106, v109, 16
v_cmp_le_u32 vcc, 256, v105
s_nop 1
v_cndmask_b32 v107, v107, v106, vcc
v_bfe_u32 v106, v105, 7, 2
v_lshlrev_b32 v106, 1, v106
v_bfe_u32 v109, v105, 2, 1
v_add3_u32 v106, v106, v109, 24
v_cmp_le_u32 vcc, 512, v105
s_nop 1
v_cndmask_b32 v107, v107, v106, vcc
v_subrev_u32 v106, 1024, v105
v_lshrrev_b32 v106, 7, v106
v_add_u32 v106, 32, v106
v_cmp_le_u32 vcc, 1024, v105
s_nop 1
v_cndmask_b32 v107, v107, v106, vcc
v_lshlrev_b32 v107, 5, v107
v_lshl_add_u32 v107, v108, 1, v107
v_add_u32 v107, 39424, v107
v_mov_b32 v106, 4096
v_cmp_gt_i32 vcc, 0, v104
s_nop 1
v_cndmask_b32 v107, v107, v106, vcc
v_add_u32 v40, s26, v107
v_subrev_u32 v104, 5, v20
v_max_i32 v105, 0, v104
v_min_i32 v105, 2047, v105
v_cvt_f32_u32 v105, v105
v_cvt_pk_bf16_f32 v105, v105, v105
v_lshlrev_b32 v105, 16, v105
v_cvt_u32_f32 v105, v105
v_bfe_u32 v108, v105, 3, 4
v_and_b32 v107, 7, v105
v_add_u32 v106, 8, v107
v_cmp_le_u32 vcc, 128, v105
s_nop 1
v_cndmask_b32 v107, v107, v106, vcc
v_bfe_u32 v106, v105, 7, 1
v_lshlrev_b32 v106, 2, v106
v_bfe_u32 v109, v105, 1, 2
v_add3_u32 v106, v106, v109, 16
v_cmp_le_u32 vcc, 256, v105
s_nop 1
v_cndmask_b32 v107, v107, v106, vcc
v_bfe_u32 v106, v105, 7, 2
v_lshlrev_b32 v106, 1, v106
v_bfe_u32 v109, v105, 2, 1
v_add3_u32 v106, v106, v109, 24
v_cmp_le_u32 vcc, 512, v105
s_nop 1
v_cndmask_b32 v107, v107, v106, vcc
v_subrev_u32 v106, 1024, v105
v_lshrrev_b32 v106, 7, v106
v_add_u32 v106, 32, v106
v_cmp_le_u32 vcc, 1024, v105
s_nop 1
v_cndmask_b32 v107, v107, v106, vcc
v_lshlrev_b32 v107, 5, v107
v_lshl_add_u32 v107, v108, 1, v107
v_add_u32 v107, 39424, v107
v_mov_b32 v106, 4096
v_cmp_gt_i32 vcc, 0, v104
s_nop 1
v_cndmask_b32 v107, v107, v106, vcc
v_add_u32 v41, s26, v107
v_subrev_u32 v104, 6, v20
v_max_i32 v105, 0, v104
v_min_i32 v105, 2047, v105
v_cvt_f32_u32 v105, v105
v_cvt_pk_bf16_f32 v105, v105, v105
v_lshlrev_b32 v105, 16, v105
v_cvt_u32_f32 v105, v105
v_bfe_u32 v108, v105, 3, 4
v_and_b32 v107, 7, v105
v_add_u32 v106, 8, v107
v_cmp_le_u32 vcc, 128, v105
s_nop 1
v_cndmask_b32 v107, v107, v106, vcc
v_bfe_u32 v106, v105, 7, 1
v_lshlrev_b32 v106, 2, v106
v_bfe_u32 v109, v105, 1, 2
v_add3_u32 v106, v106, v109, 16
v_cmp_le_u32 vcc, 256, v105
s_nop 1
v_cndmask_b32 v107, v107, v106, vcc
v_bfe_u32 v106, v105, 7, 2
v_lshlrev_b32 v106, 1, v106
v_bfe_u32 v109, v105, 2, 1
v_add3_u32 v106, v106, v109, 24
v_cmp_le_u32 vcc, 512, v105
s_nop 1
v_cndmask_b32 v107, v107, v106, vcc
v_subrev_u32 v106, 1024, v105
v_lshrrev_b32 v106, 7, v106
v_add_u32 v106, 32, v106
v_cmp_le_u32 vcc, 1024, v105
s_nop 1
v_cndmask_b32 v107, v107, v106, vcc
v_lshlrev_b32 v107, 5, v107
v_lshl_add_u32 v107, v108, 1, v107
v_add_u32 v107, 39424, v107
v_mov_b32 v106, 4096
v_cmp_gt_i32 vcc, 0, v104
s_nop 1
v_cndmask_b32 v107, v107, v106, vcc
v_add_u32 v42, s26, v107
v_subrev_u32 v104, 7, v20
v_max_i32 v105, 0, v104
v_min_i32 v105, 2047, v105
v_cvt_f32_u32 v105, v105
v_cvt_pk_bf16_f32 v105, v105, v105
v_lshlrev_b32 v105, 16, v105
v_cvt_u32_f32 v105, v105
v_bfe_u32 v108, v105, 3, 4
v_and_b32 v107, 7, v105
v_add_u32 v106, 8, v107
v_cmp_le_u32 vcc, 128, v105
s_nop 1
v_cndmask_b32 v107, v107, v106, vcc
v_bfe_u32 v106, v105, 7, 1
v_lshlrev_b32 v106, 2, v106
v_bfe_u32 v109, v105, 1, 2
v_add3_u32 v106, v106, v109, 16
v_cmp_le_u32 vcc, 256, v105
s_nop 1
v_cndmask_b32 v107, v107, v106, vcc
v_bfe_u32 v106, v105, 7, 2
v_lshlrev_b32 v106, 1, v106
v_bfe_u32 v109, v105, 2, 1
v_add3_u32 v106, v106, v109, 24
v_cmp_le_u32 vcc, 512, v105
s_nop 1
v_cndmask_b32 v107, v107, v106, vcc
v_subrev_u32 v106, 1024, v105
v_lshrrev_b32 v106, 7, v106
v_add_u32 v106, 32, v106
v_cmp_le_u32 vcc, 1024, v105
s_nop 1
v_cndmask_b32 v107, v107, v106, vcc
v_lshlrev_b32 v107, 5, v107
v_lshl_add_u32 v107, v108, 1, v107
v_add_u32 v107, 39424, v107
v_mov_b32 v106, 4096
v_cmp_gt_i32 vcc, 0, v104
s_nop 1
v_cndmask_b32 v107, v107, v106, vcc
v_add_u32 v43, s26, v107
v_subrev_u32 v104, 8, v20
v_max_i32 v105, 0, v104
v_min_i32 v105, 2047, v105
v_cvt_f32_u32 v105, v105
v_cvt_pk_bf16_f32 v105, v105, v105
v_lshlrev_b32 v105, 16, v105
v_cvt_u32_f32 v105, v105
v_bfe_u32 v108, v105, 3, 4
v_and_b32 v107, 7, v105
v_add_u32 v106, 8, v107
v_cmp_le_u32 vcc, 128, v105
s_nop 1
v_cndmask_b32 v107, v107, v106, vcc
v_bfe_u32 v106, v105, 7, 1
v_lshlrev_b32 v106, 2, v106
v_bfe_u32 v109, v105, 1, 2
v_add3_u32 v106, v106, v109, 16
v_cmp_le_u32 vcc, 256, v105
s_nop 1
v_cndmask_b32 v107, v107, v106, vcc
v_bfe_u32 v106, v105, 7, 2
v_lshlrev_b32 v106, 1, v106
v_bfe_u32 v109, v105, 2, 1
v_add3_u32 v106, v106, v109, 24
v_cmp_le_u32 vcc, 512, v105
s_nop 1
v_cndmask_b32 v107, v107, v106, vcc
v_subrev_u32 v106, 1024, v105
v_lshrrev_b32 v106, 7, v106
v_add_u32 v106, 32, v106
v_cmp_le_u32 vcc, 1024, v105
s_nop 1
v_cndmask_b32 v107, v107, v106, vcc
v_lshlrev_b32 v107, 5, v107
v_lshl_add_u32 v107, v108, 1, v107
v_add_u32 v107, 39424, v107
v_mov_b32 v106, 4096
v_cmp_gt_i32 vcc, 0, v104
s_nop 1
v_cndmask_b32 v107, v107, v106, vcc
v_add_u32 v44, s26, v107
v_subrev_u32 v104, 9, v20
v_max_i32 v105, 0, v104
v_min_i32 v105, 2047, v105
v_cvt_f32_u32 v105, v105
v_cvt_pk_bf16_f32 v105, v105, v105
v_lshlrev_b32 v105, 16, v105
v_cvt_u32_f32 v105, v105
v_bfe_u32 v108, v105, 3, 4
v_and_b32 v107, 7, v105
v_add_u32 v106, 8, v107
v_cmp_le_u32 vcc, 128, v105
s_nop 1
v_cndmask_b32 v107, v107, v106, vcc
v_bfe_u32 v106, v105, 7, 1
v_lshlrev_b32 v106, 2, v106
v_bfe_u32 v109, v105, 1, 2
v_add3_u32 v106, v106, v109, 16
v_cmp_le_u32 vcc, 256, v105
s_nop 1
v_cndmask_b32 v107, v107, v106, vcc
v_bfe_u32 v106, v105, 7, 2
v_lshlrev_b32 v106, 1, v106
v_bfe_u32 v109, v105, 2, 1
v_add3_u32 v106, v106, v109, 24
v_cmp_le_u32 vcc, 512, v105
s_nop 1
v_cndmask_b32 v107, v107, v106, vcc
v_subrev_u32 v106, 1024, v105
v_lshrrev_b32 v106, 7, v106
v_add_u32 v106, 32, v106
v_cmp_le_u32 vcc, 1024, v105
s_nop 1
v_cndmask_b32 v107, v107, v106, vcc
v_lshlrev_b32 v107, 5, v107
v_lshl_add_u32 v107, v108, 1, v107
v_add_u32 v107, 39424, v107
v_mov_b32 v106, 4096
v_cmp_gt_i32 vcc, 0, v104
s_nop 1
v_cndmask_b32 v107, v107, v106, vcc
v_add_u32 v45, s26, v107
v_subrev_u32 v104, 10, v20
v_max_i32 v105, 0, v104
v_min_i32 v105, 2047, v105
v_cvt_f32_u32 v105, v105
v_cvt_pk_bf16_f32 v105, v105, v105
v_lshlrev_b32 v105, 16, v105
v_cvt_u32_f32 v105, v105
v_bfe_u32 v108, v105, 3, 4
v_and_b32 v107, 7, v105
v_add_u32 v106, 8, v107
v_cmp_le_u32 vcc, 128, v105
s_nop 1
v_cndmask_b32 v107, v107, v106, vcc
v_bfe_u32 v106, v105, 7, 1
v_lshlrev_b32 v106, 2, v106
v_bfe_u32 v109, v105, 1, 2
v_add3_u32 v106, v106, v109, 16
v_cmp_le_u32 vcc, 256, v105
s_nop 1
v_cndmask_b32 v107, v107, v106, vcc
v_bfe_u32 v106, v105, 7, 2
v_lshlrev_b32 v106, 1, v106
v_bfe_u32 v109, v105, 2, 1
v_add3_u32 v106, v106, v109, 24
v_cmp_le_u32 vcc, 512, v105
s_nop 1
v_cndmask_b32 v107, v107, v106, vcc
v_subrev_u32 v106, 1024, v105
v_lshrrev_b32 v106, 7, v106
v_add_u32 v106, 32, v106
v_cmp_le_u32 vcc, 1024, v105
s_nop 1
v_cndmask_b32 v107, v107, v106, vcc
v_lshlrev_b32 v107, 5, v107
v_lshl_add_u32 v107, v108, 1, v107
v_add_u32 v107, 39424, v107
v_mov_b32 v106, 4096
v_cmp_gt_i32 vcc, 0, v104
s_nop 1
v_cndmask_b32 v107, v107, v106, vcc
v_add_u32 v46, s26, v107
v_subrev_u32 v104, 11, v20
v_max_i32 v105, 0, v104
v_min_i32 v105, 2047, v105
v_cvt_f32_u32 v105, v105
v_cvt_pk_bf16_f32 v105, v105, v105
v_lshlrev_b32 v105, 16, v105
v_cvt_u32_f32 v105, v105
v_bfe_u32 v108, v105, 3, 4
v_and_b32 v107, 7, v105
v_add_u32 v106, 8, v107
v_cmp_le_u32 vcc, 128, v105
s_nop 1
v_cndmask_b32 v107, v107, v106, vcc
v_bfe_u32 v106, v105, 7, 1
v_lshlrev_b32 v106, 2, v106
v_bfe_u32 v109, v105, 1, 2
v_add3_u32 v106, v106, v109, 16
v_cmp_le_u32 vcc, 256, v105
s_nop 1
v_cndmask_b32 v107, v107, v106, vcc
v_bfe_u32 v106, v105, 7, 2
v_lshlrev_b32 v106, 1, v106
v_bfe_u32 v109, v105, 2, 1
v_add3_u32 v106, v106, v109, 24
v_cmp_le_u32 vcc, 512, v105
s_nop 1
v_cndmask_b32 v107, v107, v106, vcc
v_subrev_u32 v106, 1024, v105
v_lshrrev_b32 v106, 7, v106
v_add_u32 v106, 32, v106
v_cmp_le_u32 vcc, 1024, v105
s_nop 1
v_cndmask_b32 v107, v107, v106, vcc
v_lshlrev_b32 v107, 5, v107
v_lshl_add_u32 v107, v108, 1, v107
v_add_u32 v107, 39424, v107
v_mov_b32 v106, 4096
v_cmp_gt_i32 vcc, 0, v104
s_nop 1
v_cndmask_b32 v107, v107, v106, vcc
v_add_u32 v47, s26, v107
v_subrev_u32 v104, 12, v20
v_max_i32 v105, 0, v104
v_min_i32 v105, 2047, v105
v_cvt_f32_u32 v105, v105
v_cvt_pk_bf16_f32 v105, v105, v105
v_lshlrev_b32 v105, 16, v105
v_cvt_u32_f32 v105, v105
v_bfe_u32 v108, v105, 3, 4
v_and_b32 v107, 7, v105
v_add_u32 v106, 8, v107
v_cmp_le_u32 vcc, 128, v105
s_nop 1
v_cndmask_b32 v107, v107, v106, vcc
v_bfe_u32 v106, v105, 7, 1
v_lshlrev_b32 v106, 2, v106
v_bfe_u32 v109, v105, 1, 2
v_add3_u32 v106, v106, v109, 16
v_cmp_le_u32 vcc, 256, v105
s_nop 1
v_cndmask_b32 v107, v107, v106, vcc
v_bfe_u32 v106, v105, 7, 2
v_lshlrev_b32 v106, 1, v106
v_bfe_u32 v109, v105, 2, 1
v_add3_u32 v106, v106, v109, 24
v_cmp_le_u32 vcc, 512, v105
s_nop 1
v_cndmask_b32 v107, v107, v106, vcc
v_subrev_u32 v106, 1024, v105
v_lshrrev_b32 v106, 7, v106
v_add_u32 v106, 32, v106
v_cmp_le_u32 vcc, 1024, v105
s_nop 1
v_cndmask_b32 v107, v107, v106, vcc
v_lshlrev_b32 v107, 5, v107
v_lshl_add_u32 v107, v108, 1, v107
v_add_u32 v107, 39424, v107
v_mov_b32 v106, 4096
v_cmp_gt_i32 vcc, 0, v104
s_nop 1
v_cndmask_b32 v107, v107, v106, vcc
v_add_u32 v48, s26, v107
v_subrev_u32 v104, 13, v20
v_max_i32 v105, 0, v104
v_min_i32 v105, 2047, v105
v_cvt_f32_u32 v105, v105
v_cvt_pk_bf16_f32 v105, v105, v105
v_lshlrev_b32 v105, 16, v105
v_cvt_u32_f32 v105, v105
v_bfe_u32 v108, v105, 3, 4
v_and_b32 v107, 7, v105
v_add_u32 v106, 8, v107
v_cmp_le_u32 vcc, 128, v105
s_nop 1
v_cndmask_b32 v107, v107, v106, vcc
v_bfe_u32 v106, v105, 7, 1
v_lshlrev_b32 v106, 2, v106
v_bfe_u32 v109, v105, 1, 2
v_add3_u32 v106, v106, v109, 16
v_cmp_le_u32 vcc, 256, v105
s_nop 1
v_cndmask_b32 v107, v107, v106, vcc
v_bfe_u32 v106, v105, 7, 2
v_lshlrev_b32 v106, 1, v106
v_bfe_u32 v109, v105, 2, 1
v_add3_u32 v106, v106, v109, 24
v_cmp_le_u32 vcc, 512, v105
s_nop 1
v_cndmask_b32 v107, v107, v106, vcc
v_subrev_u32 v106, 1024, v105
v_lshrrev_b32 v106, 7, v106
v_add_u32 v106, 32, v106
v_cmp_le_u32 vcc, 1024, v105
s_nop 1
v_cndmask_b32 v107, v107, v106, vcc
v_lshlrev_b32 v107, 5, v107
v_lshl_add_u32 v107, v108, 1, v107
v_add_u32 v107, 39424, v107
v_mov_b32 v106, 4096
v_cmp_gt_i32 vcc, 0, v104
s_nop 1
v_cndmask_b32 v107, v107, v106, vcc
v_add_u32 v49, s26, v107
v_subrev_u32 v104, 14, v20
v_max_i32 v105, 0, v104
v_min_i32 v105, 2047, v105
v_cvt_f32_u32 v105, v105
v_cvt_pk_bf16_f32 v105, v105, v105
v_lshlrev_b32 v105, 16, v105
v_cvt_u32_f32 v105, v105
v_bfe_u32 v108, v105, 3, 4
v_and_b32 v107, 7, v105
v_add_u32 v106, 8, v107
v_cmp_le_u32 vcc, 128, v105
s_nop 1
v_cndmask_b32 v107, v107, v106, vcc
v_bfe_u32 v106, v105, 7, 1
v_lshlrev_b32 v106, 2, v106
v_bfe_u32 v109, v105, 1, 2
v_add3_u32 v106, v106, v109, 16
v_cmp_le_u32 vcc, 256, v105
s_nop 1
v_cndmask_b32 v107, v107, v106, vcc
v_bfe_u32 v106, v105, 7, 2
v_lshlrev_b32 v106, 1, v106
v_bfe_u32 v109, v105, 2, 1
v_add3_u32 v106, v106, v109, 24
v_cmp_le_u32 vcc, 512, v105
s_nop 1
v_cndmask_b32 v107, v107, v106, vcc
v_subrev_u32 v106, 1024, v105
v_lshrrev_b32 v106, 7, v106
v_add_u32 v106, 32, v106
v_cmp_le_u32 vcc, 1024, v105
s_nop 1
v_cndmask_b32 v107, v107, v106, vcc
v_lshlrev_b32 v107, 5, v107
v_lshl_add_u32 v107, v108, 1, v107
v_add_u32 v107, 39424, v107
v_mov_b32 v106, 4096
v_cmp_gt_i32 vcc, 0, v104
s_nop 1
v_cndmask_b32 v107, v107, v106, vcc
v_add_u32 v50, s26, v107
v_subrev_u32 v104, 15, v20
v_max_i32 v105, 0, v104
v_min_i32 v105, 2047, v105
v_cvt_f32_u32 v105, v105
v_cvt_pk_bf16_f32 v105, v105, v105
v_lshlrev_b32 v105, 16, v105
v_cvt_u32_f32 v105, v105
v_bfe_u32 v108, v105, 3, 4
v_and_b32 v107, 7, v105
v_add_u32 v106, 8, v107
v_cmp_le_u32 vcc, 128, v105
s_nop 1
v_cndmask_b32 v107, v107, v106, vcc
v_bfe_u32 v106, v105, 7, 1
v_lshlrev_b32 v106, 2, v106
v_bfe_u32 v109, v105, 1, 2
v_add3_u32 v106, v106, v109, 16
v_cmp_le_u32 vcc, 256, v105
s_nop 1
v_cndmask_b32 v107, v107, v106, vcc
v_bfe_u32 v106, v105, 7, 2
v_lshlrev_b32 v106, 1, v106
v_bfe_u32 v109, v105, 2, 1
v_add3_u32 v106, v106, v109, 24
v_cmp_le_u32 vcc, 512, v105
s_nop 1
v_cndmask_b32 v107, v107, v106, vcc
v_subrev_u32 v106, 1024, v105
v_lshrrev_b32 v106, 7, v106
v_add_u32 v106, 32, v106
v_cmp_le_u32 vcc, 1024, v105
s_nop 1
v_cndmask_b32 v107, v107, v106, vcc
v_lshlrev_b32 v107, 5, v107
v_lshl_add_u32 v107, v108, 1, v107
v_add_u32 v107, 39424, v107
v_mov_b32 v106, 4096
v_cmp_gt_i32 vcc, 0, v104
s_nop 1
v_cndmask_b32 v107, v107, v106, vcc
v_add_u32 v51, s26, v107
v_subrev_u32 v104, 16, v20
v_max_i32 v105, 0, v104
v_min_i32 v105, 2047, v105
v_cvt_f32_u32 v105, v105
v_cvt_pk_bf16_f32 v105, v105, v105
v_lshlrev_b32 v105, 16, v105
v_cvt_u32_f32 v105, v105
v_bfe_u32 v108, v105, 3, 4
v_and_b32 v107, 7, v105
v_add_u32 v106, 8, v107
v_cmp_le_u32 vcc, 128, v105
s_nop 1
v_cndmask_b32 v107, v107, v106, vcc
v_bfe_u32 v106, v105, 7, 1
v_lshlrev_b32 v106, 2, v106
v_bfe_u32 v109, v105, 1, 2
v_add3_u32 v106, v106, v109, 16
v_cmp_le_u32 vcc, 256, v105
s_nop 1
v_cndmask_b32 v107, v107, v106, vcc
v_bfe_u32 v106, v105, 7, 2
v_lshlrev_b32 v106, 1, v106
v_bfe_u32 v109, v105, 2, 1
v_add3_u32 v106, v106, v109, 24
v_cmp_le_u32 vcc, 512, v105
s_nop 1
v_cndmask_b32 v107, v107, v106, vcc
v_subrev_u32 v106, 1024, v105
v_lshrrev_b32 v106, 7, v106
v_add_u32 v106, 32, v106
v_cmp_le_u32 vcc, 1024, v105
s_nop 1
v_cndmask_b32 v107, v107, v106, vcc
v_lshlrev_b32 v107, 5, v107
v_lshl_add_u32 v107, v108, 1, v107
v_add_u32 v107, 39424, v107
v_mov_b32 v106, 4096
v_cmp_gt_i32 vcc, 0, v104
s_nop 1
v_cndmask_b32 v107, v107, v106, vcc
v_add_u32 v52, s26, v107
v_subrev_u32 v104, 17, v20
v_max_i32 v105, 0, v104
v_min_i32 v105, 2047, v105
v_cvt_f32_u32 v105, v105
v_cvt_pk_bf16_f32 v105, v105, v105
v_lshlrev_b32 v105, 16, v105
v_cvt_u32_f32 v105, v105
v_bfe_u32 v108, v105, 3, 4
v_and_b32 v107, 7, v105
v_add_u32 v106, 8, v107
v_cmp_le_u32 vcc, 128, v105
s_nop 1
v_cndmask_b32 v107, v107, v106, vcc
v_bfe_u32 v106, v105, 7, 1
v_lshlrev_b32 v106, 2, v106
v_bfe_u32 v109, v105, 1, 2
v_add3_u32 v106, v106, v109, 16
v_cmp_le_u32 vcc, 256, v105
s_nop 1
v_cndmask_b32 v107, v107, v106, vcc
v_bfe_u32 v106, v105, 7, 2
v_lshlrev_b32 v106, 1, v106
v_bfe_u32 v109, v105, 2, 1
v_add3_u32 v106, v106, v109, 24
v_cmp_le_u32 vcc, 512, v105
s_nop 1
v_cndmask_b32 v107, v107, v106, vcc
v_subrev_u32 v106, 1024, v105
v_lshrrev_b32 v106, 7, v106
v_add_u32 v106, 32, v106
v_cmp_le_u32 vcc, 1024, v105
s_nop 1
v_cndmask_b32 v107, v107, v106, vcc
v_lshlrev_b32 v107, 5, v107
v_lshl_add_u32 v107, v108, 1, v107
v_add_u32 v107, 39424, v107
v_mov_b32 v106, 4096
v_cmp_gt_i32 vcc, 0, v104
s_nop 1
v_cndmask_b32 v107, v107, v106, vcc
v_add_u32 v53, s26, v107
v_subrev_u32 v104, 18, v20
v_max_i32 v105, 0, v104
v_min_i32 v105, 2047, v105
v_cvt_f32_u32 v105, v105
v_cvt_pk_bf16_f32 v105, v105, v105
v_lshlrev_b32 v105, 16, v105
v_cvt_u32_f32 v105, v105
v_bfe_u32 v108, v105, 3, 4
v_and_b32 v107, 7, v105
v_add_u32 v106, 8, v107
v_cmp_le_u32 vcc, 128, v105
s_nop 1
v_cndmask_b32 v107, v107, v106, vcc
v_bfe_u32 v106, v105, 7, 1
v_lshlrev_b32 v106, 2, v106
v_bfe_u32 v109, v105, 1, 2
v_add3_u32 v106, v106, v109, 16
v_cmp_le_u32 vcc, 256, v105
s_nop 1
v_cndmask_b32 v107, v107, v106, vcc
v_bfe_u32 v106, v105, 7, 2
v_lshlrev_b32 v106, 1, v106
v_bfe_u32 v109, v105, 2, 1
v_add3_u32 v106, v106, v109, 24
v_cmp_le_u32 vcc, 512, v105
s_nop 1
v_cndmask_b32 v107, v107, v106, vcc
v_subrev_u32 v106, 1024, v105
v_lshrrev_b32 v106, 7, v106
v_add_u32 v106, 32, v106
v_cmp_le_u32 vcc, 1024, v105
s_nop 1
v_cndmask_b32 v107, v107, v106, vcc
v_lshlrev_b32 v107, 5, v107
v_lshl_add_u32 v107, v108, 1, v107
v_add_u32 v107, 39424, v107
v_mov_b32 v106, 4096
v_cmp_gt_i32 vcc, 0, v104
s_nop 1
v_cndmask_b32 v107, v107, v106, vcc
v_add_u32 v54, s26, v107
v_subrev_u32 v104, 19, v20
v_max_i32 v105, 0, v104
v_min_i32 v105, 2047, v105
v_cvt_f32_u32 v105, v105
v_cvt_pk_bf16_f32 v105, v105, v105
v_lshlrev_b32 v105, 16, v105
v_cvt_u32_f32 v105, v105
v_bfe_u32 v108, v105, 3, 4
v_and_b32 v107, 7, v105
v_add_u32 v106, 8, v107
v_cmp_le_u32 vcc, 128, v105
s_nop 1
v_cndmask_b32 v107, v107, v106, vcc
v_bfe_u32 v106, v105, 7, 1
v_lshlrev_b32 v106, 2, v106
v_bfe_u32 v109, v105, 1, 2
v_add3_u32 v106, v106, v109, 16
v_cmp_le_u32 vcc, 256, v105
s_nop 1
v_cndmask_b32 v107, v107, v106, vcc
v_bfe_u32 v106, v105, 7, 2
v_lshlrev_b32 v106, 1, v106
v_bfe_u32 v109, v105, 2, 1
v_add3_u32 v106, v106, v109, 24
v_cmp_le_u32 vcc, 512, v105
s_nop 1
v_cndmask_b32 v107, v107, v106, vcc
v_subrev_u32 v106, 1024, v105
v_lshrrev_b32 v106, 7, v106
v_add_u32 v106, 32, v106
v_cmp_le_u32 vcc, 1024, v105
s_nop 1
v_cndmask_b32 v107, v107, v106, vcc
v_lshlrev_b32 v107, 5, v107
v_lshl_add_u32 v107, v108, 1, v107
v_add_u32 v107, 39424, v107
v_mov_b32 v106, 4096
v_cmp_gt_i32 vcc, 0, v104
s_nop 1
v_cndmask_b32 v107, v107, v106, vcc
v_add_u32 v55, s26, v107
v_subrev_u32 v104, 20, v20
v_max_i32 v105, 0, v104
v_min_i32 v105, 2047, v105
v_cvt_f32_u32 v105, v105
v_cvt_pk_bf16_f32 v105, v105, v105
v_lshlrev_b32 v105, 16, v105
v_cvt_u32_f32 v105, v105
v_bfe_u32 v108, v105, 3, 4
v_and_b32 v107, 7, v105
v_add_u32 v106, 8, v107
v_cmp_le_u32 vcc, 128, v105
s_nop 1
v_cndmask_b32 v107, v107, v106, vcc
v_bfe_u32 v106, v105, 7, 1
v_lshlrev_b32 v106, 2, v106
v_bfe_u32 v109, v105, 1, 2
v_add3_u32 v106, v106, v109, 16
v_cmp_le_u32 vcc, 256, v105
s_nop 1
v_cndmask_b32 v107, v107, v106, vcc
v_bfe_u32 v106, v105, 7, 2
v_lshlrev_b32 v106, 1, v106
v_bfe_u32 v109, v105, 2, 1
v_add3_u32 v106, v106, v109, 24
v_cmp_le_u32 vcc, 512, v105
s_nop 1
v_cndmask_b32 v107, v107, v106, vcc
v_subrev_u32 v106, 1024, v105
v_lshrrev_b32 v106, 7, v106
v_add_u32 v106, 32, v106
v_cmp_le_u32 vcc, 1024, v105
s_nop 1
v_cndmask_b32 v107, v107, v106, vcc
v_lshlrev_b32 v107, 5, v107
v_lshl_add_u32 v107, v108, 1, v107
v_add_u32 v107, 39424, v107
v_mov_b32 v106, 4096
v_cmp_gt_i32 vcc, 0, v104
s_nop 1
v_cndmask_b32 v107, v107, v106, vcc
v_add_u32 v56, s26, v107
v_subrev_u32 v104, 21, v20
v_max_i32 v105, 0, v104
v_min_i32 v105, 2047, v105
v_cvt_f32_u32 v105, v105
v_cvt_pk_bf16_f32 v105, v105, v105
v_lshlrev_b32 v105, 16, v105
v_cvt_u32_f32 v105, v105
v_bfe_u32 v108, v105, 3, 4
v_and_b32 v107, 7, v105
v_add_u32 v106, 8, v107
v_cmp_le_u32 vcc, 128, v105
s_nop 1
v_cndmask_b32 v107, v107, v106, vcc
v_bfe_u32 v106, v105, 7, 1
v_lshlrev_b32 v106, 2, v106
v_bfe_u32 v109, v105, 1, 2
v_add3_u32 v106, v106, v109, 16
v_cmp_le_u32 vcc, 256, v105
s_nop 1
v_cndmask_b32 v107, v107, v106, vcc
v_bfe_u32 v106, v105, 7, 2
v_lshlrev_b32 v106, 1, v106
v_bfe_u32 v109, v105, 2, 1
v_add3_u32 v106, v106, v109, 24
v_cmp_le_u32 vcc, 512, v105
s_nop 1
v_cndmask_b32 v107, v107, v106, vcc
v_subrev_u32 v106, 1024, v105
v_lshrrev_b32 v106, 7, v106
v_add_u32 v106, 32, v106
v_cmp_le_u32 vcc, 1024, v105
s_nop 1
v_cndmask_b32 v107, v107, v106, vcc
v_lshlrev_b32 v107, 5, v107
v_lshl_add_u32 v107, v108, 1, v107
v_add_u32 v107, 39424, v107
v_mov_b32 v106, 4096
v_cmp_gt_i32 vcc, 0, v104
s_nop 1
v_cndmask_b32 v107, v107, v106, vcc
v_add_u32 v57, s26, v107
v_subrev_u32 v104, 22, v20
v_max_i32 v105, 0, v104
v_min_i32 v105, 2047, v105
v_cvt_f32_u32 v105, v105
v_cvt_pk_bf16_f32 v105, v105, v105
v_lshlrev_b32 v105, 16, v105
v_cvt_u32_f32 v105, v105
v_bfe_u32 v108, v105, 3, 4
v_and_b32 v107, 7, v105
v_add_u32 v106, 8, v107
v_cmp_le_u32 vcc, 128, v105
s_nop 1
v_cndmask_b32 v107, v107, v106, vcc
v_bfe_u32 v106, v105, 7, 1
v_lshlrev_b32 v106, 2, v106
v_bfe_u32 v109, v105, 1, 2
v_add3_u32 v106, v106, v109, 16
v_cmp_le_u32 vcc, 256, v105
s_nop 1
v_cndmask_b32 v107, v107, v106, vcc
v_bfe_u32 v106, v105, 7, 2
v_lshlrev_b32 v106, 1, v106
v_bfe_u32 v109, v105, 2, 1
v_add3_u32 v106, v106, v109, 24
v_cmp_le_u32 vcc, 512, v105
s_nop 1
v_cndmask_b32 v107, v107, v106, vcc
v_subrev_u32 v106, 1024, v105
v_lshrrev_b32 v106, 7, v106
v_add_u32 v106, 32, v106
v_cmp_le_u32 vcc, 1024, v105
s_nop 1
v_cndmask_b32 v107, v107, v106, vcc
v_lshlrev_b32 v107, 5, v107
v_lshl_add_u32 v107, v108, 1, v107
v_add_u32 v107, 39424, v107
v_mov_b32 v106, 4096
v_cmp_gt_i32 vcc, 0, v104
s_nop 1
v_cndmask_b32 v107, v107, v106, vcc
v_add_u32 v58, s26, v107
v_subrev_u32 v104, 23, v20
v_max_i32 v105, 0, v104
v_min_i32 v105, 2047, v105
v_cvt_f32_u32 v105, v105
v_cvt_pk_bf16_f32 v105, v105, v105
v_lshlrev_b32 v105, 16, v105
v_cvt_u32_f32 v105, v105
v_bfe_u32 v108, v105, 3, 4
v_and_b32 v107, 7, v105
v_add_u32 v106, 8, v107
v_cmp_le_u32 vcc, 128, v105
s_nop 1
v_cndmask_b32 v107, v107, v106, vcc
v_bfe_u32 v106, v105, 7, 1
v_lshlrev_b32 v106, 2, v106
v_bfe_u32 v109, v105, 1, 2
v_add3_u32 v106, v106, v109, 16
v_cmp_le_u32 vcc, 256, v105
s_nop 1
v_cndmask_b32 v107, v107, v106, vcc
v_bfe_u32 v106, v105, 7, 2
v_lshlrev_b32 v106, 1, v106
v_bfe_u32 v109, v105, 2, 1
v_add3_u32 v106, v106, v109, 24
v_cmp_le_u32 vcc, 512, v105
s_nop 1
v_cndmask_b32 v107, v107, v106, vcc
v_subrev_u32 v106, 1024, v105
v_lshrrev_b32 v106, 7, v106
v_add_u32 v106, 32, v106
v_cmp_le_u32 vcc, 1024, v105
s_nop 1
v_cndmask_b32 v107, v107, v106, vcc
v_lshlrev_b32 v107, 5, v107
v_lshl_add_u32 v107, v108, 1, v107
v_add_u32 v107, 39424, v107
v_mov_b32 v106, 4096
v_cmp_gt_i32 vcc, 0, v104
s_nop 1
v_cndmask_b32 v107, v107, v106, vcc
v_add_u32 v59, s26, v107
v_subrev_u32 v104, 24, v20
v_max_i32 v105, 0, v104
v_min_i32 v105, 2047, v105
v_cvt_f32_u32 v105, v105
v_cvt_pk_bf16_f32 v105, v105, v105
v_lshlrev_b32 v105, 16, v105
v_cvt_u32_f32 v105, v105
v_bfe_u32 v108, v105, 3, 4
v_and_b32 v107, 7, v105
v_add_u32 v106, 8, v107
v_cmp_le_u32 vcc, 128, v105
s_nop 1
v_cndmask_b32 v107, v107, v106, vcc
v_bfe_u32 v106, v105, 7, 1
v_lshlrev_b32 v106, 2, v106
v_bfe_u32 v109, v105, 1, 2
v_add3_u32 v106, v106, v109, 16
v_cmp_le_u32 vcc, 256, v105
s_nop 1
v_cndmask_b32 v107, v107, v106, vcc
v_bfe_u32 v106, v105, 7, 2
v_lshlrev_b32 v106, 1, v106
v_bfe_u32 v109, v105, 2, 1
v_add3_u32 v106, v106, v109, 24
v_cmp_le_u32 vcc, 512, v105
s_nop 1
v_cndmask_b32 v107, v107, v106, vcc
v_subrev_u32 v106, 1024, v105
v_lshrrev_b32 v106, 7, v106
v_add_u32 v106, 32, v106
v_cmp_le_u32 vcc, 1024, v105
s_nop 1
v_cndmask_b32 v107, v107, v106, vcc
v_lshlrev_b32 v107, 5, v107
v_lshl_add_u32 v107, v108, 1, v107
v_add_u32 v107, 39424, v107
v_mov_b32 v106, 4096
v_cmp_gt_i32 vcc, 0, v104
s_nop 1
v_cndmask_b32 v107, v107, v106, vcc
v_add_u32 v60, s26, v107
v_subrev_u32 v104, 25, v20
v_max_i32 v105, 0, v104
v_min_i32 v105, 2047, v105
v_cvt_f32_u32 v105, v105
v_cvt_pk_bf16_f32 v105, v105, v105
v_lshlrev_b32 v105, 16, v105
v_cvt_u32_f32 v105, v105
v_bfe_u32 v108, v105, 3, 4
v_and_b32 v107, 7, v105
v_add_u32 v106, 8, v107
v_cmp_le_u32 vcc, 128, v105
s_nop 1
v_cndmask_b32 v107, v107, v106, vcc
v_bfe_u32 v106, v105, 7, 1
v_lshlrev_b32 v106, 2, v106
v_bfe_u32 v109, v105, 1, 2
v_add3_u32 v106, v106, v109, 16
v_cmp_le_u32 vcc, 256, v105
s_nop 1
v_cndmask_b32 v107, v107, v106, vcc
v_bfe_u32 v106, v105, 7, 2
v_lshlrev_b32 v106, 1, v106
v_bfe_u32 v109, v105, 2, 1
v_add3_u32 v106, v106, v109, 24
v_cmp_le_u32 vcc, 512, v105
s_nop 1
v_cndmask_b32 v107, v107, v106, vcc
v_subrev_u32 v106, 1024, v105
v_lshrrev_b32 v106, 7, v106
v_add_u32 v106, 32, v106
v_cmp_le_u32 vcc, 1024, v105
s_nop 1
v_cndmask_b32 v107, v107, v106, vcc
v_lshlrev_b32 v107, 5, v107
v_lshl_add_u32 v107, v108, 1, v107
v_add_u32 v107, 39424, v107
v_mov_b32 v106, 4096
v_cmp_gt_i32 vcc, 0, v104
s_nop 1
v_cndmask_b32 v107, v107, v106, vcc
v_add_u32 v61, s26, v107
v_subrev_u32 v104, 26, v20
v_max_i32 v105, 0, v104
v_min_i32 v105, 2047, v105
v_cvt_f32_u32 v105, v105
v_cvt_pk_bf16_f32 v105, v105, v105
v_lshlrev_b32 v105, 16, v105
v_cvt_u32_f32 v105, v105
v_bfe_u32 v108, v105, 3, 4
v_and_b32 v107, 7, v105
v_add_u32 v106, 8, v107
v_cmp_le_u32 vcc, 128, v105
s_nop 1
v_cndmask_b32 v107, v107, v106, vcc
v_bfe_u32 v106, v105, 7, 1
v_lshlrev_b32 v106, 2, v106
v_bfe_u32 v109, v105, 1, 2
v_add3_u32 v106, v106, v109, 16
v_cmp_le_u32 vcc, 256, v105
s_nop 1
v_cndmask_b32 v107, v107, v106, vcc
v_bfe_u32 v106, v105, 7, 2
v_lshlrev_b32 v106, 1, v106
v_bfe_u32 v109, v105, 2, 1
v_add3_u32 v106, v106, v109, 24
v_cmp_le_u32 vcc, 512, v105
s_nop 1
v_cndmask_b32 v107, v107, v106, vcc
v_subrev_u32 v106, 1024, v105
v_lshrrev_b32 v106, 7, v106
v_add_u32 v106, 32, v106
v_cmp_le_u32 vcc, 1024, v105
s_nop 1
v_cndmask_b32 v107, v107, v106, vcc
v_lshlrev_b32 v107, 5, v107
v_lshl_add_u32 v107, v108, 1, v107
v_add_u32 v107, 39424, v107
v_mov_b32 v106, 4096
v_cmp_gt_i32 vcc, 0, v104
s_nop 1
v_cndmask_b32 v107, v107, v106, vcc
v_add_u32 v62, s26, v107
v_subrev_u32 v104, 27, v20
v_max_i32 v105, 0, v104
v_min_i32 v105, 2047, v105
v_cvt_f32_u32 v105, v105
v_cvt_pk_bf16_f32 v105, v105, v105
v_lshlrev_b32 v105, 16, v105
v_cvt_u32_f32 v105, v105
v_bfe_u32 v108, v105, 3, 4
v_and_b32 v107, 7, v105
v_add_u32 v106, 8, v107
v_cmp_le_u32 vcc, 128, v105
s_nop 1
v_cndmask_b32 v107, v107, v106, vcc
v_bfe_u32 v106, v105, 7, 1
v_lshlrev_b32 v106, 2, v106
v_bfe_u32 v109, v105, 1, 2
v_add3_u32 v106, v106, v109, 16
v_cmp_le_u32 vcc, 256, v105
s_nop 1
v_cndmask_b32 v107, v107, v106, vcc
v_bfe_u32 v106, v105, 7, 2
v_lshlrev_b32 v106, 1, v106
v_bfe_u32 v109, v105, 2, 1
v_add3_u32 v106, v106, v109, 24
v_cmp_le_u32 vcc, 512, v105
s_nop 1
v_cndmask_b32 v107, v107, v106, vcc
v_subrev_u32 v106, 1024, v105
v_lshrrev_b32 v106, 7, v106
v_add_u32 v106, 32, v106
v_cmp_le_u32 vcc, 1024, v105
s_nop 1
v_cndmask_b32 v107, v107, v106, vcc
v_lshlrev_b32 v107, 5, v107
v_lshl_add_u32 v107, v108, 1, v107
v_add_u32 v107, 39424, v107
v_mov_b32 v106, 4096
v_cmp_gt_i32 vcc, 0, v104
s_nop 1
v_cndmask_b32 v107, v107, v106, vcc
v_add_u32 v63, s26, v107
v_subrev_u32 v104, 28, v20
v_max_i32 v105, 0, v104
v_min_i32 v105, 2047, v105
v_cvt_f32_u32 v105, v105
v_cvt_pk_bf16_f32 v105, v105, v105
v_lshlrev_b32 v105, 16, v105
v_cvt_u32_f32 v105, v105
v_bfe_u32 v108, v105, 3, 4
v_and_b32 v107, 7, v105
v_add_u32 v106, 8, v107
v_cmp_le_u32 vcc, 128, v105
s_nop 1
v_cndmask_b32 v107, v107, v106, vcc
v_bfe_u32 v106, v105, 7, 1
v_lshlrev_b32 v106, 2, v106
v_bfe_u32 v109, v105, 1, 2
v_add3_u32 v106, v106, v109, 16
v_cmp_le_u32 vcc, 256, v105
s_nop 1
v_cndmask_b32 v107, v107, v106, vcc
v_bfe_u32 v106, v105, 7, 2
v_lshlrev_b32 v106, 1, v106
v_bfe_u32 v109, v105, 2, 1
v_add3_u32 v106, v106, v109, 24
v_cmp_le_u32 vcc, 512, v105
s_nop 1
v_cndmask_b32 v107, v107, v106, vcc
v_subrev_u32 v106, 1024, v105
v_lshrrev_b32 v106, 7, v106
v_add_u32 v106, 32, v106
v_cmp_le_u32 vcc, 1024, v105
s_nop 1
v_cndmask_b32 v107, v107, v106, vcc
v_lshlrev_b32 v107, 5, v107
v_lshl_add_u32 v107, v108, 1, v107
v_add_u32 v107, 39424, v107
v_mov_b32 v106, 4096
v_cmp_gt_i32 vcc, 0, v104
s_nop 1
v_cndmask_b32 v107, v107, v106, vcc
v_add_u32 v64, s26, v107
v_subrev_u32 v104, 29, v20
v_max_i32 v105, 0, v104
v_min_i32 v105, 2047, v105
v_cvt_f32_u32 v105, v105
v_cvt_pk_bf16_f32 v105, v105, v105
v_lshlrev_b32 v105, 16, v105
v_cvt_u32_f32 v105, v105
v_bfe_u32 v108, v105, 3, 4
v_and_b32 v107, 7, v105
v_add_u32 v106, 8, v107
v_cmp_le_u32 vcc, 128, v105
s_nop 1
v_cndmask_b32 v107, v107, v106, vcc
v_bfe_u32 v106, v105, 7, 1
v_lshlrev_b32 v106, 2, v106
v_bfe_u32 v109, v105, 1, 2
v_add3_u32 v106, v106, v109, 16
v_cmp_le_u32 vcc, 256, v105
s_nop 1
v_cndmask_b32 v107, v107, v106, vcc
v_bfe_u32 v106, v105, 7, 2
v_lshlrev_b32 v106, 1, v106
v_bfe_u32 v109, v105, 2, 1
v_add3_u32 v106, v106, v109, 24
v_cmp_le_u32 vcc, 512, v105
s_nop 1
v_cndmask_b32 v107, v107, v106, vcc
v_subrev_u32 v106, 1024, v105
v_lshrrev_b32 v106, 7, v106
v_add_u32 v106, 32, v106
v_cmp_le_u32 vcc, 1024, v105
s_nop 1
v_cndmask_b32 v107, v107, v106, vcc
v_lshlrev_b32 v107, 5, v107
v_lshl_add_u32 v107, v108, 1, v107
v_add_u32 v107, 39424, v107
v_mov_b32 v106, 4096
v_cmp_gt_i32 vcc, 0, v104
s_nop 1
v_cndmask_b32 v107, v107, v106, vcc
v_add_u32 v65, s26, v107
v_subrev_u32 v104, 30, v20
v_max_i32 v105, 0, v104
v_min_i32 v105, 2047, v105
v_cvt_f32_u32 v105, v105
v_cvt_pk_bf16_f32 v105, v105, v105
v_lshlrev_b32 v105, 16, v105
v_cvt_u32_f32 v105, v105
v_bfe_u32 v108, v105, 3, 4
v_and_b32 v107, 7, v105
v_add_u32 v106, 8, v107
v_cmp_le_u32 vcc, 128, v105
s_nop 1
v_cndmask_b32 v107, v107, v106, vcc
v_bfe_u32 v106, v105, 7, 1
v_lshlrev_b32 v106, 2, v106
v_bfe_u32 v109, v105, 1, 2
v_add3_u32 v106, v106, v109, 16
v_cmp_le_u32 vcc, 256, v105
s_nop 1
v_cndmask_b32 v107, v107, v106, vcc
v_bfe_u32 v106, v105, 7, 2
v_lshlrev_b32 v106, 1, v106
v_bfe_u32 v109, v105, 2, 1
v_add3_u32 v106, v106, v109, 24
v_cmp_le_u32 vcc, 512, v105
s_nop 1
v_cndmask_b32 v107, v107, v106, vcc
v_subrev_u32 v106, 1024, v105
v_lshrrev_b32 v106, 7, v106
v_add_u32 v106, 32, v106
v_cmp_le_u32 vcc, 1024, v105
s_nop 1
v_cndmask_b32 v107, v107, v106, vcc
v_lshlrev_b32 v107, 5, v107
v_lshl_add_u32 v107, v108, 1, v107
v_add_u32 v107, 39424, v107
v_mov_b32 v106, 4096
v_cmp_gt_i32 vcc, 0, v104
s_nop 1
v_cndmask_b32 v107, v107, v106, vcc
v_add_u32 v66, s26, v107
v_subrev_u32 v104, 31, v20
v_max_i32 v105, 0, v104
v_min_i32 v105, 2047, v105
v_cvt_f32_u32 v105, v105
v_cvt_pk_bf16_f32 v105, v105, v105
v_lshlrev_b32 v105, 16, v105
v_cvt_u32_f32 v105, v105
v_bfe_u32 v108, v105, 3, 4
v_and_b32 v107, 7, v105
v_add_u32 v106, 8, v107
v_cmp_le_u32 vcc, 128, v105
s_nop 1
v_cndmask_b32 v107, v107, v106, vcc
v_bfe_u32 v106, v105, 7, 1
v_lshlrev_b32 v106, 2, v106
v_bfe_u32 v109, v105, 1, 2
v_add3_u32 v106, v106, v109, 16
v_cmp_le_u32 vcc, 256, v105
s_nop 1
v_cndmask_b32 v107, v107, v106, vcc
v_bfe_u32 v106, v105, 7, 2
v_lshlrev_b32 v106, 1, v106
v_bfe_u32 v109, v105, 2, 1
v_add3_u32 v106, v106, v109, 24
v_cmp_le_u32 vcc, 512, v105
s_nop 1
v_cndmask_b32 v107, v107, v106, vcc
v_subrev_u32 v106, 1024, v105
v_lshrrev_b32 v106, 7, v106
v_add_u32 v106, 32, v106
v_cmp_le_u32 vcc, 1024, v105
s_nop 1
v_cndmask_b32 v107, v107, v106, vcc
v_lshlrev_b32 v107, 5, v107
v_lshl_add_u32 v107, v108, 1, v107
v_add_u32 v107, 39424, v107
v_mov_b32 v106, 4096
v_cmp_gt_i32 vcc, 0, v104
s_nop 1
v_cndmask_b32 v107, v107, v106, vcc
v_add_u32 v67, s26, v107
v_subrev_u32 v104, 32, v20
v_max_i32 v105, 0, v104
v_min_i32 v105, 2047, v105
v_cvt_f32_u32 v105, v105
v_cvt_pk_bf16_f32 v105, v105, v105
v_lshlrev_b32 v105, 16, v105
v_cvt_u32_f32 v105, v105
v_bfe_u32 v108, v105, 3, 4
v_and_b32 v107, 7, v105
v_add_u32 v106, 8, v107
v_cmp_le_u32 vcc, 128, v105
s_nop 1
v_cndmask_b32 v107, v107, v106, vcc
v_bfe_u32 v106, v105, 7, 1
v_lshlrev_b32 v106, 2, v106
v_bfe_u32 v109, v105, 1, 2
v_add3_u32 v106, v106, v109, 16
v_cmp_le_u32 vcc, 256, v105
s_nop 1
v_cndmask_b32 v107, v107, v106, vcc
v_bfe_u32 v106, v105, 7, 2
v_lshlrev_b32 v106, 1, v106
v_bfe_u32 v109, v105, 2, 1
v_add3_u32 v106, v106, v109, 24
v_cmp_le_u32 vcc, 512, v105
s_nop 1
v_cndmask_b32 v107, v107, v106, vcc
v_subrev_u32 v106, 1024, v105
v_lshrrev_b32 v106, 7, v106
v_add_u32 v106, 32, v106
v_cmp_le_u32 vcc, 1024, v105
s_nop 1
v_cndmask_b32 v107, v107, v106, vcc
v_lshlrev_b32 v107, 5, v107
v_lshl_add_u32 v107, v108, 1, v107
v_add_u32 v107, 39424, v107
v_mov_b32 v106, 4096
v_cmp_gt_i32 vcc, 0, v104
s_nop 1
v_cndmask_b32 v107, v107, v106, vcc
v_add_u32 v68, s26, v107
v_subrev_u32 v104, 33, v20
v_max_i32 v105, 0, v104
v_min_i32 v105, 2047, v105
v_cvt_f32_u32 v105, v105
v_cvt_pk_bf16_f32 v105, v105, v105
v_lshlrev_b32 v105, 16, v105
v_cvt_u32_f32 v105, v105
v_bfe_u32 v108, v105, 3, 4
v_and_b32 v107, 7, v105
v_add_u32 v106, 8, v107
v_cmp_le_u32 vcc, 128, v105
s_nop 1
v_cndmask_b32 v107, v107, v106, vcc
v_bfe_u32 v106, v105, 7, 1
v_lshlrev_b32 v106, 2, v106
v_bfe_u32 v109, v105, 1, 2
v_add3_u32 v106, v106, v109, 16
v_cmp_le_u32 vcc, 256, v105
s_nop 1
v_cndmask_b32 v107, v107, v106, vcc
v_bfe_u32 v106, v105, 7, 2
v_lshlrev_b32 v106, 1, v106
v_bfe_u32 v109, v105, 2, 1
v_add3_u32 v106, v106, v109, 24
v_cmp_le_u32 vcc, 512, v105
s_nop 1
v_cndmask_b32 v107, v107, v106, vcc
v_subrev_u32 v106, 1024, v105
v_lshrrev_b32 v106, 7, v106
v_add_u32 v106, 32, v106
v_cmp_le_u32 vcc, 1024, v105
s_nop 1
v_cndmask_b32 v107, v107, v106, vcc
v_lshlrev_b32 v107, 5, v107
v_lshl_add_u32 v107, v108, 1, v107
v_add_u32 v107, 39424, v107
v_mov_b32 v106, 4096
v_cmp_gt_i32 vcc, 0, v104
s_nop 1
v_cndmask_b32 v107, v107, v106, vcc
v_add_u32 v69, s26, v107
v_subrev_u32 v104, 34, v20
v_max_i32 v105, 0, v104
v_min_i32 v105, 2047, v105
v_cvt_f32_u32 v105, v105
v_cvt_pk_bf16_f32 v105, v105, v105
v_lshlrev_b32 v105, 16, v105
v_cvt_u32_f32 v105, v105
v_bfe_u32 v108, v105, 3, 4
v_and_b32 v107, 7, v105
v_add_u32 v106, 8, v107
v_cmp_le_u32 vcc, 128, v105
s_nop 1
v_cndmask_b32 v107, v107, v106, vcc
v_bfe_u32 v106, v105, 7, 1
v_lshlrev_b32 v106, 2, v106
v_bfe_u32 v109, v105, 1, 2
v_add3_u32 v106, v106, v109, 16
v_cmp_le_u32 vcc, 256, v105
s_nop 1
v_cndmask_b32 v107, v107, v106, vcc
v_bfe_u32 v106, v105, 7, 2
v_lshlrev_b32 v106, 1, v106
v_bfe_u32 v109, v105, 2, 1
v_add3_u32 v106, v106, v109, 24
v_cmp_le_u32 vcc, 512, v105
s_nop 1
v_cndmask_b32 v107, v107, v106, vcc
v_subrev_u32 v106, 1024, v105
v_lshrrev_b32 v106, 7, v106
v_add_u32 v106, 32, v106
v_cmp_le_u32 vcc, 1024, v105
s_nop 1
v_cndmask_b32 v107, v107, v106, vcc
v_lshlrev_b32 v107, 5, v107
v_lshl_add_u32 v107, v108, 1, v107
v_add_u32 v107, 39424, v107
v_mov_b32 v106, 4096
v_cmp_gt_i32 vcc, 0, v104
s_nop 1
v_cndmask_b32 v107, v107, v106, vcc
v_add_u32 v70, s26, v107
v_subrev_u32 v104, 35, v20
v_max_i32 v105, 0, v104
v_min_i32 v105, 2047, v105
v_cvt_f32_u32 v105, v105
v_cvt_pk_bf16_f32 v105, v105, v105
v_lshlrev_b32 v105, 16, v105
v_cvt_u32_f32 v105, v105
v_bfe_u32 v108, v105, 3, 4
v_and_b32 v107, 7, v105
v_add_u32 v106, 8, v107
v_cmp_le_u32 vcc, 128, v105
s_nop 1
v_cndmask_b32 v107, v107, v106, vcc
v_bfe_u32 v106, v105, 7, 1
v_lshlrev_b32 v106, 2, v106
v_bfe_u32 v109, v105, 1, 2
v_add3_u32 v106, v106, v109, 16
v_cmp_le_u32 vcc, 256, v105
s_nop 1
v_cndmask_b32 v107, v107, v106, vcc
v_bfe_u32 v106, v105, 7, 2
v_lshlrev_b32 v106, 1, v106
v_bfe_u32 v109, v105, 2, 1
v_add3_u32 v106, v106, v109, 24
v_cmp_le_u32 vcc, 512, v105
s_nop 1
v_cndmask_b32 v107, v107, v106, vcc
v_subrev_u32 v106, 1024, v105
v_lshrrev_b32 v106, 7, v106
v_add_u32 v106, 32, v106
v_cmp_le_u32 vcc, 1024, v105
s_nop 1
v_cndmask_b32 v107, v107, v106, vcc
v_lshlrev_b32 v107, 5, v107
v_lshl_add_u32 v107, v108, 1, v107
v_add_u32 v107, 39424, v107
v_mov_b32 v106, 4096
v_cmp_gt_i32 vcc, 0, v104
s_nop 1
v_cndmask_b32 v107, v107, v106, vcc
v_add_u32 v71, s26, v107
v_subrev_u32 v104, 36, v20
v_max_i32 v105, 0, v104
v_min_i32 v105, 2047, v105
v_cvt_f32_u32 v105, v105
v_cvt_pk_bf16_f32 v105, v105, v105
v_lshlrev_b32 v105, 16, v105
v_cvt_u32_f32 v105, v105
v_bfe_u32 v108, v105, 3, 4
v_and_b32 v107, 7, v105
v_add_u32 v106, 8, v107
v_cmp_le_u32 vcc, 128, v105
s_nop 1
v_cndmask_b32 v107, v107, v106, vcc
v_bfe_u32 v106, v105, 7, 1
v_lshlrev_b32 v106, 2, v106
v_bfe_u32 v109, v105, 1, 2
v_add3_u32 v106, v106, v109, 16
v_cmp_le_u32 vcc, 256, v105
s_nop 1
v_cndmask_b32 v107, v107, v106, vcc
v_bfe_u32 v106, v105, 7, 2
v_lshlrev_b32 v106, 1, v106
v_bfe_u32 v109, v105, 2, 1
v_add3_u32 v106, v106, v109, 24
v_cmp_le_u32 vcc, 512, v105
s_nop 1
v_cndmask_b32 v107, v107, v106, vcc
v_subrev_u32 v106, 1024, v105
v_lshrrev_b32 v106, 7, v106
v_add_u32 v106, 32, v106
v_cmp_le_u32 vcc, 1024, v105
s_nop 1
v_cndmask_b32 v107, v107, v106, vcc
v_lshlrev_b32 v107, 5, v107
v_lshl_add_u32 v107, v108, 1, v107
v_add_u32 v107, 39424, v107
v_mov_b32 v106, 4096
v_cmp_gt_i32 vcc, 0, v104
s_nop 1
v_cndmask_b32 v107, v107, v106, vcc
v_add_u32 v72, s26, v107
v_subrev_u32 v104, 37, v20
v_max_i32 v105, 0, v104
v_min_i32 v105, 2047, v105
v_cvt_f32_u32 v105, v105
v_cvt_pk_bf16_f32 v105, v105, v105
v_lshlrev_b32 v105, 16, v105
v_cvt_u32_f32 v105, v105
v_bfe_u32 v108, v105, 3, 4
v_and_b32 v107, 7, v105
v_add_u32 v106, 8, v107
v_cmp_le_u32 vcc, 128, v105
s_nop 1
v_cndmask_b32 v107, v107, v106, vcc
v_bfe_u32 v106, v105, 7, 1
v_lshlrev_b32 v106, 2, v106
v_bfe_u32 v109, v105, 1, 2
v_add3_u32 v106, v106, v109, 16
v_cmp_le_u32 vcc, 256, v105
s_nop 1
v_cndmask_b32 v107, v107, v106, vcc
v_bfe_u32 v106, v105, 7, 2
v_lshlrev_b32 v106, 1, v106
v_bfe_u32 v109, v105, 2, 1
v_add3_u32 v106, v106, v109, 24
v_cmp_le_u32 vcc, 512, v105
s_nop 1
v_cndmask_b32 v107, v107, v106, vcc
v_subrev_u32 v106, 1024, v105
v_lshrrev_b32 v106, 7, v106
v_add_u32 v106, 32, v106
v_cmp_le_u32 vcc, 1024, v105
s_nop 1
v_cndmask_b32 v107, v107, v106, vcc
v_lshlrev_b32 v107, 5, v107
v_lshl_add_u32 v107, v108, 1, v107
v_add_u32 v107, 39424, v107
v_mov_b32 v106, 4096
v_cmp_gt_i32 vcc, 0, v104
s_nop 1
v_cndmask_b32 v107, v107, v106, vcc
v_add_u32 v73, s26, v107
v_subrev_u32 v104, 38, v20
v_max_i32 v105, 0, v104
v_min_i32 v105, 2047, v105
v_cvt_f32_u32 v105, v105
v_cvt_pk_bf16_f32 v105, v105, v105
v_lshlrev_b32 v105, 16, v105
v_cvt_u32_f32 v105, v105
v_bfe_u32 v108, v105, 3, 4
v_and_b32 v107, 7, v105
v_add_u32 v106, 8, v107
v_cmp_le_u32 vcc, 128, v105
s_nop 1
v_cndmask_b32 v107, v107, v106, vcc
v_bfe_u32 v106, v105, 7, 1
v_lshlrev_b32 v106, 2, v106
v_bfe_u32 v109, v105, 1, 2
v_add3_u32 v106, v106, v109, 16
v_cmp_le_u32 vcc, 256, v105
s_nop 1
v_cndmask_b32 v107, v107, v106, vcc
v_bfe_u32 v106, v105, 7, 2
v_lshlrev_b32 v106, 1, v106
v_bfe_u32 v109, v105, 2, 1
v_add3_u32 v106, v106, v109, 24
v_cmp_le_u32 vcc, 512, v105
s_nop 1
v_cndmask_b32 v107, v107, v106, vcc
v_subrev_u32 v106, 1024, v105
v_lshrrev_b32 v106, 7, v106
v_add_u32 v106, 32, v106
v_cmp_le_u32 vcc, 1024, v105
s_nop 1
v_cndmask_b32 v107, v107, v106, vcc
v_lshlrev_b32 v107, 5, v107
v_lshl_add_u32 v107, v108, 1, v107
v_add_u32 v107, 39424, v107
v_mov_b32 v106, 4096
v_cmp_gt_i32 vcc, 0, v104
s_nop 1
v_cndmask_b32 v107, v107, v106, vcc
v_add_u32 v74, s26, v107
v_subrev_u32 v104, 39, v20
v_max_i32 v105, 0, v104
v_min_i32 v105, 2047, v105
v_cvt_f32_u32 v105, v105
v_cvt_pk_bf16_f32 v105, v105, v105
v_lshlrev_b32 v105, 16, v105
v_cvt_u32_f32 v105, v105
v_bfe_u32 v108, v105, 3, 4
v_and_b32 v107, 7, v105
v_add_u32 v106, 8, v107
v_cmp_le_u32 vcc, 128, v105
s_nop 1
v_cndmask_b32 v107, v107, v106, vcc
v_bfe_u32 v106, v105, 7, 1
v_lshlrev_b32 v106, 2, v106
v_bfe_u32 v109, v105, 1, 2
v_add3_u32 v106, v106, v109, 16
v_cmp_le_u32 vcc, 256, v105
s_nop 1
v_cndmask_b32 v107, v107, v106, vcc
v_bfe_u32 v106, v105, 7, 2
v_lshlrev_b32 v106, 1, v106
v_bfe_u32 v109, v105, 2, 1
v_add3_u32 v106, v106, v109, 24
v_cmp_le_u32 vcc, 512, v105
s_nop 1
v_cndmask_b32 v107, v107, v106, vcc
v_subrev_u32 v106, 1024, v105
v_lshrrev_b32 v106, 7, v106
v_add_u32 v106, 32, v106
v_cmp_le_u32 vcc, 1024, v105
s_nop 1
v_cndmask_b32 v107, v107, v106, vcc
v_lshlrev_b32 v107, 5, v107
v_lshl_add_u32 v107, v108, 1, v107
v_add_u32 v107, 39424, v107
v_mov_b32 v106, 4096
v_cmp_gt_i32 vcc, 0, v104
s_nop 1
v_cndmask_b32 v107, v107, v106, vcc
v_add_u32 v75, s26, v107
v_mov_b32 v104, 0
v_mov_b32 v105, 0
v_mov_b32 v106, 0
v_mov_b32 v107, 0
v_lshlrev_b32 v32, 4, v1
v_add_u32 v32, s26, v32
ds_write_b128 v32, v[104:107] offset:33280
ds_write_b128 v32, v[104:107] offset:34304
v_bfe_u32 v33, v1, 2, 3
v_mul_u32_u24 v33, 4160, v33
v_and_b32 v34, 3, v1
v_lshl_add_u32 v33, v34, 4, v33
v_add_u32 v33, s26, v33
ds_write_b128 v33, v[104:107] offset:4096
s_waitcnt lgkmcnt(0)
s_mov_b32 s30, s23
Al_5:
s_lshl_b32 s31, s30, 2
s_add_u32 s32, s31, s3
v_mul_u32_u24 v34, 1280, v0
s_lshl_b32 s40, s31, 1
v_add_u32 v34, s40, v34
s_mov_b32 s42, s62
s_mov_b32 s43, s63
global_load_dwordx2 v[192:193], v34, s[42:43]
s_add_u32 s42, s42, 327680
s_addc_u32 s43, s43, 0
global_load_dwordx2 v[194:195], v34, s[42:43]
s_add_u32 s42, s42, 327680
s_addc_u32 s43, s43, 0
global_load_dwordx2 v[196:197], v34, s[42:43]
s_add_u32 s42, s42, 327680
s_addc_u32 s43, s43, 0
global_load_dwordx2 v[198:199], v34, s[42:43]
s_add_u32 s42, s42, 327680
s_addc_u32 s43, s43, 0
global_load_dwordx2 v[200:201], v34, s[42:43]
s_add_u32 s42, s42, 327680
s_addc_u32 s43, s43, 0
global_load_dwordx2 v[202:203], v34, s[42:43]
s_add_u32 s42, s42, 327680
s_addc_u32 s43, s43, 0
global_load_dwordx2 v[204:205], v34, s[42:43]
s_add_u32 s42, s42, 327680
s_addc_u32 s43, s43, 0
global_load_dwordx2 v[206:207], v34, s[42:43]
s_lshl_b32 s40, s32, 8
v_add_u32 v35, s40, v22
global_load_dword v104, v35, s[46:47]
global_load_dword v105, v35, s[48:49]
global_load_dword v106, v35, s[50:51]
global_load_dword v107, v35, s[52:53]
global_load_dword v108, v35, s[54:55]
global_load_dword v109, v35, s[56:57]
s_lshl_b32 s40, s32, 1
v_mov_b32 v35, s40
global_load_ushort v110, v35, s[58:59]
global_load_ushort v111, v35, s[60:61]
s_waitcnt vmcnt(0)
v_lshlrev_b32 v23, 16, v111
v_lshlrev_b32 v110, 16, v110
v_mul_f32 v110, 1069066811, v110
v_exp_f32 v110, v110
s_nop 0
v_cvt_pk_bf16_f32 v110, v110, v110
v_lshlrev_b32 v110, 16, v110
v_lshlrev_b32 v112, 16, v104
v_lshlrev_b32 v113, 16, v105
v_lshlrev_b32 v114, 16, v106
v_lshlrev_b32 v115, 16, v107
v_lshlrev_b32 v116, 16, v108
v_lshlrev_b32 v117, 16, v109
v_mul_f32 v112, v110, v112
v_mul_f32 v76, 1069066811, v112
v_mul_f32 v113, v110, v113
v_mul_f32 v77, 1042479491, v113
v_mul_f32 v114, v110, v114
v_mul_f32 v115, v110, v115
v_mul_f32 v78, v116, v114
v_fma_f32 v78, -v117, v115, v78
v_mul_f32 v82, v116, v115
v_fma_f32 v82, v117, v114, v82
v_sub_f32 v82, 0, v82
v_mov_b32 v79, v82
v_sub_f32 v83, 0, v78
v_mov_b32 v80, v76
v_mov_b32 v81, v77
ds_write_b128 v21, v[76:79] offset:0
ds_write_b128 v21, v[80:83] offset:16
v_and_b32 v112, 0xffff0000, v104
v_and_b32 v113, 0xffff0000, v105
v_and_b32 v114, 0xffff0000, v106
v_and_b32 v115, 0xffff0000, v107
v_and_b32 v116, 0xffff0000, v108
v_and_b32 v117, 0xffff0000, v109
v_mul_f32 v112, v110, v112
v_mul_f32 v76, 1069066811, v112
v_mul_f32 v113, v110, v113
v_mul_f32 v77, 1042479491, v113
v_mul_f32 v114, v110, v114
v_mul_f32 v115, v110, v115
v_mul_f32 v78, v116, v114
v_fma_f32 v78, -v117, v115, v78
v_mul_f32 v82, v116, v115
v_fma_f32 v82, v117, v114, v82
v_sub_f32 v82, 0, v82
v_mov_b32 v79, v82
v_sub_f32 v83, 0, v78
v_mov_b32 v80, v76
v_mov_b32 v81, v77
ds_write_b128 v21, v[76:79] offset:32
ds_write_b128 v21, v[80:83] offset:48
v_add_u32 v35, 0, v17
ds_write_b16 v35, v192
v_add_u32 v35, 40960, v17
ds_write_b16_d16_hi v35, v192
v_add_u32 v35, 81920, v17
ds_write_b16 v35, v193
v_add_u32 v35, 122880, v17
ds_write_b16_d16_hi v35, v193
v_add_u32 v35, 512, v17
ds_write_b16 v35, v194
v_add_u32 v35, 41472, v17
ds_write_b16_d16_hi v35, v194
v_add_u32 v35, 82432, v17
ds_write_b16 v35, v195
v_add_u32 v35, 123392, v17
ds_write_b16_d16_hi v35, v195
v_add_u32 v35, 1024, v17
ds_write_b16 v35, v196
v_add_u32 v35, 41984, v17
ds_write_b16_d16_hi v35, v196
v_add_u32 v35, 82944, v17
ds_write_b16 v35, v197
v_add_u32 v35, 123904, v17
ds_write_b16_d16_hi v35, v197
v_add_u32 v35, 1536, v17
ds_write_b16 v35, v198
v_add_u32 v35, 42496, v17
ds_write_b16_d16_hi v35, v198
v_add_u32 v35, 83456, v17
ds_write_b16 v35, v199
v_add_u32 v35, 124416, v17
ds_write_b16_d16_hi v35, v199
v_add_u32 v35, 2048, v17
ds_write_b16 v35, v200
v_add_u32 v35, 43008, v17
ds_write_b16_d16_hi v35, v200
v_add_u32 v35, 83968, v17
ds_write_b16 v35, v201
v_add_u32 v35, 124928, v17
ds_write_b16_d16_hi v35, v201
v_add_u32 v35, 2560, v17
ds_write_b16 v35, v202
v_add_u32 v35, 43520, v17
ds_write_b16_d16_hi v35, v202
v_add_u32 v35, 84480, v17
ds_write_b16 v35, v203
v_add_u32 v35, 125440, v17
ds_write_b16_d16_hi v35, v203
v_add_u32 v35, 3072, v17
ds_write_b16 v35, v204
v_add_u32 v35, 44032, v17
ds_write_b16_d16_hi v35, v204
v_add_u32 v35, 84992, v17
ds_write_b16 v35, v205
v_add_u32 v35, 125952, v17
ds_write_b16_d16_hi v35, v205
v_add_u32 v35, 3584, v17
ds_write_b16 v35, v206
v_add_u32 v35, 44544, v17
ds_write_b16_d16_hi v35, v206
v_add_u32 v35, 85504, v17
ds_write_b16 v35, v207
v_add_u32 v35, 126464, v17
ds_write_b16_d16_hi v35, v207
s_waitcnt lgkmcnt(0)
ds_read_b128 v[76:79], v2 offset:0
ds_read_b128 v[80:83], v2 offset:64
s_waitcnt lgkmcnt(1)
v_pk_mul_f32 v[104:105], v[76:77], v[10:11]
v_pk_fma_f32 v[106:107], v[76:77], v[4:5], v[12:13]
v_pk_fma_f32 v[108:109], v[76:77], v[6:7], v[12:13]
v_pk_fma_f32 v[110:111], v[76:77], v[8:9], v[12:13]
v_fract_f32 v105, v105
v_fract_f32 v107, v107
v_fract_f32 v109, v109
v_fract_f32 v111, v111
v_exp_f32 v104, v104
v_cos_f32 v112, v105
v_sin_f32 v113, v105
v_exp_f32 v106, v106
v_cos_f32 v107, v107
v_exp_f32 v108, v108
v_cos_f32 v109, v109
v_exp_f32 v110, v110
v_cos_f32 v111, v111
v_mul_f32 v112, v78, v112
v_fmac_f32 v112, v79, v113
v_mul_f32 v99, v112, v104
v_mul_f32 v96, v106, v107
v_mul_f32 v97, v108, v109
v_mul_f32 v98, v110, v111
v_mfma_f32_16x16x4_f32 v[84:87], v96, v99, 0
v_mfma_f32_16x16x4_f32 v[88:91], v97, v99, 0
v_mfma_f32_16x16x4_f32 v[92:95], v98, v99, 0
ds_read_b128 v[76:79], v2 offset:128
s_waitcnt lgkmcnt(1)
v_pk_mul_f32 v[104:105], v[80:81], v[10:11]
v_pk_fma_f32 v[106:107], v[80:81], v[4:5], v[12:13]
v_pk_fma_f32 v[108:109], v[80:81], v[6:7], v[12:13]
v_pk_fma_f32 v[110:111], v[80:81], v[8:9], v[12:13]
v_fract_f32 v105, v105
v_fract_f32 v107, v107
v_fract_f32 v109, v109
v_fract_f32 v111, v111
v_exp_f32 v104, v104
v_cos_f32 v112, v105
v_sin_f32 v113, v105
v_exp_f32 v106, v106
v_cos_f32 v107, v107
v_exp_f32 v108, v108
v_cos_f32 v109, v109
v_exp_f32 v110, v110
v_cos_f32 v111, v111
v_mul_f32 v112, v82, v112
v_fmac_f32 v112, v83, v113
v_mul_f32 v103, v112, v104
v_mul_f32 v100, v106, v107
v_mul_f32 v101, v108, v109
v_mul_f32 v102, v110, v111
v_mfma_f32_16x16x4_f32 v[84:87], v100, v103, v[84:87]
v_mfma_f32_16x16x4_f32 v[88:91], v101, v103, v[88:91]
v_mfma_f32_16x16x4_f32 v[92:95], v102, v103, v[92:95]
ds_read_b128 v[80:83], v2 offset:192
s_waitcnt lgkmcnt(1)
v_pk_mul_f32 v[104:105], v[76:77], v[10:11]
v_pk_fma_f32 v[106:107], v[76:77], v[4:5], v[12:13]
v_pk_fma_f32 v[108:109], v[76:77], v[6:7], v[12:13]
v_pk_fma_f32 v[110:111], v[76:77], v[8:9], v[12:13]
v_fract_f32 v105, v105
v_fract_f32 v107, v107
v_fract_f32 v109, v109
v_fract_f32 v111, v111
v_exp_f32 v104, v104
v_cos_f32 v112, v105
v_sin_f32 v113, v105
v_exp_f32 v106, v106
v_cos_f32 v107, v107
v_exp_f32 v108, v108
v_cos_f32 v109, v109
v_exp_f32 v110, v110
v_cos_f32 v111, v111
v_mul_f32 v112, v78, v112
v_fmac_f32 v112, v79, v113
v_mul_f32 v99, v112, v104
v_mul_f32 v96, v106, v107
v_mul_f32 v97, v108, v109
v_mul_f32 v98, v110, v111
v_mfma_f32_16x16x4_f32 v[84:87], v96, v99, v[84:87]
v_mfma_f32_16x16x4_f32 v[88:91], v97, v99, v[88:91]
v_mfma_f32_16x16x4_f32 v[92:95], v98, v99, v[92:95]
ds_read_b128 v[76:79], v2 offset:256
s_waitcnt lgkmcnt(1)
v_pk_mul_f32 v[104:105], v[80:81], v[10:11]
v_pk_fma_f32 v[106:107], v[80:81], v[4:5], v[12:13]
v_pk_fma_f32 v[108:109], v[80:81], v[6:7], v[12:13]
v_pk_fma_f32 v[110:111], v[80:81], v[8:9], v[12:13]
v_fract_f32 v105, v105
v_fract_f32 v107, v107
v_fract_f32 v109, v109
v_fract_f32 v111, v111
v_exp_f32 v104, v104
v_cos_f32 v112, v105
v_sin_f32 v113, v105
v_exp_f32 v106, v106
v_cos_f32 v107, v107
v_exp_f32 v108, v108
v_cos_f32 v109, v109
v_exp_f32 v110, v110
v_cos_f32 v111, v111
v_mul_f32 v112, v82, v112
v_fmac_f32 v112, v83, v113
v_mul_f32 v103, v112, v104
v_mul_f32 v100, v106, v107
v_mul_f32 v101, v108, v109
v_mul_f32 v102, v110, v111
v_mfma_f32_16x16x4_f32 v[84:87], v100, v103, v[84:87]
v_mfma_f32_16x16x4_f32 v[88:91], v101, v103, v[88:91]
v_mfma_f32_16x16x4_f32 v[92:95], v102, v103, v[92:95]
ds_read_b128 v[80:83], v2 offset:320
s_waitcnt lgkmcnt(1)
v_pk_mul_f32 v[104:105], v[76:77], v[10:11]
v_pk_fma_f32 v[106:107], v[76:77], v[4:5], v[12:13]
v_pk_fma_f32 v[108:109], v[76:77], v[6:7], v[12:13]
v_pk_fma_f32 v[110:111], v[76:77], v[8:9], v[12:13]
v_fract_f32 v105, v105
v_fract_f32 v107, v107
v_fract_f32 v109, v109
v_fract_f32 v111, v111
v_exp_f32 v104, v104
v_cos_f32 v112, v105
v_sin_f32 v113, v105
v_exp_f32 v106, v106
v_cos_f32 v107, v107
v_exp_f32 v108, v108
v_cos_f32 v109, v109
v_exp_f32 v110, v110
v_cos_f32 v111, v111
v_mul_f32 v112, v78, v112
v_fmac_f32 v112, v79, v113
v_mul_f32 v99, v112, v104
v_mul_f32 v96, v106, v107
v_mul_f32 v97, v108, v109
v_mul_f32 v98, v110, v111
v_mfma_f32_16x16x4_f32 v[84:87], v96, v99, v[84:87]
v_mfma_f32_16x16x4_f32 v[88:91], v97, v99, v[88:91]
v_mfma_f32_16x16x4_f32 v[92:95], v98, v99, v[92:95]
ds_read_b128 v[76:79], v2 offset:384
s_waitcnt lgkmcnt(1)
v_pk_mul_f32 v[104:105], v[80:81], v[10:11]
v_pk_fma_f32 v[106:107], v[80:81], v[4:5], v[12:13]
v_pk_fma_f32 v[108:109], v[80:81], v[6:7], v[12:13]
v_pk_fma_f32 v[110:111], v[80:81], v[8:9], v[12:13]
v_fract_f32 v105, v105
v_fract_f32 v107, v107
v_fract_f32 v109, v109
v_fract_f32 v111, v111
v_exp_f32 v104, v104
v_cos_f32 v112, v105
v_sin_f32 v113, v105
v_exp_f32 v106, v106
v_cos_f32 v107, v107
v_exp_f32 v108, v108
v_cos_f32 v109, v109
v_exp_f32 v110, v110
v_cos_f32 v111, v111
v_mul_f32 v112, v82, v112
v_fmac_f32 v112, v83, v113
v_mul_f32 v103, v112, v104
v_mul_f32 v100, v106, v107
v_mul_f32 v101, v108, v109
v_mul_f32 v102, v110, v111
v_mfma_f32_16x16x4_f32 v[84:87], v100, v103, v[84:87]
v_mfma_f32_16x16x4_f32 v[88:91], v101, v103, v[88:91]
v_mfma_f32_16x16x4_f32 v[92:95], v102, v103, v[92:95]
ds_read_b128 v[80:83], v2 offset:448
s_waitcnt lgkmcnt(1)
v_pk_mul_f32 v[104:105], v[76:77], v[10:11]
v_pk_fma_f32 v[106:107], v[76:77], v[4:5], v[12:13]
v_pk_fma_f32 v[108:109], v[76:77], v[6:7], v[12:13]
v_pk_fma_f32 v[110:111], v[76:77], v[8:9], v[12:13]
v_fract_f32 v105, v105
v_fract_f32 v107, v107
v_fract_f32 v109, v109
v_fract_f32 v111, v111
v_exp_f32 v104, v104
v_cos_f32 v112, v105
v_sin_f32 v113, v105
v_exp_f32 v106, v106
v_cos_f32 v107, v107
v_exp_f32 v108, v108
v_cos_f32 v109, v109
v_exp_f32 v110, v110
v_cos_f32 v111, v111
v_mul_f32 v112, v78, v112
v_fmac_f32 v112, v79, v113
v_mul_f32 v99, v112, v104
v_mul_f32 v96, v106, v107
v_mul_f32 v97, v108, v109
v_mul_f32 v98, v110, v111
v_mfma_f32_16x16x4_f32 v[84:87], v96, v99, v[84:87]
v_mfma_f32_16x16x4_f32 v[88:91], v97, v99, v[88:91]
v_mfma_f32_16x16x4_f32 v[92:95], v98, v99, v[92:95]
ds_read_b128 v[76:79], v2 offset:512
s_waitcnt lgkmcnt(1)
v_pk_mul_f32 v[104:105], v[80:81], v[10:11]
v_pk_fma_f32 v[106:107], v[80:81], v[4:5], v[12:13]
v_pk_fma_f32 v[108:109], v[80:81], v[6:7], v[12:13]
v_pk_fma_f32 v[110:111], v[80:81], v[8:9], v[12:13]
v_fract_f32 v105, v105
v_fract_f32 v107, v107
v_fract_f32 v109, v109
v_fract_f32 v111, v111
v_exp_f32 v104, v104
v_cos_f32 v112, v105
v_sin_f32 v113, v105
v_exp_f32 v106, v106
v_cos_f32 v107, v107
v_exp_f32 v108, v108
v_cos_f32 v109, v109
v_exp_f32 v110, v110
v_cos_f32 v111, v111
v_mul_f32 v112, v82, v112
v_fmac_f32 v112, v83, v113
v_mul_f32 v103, v112, v104
v_mul_f32 v100, v106, v107
v_mul_f32 v101, v108, v109
v_mul_f32 v102, v110, v111
v_mfma_f32_16x16x4_f32 v[84:87], v100, v103, v[84:87]
v_mfma_f32_16x16x4_f32 v[88:91], v101, v103, v[88:91]
v_mfma_f32_16x16x4_f32 v[92:95], v102, v103, v[92:95]
ds_read_b128 v[80:83], v2 offset:576
s_waitcnt lgkmcnt(1)
v_pk_mul_f32 v[104:105], v[76:77], v[10:11]
v_pk_fma_f32 v[106:107], v[76:77], v[4:5], v[12:13]
v_pk_fma_f32 v[108:109], v[76:77], v[6:7], v[12:13]
v_pk_fma_f32 v[110:111], v[76:77], v[8:9], v[12:13]
v_fract_f32 v105, v105
v_fract_f32 v107, v107
v_fract_f32 v109, v109
v_fract_f32 v111, v111
v_exp_f32 v104, v104
v_cos_f32 v112, v105
v_sin_f32 v113, v105
v_exp_f32 v106, v106
v_cos_f32 v107, v107
v_exp_f32 v108, v108
v_cos_f32 v109, v109
v_exp_f32 v110, v110
v_cos_f32 v111, v111
v_mul_f32 v112, v78, v112
v_fmac_f32 v112, v79, v113
v_mul_f32 v99, v112, v104
v_mul_f32 v96, v106, v107
v_mul_f32 v97, v108, v109
v_mul_f32 v98, v110, v111
v_mfma_f32_16x16x4_f32 v[84:87], v96, v99, v[84:87]
v_mfma_f32_16x16x4_f32 v[88:91], v97, v99, v[88:91]
v_mfma_f32_16x16x4_f32 v[92:95], v98, v99, v[92:95]
ds_read_b128 v[76:79], v2 offset:640
s_waitcnt lgkmcnt(1)
v_pk_mul_f32 v[104:105], v[80:81], v[10:11]
v_pk_fma_f32 v[106:107], v[80:81], v[4:5], v[12:13]
v_pk_fma_f32 v[108:109], v[80:81], v[6:7], v[12:13]
v_pk_fma_f32 v[110:111], v[80:81], v[8:9], v[12:13]
v_fract_f32 v105, v105
v_fract_f32 v107, v107
v_fract_f32 v109, v109
v_fract_f32 v111, v111
v_exp_f32 v104, v104
v_cos_f32 v112, v105
v_sin_f32 v113, v105
v_exp_f32 v106, v106
v_cos_f32 v107, v107
v_exp_f32 v108, v108
v_cos_f32 v109, v109
v_exp_f32 v110, v110
v_cos_f32 v111, v111
v_mul_f32 v112, v82, v112
v_fmac_f32 v112, v83, v113
v_mul_f32 v103, v112, v104
v_mul_f32 v100, v106, v107
v_mul_f32 v101, v108, v109
v_mul_f32 v102, v110, v111
v_mfma_f32_16x16x4_f32 v[84:87], v100, v103, v[84:87]
v_mfma_f32_16x16x4_f32 v[88:91], v101, v103, v[88:91]
v_mfma_f32_16x16x4_f32 v[92:95], v102, v103, v[92:95]
ds_read_b128 v[80:83], v2 offset:704
s_waitcnt lgkmcnt(1)
v_pk_mul_f32 v[104:105], v[76:77], v[10:11]
v_pk_fma_f32 v[106:107], v[76:77], v[4:5], v[12:13]
v_pk_fma_f32 v[108:109], v[76:77], v[6:7], v[12:13]
v_pk_fma_f32 v[110:111], v[76:77], v[8:9], v[12:13]
v_fract_f32 v105, v105
v_fract_f32 v107, v107
v_fract_f32 v109, v109
v_fract_f32 v111, v111
v_exp_f32 v104, v104
v_cos_f32 v112, v105
v_sin_f32 v113, v105
v_exp_f32 v106, v106
v_cos_f32 v107, v107
v_exp_f32 v108, v108
v_cos_f32 v109, v109
v_exp_f32 v110, v110
v_cos_f32 v111, v111
v_mul_f32 v112, v78, v112
v_fmac_f32 v112, v79, v113
v_mul_f32 v99, v112, v104
v_mul_f32 v96, v106, v107
v_mul_f32 v97, v108, v109
v_mul_f32 v98, v110, v111
v_mfma_f32_16x16x4_f32 v[84:87], v96, v99, v[84:87]
v_mfma_f32_16x16x4_f32 v[88:91], v97, v99, v[88:91]
v_mfma_f32_16x16x4_f32 v[92:95], v98, v99, v[92:95]
ds_read_b128 v[76:79], v2 offset:768
s_waitcnt lgkmcnt(1)
v_pk_mul_f32 v[104:105], v[80:81], v[10:11]
v_pk_fma_f32 v[106:107], v[80:81], v[4:5], v[12:13]
v_pk_fma_f32 v[108:109], v[80:81], v[6:7], v[12:13]
v_pk_fma_f32 v[110:111], v[80:81], v[8:9], v[12:13]
v_fract_f32 v105, v105
v_fract_f32 v107, v107
v_fract_f32 v109, v109
v_fract_f32 v111, v111
v_exp_f32 v104, v104
v_cos_f32 v112, v105
v_sin_f32 v113, v105
v_exp_f32 v106, v106
v_cos_f32 v107, v107
v_exp_f32 v108, v108
v_cos_f32 v109, v109
v_exp_f32 v110, v110
v_cos_f32 v111, v111
v_mul_f32 v112, v82, v112
v_fmac_f32 v112, v83, v113
v_mul_f32 v103, v112, v104
v_mul_f32 v100, v106, v107
v_mul_f32 v101, v108, v109
v_mul_f32 v102, v110, v111
v_mfma_f32_16x16x4_f32 v[84:87], v100, v103, v[84:87]
v_mfma_f32_16x16x4_f32 v[88:91], v101, v103, v[88:91]
v_mfma_f32_16x16x4_f32 v[92:95], v102, v103, v[92:95]
ds_read_b128 v[80:83], v2 offset:832
s_waitcnt lgkmcnt(1)
v_pk_mul_f32 v[104:105], v[76:77], v[10:11]
v_pk_fma_f32 v[106:107], v[76:77], v[4:5], v[12:13]
v_pk_fma_f32 v[108:109], v[76:77], v[6:7], v[12:13]
v_pk_fma_f32 v[110:111], v[76:77], v[8:9], v[12:13]
v_fract_f32 v105, v105
v_fract_f32 v107, v107
v_fract_f32 v109, v109
v_fract_f32 v111, v111
v_exp_f32 v104, v104
v_cos_f32 v112, v105
v_sin_f32 v113, v105
v_exp_f32 v106, v106
v_cos_f32 v107, v107
v_exp_f32 v108, v108
v_cos_f32 v109, v109
v_exp_f32 v110, v110
v_cos_f32 v111, v111
v_mul_f32 v112, v78, v112
v_fmac_f32 v112, v79, v113
v_mul_f32 v99, v112, v104
v_mul_f32 v96, v106, v107
v_mul_f32 v97, v108, v109
v_mul_f32 v98, v110, v111
v_mfma_f32_16x16x4_f32 v[84:87], v96, v99, v[84:87]
v_mfma_f32_16x16x4_f32 v[88:91], v97, v99, v[88:91]
v_mfma_f32_16x16x4_f32 v[92:95], v98, v99, v[92:95]
ds_read_b128 v[76:79], v2 offset:896
s_waitcnt lgkmcnt(1)
v_pk_mul_f32 v[104:105], v[80:81], v[10:11]
v_pk_fma_f32 v[106:107], v[80:81], v[4:5], v[12:13]
v_pk_fma_f32 v[108:109], v[80:81], v[6:7], v[12:13]
v_pk_fma_f32 v[110:111], v[80:81], v[8:9], v[12:13]
v_fract_f32 v105, v105
v_fract_f32 v107, v107
v_fract_f32 v109, v109
v_fract_f32 v111, v111
v_exp_f32 v104, v104
v_cos_f32 v112, v105
v_sin_f32 v113, v105
v_exp_f32 v106, v106
v_cos_f32 v107, v107
v_exp_f32 v108, v108
v_cos_f32 v109, v109
v_exp_f32 v110, v110
v_cos_f32 v111, v111
v_mul_f32 v112, v82, v112
v_fmac_f32 v112, v83, v113
v_mul_f32 v103, v112, v104
v_mul_f32 v100, v106, v107
v_mul_f32 v101, v108, v109
v_mul_f32 v102, v110, v111
v_mfma_f32_16x16x4_f32 v[84:87], v100, v103, v[84:87]
v_mfma_f32_16x16x4_f32 v[88:91], v101, v103, v[88:91]
v_mfma_f32_16x16x4_f32 v[92:95], v102, v103, v[92:95]
ds_read_b128 v[80:83], v2 offset:960
s_waitcnt lgkmcnt(1)
v_pk_mul_f32 v[104:105], v[76:77], v[10:11]
v_pk_fma_f32 v[106:107], v[76:77], v[4:5], v[12:13]
v_pk_fma_f32 v[108:109], v[76:77], v[6:7], v[12:13]
v_pk_fma_f32 v[110:111], v[76:77], v[8:9], v[12:13]
v_fract_f32 v105, v105
v_fract_f32 v107, v107
v_fract_f32 v109, v109
v_fract_f32 v111, v111
v_exp_f32 v104, v104
v_cos_f32 v112, v105
v_sin_f32 v113, v105
v_exp_f32 v106, v106
v_cos_f32 v107, v107
v_exp_f32 v108, v108
v_cos_f32 v109, v109
v_exp_f32 v110, v110
v_cos_f32 v111, v111
v_mul_f32 v112, v78, v112
v_fmac_f32 v112, v79, v113
v_mul_f32 v99, v112, v104
v_mul_f32 v96, v106, v107
v_mul_f32 v97, v108, v109
v_mul_f32 v98, v110, v111
v_mfma_f32_16x16x4_f32 v[84:87], v96, v99, v[84:87]
v_mfma_f32_16x16x4_f32 v[88:91], v97, v99, v[88:91]
v_mfma_f32_16x16x4_f32 v[92:95], v98, v99, v[92:95]
ds_read_b128 v[76:79], v2 offset:1024
s_waitcnt lgkmcnt(1)
v_pk_mul_f32 v[104:105], v[80:81], v[10:11]
v_pk_fma_f32 v[106:107], v[80:81], v[4:5], v[12:13]
v_pk_fma_f32 v[108:109], v[80:81], v[6:7], v[12:13]
v_pk_fma_f32 v[110:111], v[80:81], v[8:9], v[12:13]
v_fract_f32 v105, v105
v_fract_f32 v107, v107
v_fract_f32 v109, v109
v_fract_f32 v111, v111
v_exp_f32 v104, v104
v_cos_f32 v112, v105
v_sin_f32 v113, v105
v_exp_f32 v106, v106
v_cos_f32 v107, v107
v_exp_f32 v108, v108
v_cos_f32 v109, v109
v_exp_f32 v110, v110
v_cos_f32 v111, v111
v_mul_f32 v112, v82, v112
v_fmac_f32 v112, v83, v113
v_mul_f32 v103, v112, v104
v_mul_f32 v100, v106, v107
v_mul_f32 v101, v108, v109
v_mul_f32 v102, v110, v111
v_mfma_f32_16x16x4_f32 v[84:87], v100, v103, v[84:87]
v_mfma_f32_16x16x4_f32 v[88:91], v101, v103, v[88:91]
v_mfma_f32_16x16x4_f32 v[92:95], v102, v103, v[92:95]
ds_read_b128 v[80:83], v2 offset:1088
s_waitcnt lgkmcnt(1)
v_pk_mul_f32 v[104:105], v[76:77], v[10:11]
v_pk_fma_f32 v[106:107], v[76:77], v[4:5], v[12:13]
v_pk_fma_f32 v[108:109], v[76:77], v[6:7], v[12:13]
v_pk_fma_f32 v[110:111], v[76:77], v[8:9], v[12:13]
v_fract_f32 v105, v105
v_fract_f32 v107, v107
v_fract_f32 v109, v109
v_fract_f32 v111, v111
v_exp_f32 v104, v104
v_cos_f32 v112, v105
v_sin_f32 v113, v105
v_exp_f32 v106, v106
v_cos_f32 v107, v107
v_exp_f32 v108, v108
v_cos_f32 v109, v109
v_exp_f32 v110, v110
v_cos_f32 v111, v111
v_mul_f32 v112, v78, v112
v_fmac_f32 v112, v79, v113
v_mul_f32 v99, v112, v104
v_mul_f32 v96, v106, v107
v_mul_f32 v97, v108, v109
v_mul_f32 v98, v110, v111
v_mfma_f32_16x16x4_f32 v[84:87], v96, v99, v[84:87]
v_mfma_f32_16x16x4_f32 v[88:91], v97, v99, v[88:91]
v_mfma_f32_16x16x4_f32 v[92:95], v98, v99, v[92:95]
ds_read_b128 v[76:79], v2 offset:1152
s_waitcnt lgkmcnt(1)
v_pk_mul_f32 v[104:105], v[80:81], v[10:11]
v_pk_fma_f32 v[106:107], v[80:81], v[4:5], v[12:13]
v_pk_fma_f32 v[108:109], v[80:81], v[6:7], v[12:13]
v_pk_fma_f32 v[110:111], v[80:81], v[8:9], v[12:13]
v_fract_f32 v105, v105
v_fract_f32 v107, v107
v_fract_f32 v109, v109
v_fract_f32 v111, v111
v_exp_f32 v104, v104
v_cos_f32 v112, v105
v_sin_f32 v113, v105
v_exp_f32 v106, v106
v_cos_f32 v107, v107
v_exp_f32 v108, v108
v_cos_f32 v109, v109
v_exp_f32 v110, v110
v_cos_f32 v111, v111
v_mul_f32 v112, v82, v112
v_fmac_f32 v112, v83, v113
v_mul_f32 v103, v112, v104
v_mul_f32 v100, v106, v107
v_mul_f32 v101, v108, v109
v_mul_f32 v102, v110, v111
v_mfma_f32_16x16x4_f32 v[84:87], v100, v103, v[84:87]
v_mfma_f32_16x16x4_f32 v[88:91], v101, v103, v[88:91]
v_mfma_f32_16x16x4_f32 v[92:95], v102, v103, v[92:95]
ds_read_b128 v[80:83], v2 offset:1216
s_waitcnt lgkmcnt(1)
v_pk_mul_f32 v[104:105], v[76:77], v[10:11]
v_pk_fma_f32 v[106:107], v[76:77], v[4:5], v[12:13]
v_pk_fma_f32 v[108:109], v[76:77], v[6:7], v[12:13]
v_pk_fma_f32 v[110:111], v[76:77], v[8:9], v[12:13]
v_fract_f32 v105, v105
v_fract_f32 v107, v107
v_fract_f32 v109, v109
v_fract_f32 v111, v111
v_exp_f32 v104, v104
v_cos_f32 v112, v105
v_sin_f32 v113, v105
v_exp_f32 v106, v106
v_cos_f32 v107, v107
v_exp_f32 v108, v108
v_cos_f32 v109, v109
v_exp_f32 v110, v110
v_cos_f32 v111, v111
v_mul_f32 v112, v78, v112
v_fmac_f32 v112, v79, v113
v_mul_f32 v99, v112, v104
v_mul_f32 v96, v106, v107
v_mul_f32 v97, v108, v109
v_mul_f32 v98, v110, v111
v_mfma_f32_16x16x4_f32 v[84:87], v96, v99, v[84:87]
v_mfma_f32_16x16x4_f32 v[88:91], v97, v99, v[88:91]
v_mfma_f32_16x16x4_f32 v[92:95], v98, v99, v[92:95]
ds_read_b128 v[76:79], v2 offset:1280
s_waitcnt lgkmcnt(1)
v_pk_mul_f32 v[104:105], v[80:81], v[10:11]
v_pk_fma_f32 v[106:107], v[80:81], v[4:5], v[12:13]
v_pk_fma_f32 v[108:109], v[80:81], v[6:7], v[12:13]
v_pk_fma_f32 v[110:111], v[80:81], v[8:9], v[12:13]
v_fract_f32 v105, v105
v_fract_f32 v107, v107
v_fract_f32 v109, v109
v_fract_f32 v111, v111
v_exp_f32 v104, v104
v_cos_f32 v112, v105
v_sin_f32 v113, v105
v_exp_f32 v106, v106
v_cos_f32 v107, v107
v_exp_f32 v108, v108
v_cos_f32 v109, v109
v_exp_f32 v110, v110
v_cos_f32 v111, v111
v_mul_f32 v112, v82, v112
v_fmac_f32 v112, v83, v113
v_mul_f32 v103, v112, v104
v_mul_f32 v100, v106, v107
v_mul_f32 v101, v108, v109
v_mul_f32 v102, v110, v111
v_mfma_f32_16x16x4_f32 v[84:87], v100, v103, v[84:87]
v_mfma_f32_16x16x4_f32 v[88:91], v101, v103, v[88:91]
v_mfma_f32_16x16x4_f32 v[92:95], v102, v103, v[92:95]
ds_read_b128 v[80:83], v2 offset:1344
s_waitcnt lgkmcnt(1)
v_pk_mul_f32 v[104:105], v[76:77], v[10:11]
v_pk_fma_f32 v[106:107], v[76:77], v[4:5], v[12:13]
v_pk_fma_f32 v[108:109], v[76:77], v[6:7], v[12:13]
v_pk_fma_f32 v[110:111], v[76:77], v[8:9], v[12:13]
v_fract_f32 v105, v105
v_fract_f32 v107, v107
v_fract_f32 v109, v109
v_fract_f32 v111, v111
v_exp_f32 v104, v104
v_cos_f32 v112, v105
v_sin_f32 v113, v105
v_exp_f32 v106, v106
v_cos_f32 v107, v107
v_exp_f32 v108, v108
v_cos_f32 v109, v109
v_exp_f32 v110, v110
v_cos_f32 v111, v111
v_mul_f32 v112, v78, v112
v_fmac_f32 v112, v79, v113
v_mul_f32 v99, v112, v104
v_mul_f32 v96, v106, v107
v_mul_f32 v97, v108, v109
v_mul_f32 v98, v110, v111
v_mfma_f32_16x16x4_f32 v[84:87], v96, v99, v[84:87]
v_mfma_f32_16x16x4_f32 v[88:91], v97, v99, v[88:91]
v_mfma_f32_16x16x4_f32 v[92:95], v98, v99, v[92:95]
ds_read_b128 v[76:79], v2 offset:1408
s_waitcnt lgkmcnt(1)
v_pk_mul_f32 v[104:105], v[80:81], v[10:11]
v_pk_fma_f32 v[106:107], v[80:81], v[4:5], v[12:13]
v_pk_fma_f32 v[108:109], v[80:81], v[6:7], v[12:13]
v_pk_fma_f32 v[110:111], v[80:81], v[8:9], v[12:13]
v_fract_f32 v105, v105
v_fract_f32 v107, v107
v_fract_f32 v109, v109
v_fract_f32 v111, v111
v_exp_f32 v104, v104
v_cos_f32 v112, v105
v_sin_f32 v113, v105
v_exp_f32 v106, v106
v_cos_f32 v107, v107
v_exp_f32 v108, v108
v_cos_f32 v109, v109
v_exp_f32 v110, v110
v_cos_f32 v111, v111
v_mul_f32 v112, v82, v112
v_fmac_f32 v112, v83, v113
v_mul_f32 v103, v112, v104
v_mul_f32 v100, v106, v107
v_mul_f32 v101, v108, v109
v_mul_f32 v102, v110, v111
v_mfma_f32_16x16x4_f32 v[84:87], v100, v103, v[84:87]
v_mfma_f32_16x16x4_f32 v[88:91], v101, v103, v[88:91]
v_mfma_f32_16x16x4_f32 v[92:95], v102, v103, v[92:95]
ds_read_b128 v[80:83], v2 offset:1472
s_waitcnt lgkmcnt(1)
v_pk_mul_f32 v[104:105], v[76:77], v[10:11]
v_pk_fma_f32 v[106:107], v[76:77], v[4:5], v[12:13]
v_pk_fma_f32 v[108:109], v[76:77], v[6:7], v[12:13]
v_pk_fma_f32 v[110:111], v[76:77], v[8:9], v[12:13]
v_fract_f32 v105, v105
v_fract_f32 v107, v107
v_fract_f32 v109, v109
v_fract_f32 v111, v111
v_exp_f32 v104, v104
v_cos_f32 v112, v105
v_sin_f32 v113, v105
v_exp_f32 v106, v106
v_cos_f32 v107, v107
v_exp_f32 v108, v108
v_cos_f32 v109, v109
v_exp_f32 v110, v110
v_cos_f32 v111, v111
v_mul_f32 v112, v78, v112
v_fmac_f32 v112, v79, v113
v_mul_f32 v99, v112, v104
v_mul_f32 v96, v106, v107
v_mul_f32 v97, v108, v109
v_mul_f32 v98, v110, v111
v_mfma_f32_16x16x4_f32 v[84:87], v96, v99, v[84:87]
v_mfma_f32_16x16x4_f32 v[88:91], v97, v99, v[88:91]
v_mfma_f32_16x16x4_f32 v[92:95], v98, v99, v[92:95]
ds_read_b128 v[76:79], v2 offset:1536
s_waitcnt lgkmcnt(1)
v_pk_mul_f32 v[104:105], v[80:81], v[10:11]
v_pk_fma_f32 v[106:107], v[80:81], v[4:5], v[12:13]
v_pk_fma_f32 v[108:109], v[80:81], v[6:7], v[12:13]
v_pk_fma_f32 v[110:111], v[80:81], v[8:9], v[12:13]
v_fract_f32 v105, v105
v_fract_f32 v107, v107
v_fract_f32 v109, v109
v_fract_f32 v111, v111
v_exp_f32 v104, v104
v_cos_f32 v112, v105
v_sin_f32 v113, v105
v_exp_f32 v106, v106
v_cos_f32 v107, v107
v_exp_f32 v108, v108
v_cos_f32 v109, v109
v_exp_f32 v110, v110
v_cos_f32 v111, v111
v_mul_f32 v112, v82, v112
v_fmac_f32 v112, v83, v113
v_mul_f32 v103, v112, v104
v_mul_f32 v100, v106, v107
v_mul_f32 v101, v108, v109
v_mul_f32 v102, v110, v111
v_mfma_f32_16x16x4_f32 v[84:87], v100, v103, v[84:87]
v_mfma_f32_16x16x4_f32 v[88:91], v101, v103, v[88:91]
v_mfma_f32_16x16x4_f32 v[92:95], v102, v103, v[92:95]
ds_read_b128 v[80:83], v2 offset:1600
s_waitcnt lgkmcnt(1)
v_pk_mul_f32 v[104:105], v[76:77], v[10:11]
v_pk_fma_f32 v[106:107], v[76:77], v[4:5], v[12:13]
v_pk_fma_f32 v[108:109], v[76:77], v[6:7], v[12:13]
v_pk_fma_f32 v[110:111], v[76:77], v[8:9], v[12:13]
v_fract_f32 v105, v105
v_fract_f32 v107, v107
v_fract_f32 v109, v109
v_fract_f32 v111, v111
v_exp_f32 v104, v104
v_cos_f32 v112, v105
v_sin_f32 v113, v105
v_exp_f32 v106, v106
v_cos_f32 v107, v107
v_exp_f32 v108, v108
v_cos_f32 v109, v109
v_exp_f32 v110, v110
v_cos_f32 v111, v111
v_mul_f32 v112, v78, v112
v_fmac_f32 v112, v79, v113
v_mul_f32 v99, v112, v104
v_mul_f32 v96, v106, v107
v_mul_f32 v97, v108, v109
v_mul_f32 v98, v110, v111
v_mfma_f32_16x16x4_f32 v[84:87], v96, v99, v[84:87]
v_mfma_f32_16x16x4_f32 v[88:91], v97, v99, v[88:91]
v_mfma_f32_16x16x4_f32 v[92:95], v98, v99, v[92:95]
ds_read_b128 v[76:79], v2 offset:1664
s_waitcnt lgkmcnt(1)
v_pk_mul_f32 v[104:105], v[80:81], v[10:11]
v_pk_fma_f32 v[106:107], v[80:81], v[4:5], v[12:13]
v_pk_fma_f32 v[108:109], v[80:81], v[6:7], v[12:13]
v_pk_fma_f32 v[110:111], v[80:81], v[8:9], v[12:13]
v_fract_f32 v105, v105
v_fract_f32 v107, v107
v_fract_f32 v109, v109
v_fract_f32 v111, v111
v_exp_f32 v104, v104
v_cos_f32 v112, v105
v_sin_f32 v113, v105
v_exp_f32 v106, v106
v_cos_f32 v107, v107
v_exp_f32 v108, v108
v_cos_f32 v109, v109
v_exp_f32 v110, v110
v_cos_f32 v111, v111
v_mul_f32 v112, v82, v112
v_fmac_f32 v112, v83, v113
v_mul_f32 v103, v112, v104
v_mul_f32 v100, v106, v107
v_mul_f32 v101, v108, v109
v_mul_f32 v102, v110, v111
v_mfma_f32_16x16x4_f32 v[84:87], v100, v103, v[84:87]
v_mfma_f32_16x16x4_f32 v[88:91], v101, v103, v[88:91]
v_mfma_f32_16x16x4_f32 v[92:95], v102, v103, v[92:95]
ds_read_b128 v[80:83], v2 offset:1728
s_waitcnt lgkmcnt(1)
v_pk_mul_f32 v[104:105], v[76:77], v[10:11]
v_pk_fma_f32 v[106:107], v[76:77], v[4:5], v[12:13]
v_pk_fma_f32 v[108:109], v[76:77], v[6:7], v[12:13]
v_pk_fma_f32 v[110:111], v[76:77], v[8:9], v[12:13]
v_fract_f32 v105, v105
v_fract_f32 v107, v107
v_fract_f32 v109, v109
v_fract_f32 v111, v111
v_exp_f32 v104, v104
v_cos_f32 v112, v105
v_sin_f32 v113, v105
v_exp_f32 v106, v106
v_cos_f32 v107, v107
v_exp_f32 v108, v108
v_cos_f32 v109, v109
v_exp_f32 v110, v110
v_cos_f32 v111, v111
v_mul_f32 v112, v78, v112
v_fmac_f32 v112, v79, v113
v_mul_f32 v99, v112, v104
v_mul_f32 v96, v106, v107
v_mul_f32 v97, v108, v109
v_mul_f32 v98, v110, v111
v_mfma_f32_16x16x4_f32 v[84:87], v96, v99, v[84:87]
v_mfma_f32_16x16x4_f32 v[88:91], v97, v99, v[88:91]
v_mfma_f32_16x16x4_f32 v[92:95], v98, v99, v[92:95]
ds_read_b128 v[76:79], v2 offset:1792
s_waitcnt lgkmcnt(1)
v_pk_mul_f32 v[104:105], v[80:81], v[10:11]
v_pk_fma_f32 v[106:107], v[80:81], v[4:5], v[12:13]
v_pk_fma_f32 v[108:109], v[80:81], v[6:7], v[12:13]
v_pk_fma_f32 v[110:111], v[80:81], v[8:9], v[12:13]
v_fract_f32 v105, v105
v_fract_f32 v107, v107
v_fract_f32 v109, v109
v_fract_f32 v111, v111
v_exp_f32 v104, v104
v_cos_f32 v112, v105
v_sin_f32 v113, v105
v_exp_f32 v106, v106
v_cos_f32 v107, v107
v_exp_f32 v108, v108
v_cos_f32 v109, v109
v_exp_f32 v110, v110
v_cos_f32 v111, v111
v_mul_f32 v112, v82, v112
v_fmac_f32 v112, v83, v113
v_mul_f32 v103, v112, v104
v_mul_f32 v100, v106, v107
v_mul_f32 v101, v108, v109
v_mul_f32 v102, v110, v111
v_mfma_f32_16x16x4_f32 v[84:87], v100, v103, v[84:87]
v_mfma_f32_16x16x4_f32 v[88:91], v101, v103, v[88:91]
v_mfma_f32_16x16x4_f32 v[92:95], v102, v103, v[92:95]
ds_read_b128 v[80:83], v2 offset:1856
s_waitcnt lgkmcnt(1)
v_pk_mul_f32 v[104:105], v[76:77], v[10:11]
v_pk_fma_f32 v[106:107], v[76:77], v[4:5], v[12:13]
v_pk_fma_f32 v[108:109], v[76:77], v[6:7], v[12:13]
v_pk_fma_f32 v[110:111], v[76:77], v[8:9], v[12:13]
v_fract_f32 v105, v105
v_fract_f32 v107, v107
v_fract_f32 v109, v109
v_fract_f32 v111, v111
v_exp_f32 v104, v104
v_cos_f32 v112, v105
v_sin_f32 v113, v105
v_exp_f32 v106, v106
v_cos_f32 v107, v107
v_exp_f32 v108, v108
v_cos_f32 v109, v109
v_exp_f32 v110, v110
v_cos_f32 v111, v111
v_mul_f32 v112, v78, v112
v_fmac_f32 v112, v79, v113
v_mul_f32 v99, v112, v104
v_mul_f32 v96, v106, v107
v_mul_f32 v97, v108, v109
v_mul_f32 v98, v110, v111
v_mfma_f32_16x16x4_f32 v[84:87], v96, v99, v[84:87]
v_mfma_f32_16x16x4_f32 v[88:91], v97, v99, v[88:91]
v_mfma_f32_16x16x4_f32 v[92:95], v98, v99, v[92:95]
ds_read_b128 v[76:79], v2 offset:1920
s_waitcnt lgkmcnt(1)
v_pk_mul_f32 v[104:105], v[80:81], v[10:11]
v_pk_fma_f32 v[106:107], v[80:81], v[4:5], v[12:13]
v_pk_fma_f32 v[108:109], v[80:81], v[6:7], v[12:13]
v_pk_fma_f32 v[110:111], v[80:81], v[8:9], v[12:13]
v_fract_f32 v105, v105
v_fract_f32 v107, v107
v_fract_f32 v109, v109
v_fract_f32 v111, v111
v_exp_f32 v104, v104
v_cos_f32 v112, v105
v_sin_f32 v113, v105
v_exp_f32 v106, v106
v_cos_f32 v107, v107
v_exp_f32 v108, v108
v_cos_f32 v109, v109
v_exp_f32 v110, v110
v_cos_f32 v111, v111
v_mul_f32 v112, v82, v112
v_fmac_f32 v112, v83, v113
v_mul_f32 v103, v112, v104
v_mul_f32 v100, v106, v107
v_mul_f32 v101, v108, v109
v_mul_f32 v102, v110, v111
v_mfma_f32_16x16x4_f32 v[84:87], v100, v103, v[84:87]
v_mfma_f32_16x16x4_f32 v[88:91], v101, v103, v[88:91]
v_mfma_f32_16x16x4_f32 v[92:95], v102, v103, v[92:95]
ds_read_b128 v[80:83], v2 offset:1984
s_waitcnt lgkmcnt(1)
v_pk_mul_f32 v[104:105], v[76:77], v[10:11]
v_pk_fma_f32 v[106:107], v[76:77], v[4:5], v[12:13]
v_pk_fma_f32 v[108:109], v[76:77], v[6:7], v[12:13]
v_pk_fma_f32 v[110:111], v[76:77], v[8:9], v[12:13]
v_fract_f32 v105, v105
v_fract_f32 v107, v107
v_fract_f32 v109, v109
v_fract_f32 v111, v111
v_exp_f32 v104, v104
v_cos_f32 v112, v105
v_sin_f32 v113, v105
v_exp_f32 v106, v106
v_cos_f32 v107, v107
v_exp_f32 v108, v108
v_cos_f32 v109, v109
v_exp_f32 v110, v110
v_cos_f32 v111, v111
v_mul_f32 v112, v78, v112
v_fmac_f32 v112, v79, v113
v_mul_f32 v99, v112, v104
v_mul_f32 v96, v106, v107
v_mul_f32 v97, v108, v109
v_mul_f32 v98, v110, v111
v_mfma_f32_16x16x4_f32 v[84:87], v96, v99, v[84:87]
v_mfma_f32_16x16x4_f32 v[88:91], v97, v99, v[88:91]
v_mfma_f32_16x16x4_f32 v[92:95], v98, v99, v[92:95]
ds_read_b128 v[76:79], v2 offset:2048
s_waitcnt lgkmcnt(1)
v_pk_mul_f32 v[104:105], v[80:81], v[10:11]
v_pk_fma_f32 v[106:107], v[80:81], v[4:5], v[12:13]
v_pk_fma_f32 v[108:109], v[80:81], v[6:7], v[12:13]
v_pk_fma_f32 v[110:111], v[80:81], v[8:9], v[12:13]
v_fract_f32 v105, v105
v_fract_f32 v107, v107
v_fract_f32 v109, v109
v_fract_f32 v111, v111
v_exp_f32 v104, v104
v_cos_f32 v112, v105
v_sin_f32 v113, v105
v_exp_f32 v106, v106
v_cos_f32 v107, v107
v_exp_f32 v108, v108
v_cos_f32 v109, v109
v_exp_f32 v110, v110
v_cos_f32 v111, v111
v_mul_f32 v112, v82, v112
v_fmac_f32 v112, v83, v113
v_mul_f32 v103, v112, v104
v_mul_f32 v100, v106, v107
v_mul_f32 v101, v108, v109
v_mul_f32 v102, v110, v111
v_mfma_f32_16x16x4_f32 v[84:87], v100, v103, v[84:87]
v_mfma_f32_16x16x4_f32 v[88:91], v101, v103, v[88:91]
v_mfma_f32_16x16x4_f32 v[92:95], v102, v103, v[92:95]
ds_read_b128 v[80:83], v2 offset:2112
s_waitcnt lgkmcnt(1)
v_pk_mul_f32 v[104:105], v[76:77], v[10:11]
v_pk_fma_f32 v[106:107], v[76:77], v[4:5], v[12:13]
v_pk_fma_f32 v[108:109], v[76:77], v[6:7], v[12:13]
v_pk_fma_f32 v[110:111], v[76:77], v[8:9], v[12:13]
v_fract_f32 v105, v105
v_fract_f32 v107, v107
v_fract_f32 v109, v109
v_fract_f32 v111, v111
v_exp_f32 v104, v104
v_cos_f32 v112, v105
v_sin_f32 v113, v105
v_exp_f32 v106, v106
v_cos_f32 v107, v107
v_exp_f32 v108, v108
v_cos_f32 v109, v109
v_exp_f32 v110, v110
v_cos_f32 v111, v111
v_mul_f32 v112, v78, v112
v_fmac_f32 v112, v79, v113
v_mul_f32 v99, v112, v104
v_mul_f32 v96, v106, v107
v_mul_f32 v97, v108, v109
v_mul_f32 v98, v110, v111
v_mfma_f32_16x16x4_f32 v[84:87], v96, v99, v[84:87]
v_mfma_f32_16x16x4_f32 v[88:91], v97, v99, v[88:91]
v_mfma_f32_16x16x4_f32 v[92:95], v98, v99, v[92:95]
ds_read_b128 v[76:79], v2 offset:2176
s_waitcnt lgkmcnt(1)
v_pk_mul_f32 v[104:105], v[80:81], v[10:11]
v_pk_fma_f32 v[106:107], v[80:81], v[4:5], v[12:13]
v_pk_fma_f32 v[108:109], v[80:81], v[6:7], v[12:13]
v_pk_fma_f32 v[110:111], v[80:81], v[8:9], v[12:13]
v_fract_f32 v105, v105
v_fract_f32 v107, v107
v_fract_f32 v109, v109
v_fract_f32 v111, v111
v_exp_f32 v104, v104
v_cos_f32 v112, v105
v_sin_f32 v113, v105
v_exp_f32 v106, v106
v_cos_f32 v107, v107
v_exp_f32 v108, v108
v_cos_f32 v109, v109
v_exp_f32 v110, v110
v_cos_f32 v111, v111
v_mul_f32 v112, v82, v112
v_fmac_f32 v112, v83, v113
v_mul_f32 v103, v112, v104
v_mul_f32 v100, v106, v107
v_mul_f32 v101, v108, v109
v_mul_f32 v102, v110, v111
v_mfma_f32_16x16x4_f32 v[84:87], v100, v103, v[84:87]
v_mfma_f32_16x16x4_f32 v[88:91], v101, v103, v[88:91]
v_mfma_f32_16x16x4_f32 v[92:95], v102, v103, v[92:95]
ds_read_b128 v[80:83], v2 offset:2240
s_waitcnt lgkmcnt(1)
v_pk_mul_f32 v[104:105], v[76:77], v[10:11]
v_pk_fma_f32 v[106:107], v[76:77], v[4:5], v[12:13]
v_pk_fma_f32 v[108:109], v[76:77], v[6:7], v[12:13]
v_pk_fma_f32 v[110:111], v[76:77], v[8:9], v[12:13]
v_fract_f32 v105, v105
v_fract_f32 v107, v107
v_fract_f32 v109, v109
v_fract_f32 v111, v111
v_exp_f32 v104, v104
v_cos_f32 v112, v105
v_sin_f32 v113, v105
v_exp_f32 v106, v106
v_cos_f32 v107, v107
v_exp_f32 v108, v108
v_cos_f32 v109, v109
v_exp_f32 v110, v110
v_cos_f32 v111, v111
v_mul_f32 v112, v78, v112
v_fmac_f32 v112, v79, v113
v_mul_f32 v99, v112, v104
v_mul_f32 v96, v106, v107
v_mul_f32 v97, v108, v109
v_mul_f32 v98, v110, v111
v_mfma_f32_16x16x4_f32 v[84:87], v96, v99, v[84:87]
v_mfma_f32_16x16x4_f32 v[88:91], v97, v99, v[88:91]
v_mfma_f32_16x16x4_f32 v[92:95], v98, v99, v[92:95]
ds_read_b128 v[76:79], v2 offset:2304
s_waitcnt lgkmcnt(1)
v_pk_mul_f32 v[104:105], v[80:81], v[10:11]
v_pk_fma_f32 v[106:107], v[80:81], v[4:5], v[12:13]
v_pk_fma_f32 v[108:109], v[80:81], v[6:7], v[12:13]
v_pk_fma_f32 v[110:111], v[80:81], v[8:9], v[12:13]
v_fract_f32 v105, v105
v_fract_f32 v107, v107
v_fract_f32 v109, v109
v_fract_f32 v111, v111
v_exp_f32 v104, v104
v_cos_f32 v112, v105
v_sin_f32 v113, v105
v_exp_f32 v106, v106
v_cos_f32 v107, v107
v_exp_f32 v108, v108
v_cos_f32 v109, v109
v_exp_f32 v110, v110
v_cos_f32 v111, v111
v_mul_f32 v112, v82, v112
v_fmac_f32 v112, v83, v113
v_mul_f32 v103, v112, v104
v_mul_f32 v100, v106, v107
v_mul_f32 v101, v108, v109
v_mul_f32 v102, v110, v111
v_mfma_f32_16x16x4_f32 v[84:87], v100, v103, v[84:87]
v_mfma_f32_16x16x4_f32 v[88:91], v101, v103, v[88:91]
v_mfma_f32_16x16x4_f32 v[92:95], v102, v103, v[92:95]
ds_read_b128 v[80:83], v2 offset:2368
s_waitcnt lgkmcnt(1)
v_pk_mul_f32 v[104:105], v[76:77], v[10:11]
v_pk_fma_f32 v[106:107], v[76:77], v[4:5], v[12:13]
v_pk_fma_f32 v[108:109], v[76:77], v[6:7], v[12:13]
v_pk_fma_f32 v[110:111], v[76:77], v[8:9], v[12:13]
v_fract_f32 v105, v105
v_fract_f32 v107, v107
v_fract_f32 v109, v109
v_fract_f32 v111, v111
v_exp_f32 v104, v104
v_cos_f32 v112, v105
v_sin_f32 v113, v105
v_exp_f32 v106, v106
v_cos_f32 v107, v107
v_exp_f32 v108, v108
v_cos_f32 v109, v109
v_exp_f32 v110, v110
v_cos_f32 v111, v111
v_mul_f32 v112, v78, v112
v_fmac_f32 v112, v79, v113
v_mul_f32 v99, v112, v104
v_mul_f32 v96, v106, v107
v_mul_f32 v97, v108, v109
v_mul_f32 v98, v110, v111
v_mfma_f32_16x16x4_f32 v[84:87], v96, v99, v[84:87]
v_mfma_f32_16x16x4_f32 v[88:91], v97, v99, v[88:91]
v_mfma_f32_16x16x4_f32 v[92:95], v98, v99, v[92:95]
ds_read_b128 v[76:79], v2 offset:2432
s_waitcnt lgkmcnt(1)
v_pk_mul_f32 v[104:105], v[80:81], v[10:11]
v_pk_fma_f32 v[106:107], v[80:81], v[4:5], v[12:13]
v_pk_fma_f32 v[108:109], v[80:81], v[6:7], v[12:13]
v_pk_fma_f32 v[110:111], v[80:81], v[8:9], v[12:13]
v_fract_f32 v105, v105
v_fract_f32 v107, v107
v_fract_f32 v109, v109
v_fract_f32 v111, v111
v_exp_f32 v104, v104
v_cos_f32 v112, v105
v_sin_f32 v113, v105
v_exp_f32 v106, v106
v_cos_f32 v107, v107
v_exp_f32 v108, v108
v_cos_f32 v109, v109
v_exp_f32 v110, v110
v_cos_f32 v111, v111
v_mul_f32 v112, v82, v112
v_fmac_f32 v112, v83, v113
v_mul_f32 v103, v112, v104
v_mul_f32 v100, v106, v107
v_mul_f32 v101, v108, v109
v_mul_f32 v102, v110, v111
v_mfma_f32_16x16x4_f32 v[84:87], v100, v103, v[84:87]
v_mfma_f32_16x16x4_f32 v[88:91], v101, v103, v[88:91]
v_mfma_f32_16x16x4_f32 v[92:95], v102, v103, v[92:95]
ds_read_b128 v[80:83], v2 offset:2496
s_waitcnt lgkmcnt(1)
v_pk_mul_f32 v[104:105], v[76:77], v[10:11]
v_pk_fma_f32 v[106:107], v[76:77], v[4:5], v[12:13]
v_pk_fma_f32 v[108:109], v[76:77], v[6:7], v[12:13]
v_pk_fma_f32 v[110:111], v[76:77], v[8:9], v[12:13]
v_fract_f32 v105, v105
v_fract_f32 v107, v107
v_fract_f32 v109, v109
v_fract_f32 v111, v111
v_exp_f32 v104, v104
v_cos_f32 v112, v105
v_sin_f32 v113, v105
v_exp_f32 v106, v106
v_cos_f32 v107, v107
v_exp_f32 v108, v108
v_cos_f32 v109, v109
v_exp_f32 v110, v110
v_cos_f32 v111, v111
v_mul_f32 v112, v78, v112
v_fmac_f32 v112, v79, v113
v_mul_f32 v99, v112, v104
v_mul_f32 v96, v106, v107
v_mul_f32 v97, v108, v109
v_mul_f32 v98, v110, v111
v_mfma_f32_16x16x4_f32 v[84:87], v96, v99, v[84:87]
v_mfma_f32_16x16x4_f32 v[88:91], v97, v99, v[88:91]
v_mfma_f32_16x16x4_f32 v[92:95], v98, v99, v[92:95]
ds_read_b128 v[76:79], v2 offset:2560
s_waitcnt lgkmcnt(1)
v_pk_mul_f32 v[104:105], v[80:81], v[10:11]
v_pk_fma_f32 v[106:107], v[80:81], v[4:5], v[12:13]
v_pk_fma_f32 v[108:109], v[80:81], v[6:7], v[12:13]
v_pk_fma_f32 v[110:111], v[80:81], v[8:9], v[12:13]
v_fract_f32 v105, v105
v_fract_f32 v107, v107
v_fract_f32 v109, v109
v_fract_f32 v111, v111
v_exp_f32 v104, v104
v_cos_f32 v112, v105
v_sin_f32 v113, v105
v_exp_f32 v106, v106
v_cos_f32 v107, v107
v_exp_f32 v108, v108
v_cos_f32 v109, v109
v_exp_f32 v110, v110
v_cos_f32 v111, v111
v_mul_f32 v112, v82, v112
v_fmac_f32 v112, v83, v113
v_mul_f32 v103, v112, v104
v_mul_f32 v100, v106, v107
v_mul_f32 v101, v108, v109
v_mul_f32 v102, v110, v111
v_mfma_f32_16x16x4_f32 v[84:87], v100, v103, v[84:87]
v_mfma_f32_16x16x4_f32 v[88:91], v101, v103, v[88:91]
v_mfma_f32_16x16x4_f32 v[92:95], v102, v103, v[92:95]
ds_read_b128 v[80:83], v2 offset:2624
s_waitcnt lgkmcnt(1)
v_pk_mul_f32 v[104:105], v[76:77], v[10:11]
v_pk_fma_f32 v[106:107], v[76:77], v[4:5], v[12:13]
v_pk_fma_f32 v[108:109], v[76:77], v[6:7], v[12:13]
v_pk_fma_f32 v[110:111], v[76:77], v[8:9], v[12:13]
v_fract_f32 v105, v105
v_fract_f32 v107, v107
v_fract_f32 v109, v109
v_fract_f32 v111, v111
v_exp_f32 v104, v104
v_cos_f32 v112, v105
v_sin_f32 v113, v105
v_exp_f32 v106, v106
v_cos_f32 v107, v107
v_exp_f32 v108, v108
v_cos_f32 v109, v109
v_exp_f32 v110, v110
v_cos_f32 v111, v111
v_mul_f32 v112, v78, v112
v_fmac_f32 v112, v79, v113
v_mul_f32 v99, v112, v104
v_mul_f32 v96, v106, v107
v_mul_f32 v97, v108, v109
v_mul_f32 v98, v110, v111
v_mfma_f32_16x16x4_f32 v[84:87], v96, v99, v[84:87]
v_mfma_f32_16x16x4_f32 v[88:91], v97, v99, v[88:91]
v_mfma_f32_16x16x4_f32 v[92:95], v98, v99, v[92:95]
ds_read_b128 v[76:79], v2 offset:2688
s_waitcnt lgkmcnt(1)
v_pk_mul_f32 v[104:105], v[80:81], v[10:11]
v_pk_fma_f32 v[106:107], v[80:81], v[4:5], v[12:13]
v_pk_fma_f32 v[108:109], v[80:81], v[6:7], v[12:13]
v_pk_fma_f32 v[110:111], v[80:81], v[8:9], v[12:13]
v_fract_f32 v105, v105
v_fract_f32 v107, v107
v_fract_f32 v109, v109
v_fract_f32 v111, v111
v_exp_f32 v104, v104
v_cos_f32 v112, v105
v_sin_f32 v113, v105
v_exp_f32 v106, v106
v_cos_f32 v107, v107
v_exp_f32 v108, v108
v_cos_f32 v109, v109
v_exp_f32 v110, v110
v_cos_f32 v111, v111
v_mul_f32 v112, v82, v112
v_fmac_f32 v112, v83, v113
v_mul_f32 v103, v112, v104
v_mul_f32 v100, v106, v107
v_mul_f32 v101, v108, v109
v_mul_f32 v102, v110, v111
v_mfma_f32_16x16x4_f32 v[84:87], v100, v103, v[84:87]
v_mfma_f32_16x16x4_f32 v[88:91], v101, v103, v[88:91]
v_mfma_f32_16x16x4_f32 v[92:95], v102, v103, v[92:95]
ds_read_b128 v[80:83], v2 offset:2752
s_waitcnt lgkmcnt(1)
v_pk_mul_f32 v[104:105], v[76:77], v[10:11]
v_pk_fma_f32 v[106:107], v[76:77], v[4:5], v[12:13]
v_pk_fma_f32 v[108:109], v[76:77], v[6:7], v[12:13]
v_pk_fma_f32 v[110:111], v[76:77], v[8:9], v[12:13]
v_fract_f32 v105, v105
v_fract_f32 v107, v107
v_fract_f32 v109, v109
v_fract_f32 v111, v111
v_exp_f32 v104, v104
v_cos_f32 v112, v105
v_sin_f32 v113, v105
v_exp_f32 v106, v106
v_cos_f32 v107, v107
v_exp_f32 v108, v108
v_cos_f32 v109, v109
v_exp_f32 v110, v110
v_cos_f32 v111, v111
v_mul_f32 v112, v78, v112
v_fmac_f32 v112, v79, v113
v_mul_f32 v99, v112, v104
v_mul_f32 v96, v106, v107
v_mul_f32 v97, v108, v109
v_mul_f32 v98, v110, v111
v_mfma_f32_16x16x4_f32 v[84:87], v96, v99, v[84:87]
v_mfma_f32_16x16x4_f32 v[88:91], v97, v99, v[88:91]
v_mfma_f32_16x16x4_f32 v[92:95], v98, v99, v[92:95]
ds_read_b128 v[76:79], v2 offset:2816
s_waitcnt lgkmcnt(1)
v_pk_mul_f32 v[104:105], v[80:81], v[10:11]
v_pk_fma_f32 v[106:107], v[80:81], v[4:5], v[12:13]
v_pk_fma_f32 v[108:109], v[80:81], v[6:7], v[12:13]
v_pk_fma_f32 v[110:111], v[80:81], v[8:9], v[12:13]
v_fract_f32 v105, v105
v_fract_f32 v107, v107
v_fract_f32 v109, v109
v_fract_f32 v111, v111
v_exp_f32 v104, v104
v_cos_f32 v112, v105
v_sin_f32 v113, v105
v_exp_f32 v106, v106
v_cos_f32 v107, v107
v_exp_f32 v108, v108
v_cos_f32 v109, v109
v_exp_f32 v110, v110
v_cos_f32 v111, v111
v_mul_f32 v112, v82, v112
v_fmac_f32 v112, v83, v113
v_mul_f32 v103, v112, v104
v_mul_f32 v100, v106, v107
v_mul_f32 v101, v108, v109
v_mul_f32 v102, v110, v111
v_mfma_f32_16x16x4_f32 v[84:87], v100, v103, v[84:87]
v_mfma_f32_16x16x4_f32 v[88:91], v101, v103, v[88:91]
v_mfma_f32_16x16x4_f32 v[92:95], v102, v103, v[92:95]
ds_read_b128 v[80:83], v2 offset:2880
s_waitcnt lgkmcnt(1)
v_pk_mul_f32 v[104:105], v[76:77], v[10:11]
v_pk_fma_f32 v[106:107], v[76:77], v[4:5], v[12:13]
v_pk_fma_f32 v[108:109], v[76:77], v[6:7], v[12:13]
v_pk_fma_f32 v[110:111], v[76:77], v[8:9], v[12:13]
v_fract_f32 v105, v105
v_fract_f32 v107, v107
v_fract_f32 v109, v109
v_fract_f32 v111, v111
v_exp_f32 v104, v104
v_cos_f32 v112, v105
v_sin_f32 v113, v105
v_exp_f32 v106, v106
v_cos_f32 v107, v107
v_exp_f32 v108, v108
v_cos_f32 v109, v109
v_exp_f32 v110, v110
v_cos_f32 v111, v111
v_mul_f32 v112, v78, v112
v_fmac_f32 v112, v79, v113
v_mul_f32 v99, v112, v104
v_mul_f32 v96, v106, v107
v_mul_f32 v97, v108, v109
v_mul_f32 v98, v110, v111
v_mfma_f32_16x16x4_f32 v[84:87], v96, v99, v[84:87]
v_mfma_f32_16x16x4_f32 v[88:91], v97, v99, v[88:91]
v_mfma_f32_16x16x4_f32 v[92:95], v98, v99, v[92:95]
ds_read_b128 v[76:79], v2 offset:2944
s_waitcnt lgkmcnt(1)
v_pk_mul_f32 v[104:105], v[80:81], v[10:11]
v_pk_fma_f32 v[106:107], v[80:81], v[4:5], v[12:13]
v_pk_fma_f32 v[108:109], v[80:81], v[6:7], v[12:13]
v_pk_fma_f32 v[110:111], v[80:81], v[8:9], v[12:13]
v_fract_f32 v105, v105
v_fract_f32 v107, v107
v_fract_f32 v109, v109
v_fract_f32 v111, v111
v_exp_f32 v104, v104
v_cos_f32 v112, v105
v_sin_f32 v113, v105
v_exp_f32 v106, v106
v_cos_f32 v107, v107
v_exp_f32 v108, v108
v_cos_f32 v109, v109
v_exp_f32 v110, v110
v_cos_f32 v111, v111
v_mul_f32 v112, v82, v112
v_fmac_f32 v112, v83, v113
v_mul_f32 v103, v112, v104
v_mul_f32 v100, v106, v107
v_mul_f32 v101, v108, v109
v_mul_f32 v102, v110, v111
v_mfma_f32_16x16x4_f32 v[84:87], v100, v103, v[84:87]
v_mfma_f32_16x16x4_f32 v[88:91], v101, v103, v[88:91]
v_mfma_f32_16x16x4_f32 v[92:95], v102, v103, v[92:95]
ds_read_b128 v[80:83], v2 offset:3008
s_waitcnt lgkmcnt(1)
v_pk_mul_f32 v[104:105], v[76:77], v[10:11]
v_pk_fma_f32 v[106:107], v[76:77], v[4:5], v[12:13]
v_pk_fma_f32 v[108:109], v[76:77], v[6:7], v[12:13]
v_pk_fma_f32 v[110:111], v[76:77], v[8:9], v[12:13]
v_fract_f32 v105, v105
v_fract_f32 v107, v107
v_fract_f32 v109, v109
v_fract_f32 v111, v111
v_exp_f32 v104, v104
v_cos_f32 v112, v105
v_sin_f32 v113, v105
v_exp_f32 v106, v106
v_cos_f32 v107, v107
v_exp_f32 v108, v108
v_cos_f32 v109, v109
v_exp_f32 v110, v110
v_cos_f32 v111, v111
v_mul_f32 v112, v78, v112
v_fmac_f32 v112, v79, v113
v_mul_f32 v99, v112, v104
v_mul_f32 v96, v106, v107
v_mul_f32 v97, v108, v109
v_mul_f32 v98, v110, v111
v_mfma_f32_16x16x4_f32 v[84:87], v96, v99, v[84:87]
v_mfma_f32_16x16x4_f32 v[88:91], v97, v99, v[88:91]
v_mfma_f32_16x16x4_f32 v[92:95], v98, v99, v[92:95]
ds_read_b128 v[76:79], v2 offset:3072
s_waitcnt lgkmcnt(1)
v_pk_mul_f32 v[104:105], v[80:81], v[10:11]
v_pk_fma_f32 v[106:107], v[80:81], v[4:5], v[12:13]
v_pk_fma_f32 v[108:109], v[80:81], v[6:7], v[12:13]
v_pk_fma_f32 v[110:111], v[80:81], v[8:9], v[12:13]
v_fract_f32 v105, v105
v_fract_f32 v107, v107
v_fract_f32 v109, v109
v_fract_f32 v111, v111
v_exp_f32 v104, v104
v_cos_f32 v112, v105
v_sin_f32 v113, v105
v_exp_f32 v106, v106
v_cos_f32 v107, v107
v_exp_f32 v108, v108
v_cos_f32 v109, v109
v_exp_f32 v110, v110
v_cos_f32 v111, v111
v_mul_f32 v112, v82, v112
v_fmac_f32 v112, v83, v113
v_mul_f32 v103, v112, v104
v_mul_f32 v100, v106, v107
v_mul_f32 v101, v108, v109
v_mul_f32 v102, v110, v111
v_mfma_f32_16x16x4_f32 v[84:87], v100, v103, v[84:87]
v_mfma_f32_16x16x4_f32 v[88:91], v101, v103, v[88:91]
v_mfma_f32_16x16x4_f32 v[92:95], v102, v103, v[92:95]
ds_read_b128 v[80:83], v2 offset:3136
s_waitcnt lgkmcnt(1)
v_pk_mul_f32 v[104:105], v[76:77], v[10:11]
v_pk_fma_f32 v[106:107], v[76:77], v[4:5], v[12:13]
v_pk_fma_f32 v[108:109], v[76:77], v[6:7], v[12:13]
v_pk_fma_f32 v[110:111], v[76:77], v[8:9], v[12:13]
v_fract_f32 v105, v105
v_fract_f32 v107, v107
v_fract_f32 v109, v109
v_fract_f32 v111, v111
v_exp_f32 v104, v104
v_cos_f32 v112, v105
v_sin_f32 v113, v105
v_exp_f32 v106, v106
v_cos_f32 v107, v107
v_exp_f32 v108, v108
v_cos_f32 v109, v109
v_exp_f32 v110, v110
v_cos_f32 v111, v111
v_mul_f32 v112, v78, v112
v_fmac_f32 v112, v79, v113
v_mul_f32 v99, v112, v104
v_mul_f32 v96, v106, v107
v_mul_f32 v97, v108, v109
v_mul_f32 v98, v110, v111
v_mfma_f32_16x16x4_f32 v[84:87], v96, v99, v[84:87]
v_mfma_f32_16x16x4_f32 v[88:91], v97, v99, v[88:91]
v_mfma_f32_16x16x4_f32 v[92:95], v98, v99, v[92:95]
ds_read_b128 v[76:79], v2 offset:3200
s_waitcnt lgkmcnt(1)
v_pk_mul_f32 v[104:105], v[80:81], v[10:11]
v_pk_fma_f32 v[106:107], v[80:81], v[4:5], v[12:13]
v_pk_fma_f32 v[108:109], v[80:81], v[6:7], v[12:13]
v_pk_fma_f32 v[110:111], v[80:81], v[8:9], v[12:13]
v_fract_f32 v105, v105
v_fract_f32 v107, v107
v_fract_f32 v109, v109
v_fract_f32 v111, v111
v_exp_f32 v104, v104
v_cos_f32 v112, v105
v_sin_f32 v113, v105
v_exp_f32 v106, v106
v_cos_f32 v107, v107
v_exp_f32 v108, v108
v_cos_f32 v109, v109
v_exp_f32 v110, v110
v_cos_f32 v111, v111
v_mul_f32 v112, v82, v112
v_fmac_f32 v112, v83, v113
v_mul_f32 v103, v112, v104
v_mul_f32 v100, v106, v107
v_mul_f32 v101, v108, v109
v_mul_f32 v102, v110, v111
v_mfma_f32_16x16x4_f32 v[84:87], v100, v103, v[84:87]
v_mfma_f32_16x16x4_f32 v[88:91], v101, v103, v[88:91]
v_mfma_f32_16x16x4_f32 v[92:95], v102, v103, v[92:95]
ds_read_b128 v[80:83], v2 offset:3264
s_waitcnt lgkmcnt(1)
v_pk_mul_f32 v[104:105], v[76:77], v[10:11]
v_pk_fma_f32 v[106:107], v[76:77], v[4:5], v[12:13]
v_pk_fma_f32 v[108:109], v[76:77], v[6:7], v[12:13]
v_pk_fma_f32 v[110:111], v[76:77], v[8:9], v[12:13]
v_fract_f32 v105, v105
v_fract_f32 v107, v107
v_fract_f32 v109, v109
v_fract_f32 v111, v111
v_exp_f32 v104, v104
v_cos_f32 v112, v105
v_sin_f32 v113, v105
v_exp_f32 v106, v106
v_cos_f32 v107, v107
v_exp_f32 v108, v108
v_cos_f32 v109, v109
v_exp_f32 v110, v110
v_cos_f32 v111, v111
v_mul_f32 v112, v78, v112
v_fmac_f32 v112, v79, v113
v_mul_f32 v99, v112, v104
v_mul_f32 v96, v106, v107
v_mul_f32 v97, v108, v109
v_mul_f32 v98, v110, v111
v_mfma_f32_16x16x4_f32 v[84:87], v96, v99, v[84:87]
v_mfma_f32_16x16x4_f32 v[88:91], v97, v99, v[88:91]
v_mfma_f32_16x16x4_f32 v[92:95], v98, v99, v[92:95]
ds_read_b128 v[76:79], v2 offset:3328
s_waitcnt lgkmcnt(1)
v_pk_mul_f32 v[104:105], v[80:81], v[10:11]
v_pk_fma_f32 v[106:107], v[80:81], v[4:5], v[12:13]
v_pk_fma_f32 v[108:109], v[80:81], v[6:7], v[12:13]
v_pk_fma_f32 v[110:111], v[80:81], v[8:9], v[12:13]
v_fract_f32 v105, v105
v_fract_f32 v107, v107
v_fract_f32 v109, v109
v_fract_f32 v111, v111
v_exp_f32 v104, v104
v_cos_f32 v112, v105
v_sin_f32 v113, v105
v_exp_f32 v106, v106
v_cos_f32 v107, v107
v_exp_f32 v108, v108
v_cos_f32 v109, v109
v_exp_f32 v110, v110
v_cos_f32 v111, v111
v_mul_f32 v112, v82, v112
v_fmac_f32 v112, v83, v113
v_mul_f32 v103, v112, v104
v_mul_f32 v100, v106, v107
v_mul_f32 v101, v108, v109
v_mul_f32 v102, v110, v111
v_mfma_f32_16x16x4_f32 v[84:87], v100, v103, v[84:87]
v_mfma_f32_16x16x4_f32 v[88:91], v101, v103, v[88:91]
v_mfma_f32_16x16x4_f32 v[92:95], v102, v103, v[92:95]
ds_read_b128 v[80:83], v2 offset:3392
s_waitcnt lgkmcnt(1)
v_pk_mul_f32 v[104:105], v[76:77], v[10:11]
v_pk_fma_f32 v[106:107], v[76:77], v[4:5], v[12:13]
v_pk_fma_f32 v[108:109], v[76:77], v[6:7], v[12:13]
v_pk_fma_f32 v[110:111], v[76:77], v[8:9], v[12:13]
v_fract_f32 v105, v105
v_fract_f32 v107, v107
v_fract_f32 v109, v109
v_fract_f32 v111, v111
v_exp_f32 v104, v104
v_cos_f32 v112, v105
v_sin_f32 v113, v105
v_exp_f32 v106, v106
v_cos_f32 v107, v107
v_exp_f32 v108, v108
v_cos_f32 v109, v109
v_exp_f32 v110, v110
v_cos_f32 v111, v111
v_mul_f32 v112, v78, v112
v_fmac_f32 v112, v79, v113
v_mul_f32 v99, v112, v104
v_mul_f32 v96, v106, v107
v_mul_f32 v97, v108, v109
v_mul_f32 v98, v110, v111
v_mfma_f32_16x16x4_f32 v[84:87], v96, v99, v[84:87]
v_mfma_f32_16x16x4_f32 v[88:91], v97, v99, v[88:91]
v_mfma_f32_16x16x4_f32 v[92:95], v98, v99, v[92:95]
ds_read_b128 v[76:79], v2 offset:3456
s_waitcnt lgkmcnt(1)
v_pk_mul_f32 v[104:105], v[80:81], v[10:11]
v_pk_fma_f32 v[106:107], v[80:81], v[4:5], v[12:13]
v_pk_fma_f32 v[108:109], v[80:81], v[6:7], v[12:13]
v_pk_fma_f32 v[110:111], v[80:81], v[8:9], v[12:13]
v_fract_f32 v105, v105
v_fract_f32 v107, v107
v_fract_f32 v109, v109
v_fract_f32 v111, v111
v_exp_f32 v104, v104
v_cos_f32 v112, v105
v_sin_f32 v113, v105
v_exp_f32 v106, v106
v_cos_f32 v107, v107
v_exp_f32 v108, v108
v_cos_f32 v109, v109
v_exp_f32 v110, v110
v_cos_f32 v111, v111
v_mul_f32 v112, v82, v112
v_fmac_f32 v112, v83, v113
v_mul_f32 v103, v112, v104
v_mul_f32 v100, v106, v107
v_mul_f32 v101, v108, v109
v_mul_f32 v102, v110, v111
v_mfma_f32_16x16x4_f32 v[84:87], v100, v103, v[84:87]
v_mfma_f32_16x16x4_f32 v[88:91], v101, v103, v[88:91]
v_mfma_f32_16x16x4_f32 v[92:95], v102, v103, v[92:95]
ds_read_b128 v[80:83], v2 offset:3520
s_waitcnt lgkmcnt(1)
v_pk_mul_f32 v[104:105], v[76:77], v[10:11]
v_pk_fma_f32 v[106:107], v[76:77], v[4:5], v[12:13]
v_pk_fma_f32 v[108:109], v[76:77], v[6:7], v[12:13]
v_pk_fma_f32 v[110:111], v[76:77], v[8:9], v[12:13]
v_fract_f32 v105, v105
v_fract_f32 v107, v107
v_fract_f32 v109, v109
v_fract_f32 v111, v111
v_exp_f32 v104, v104
v_cos_f32 v112, v105
v_sin_f32 v113, v105
v_exp_f32 v106, v106
v_cos_f32 v107, v107
v_exp_f32 v108, v108
v_cos_f32 v109, v109
v_exp_f32 v110, v110
v_cos_f32 v111, v111
v_mul_f32 v112, v78, v112
v_fmac_f32 v112, v79, v113
v_mul_f32 v99, v112, v104
v_mul_f32 v96, v106, v107
v_mul_f32 v97, v108, v109
v_mul_f32 v98, v110, v111
v_mfma_f32_16x16x4_f32 v[84:87], v96, v99, v[84:87]
v_mfma_f32_16x16x4_f32 v[88:91], v97, v99, v[88:91]
v_mfma_f32_16x16x4_f32 v[92:95], v98, v99, v[92:95]
ds_read_b128 v[76:79], v2 offset:3584
s_waitcnt lgkmcnt(1)
v_pk_mul_f32 v[104:105], v[80:81], v[10:11]
v_pk_fma_f32 v[106:107], v[80:81], v[4:5], v[12:13]
v_pk_fma_f32 v[108:109], v[80:81], v[6:7], v[12:13]
v_pk_fma_f32 v[110:111], v[80:81], v[8:9], v[12:13]
v_fract_f32 v105, v105
v_fract_f32 v107, v107
v_fract_f32 v109, v109
v_fract_f32 v111, v111
v_exp_f32 v104, v104
v_cos_f32 v112, v105
v_sin_f32 v113, v105
v_exp_f32 v106, v106
v_cos_f32 v107, v107
v_exp_f32 v108, v108
v_cos_f32 v109, v109
v_exp_f32 v110, v110
v_cos_f32 v111, v111
v_mul_f32 v112, v82, v112
v_fmac_f32 v112, v83, v113
v_mul_f32 v103, v112, v104
v_mul_f32 v100, v106, v107
v_mul_f32 v101, v108, v109
v_mul_f32 v102, v110, v111
v_mfma_f32_16x16x4_f32 v[84:87], v100, v103, v[84:87]
v_mfma_f32_16x16x4_f32 v[88:91], v101, v103, v[88:91]
v_mfma_f32_16x16x4_f32 v[92:95], v102, v103, v[92:95]
ds_read_b128 v[80:83], v2 offset:3648
s_waitcnt lgkmcnt(1)
v_pk_mul_f32 v[104:105], v[76:77], v[10:11]
v_pk_fma_f32 v[106:107], v[76:77], v[4:5], v[12:13]
v_pk_fma_f32 v[108:109], v[76:77], v[6:7], v[12:13]
v_pk_fma_f32 v[110:111], v[76:77], v[8:9], v[12:13]
v_fract_f32 v105, v105
v_fract_f32 v107, v107
v_fract_f32 v109, v109
v_fract_f32 v111, v111
v_exp_f32 v104, v104
v_cos_f32 v112, v105
v_sin_f32 v113, v105
v_exp_f32 v106, v106
v_cos_f32 v107, v107
v_exp_f32 v108, v108
v_cos_f32 v109, v109
v_exp_f32 v110, v110
v_cos_f32 v111, v111
v_mul_f32 v112, v78, v112
v_fmac_f32 v112, v79, v113
v_mul_f32 v99, v112, v104
v_mul_f32 v96, v106, v107
v_mul_f32 v97, v108, v109
v_mul_f32 v98, v110, v111
v_mfma_f32_16x16x4_f32 v[84:87], v96, v99, v[84:87]
v_mfma_f32_16x16x4_f32 v[88:91], v97, v99, v[88:91]
v_mfma_f32_16x16x4_f32 v[92:95], v98, v99, v[92:95]
ds_read_b128 v[76:79], v2 offset:3712
s_waitcnt lgkmcnt(1)
v_pk_mul_f32 v[104:105], v[80:81], v[10:11]
v_pk_fma_f32 v[106:107], v[80:81], v[4:5], v[12:13]
v_pk_fma_f32 v[108:109], v[80:81], v[6:7], v[12:13]
v_pk_fma_f32 v[110:111], v[80:81], v[8:9], v[12:13]
v_fract_f32 v105, v105
v_fract_f32 v107, v107
v_fract_f32 v109, v109
v_fract_f32 v111, v111
v_exp_f32 v104, v104
v_cos_f32 v112, v105
v_sin_f32 v113, v105
v_exp_f32 v106, v106
v_cos_f32 v107, v107
v_exp_f32 v108, v108
v_cos_f32 v109, v109
v_exp_f32 v110, v110
v_cos_f32 v111, v111
v_mul_f32 v112, v82, v112
v_fmac_f32 v112, v83, v113
v_mul_f32 v103, v112, v104
v_mul_f32 v100, v106, v107
v_mul_f32 v101, v108, v109
v_mul_f32 v102, v110, v111
v_mfma_f32_16x16x4_f32 v[84:87], v100, v103, v[84:87]
v_mfma_f32_16x16x4_f32 v[88:91], v101, v103, v[88:91]
v_mfma_f32_16x16x4_f32 v[92:95], v102, v103, v[92:95]
ds_read_b128 v[80:83], v2 offset:3776
s_waitcnt lgkmcnt(1)
v_pk_mul_f32 v[104:105], v[76:77], v[10:11]
v_pk_fma_f32 v[106:107], v[76:77], v[4:5], v[12:13]
v_pk_fma_f32 v[108:109], v[76:77], v[6:7], v[12:13]
v_pk_fma_f32 v[110:111], v[76:77], v[8:9], v[12:13]
v_fract_f32 v105, v105
v_fract_f32 v107, v107
v_fract_f32 v109, v109
v_fract_f32 v111, v111
v_exp_f32 v104, v104
v_cos_f32 v112, v105
v_sin_f32 v113, v105
v_exp_f32 v106, v106
v_cos_f32 v107, v107
v_exp_f32 v108, v108
v_cos_f32 v109, v109
v_exp_f32 v110, v110
v_cos_f32 v111, v111
v_mul_f32 v112, v78, v112
v_fmac_f32 v112, v79, v113
v_mul_f32 v99, v112, v104
v_mul_f32 v96, v106, v107
v_mul_f32 v97, v108, v109
v_mul_f32 v98, v110, v111
v_mfma_f32_16x16x4_f32 v[84:87], v96, v99, v[84:87]
v_mfma_f32_16x16x4_f32 v[88:91], v97, v99, v[88:91]
v_mfma_f32_16x16x4_f32 v[92:95], v98, v99, v[92:95]
ds_read_b128 v[76:79], v2 offset:3840
s_waitcnt lgkmcnt(1)
v_pk_mul_f32 v[104:105], v[80:81], v[10:11]
v_pk_fma_f32 v[106:107], v[80:81], v[4:5], v[12:13]
v_pk_fma_f32 v[108:109], v[80:81], v[6:7], v[12:13]
v_pk_fma_f32 v[110:111], v[80:81], v[8:9], v[12:13]
v_fract_f32 v105, v105
v_fract_f32 v107, v107
v_fract_f32 v109, v109
v_fract_f32 v111, v111
v_exp_f32 v104, v104
v_cos_f32 v112, v105
v_sin_f32 v113, v105
v_exp_f32 v106, v106
v_cos_f32 v107, v107
v_exp_f32 v108, v108
v_cos_f32 v109, v109
v_exp_f32 v110, v110
v_cos_f32 v111, v111
v_mul_f32 v112, v82, v112
v_fmac_f32 v112, v83, v113
v_mul_f32 v103, v112, v104
v_mul_f32 v100, v106, v107
v_mul_f32 v101, v108, v109
v_mul_f32 v102, v110, v111
v_mfma_f32_16x16x4_f32 v[84:87], v100, v103, v[84:87]
v_mfma_f32_16x16x4_f32 v[88:91], v101, v103, v[88:91]
v_mfma_f32_16x16x4_f32 v[92:95], v102, v103, v[92:95]
ds_read_b128 v[80:83], v2 offset:3904
s_waitcnt lgkmcnt(1)
v_pk_mul_f32 v[104:105], v[76:77], v[10:11]
v_pk_fma_f32 v[106:107], v[76:77], v[4:5], v[12:13]
v_pk_fma_f32 v[108:109], v[76:77], v[6:7], v[12:13]
v_pk_fma_f32 v[110:111], v[76:77], v[8:9], v[12:13]
v_fract_f32 v105, v105
v_fract_f32 v107, v107
v_fract_f32 v109, v109
v_fract_f32 v111, v111
v_exp_f32 v104, v104
v_cos_f32 v112, v105
v_sin_f32 v113, v105
v_exp_f32 v106, v106
v_cos_f32 v107, v107
v_exp_f32 v108, v108
v_cos_f32 v109, v109
v_exp_f32 v110, v110
v_cos_f32 v111, v111
v_mul_f32 v112, v78, v112
v_fmac_f32 v112, v79, v113
v_mul_f32 v99, v112, v104
v_mul_f32 v96, v106, v107
v_mul_f32 v97, v108, v109
v_mul_f32 v98, v110, v111
v_mfma_f32_16x16x4_f32 v[84:87], v96, v99, v[84:87]
v_mfma_f32_16x16x4_f32 v[88:91], v97, v99, v[88:91]
v_mfma_f32_16x16x4_f32 v[92:95], v98, v99, v[92:95]
ds_read_b128 v[76:79], v2 offset:3968
s_waitcnt lgkmcnt(1)
v_pk_mul_f32 v[104:105], v[80:81], v[10:11]
v_pk_fma_f32 v[106:107], v[80:81], v[4:5], v[12:13]
v_pk_fma_f32 v[108:109], v[80:81], v[6:7], v[12:13]
v_pk_fma_f32 v[110:111], v[80:81], v[8:9], v[12:13]
v_fract_f32 v105, v105
v_fract_f32 v107, v107
v_fract_f32 v109, v109
v_fract_f32 v111, v111
v_exp_f32 v104, v104
v_cos_f32 v112, v105
v_sin_f32 v113, v105
v_exp_f32 v106, v106
v_cos_f32 v107, v107
v_exp_f32 v108, v108
v_cos_f32 v109, v109
v_exp_f32 v110, v110
v_cos_f32 v111, v111
v_mul_f32 v112, v82, v112
v_fmac_f32 v112, v83, v113
v_mul_f32 v103, v112, v104
v_mul_f32 v100, v106, v107
v_mul_f32 v101, v108, v109
v_mul_f32 v102, v110, v111
v_mfma_f32_16x16x4_f32 v[84:87], v100, v103, v[84:87]
v_mfma_f32_16x16x4_f32 v[88:91], v101, v103, v[88:91]
v_mfma_f32_16x16x4_f32 v[92:95], v102, v103, v[92:95]
ds_read_b128 v[80:83], v2 offset:4032
s_waitcnt lgkmcnt(1)
v_pk_mul_f32 v[104:105], v[76:77], v[10:11]
v_pk_fma_f32 v[106:107], v[76:77], v[4:5], v[12:13]
v_pk_fma_f32 v[108:109], v[76:77], v[6:7], v[12:13]
v_pk_fma_f32 v[110:111], v[76:77], v[8:9], v[12:13]
v_fract_f32 v105, v105
v_fract_f32 v107, v107
v_fract_f32 v109, v109
v_fract_f32 v111, v111
v_exp_f32 v104, v104
v_cos_f32 v112, v105
v_sin_f32 v113, v105
v_exp_f32 v106, v106
v_cos_f32 v107, v107
v_exp_f32 v108, v108
v_cos_f32 v109, v109
v_exp_f32 v110, v110
v_cos_f32 v111, v111
v_mul_f32 v112, v78, v112
v_fmac_f32 v112, v79, v113
v_mul_f32 v99, v112, v104
v_mul_f32 v96, v106, v107
v_mul_f32 v97, v108, v109
v_mul_f32 v98, v110, v111
v_mfma_f32_16x16x4_f32 v[84:87], v96, v99, v[84:87]
v_mfma_f32_16x16x4_f32 v[88:91], v97, v99, v[88:91]
v_mfma_f32_16x16x4_f32 v[92:95], v98, v99, v[92:95]
s_waitcnt lgkmcnt(0)
v_pk_mul_f32 v[104:105], v[80:81], v[10:11]
v_pk_fma_f32 v[106:107], v[80:81], v[4:5], v[12:13]
v_pk_fma_f32 v[108:109], v[80:81], v[6:7], v[12:13]
v_pk_fma_f32 v[110:111], v[80:81], v[8:9], v[12:13]
v_fract_f32 v105, v105
v_fract_f32 v107, v107
v_fract_f32 v109, v109
v_fract_f32 v111, v111
v_exp_f32 v104, v104
v_cos_f32 v112, v105
v_sin_f32 v113, v105
v_exp_f32 v106, v106
v_cos_f32 v107, v107
v_exp_f32 v108, v108
v_cos_f32 v109, v109
v_exp_f32 v110, v110
v_cos_f32 v111, v111
v_mul_f32 v112, v82, v112
v_fmac_f32 v112, v83, v113
v_mul_f32 v103, v112, v104
v_mul_f32 v100, v106, v107
v_mul_f32 v101, v108, v109
v_mul_f32 v102, v110, v111
v_mfma_f32_16x16x4_f32 v[84:87], v100, v103, v[84:87]
v_mfma_f32_16x16x4_f32 v[88:91], v101, v103, v[88:91]
v_mfma_f32_16x16x4_f32 v[92:95], v102, v103, v[92:95]
s_nop 7
v_cvt_pk_bf16_f32 v104, v84, v85
ds_write_b16 v14, v104 offset:0
ds_write_b16_d16_hi v14, v104 offset:32
v_cvt_pk_bf16_f32 v105, v86, v87
ds_write_b16 v14, v105 offset:64
ds_write_b16_d16_hi v14, v105 offset:96
v_cvt_pk_bf16_f32 v104, v88, v89
ds_write_b16 v14, v104 offset:512
ds_write_b16_d16_hi v14, v104 offset:544
v_cvt_pk_bf16_f32 v105, v90, v91
ds_write_b16 v14, v105 offset:576
ds_write_b16_d16_hi v14, v105 offset:608
v_cvt_pk_bf16_f32 v104, v92, v93
ds_write_b16 v14, v104 offset:1024
ds_write_b16_d16_hi v14, v104 offset:1056
v_cvt_pk_bf16_f32 v105, v94, v95
ds_write_b16 v14, v105 offset:1088
ds_write_b16_d16_hi v14, v105 offset:1120
s_waitcnt lgkmcnt(0)
ds_read_u16 v120, v36
ds_read_u16 v121, v37
ds_read_u16 v122, v38
ds_read_u16 v123, v39
ds_read_u16 v124, v40
ds_read_u16 v125, v41
ds_read_u16 v126, v42
ds_read_u16 v127, v43
ds_read_u16 v128, v44
ds_read_u16 v129, v45
ds_read_u16 v130, v46
ds_read_u16 v131, v47
s_waitcnt lgkmcnt(0)
ds_read_u16 v132, v48
ds_read_u16 v133, v49
ds_read_u16 v134, v50
ds_read_u16 v135, v51
ds_read_u16 v136, v52
ds_read_u16 v137, v53
ds_read_u16 v138, v54
ds_read_u16 v139, v55
ds_read_u16 v140, v56
ds_read_u16 v141, v57
ds_read_u16 v142, v58
ds_read_u16 v143, v59
s_waitcnt lgkmcnt(0)
ds_read_u16 v144, v60
ds_read_u16 v145, v61
ds_read_u16 v146, v62
ds_read_u16 v147, v63
ds_read_u16 v148, v64
ds_read_u16 v149, v65
ds_read_u16 v150, v66
ds_read_u16 v151, v67
ds_read_u16 v152, v68
ds_read_u16 v153, v69
ds_read_u16 v154, v70
ds_read_u16 v155, v71
s_waitcnt lgkmcnt(0)
ds_read_u16 v156, v72
ds_read_u16 v157, v73
ds_read_u16 v158, v74
ds_read_u16 v159, v75
s_waitcnt lgkmcnt(0)
v_lshl_or_b32 v160, v121, 16, v120
v_lshl_or_b32 v161, v123, 16, v122
v_lshl_or_b32 v162, v125, 16, v124
v_lshl_or_b32 v163, v127, 16, v126
v_lshl_or_b32 v164, v129, 16, v128
v_lshl_or_b32 v165, v131, 16, v130
v_lshl_or_b32 v166, v133, 16, v132
v_lshl_or_b32 v167, v135, 16, v134
v_lshl_or_b32 v168, v137, 16, v136
v_lshl_or_b32 v169, v139, 16, v138
v_lshl_or_b32 v170, v141, 16, v140
v_lshl_or_b32 v171, v143, 16, v142
v_lshl_or_b32 v172, v145, 16, v144
v_lshl_or_b32 v173, v147, 16, v146
v_lshl_or_b32 v174, v149, 16, v148
v_lshl_or_b32 v175, v151, 16, v150
v_lshl_or_b32 v176, v153, 16, v152
v_lshl_or_b32 v177, v155, 16, v154
v_lshl_or_b32 v178, v157, 16, v156
v_lshl_or_b32 v179, v159, 16, v158
v_mov_b32 v182, v161
v_mov_b32 v183, v162
v_mov_b32 v184, v163
v_mov_b32 v185, v164
v_mov_b32 v186, v165
v_mov_b32 v187, v166
v_mov_b32 v188, v167
v_mov_b32 v189, v168
v_mov_b32 v190, v169
v_mov_b32 v191, v170
v_mov_b32 v192, v171
v_mov_b32 v193, v172
v_mov_b32 v194, v173
v_mov_b32 v195, v174
v_mov_b32 v196, v175
v_mov_b32 v197, v176
v_mov_b32 v198, v177
v_mov_b32 v199, v178
v_mov_b32 v200, v179
v_alignbit_b32 v204, v161, v160, 16
v_alignbit_b32 v205, v162, v161, 16
v_alignbit_b32 v206, v163, v162, 16
v_alignbit_b32 v207, v164, v163, 16
v_alignbit_b32 v208, v165, v164, 16
v_alignbit_b32 v209, v166, v165, 16
v_alignbit_b32 v210, v167, v166, 16
v_alignbit_b32 v211, v168, v167, 16
v_alignbit_b32 v212, v169, v168, 16
v_alignbit_b32 v213, v170, v169, 16
v_alignbit_b32 v214, v171, v170, 16
v_alignbit_b32 v215, v172, v171, 16
v_alignbit_b32 v216, v173, v172, 16
v_alignbit_b32 v217, v174, v173, 16
v_alignbit_b32 v218, v175, v174, 16
v_alignbit_b32 v219, v176, v175, 16
v_alignbit_b32 v220, v177, v176, 16
v_alignbit_b32 v221, v178, v177, 16
v_alignbit_b32 v222, v179, v178, 16
v_mov_b32 v226, v205
v_mov_b32 v227, v206
v_mov_b32 v228, v207
v_mov_b32 v229, v208
v_mov_b32 v230, v209
v_mov_b32 v231, v210
v_mov_b32 v232, v211
v_mov_b32 v233, v212
v_mov_b32 v234, v213
v_mov_b32 v235, v214
v_mov_b32 v236, v215
v_mov_b32 v237, v216
v_mov_b32 v238, v217
v_mov_b32 v239, v218
v_mov_b32 v240, v219
v_mov_b32 v241, v220
v_mov_b32 v242, v221
v_mov_b32 v243, v222
ds_write_b128 v21, v[164:167] offset:0
ds_write_b128 v21, v[168:171] offset:16
ds_write_b128 v21, v[172:175] offset:32
ds_write_b128 v21, v[176:179] offset:48
ds_write_b128 v21, v[228:231] offset:4160
ds_write_b128 v21, v[232:235] offset:4176
ds_write_b128 v21, v[236:239] offset:4192
ds_write_b128 v21, v[240:243] offset:4208
ds_write_b128 v21, v[184:187] offset:8320
ds_write_b128 v21, v[188:191] offset:8336
ds_write_b128 v21, v[192:195] offset:8352
ds_write_b128 v21, v[196:199] offset:8368
ds_write_b128 v21, v[206:209] offset:12480
ds_write_b128 v21, v[210:213] offset:12496
ds_write_b128 v21, v[214:217] offset:12512
ds_write_b128 v21, v[218:221] offset:12528
ds_write_b128 v21, v[162:165] offset:16640
ds_write_b128 v21, v[166:169] offset:16656
ds_write_b128 v21, v[170:173] offset:16672
ds_write_b128 v21, v[174:177] offset:16688
ds_write_b128 v21, v[226:229] offset:20800
ds_write_b128 v21, v[230:233] offset:20816
ds_write_b128 v21, v[234:237] offset:20832
ds_write_b128 v21, v[238:241] offset:20848
ds_write_b128 v21, v[182:185] offset:24960
ds_write_b128 v21, v[186:189] offset:24976
ds_write_b128 v21, v[190:193] offset:24992
ds_write_b128 v21, v[194:197] offset:25008
ds_write_b128 v21, v[204:207] offset:29120
ds_write_b128 v21, v[208:211] offset:29136
ds_write_b128 v21, v[212:215] offset:29152
ds_write_b128 v21, v[216:219] offset:29168
s_waitcnt lgkmcnt(0)
s_barrier
ds_read_b128 v[128:131], v15 offset:4032
ds_read_b128 v[136:139], v15 offset:1984
ds_read_b128 v[160:163], v16 offset:1984
ds_read_b128 v[168:171], v16 offset:4032
ds_read_b128 v[132:135], v15 offset:4064
ds_read_b128 v[140:143], v15 offset:2016
ds_read_b128 v[164:167], v16 offset:2016
ds_read_b128 v[172:175], v16 offset:4064
ds_read_b128 v[144:147], v15 offset:3968
ds_read_b128 v[152:155], v15 offset:1920
ds_read_b128 v[176:179], v16 offset:1920
ds_read_b128 v[184:187], v16 offset:3968
ds_read_b128 v[148:151], v15 offset:4000
ds_read_b128 v[156:159], v15 offset:1952
ds_read_b128 v[180:183], v16 offset:1952
ds_read_b128 v[188:191], v16 offset:4000
s_waitcnt lgkmcnt(8)
v_mfma_f32_32x32x16_bf16 v[96:111], v[128:131], v[160:163], 0
v_mfma_f32_32x32x16_bf16 v[112:127], v[136:139], v[160:163], 0
v_mfma_f32_32x32x16_bf16 v[112:127], v[128:131], v[168:171], v[112:127]
v_mfma_f32_32x32x16_bf16 v[96:111], v[132:135], v[164:167], v[96:111]
v_mfma_f32_32x32x16_bf16 v[112:127], v[140:143], v[164:167], v[112:127]
v_mfma_f32_32x32x16_bf16 v[112:127], v[132:135], v[172:175], v[112:127]
ds_read_b128 v[128:131], v15 offset:3904
ds_read_b128 v[136:139], v15 offset:1856
ds_read_b128 v[160:163], v16 offset:1856
ds_read_b128 v[168:171], v16 offset:3904
ds_read_b128 v[132:135], v15 offset:3936
ds_read_b128 v[140:143], v15 offset:1888
ds_read_b128 v[164:167], v16 offset:1888
ds_read_b128 v[172:175], v16 offset:3936
s_waitcnt lgkmcnt(8)
v_mfma_f32_32x32x16_bf16 v[96:111], v[144:147], v[176:179], v[96:111]
v_mfma_f32_32x32x16_bf16 v[112:127], v[152:155], v[176:179], v[112:127]
v_mfma_f32_32x32x16_bf16 v[112:127], v[144:147], v[184:187], v[112:127]
v_mfma_f32_32x32x16_bf16 v[96:111], v[148:151], v[180:183], v[96:111]
v_mfma_f32_32x32x16_bf16 v[112:127], v[156:159], v[180:183], v[112:127]
v_mfma_f32_32x32x16_bf16 v[112:127], v[148:151], v[188:191], v[112:127]
ds_read_b128 v[144:147], v15 offset:3840
ds_read_b128 v[152:155], v15 offset:1792
ds_read_b128 v[176:179], v16 offset:1792
ds_read_b128 v[184:187], v16 offset:3840
ds_read_b128 v[148:151], v15 offset:3872
ds_read_b128 v[156:159], v15 offset:1824
ds_read_b128 v[180:183], v16 offset:1824
ds_read_b128 v[188:191], v16 offset:3872
s_waitcnt lgkmcnt(8)
v_mfma_f32_32x32x16_bf16 v[96:111], v[128:131], v[160:163], v[96:111]
v_mfma_f32_32x32x16_bf16 v[112:127], v[136:139], v[160:163], v[112:127]
v_mfma_f32_32x32x16_bf16 v[112:127], v[128:131], v[168:171], v[112:127]
v_mfma_f32_32x32x16_bf16 v[96:111], v[132:135], v[164:167], v[96:111]
v_mfma_f32_32x32x16_bf16 v[112:127], v[140:143], v[164:167], v[112:127]
v_mfma_f32_32x32x16_bf16 v[112:127], v[132:135], v[172:175], v[112:127]
ds_read_b128 v[128:131], v15 offset:3776
ds_read_b128 v[136:139], v15 offset:1728
ds_read_b128 v[160:163], v16 offset:1728
ds_read_b128 v[168:171], v16 offset:3776
ds_read_b128 v[132:135], v15 offset:3808
ds_read_b128 v[140:143], v15 offset:1760
ds_read_b128 v[164:167], v16 offset:1760
ds_read_b128 v[172:175], v16 offset:3808
s_waitcnt lgkmcnt(8)
v_mfma_f32_32x32x16_bf16 v[96:111], v[144:147], v[176:179], v[96:111]
v_mfma_f32_32x32x16_bf16 v[112:127], v[152:155], v[176:179], v[112:127]
v_mfma_f32_32x32x16_bf16 v[112:127], v[144:147], v[184:187], v[112:127]
v_mfma_f32_32x32x16_bf16 v[96:111], v[148:151], v[180:183], v[96:111]
v_mfma_f32_32x32x16_bf16 v[112:127], v[156:159], v[180:183], v[112:127]
v_mfma_f32_32x32x16_bf16 v[112:127], v[148:151], v[188:191], v[112:127]
ds_read_b128 v[144:147], v15 offset:3712
ds_read_b128 v[152:155], v15 offset:1664
ds_read_b128 v[176:179], v16 offset:1664
ds_read_b128 v[184:187], v16 offset:3712
ds_read_b128 v[148:151], v15 offset:3744
ds_read_b128 v[156:159], v15 offset:1696
ds_read_b128 v[180:183], v16 offset:1696
ds_read_b128 v[188:191], v16 offset:3744
s_waitcnt lgkmcnt(8)
v_mfma_f32_32x32x16_bf16 v[96:111], v[128:131], v[160:163], v[96:111]
v_mfma_f32_32x32x16_bf16 v[112:127], v[136:139], v[160:163], v[112:127]
v_mfma_f32_32x32x16_bf16 v[112:127], v[128:131], v[168:171], v[112:127]
v_mfma_f32_32x32x16_bf16 v[96:111], v[132:135], v[164:167], v[96:111]
v_mfma_f32_32x32x16_bf16 v[112:127], v[140:143], v[164:167], v[112:127]
v_mfma_f32_32x32x16_bf16 v[112:127], v[132:135], v[172:175], v[112:127]
ds_read_b128 v[128:131], v15 offset:3648
ds_read_b128 v[136:139], v15 offset:1600
ds_read_b128 v[160:163], v16 offset:1600
ds_read_b128 v[168:171], v16 offset:3648
ds_read_b128 v[132:135], v15 offset:3680
ds_read_b128 v[140:143], v15 offset:1632
ds_read_b128 v[164:167], v16 offset:1632
ds_read_b128 v[172:175], v16 offset:3680
s_waitcnt lgkmcnt(8)
v_mfma_f32_32x32x16_bf16 v[96:111], v[144:147], v[176:179], v[96:111]
v_mfma_f32_32x32x16_bf16 v[112:127], v[152:155], v[176:179], v[112:127]
v_mfma_f32_32x32x16_bf16 v[112:127], v[144:147], v[184:187], v[112:127]
v_mfma_f32_32x32x16_bf16 v[96:111], v[148:151], v[180:183], v[96:111]
v_mfma_f32_32x32x16_bf16 v[112:127], v[156:159], v[180:183], v[112:127]
v_mfma_f32_32x32x16_bf16 v[112:127], v[148:151], v[188:191], v[112:127]
ds_read_b128 v[144:147], v15 offset:3584
ds_read_b128 v[152:155], v15 offset:1536
ds_read_b128 v[176:179], v16 offset:1536
ds_read_b128 v[184:187], v16 offset:3584
ds_read_b128 v[148:151], v15 offset:3616
ds_read_b128 v[156:159], v15 offset:1568
ds_read_b128 v[180:183], v16 offset:1568
ds_read_b128 v[188:191], v16 offset:3616
s_waitcnt lgkmcnt(8)
v_mfma_f32_32x32x16_bf16 v[96:111], v[128:131], v[160:163], v[96:111]
v_mfma_f32_32x32x16_bf16 v[112:127], v[136:139], v[160:163], v[112:127]
v_mfma_f32_32x32x16_bf16 v[112:127], v[128:131], v[168:171], v[112:127]
v_mfma_f32_32x32x16_bf16 v[96:111], v[132:135], v[164:167], v[96:111]
v_mfma_f32_32x32x16_bf16 v[112:127], v[140:143], v[164:167], v[112:127]
v_mfma_f32_32x32x16_bf16 v[112:127], v[132:135], v[172:175], v[112:127]
ds_read_b128 v[128:131], v15 offset:3520
ds_read_b128 v[136:139], v15 offset:1472
ds_read_b128 v[160:163], v16 offset:1472
ds_read_b128 v[168:171], v16 offset:3520
ds_read_b128 v[132:135], v15 offset:3552
ds_read_b128 v[140:143], v15 offset:1504
ds_read_b128 v[164:167], v16 offset:1504
ds_read_b128 v[172:175], v16 offset:3552
s_waitcnt lgkmcnt(8)
v_mfma_f32_32x32x16_bf16 v[96:111], v[144:147], v[176:179], v[96:111]
v_mfma_f32_32x32x16_bf16 v[112:127], v[152:155], v[176:179], v[112:127]
v_mfma_f32_32x32x16_bf16 v[112:127], v[144:147], v[184:187], v[112:127]
v_mfma_f32_32x32x16_bf16 v[96:111], v[148:151], v[180:183], v[96:111]
v_mfma_f32_32x32x16_bf16 v[112:127], v[156:159], v[180:183], v[112:127]
v_mfma_f32_32x32x16_bf16 v[112:127], v[148:151], v[188:191], v[112:127]
ds_read_b128 v[144:147], v15 offset:3456
ds_read_b128 v[152:155], v15 offset:1408
ds_read_b128 v[176:179], v16 offset:1408
ds_read_b128 v[184:187], v16 offset:3456
ds_read_b128 v[148:151], v15 offset:3488
ds_read_b128 v[156:159], v15 offset:1440
ds_read_b128 v[180:183], v16 offset:1440
ds_read_b128 v[188:191], v16 offset:3488
s_waitcnt lgkmcnt(8)
v_mfma_f32_32x32x16_bf16 v[96:111], v[128:131], v[160:163], v[96:111]
v_mfma_f32_32x32x16_bf16 v[112:127], v[136:139], v[160:163], v[112:127]
v_mfma_f32_32x32x16_bf16 v[112:127], v[128:131], v[168:171], v[112:127]
v_mfma_f32_32x32x16_bf16 v[96:111], v[132:135], v[164:167], v[96:111]
v_mfma_f32_32x32x16_bf16 v[112:127], v[140:143], v[164:167], v[112:127]
v_mfma_f32_32x32x16_bf16 v[112:127], v[132:135], v[172:175], v[112:127]
ds_read_b128 v[128:131], v15 offset:3392
ds_read_b128 v[136:139], v15 offset:1344
ds_read_b128 v[160:163], v16 offset:1344
ds_read_b128 v[168:171], v16 offset:3392
ds_read_b128 v[132:135], v15 offset:3424
ds_read_b128 v[140:143], v15 offset:1376
ds_read_b128 v[164:167], v16 offset:1376
ds_read_b128 v[172:175], v16 offset:3424
s_waitcnt lgkmcnt(8)
v_mfma_f32_32x32x16_bf16 v[96:111], v[144:147], v[176:179], v[96:111]
v_mfma_f32_32x32x16_bf16 v[112:127], v[152:155], v[176:179], v[112:127]
v_mfma_f32_32x32x16_bf16 v[112:127], v[144:147], v[184:187], v[112:127]
v_mfma_f32_32x32x16_bf16 v[96:111], v[148:151], v[180:183], v[96:111]
v_mfma_f32_32x32x16_bf16 v[112:127], v[156:159], v[180:183], v[112:127]
v_mfma_f32_32x32x16_bf16 v[112:127], v[148:151], v[188:191], v[112:127]
ds_read_b128 v[144:147], v15 offset:3328
ds_read_b128 v[152:155], v15 offset:1280
ds_read_b128 v[176:179], v16 offset:1280
ds_read_b128 v[184:187], v16 offset:3328
ds_read_b128 v[148:151], v15 offset:3360
ds_read_b128 v[156:159], v15 offset:1312
ds_read_b128 v[180:183], v16 offset:1312
ds_read_b128 v[188:191], v16 offset:3360
s_waitcnt lgkmcnt(8)
v_mfma_f32_32x32x16_bf16 v[96:111], v[128:131], v[160:163], v[96:111]
v_mfma_f32_32x32x16_bf16 v[112:127], v[136:139], v[160:163], v[112:127]
v_mfma_f32_32x32x16_bf16 v[112:127], v[128:131], v[168:171], v[112:127]
v_mfma_f32_32x32x16_bf16 v[96:111], v[132:135], v[164:167], v[96:111]
v_mfma_f32_32x32x16_bf16 v[112:127], v[140:143], v[164:167], v[112:127]
v_mfma_f32_32x32x16_bf16 v[112:127], v[132:135], v[172:175], v[112:127]
ds_read_b128 v[128:131], v15 offset:3264
ds_read_b128 v[136:139], v15 offset:1216
ds_read_b128 v[160:163], v16 offset:1216
ds_read_b128 v[168:171], v16 offset:3264
ds_read_b128 v[132:135], v15 offset:3296
ds_read_b128 v[140:143], v15 offset:1248
ds_read_b128 v[164:167], v16 offset:1248
ds_read_b128 v[172:175], v16 offset:3296
s_waitcnt lgkmcnt(8)
v_mfma_f32_32x32x16_bf16 v[96:111], v[144:147], v[176:179], v[96:111]
v_mfma_f32_32x32x16_bf16 v[112:127], v[152:155], v[176:179], v[112:127]
v_mfma_f32_32x32x16_bf16 v[112:127], v[144:147], v[184:187], v[112:127]
v_mfma_f32_32x32x16_bf16 v[96:111], v[148:151], v[180:183], v[96:111]
v_mfma_f32_32x32x16_bf16 v[112:127], v[156:159], v[180:183], v[112:127]
v_mfma_f32_32x32x16_bf16 v[112:127], v[148:151], v[188:191], v[112:127]
ds_read_b128 v[144:147], v15 offset:3200
ds_read_b128 v[152:155], v15 offset:1152
ds_read_b128 v[176:179], v16 offset:1152
ds_read_b128 v[184:187], v16 offset:3200
ds_read_b128 v[148:151], v15 offset:3232
ds_read_b128 v[156:159], v15 offset:1184
ds_read_b128 v[180:183], v16 offset:1184
ds_read_b128 v[188:191], v16 offset:3232
s_waitcnt lgkmcnt(8)
v_mfma_f32_32x32x16_bf16 v[96:111], v[128:131], v[160:163], v[96:111]
v_mfma_f32_32x32x16_bf16 v[112:127], v[136:139], v[160:163], v[112:127]
v_mfma_f32_32x32x16_bf16 v[112:127], v[128:131], v[168:171], v[112:127]
v_mfma_f32_32x32x16_bf16 v[96:111], v[132:135], v[164:167], v[96:111]
v_mfma_f32_32x32x16_bf16 v[112:127], v[140:143], v[164:167], v[112:127]
v_mfma_f32_32x32x16_bf16 v[112:127], v[132:135], v[172:175], v[112:127]
ds_read_b128 v[128:131], v15 offset:3136
ds_read_b128 v[136:139], v15 offset:1088
ds_read_b128 v[160:163], v16 offset:1088
ds_read_b128 v[168:171], v16 offset:3136
ds_read_b128 v[132:135], v15 offset:3168
ds_read_b128 v[140:143], v15 offset:1120
ds_read_b128 v[164:167], v16 offset:1120
ds_read_b128 v[172:175], v16 offset:3168
s_waitcnt lgkmcnt(8)
v_mfma_f32_32x32x16_bf16 v[96:111], v[144:147], v[176:179], v[96:111]
v_mfma_f32_32x32x16_bf16 v[112:127], v[152:155], v[176:179], v[112:127]
v_mfma_f32_32x32x16_bf16 v[112:127], v[144:147], v[184:187], v[112:127]
v_mfma_f32_32x32x16_bf16 v[96:111], v[148:151], v[180:183], v[96:111]
v_mfma_f32_32x32x16_bf16 v[112:127], v[156:159], v[180:183], v[112:127]
v_mfma_f32_32x32x16_bf16 v[112:127], v[148:151], v[188:191], v[112:127]
ds_read_b128 v[144:147], v15 offset:3072
ds_read_b128 v[152:155], v15 offset:1024
ds_read_b128 v[176:179], v16 offset:1024
ds_read_b128 v[184:187], v16 offset:3072
ds_read_b128 v[148:151], v15 offset:3104
ds_read_b128 v[156:159], v15 offset:1056
ds_read_b128 v[180:183], v16 offset:1056
ds_read_b128 v[188:191], v16 offset:3104
s_waitcnt lgkmcnt(8)
v_mfma_f32_32x32x16_bf16 v[96:111], v[128:131], v[160:163], v[96:111]
v_mfma_f32_32x32x16_bf16 v[112:127], v[136:139], v[160:163], v[112:127]
v_mfma_f32_32x32x16_bf16 v[112:127], v[128:131], v[168:171], v[112:127]
v_mfma_f32_32x32x16_bf16 v[96:111], v[132:135], v[164:167], v[96:111]
v_mfma_f32_32x32x16_bf16 v[112:127], v[140:143], v[164:167], v[112:127]
v_mfma_f32_32x32x16_bf16 v[112:127], v[132:135], v[172:175], v[112:127]
ds_read_b128 v[128:131], v15 offset:3008
ds_read_b128 v[136:139], v15 offset:960
ds_read_b128 v[160:163], v16 offset:960
ds_read_b128 v[168:171], v16 offset:3008
ds_read_b128 v[132:135], v15 offset:3040
ds_read_b128 v[140:143], v15 offset:992
ds_read_b128 v[164:167], v16 offset:992
ds_read_b128 v[172:175], v16 offset:3040
s_waitcnt lgkmcnt(8)
v_mfma_f32_32x32x16_bf16 v[96:111], v[144:147], v[176:179], v[96:111]
v_mfma_f32_32x32x16_bf16 v[112:127], v[152:155], v[176:179], v[112:127]
v_mfma_f32_32x32x16_bf16 v[112:127], v[144:147], v[184:187], v[112:127]
v_mfma_f32_32x32x16_bf16 v[96:111], v[148:151], v[180:183], v[96:111]
v_mfma_f32_32x32x16_bf16 v[112:127], v[156:159], v[180:183], v[112:127]
v_mfma_f32_32x32x16_bf16 v[112:127], v[148:151], v[188:191], v[112:127]
ds_read_b128 v[144:147], v15 offset:2944
ds_read_b128 v[152:155], v15 offset:896
ds_read_b128 v[176:179], v16 offset:896
ds_read_b128 v[184:187], v16 offset:2944
ds_read_b128 v[148:151], v15 offset:2976
ds_read_b128 v[156:159], v15 offset:928
ds_read_b128 v[180:183], v16 offset:928
ds_read_b128 v[188:191], v16 offset:2976
s_waitcnt lgkmcnt(8)
v_mfma_f32_32x32x16_bf16 v[96:111], v[128:131], v[160:163], v[96:111]
v_mfma_f32_32x32x16_bf16 v[112:127], v[136:139], v[160:163], v[112:127]
v_mfma_f32_32x32x16_bf16 v[112:127], v[128:131], v[168:171], v[112:127]
v_mfma_f32_32x32x16_bf16 v[96:111], v[132:135], v[164:167], v[96:111]
v_mfma_f32_32x32x16_bf16 v[112:127], v[140:143], v[164:167], v[112:127]
v_mfma_f32_32x32x16_bf16 v[112:127], v[132:135], v[172:175], v[112:127]
ds_read_b128 v[128:131], v15 offset:2880
ds_read_b128 v[136:139], v15 offset:832
ds_read_b128 v[160:163], v16 offset:832
ds_read_b128 v[168:171], v16 offset:2880
ds_read_b128 v[132:135], v15 offset:2912
ds_read_b128 v[140:143], v15 offset:864
ds_read_b128 v[164:167], v16 offset:864
ds_read_b128 v[172:175], v16 offset:2912
s_waitcnt lgkmcnt(8)
v_mfma_f32_32x32x16_bf16 v[96:111], v[144:147], v[176:179], v[96:111]
v_mfma_f32_32x32x16_bf16 v[112:127], v[152:155], v[176:179], v[112:127]
v_mfma_f32_32x32x16_bf16 v[112:127], v[144:147], v[184:187], v[112:127]
v_mfma_f32_32x32x16_bf16 v[96:111], v[148:151], v[180:183], v[96:111]
v_mfma_f32_32x32x16_bf16 v[112:127], v[156:159], v[180:183], v[112:127]
v_mfma_f32_32x32x16_bf16 v[112:127], v[148:151], v[188:191], v[112:127]
ds_read_b128 v[144:147], v15 offset:2816
ds_read_b128 v[152:155], v15 offset:768
ds_read_b128 v[176:179], v16 offset:768
ds_read_b128 v[184:187], v16 offset:2816
ds_read_b128 v[148:151], v15 offset:2848
ds_read_b128 v[156:159], v15 offset:800
ds_read_b128 v[180:183], v16 offset:800
ds_read_b128 v[188:191], v16 offset:2848
s_waitcnt lgkmcnt(8)
v_mfma_f32_32x32x16_bf16 v[96:111], v[128:131], v[160:163], v[96:111]
v_mfma_f32_32x32x16_bf16 v[112:127], v[136:139], v[160:163], v[112:127]
v_mfma_f32_32x32x16_bf16 v[112:127], v[128:131], v[168:171], v[112:127]
v_mfma_f32_32x32x16_bf16 v[96:111], v[132:135], v[164:167], v[96:111]
v_mfma_f32_32x32x16_bf16 v[112:127], v[140:143], v[164:167], v[112:127]
v_mfma_f32_32x32x16_bf16 v[112:127], v[132:135], v[172:175], v[112:127]
ds_read_b128 v[128:131], v15 offset:2752
ds_read_b128 v[136:139], v15 offset:704
ds_read_b128 v[160:163], v16 offset:704
ds_read_b128 v[168:171], v16 offset:2752
ds_read_b128 v[132:135], v15 offset:2784
ds_read_b128 v[140:143], v15 offset:736
ds_read_b128 v[164:167], v16 offset:736
ds_read_b128 v[172:175], v16 offset:2784
s_waitcnt lgkmcnt(8)
v_mfma_f32_32x32x16_bf16 v[96:111], v[144:147], v[176:179], v[96:111]
v_mfma_f32_32x32x16_bf16 v[112:127], v[152:155], v[176:179], v[112:127]
v_mfma_f32_32x32x16_bf16 v[112:127], v[144:147], v[184:187], v[112:127]
v_mfma_f32_32x32x16_bf16 v[96:111], v[148:151], v[180:183], v[96:111]
v_mfma_f32_32x32x16_bf16 v[112:127], v[156:159], v[180:183], v[112:127]
v_mfma_f32_32x32x16_bf16 v[112:127], v[148:151], v[188:191], v[112:127]
ds_read_b128 v[144:147], v15 offset:2688
ds_read_b128 v[152:155], v15 offset:640
ds_read_b128 v[176:179], v16 offset:640
ds_read_b128 v[184:187], v16 offset:2688
ds_read_b128 v[148:151], v15 offset:2720
ds_read_b128 v[156:159], v15 offset:672
ds_read_b128 v[180:183], v16 offset:672
ds_read_b128 v[188:191], v16 offset:2720
s_waitcnt lgkmcnt(8)
v_mfma_f32_32x32x16_bf16 v[96:111], v[128:131], v[160:163], v[96:111]
v_mfma_f32_32x32x16_bf16 v[112:127], v[136:139], v[160:163], v[112:127]
v_mfma_f32_32x32x16_bf16 v[112:127], v[128:131], v[168:171], v[112:127]
v_mfma_f32_32x32x16_bf16 v[96:111], v[132:135], v[164:167], v[96:111]
v_mfma_f32_32x32x16_bf16 v[112:127], v[140:143], v[164:167], v[112:127]
v_mfma_f32_32x32x16_bf16 v[112:127], v[132:135], v[172:175], v[112:127]
ds_read_b128 v[128:131], v15 offset:2624
ds_read_b128 v[136:139], v15 offset:576
ds_read_b128 v[160:163], v16 offset:576
ds_read_b128 v[168:171], v16 offset:2624
ds_read_b128 v[132:135], v15 offset:2656
ds_read_b128 v[140:143], v15 offset:608
ds_read_b128 v[164:167], v16 offset:608
ds_read_b128 v[172:175], v16 offset:2656
s_waitcnt lgkmcnt(8)
v_mfma_f32_32x32x16_bf16 v[96:111], v[144:147], v[176:179], v[96:111]
v_mfma_f32_32x32x16_bf16 v[112:127], v[152:155], v[176:179], v[112:127]
v_mfma_f32_32x32x16_bf16 v[112:127], v[144:147], v[184:187], v[112:127]
v_mfma_f32_32x32x16_bf16 v[96:111], v[148:151], v[180:183], v[96:111]
v_mfma_f32_32x32x16_bf16 v[112:127], v[156:159], v[180:183], v[112:127]
v_mfma_f32_32x32x16_bf16 v[112:127], v[148:151], v[188:191], v[112:127]
ds_read_b128 v[144:147], v15 offset:2560
ds_read_b128 v[152:155], v15 offset:512
ds_read_b128 v[176:179], v16 offset:512
ds_read_b128 v[184:187], v16 offset:2560
ds_read_b128 v[148:151], v15 offset:2592
ds_read_b128 v[156:159], v15 offset:544
ds_read_b128 v[180:183], v16 offset:544
ds_read_b128 v[188:191], v16 offset:2592
s_waitcnt lgkmcnt(8)
v_mfma_f32_32x32x16_bf16 v[96:111], v[128:131], v[160:163], v[96:111]
v_mfma_f32_32x32x16_bf16 v[112:127], v[136:139], v[160:163], v[112:127]
v_mfma_f32_32x32x16_bf16 v[112:127], v[128:131], v[168:171], v[112:127]
v_mfma_f32_32x32x16_bf16 v[96:111], v[132:135], v[164:167], v[96:111]
v_mfma_f32_32x32x16_bf16 v[112:127], v[140:143], v[164:167], v[112:127]
v_mfma_f32_32x32x16_bf16 v[112:127], v[132:135], v[172:175], v[112:127]
ds_read_b128 v[128:131], v15 offset:2496
ds_read_b128 v[136:139], v15 offset:448
ds_read_b128 v[160:163], v16 offset:448
ds_read_b128 v[168:171], v16 offset:2496
ds_read_b128 v[132:135], v15 offset:2528
ds_read_b128 v[140:143], v15 offset:480
ds_read_b128 v[164:167], v16 offset:480
ds_read_b128 v[172:175], v16 offset:2528
s_waitcnt lgkmcnt(8)
v_mfma_f32_32x32x16_bf16 v[96:111], v[144:147], v[176:179], v[96:111]
v_mfma_f32_32x32x16_bf16 v[112:127], v[152:155], v[176:179], v[112:127]
v_mfma_f32_32x32x16_bf16 v[112:127], v[144:147], v[184:187], v[112:127]
v_mfma_f32_32x32x16_bf16 v[96:111], v[148:151], v[180:183], v[96:111]
v_mfma_f32_32x32x16_bf16 v[112:127], v[156:159], v[180:183], v[112:127]
v_mfma_f32_32x32x16_bf16 v[112:127], v[148:151], v[188:191], v[112:127]
ds_read_b128 v[144:147], v15 offset:2432
ds_read_b128 v[152:155], v15 offset:384
ds_read_b128 v[176:179], v16 offset:384
ds_read_b128 v[184:187], v16 offset:2432
ds_read_b128 v[148:151], v15 offset:2464
ds_read_b128 v[156:159], v15 offset:416
ds_read_b128 v[180:183], v16 offset:416
ds_read_b128 v[188:191], v16 offset:2464
s_waitcnt lgkmcnt(8)
v_mfma_f32_32x32x16_bf16 v[96:111], v[128:131], v[160:163], v[96:111]
v_mfma_f32_32x32x16_bf16 v[112:127], v[136:139], v[160:163], v[112:127]
v_mfma_f32_32x32x16_bf16 v[112:127], v[128:131], v[168:171], v[112:127]
v_mfma_f32_32x32x16_bf16 v[96:111], v[132:135], v[164:167], v[96:111]
v_mfma_f32_32x32x16_bf16 v[112:127], v[140:143], v[164:167], v[112:127]
v_mfma_f32_32x32x16_bf16 v[112:127], v[132:135], v[172:175], v[112:127]
ds_read_b128 v[128:131], v15 offset:2368
ds_read_b128 v[136:139], v15 offset:320
ds_read_b128 v[160:163], v16 offset:320
ds_read_b128 v[168:171], v16 offset:2368
ds_read_b128 v[132:135], v15 offset:2400
ds_read_b128 v[140:143], v15 offset:352
ds_read_b128 v[164:167], v16 offset:352
ds_read_b128 v[172:175], v16 offset:2400
s_waitcnt lgkmcnt(8)
v_mfma_f32_32x32x16_bf16 v[96:111], v[144:147], v[176:179], v[96:111]
v_mfma_f32_32x32x16_bf16 v[112:127], v[152:155], v[176:179], v[112:127]
v_mfma_f32_32x32x16_bf16 v[112:127], v[144:147], v[184:187], v[112:127]
v_mfma_f32_32x32x16_bf16 v[96:111], v[148:151], v[180:183], v[96:111]
v_mfma_f32_32x32x16_bf16 v[112:127], v[156:159], v[180:183], v[112:127]
v_mfma_f32_32x32x16_bf16 v[112:127], v[148:151], v[188:191], v[112:127]
ds_read_b128 v[144:147], v15 offset:2304
ds_read_b128 v[152:155], v15 offset:256
ds_read_b128 v[176:179], v16 offset:256
ds_read_b128 v[184:187], v16 offset:2304
ds_read_b128 v[148:151], v15 offset:2336
ds_read_b128 v[156:159], v15 offset:288
ds_read_b128 v[180:183], v16 offset:288
ds_read_b128 v[188:191], v16 offset:2336
s_waitcnt lgkmcnt(8)
v_mfma_f32_32x32x16_bf16 v[96:111], v[128:131], v[160:163], v[96:111]
v_mfma_f32_32x32x16_bf16 v[112:127], v[136:139], v[160:163], v[112:127]
v_mfma_f32_32x32x16_bf16 v[112:127], v[128:131], v[168:171], v[112:127]
v_mfma_f32_32x32x16_bf16 v[96:111], v[132:135], v[164:167], v[96:111]
v_mfma_f32_32x32x16_bf16 v[112:127], v[140:143], v[164:167], v[112:127]
v_mfma_f32_32x32x16_bf16 v[112:127], v[132:135], v[172:175], v[112:127]
ds_read_b128 v[128:131], v15 offset:2240
ds_read_b128 v[136:139], v15 offset:192
ds_read_b128 v[160:163], v16 offset:192
ds_read_b128 v[168:171], v16 offset:2240
ds_read_b128 v[132:135], v15 offset:2272
ds_read_b128 v[140:143], v15 offset:224
ds_read_b128 v[164:167], v16 offset:224
ds_read_b128 v[172:175], v16 offset:2272
s_waitcnt lgkmcnt(8)
v_mfma_f32_32x32x16_bf16 v[96:111], v[144:147], v[176:179], v[96:111]
v_mfma_f32_32x32x16_bf16 v[112:127], v[152:155], v[176:179], v[112:127]
v_mfma_f32_32x32x16_bf16 v[112:127], v[144:147], v[184:187], v[112:127]
v_mfma_f32_32x32x16_bf16 v[96:111], v[148:151], v[180:183], v[96:111]
v_mfma_f32_32x32x16_bf16 v[112:127], v[156:159], v[180:183], v[112:127]
v_mfma_f32_32x32x16_bf16 v[112:127], v[148:151], v[188:191], v[112:127]
ds_read_b128 v[144:147], v15 offset:2176
ds_read_b128 v[152:155], v15 offset:128
ds_read_b128 v[176:179], v16 offset:128
ds_read_b128 v[184:187], v16 offset:2176
ds_read_b128 v[148:151], v15 offset:2208
ds_read_b128 v[156:159], v15 offset:160
ds_read_b128 v[180:183], v16 offset:160
ds_read_b128 v[188:191], v16 offset:2208
s_waitcnt lgkmcnt(8)
v_mfma_f32_32x32x16_bf16 v[96:111], v[128:131], v[160:163], v[96:111]
v_mfma_f32_32x32x16_bf16 v[112:127], v[136:139], v[160:163], v[112:127]
v_mfma_f32_32x32x16_bf16 v[112:127], v[128:131], v[168:171], v[112:127]
v_mfma_f32_32x32x16_bf16 v[96:111], v[132:135], v[164:167], v[96:111]
v_mfma_f32_32x32x16_bf16 v[112:127], v[140:143], v[164:167], v[112:127]
v_mfma_f32_32x32x16_bf16 v[112:127], v[132:135], v[172:175], v[112:127]
ds_read_b128 v[128:131], v15 offset:2112
ds_read_b128 v[136:139], v15 offset:64
ds_read_b128 v[160:163], v16 offset:64
ds_read_b128 v[168:171], v16 offset:2112
ds_read_b128 v[132:135], v15 offset:2144
ds_read_b128 v[140:143], v15 offset:96
ds_read_b128 v[164:167], v16 offset:96
ds_read_b128 v[172:175], v16 offset:2144
s_waitcnt lgkmcnt(8)
v_mfma_f32_32x32x16_bf16 v[96:111], v[144:147], v[176:179], v[96:111]
v_mfma_f32_32x32x16_bf16 v[112:127], v[152:155], v[176:179], v[112:127]
v_mfma_f32_32x32x16_bf16 v[112:127], v[144:147], v[184:187], v[112:127]
v_mfma_f32_32x32x16_bf16 v[96:111], v[148:151], v[180:183], v[96:111]
v_mfma_f32_32x32x16_bf16 v[112:127], v[156:159], v[180:183], v[112:127]
v_mfma_f32_32x32x16_bf16 v[112:127], v[148:151], v[188:191], v[112:127]
ds_read_b128 v[144:147], v15 offset:2048
ds_read_b128 v[152:155], v15 offset:0
ds_read_b128 v[176:179], v16 offset:0
ds_read_b128 v[184:187], v16 offset:2048
ds_read_b128 v[148:151], v15 offset:2080
ds_read_b128 v[156:159], v15 offset:32
ds_read_b128 v[180:183], v16 offset:32
ds_read_b128 v[188:191], v16 offset:2080
s_waitcnt lgkmcnt(8)
v_mfma_f32_32x32x16_bf16 v[96:111], v[128:131], v[160:163], v[96:111]
v_mfma_f32_32x32x16_bf16 v[112:127], v[136:139], v[160:163], v[112:127]
v_mfma_f32_32x32x16_bf16 v[112:127], v[128:131], v[168:171], v[112:127]
v_mfma_f32_32x32x16_bf16 v[96:111], v[132:135], v[164:167], v[96:111]
v_mfma_f32_32x32x16_bf16 v[112:127], v[140:143], v[164:167], v[112:127]
v_mfma_f32_32x32x16_bf16 v[112:127], v[132:135], v[172:175], v[112:127]
s_waitcnt lgkmcnt(0)
v_mfma_f32_32x32x16_bf16 v[96:111], v[144:147], v[176:179], v[96:111]
v_mfma_f32_32x32x16_bf16 v[112:127], v[152:155], v[176:179], v[112:127]
v_mfma_f32_32x32x16_bf16 v[112:127], v[144:147], v[184:187], v[112:127]
v_mfma_f32_32x32x16_bf16 v[96:111], v[148:151], v[180:183], v[96:111]
v_mfma_f32_32x32x16_bf16 v[112:127], v[156:159], v[180:183], v[112:127]
v_mfma_f32_32x32x16_bf16 v[112:127], v[148:151], v[188:191], v[112:127]
ds_read_b64 v[128:129], v18 offset:0
ds_read_b64 v[130:131], v18 offset:16
ds_read_b64 v[132:133], v18 offset:32
ds_read_b64 v[134:135], v18 offset:48
ds_read_b64 v[136:137], v18 offset:2048
ds_read_b64 v[138:139], v18 offset:2064
ds_read_b64 v[140:141], v18 offset:2080
ds_read_b64 v[142:143], v18 offset:2096
s_waitcnt lgkmcnt(0)
s_nop 0
v_cvt_pk_bf16_f32 v244, v96, v97
v_lshlrev_b32 v245, 16, v128
v_and_b32 v246, 0xffff0000, v128
v_mul_f32 v245, v245, v23
v_mul_f32 v246, v246, v23
v_cvt_pk_bf16_f32 v247, v245, v246
v_lshlrev_b32 v245, 16, v244
v_and_b32 v246, 0xffff0000, v244
v_lshlrev_b32 v244, 16, v247
v_and_b32 v247, 0xffff0000, v247
v_add_f32 v245, v245, v244
v_add_f32 v246, v246, v247
v_cvt_pk_bf16_f32 v160, v245, v246
v_cvt_pk_bf16_f32 v244, v98, v99
v_lshlrev_b32 v245, 16, v129
v_and_b32 v246, 0xffff0000, v129
v_mul_f32 v245, v245, v23
v_mul_f32 v246, v246, v23
v_cvt_pk_bf16_f32 v247, v245, v246
v_lshlrev_b32 v245, 16, v244
v_and_b32 v246, 0xffff0000, v244
v_lshlrev_b32 v244, 16, v247
v_and_b32 v247, 0xffff0000, v247
v_add_f32 v245, v245, v244
v_add_f32 v246, v246, v247
v_cvt_pk_bf16_f32 v161, v245, v246
v_cvt_pk_bf16_f32 v244, v100, v101
v_lshlrev_b32 v245, 16, v130
v_and_b32 v246, 0xffff0000, v130
v_mul_f32 v245, v245, v23
v_mul_f32 v246, v246, v23
v_cvt_pk_bf16_f32 v247, v245, v246
v_lshlrev_b32 v245, 16, v244
v_and_b32 v246, 0xffff0000, v244
v_lshlrev_b32 v244, 16, v247
v_and_b32 v247, 0xffff0000, v247
v_add_f32 v245, v245, v244
v_add_f32 v246, v246, v247
v_cvt_pk_bf16_f32 v162, v245, v246
v_cvt_pk_bf16_f32 v244, v102, v103
v_lshlrev_b32 v245, 16, v131
v_and_b32 v246, 0xffff0000, v131
v_mul_f32 v245, v245, v23
v_mul_f32 v246, v246, v23
v_cvt_pk_bf16_f32 v247, v245, v246
v_lshlrev_b32 v245, 16, v244
v_and_b32 v246, 0xffff0000, v244
v_lshlrev_b32 v244, 16, v247
v_and_b32 v247, 0xffff0000, v247
v_add_f32 v245, v245, v244
v_add_f32 v246, v246, v247
v_cvt_pk_bf16_f32 v163, v245, v246
v_cvt_pk_bf16_f32 v244, v104, v105
v_lshlrev_b32 v245, 16, v132
v_and_b32 v246, 0xffff0000, v132
v_mul_f32 v245, v245, v23
v_mul_f32 v246, v246, v23
v_cvt_pk_bf16_f32 v247, v245, v246
v_lshlrev_b32 v245, 16, v244
v_and_b32 v246, 0xffff0000, v244
v_lshlrev_b32 v244, 16, v247
v_and_b32 v247, 0xffff0000, v247
v_add_f32 v245, v245, v244
v_add_f32 v246, v246, v247
v_cvt_pk_bf16_f32 v164, v245, v246
v_cvt_pk_bf16_f32 v244, v106, v107
v_lshlrev_b32 v245, 16, v133
v_and_b32 v246, 0xffff0000, v133
v_mul_f32 v245, v245, v23
v_mul_f32 v246, v246, v23
v_cvt_pk_bf16_f32 v247, v245, v246
v_lshlrev_b32 v245, 16, v244
v_and_b32 v246, 0xffff0000, v244
v_lshlrev_b32 v244, 16, v247
v_and_b32 v247, 0xffff0000, v247
v_add_f32 v245, v245, v244
v_add_f32 v246, v246, v247
v_cvt_pk_bf16_f32 v165, v245, v246
v_cvt_pk_bf16_f32 v244, v108, v109
v_lshlrev_b32 v245, 16, v134
v_and_b32 v246, 0xffff0000, v134
v_mul_f32 v245, v245, v23
v_mul_f32 v246, v246, v23
v_cvt_pk_bf16_f32 v247, v245, v246
v_lshlrev_b32 v245, 16, v244
v_and_b32 v246, 0xffff0000, v244
v_lshlrev_b32 v244, 16, v247
v_and_b32 v247, 0xffff0000, v247
v_add_f32 v245, v245, v244
v_add_f32 v246, v246, v247
v_cvt_pk_bf16_f32 v166, v245, v246
v_cvt_pk_bf16_f32 v244, v110, v111
v_lshlrev_b32 v245, 16, v135
v_and_b32 v246, 0xffff0000, v135
v_mul_f32 v245, v245, v23
v_mul_f32 v246, v246, v23
v_cvt_pk_bf16_f32 v247, v245, v246
v_lshlrev_b32 v245, 16, v244
v_and_b32 v246, 0xffff0000, v244
v_lshlrev_b32 v244, 16, v247
v_and_b32 v247, 0xffff0000, v247
v_add_f32 v245, v245, v244
v_add_f32 v246, v246, v247
v_cvt_pk_bf16_f32 v167, v245, v246
v_cvt_pk_bf16_f32 v244, v112, v113
v_lshlrev_b32 v245, 16, v136
v_and_b32 v246, 0xffff0000, v136
v_mul_f32 v245, v245, v23
v_mul_f32 v246, v246, v23
v_cvt_pk_bf16_f32 v247, v245, v246
v_lshlrev_b32 v245, 16, v244
v_and_b32 v246, 0xffff0000, v244
v_lshlrev_b32 v244, 16, v247
v_and_b32 v247, 0xffff0000, v247
v_add_f32 v245, v245, v244
v_add_f32 v246, v246, v247
v_cvt_pk_bf16_f32 v168, v245, v246
v_cvt_pk_bf16_f32 v244, v114, v115
v_lshlrev_b32 v245, 16, v137
v_and_b32 v246, 0xffff0000, v137
v_mul_f32 v245, v245, v23
v_mul_f32 v246, v246, v23
v_cvt_pk_bf16_f32 v247, v245, v246
v_lshlrev_b32 v245, 16, v244
v_and_b32 v246, 0xffff0000, v244
v_lshlrev_b32 v244, 16, v247
v_and_b32 v247, 0xffff0000, v247
v_add_f32 v245, v245, v244
v_add_f32 v246, v246, v247
v_cvt_pk_bf16_f32 v169, v245, v246
v_cvt_pk_bf16_f32 v244, v116, v117
v_lshlrev_b32 v245, 16, v138
v_and_b32 v246, 0xffff0000, v138
v_mul_f32 v245, v245, v23
v_mul_f32 v246, v246, v23
v_cvt_pk_bf16_f32 v247, v245, v246
v_lshlrev_b32 v245, 16, v244
v_and_b32 v246, 0xffff0000, v244
v_lshlrev_b32 v244, 16, v247
v_and_b32 v247, 0xffff0000, v247
v_add_f32 v245, v245, v244
v_add_f32 v246, v246, v247
v_cvt_pk_bf16_f32 v170, v245, v246
v_cvt_pk_bf16_f32 v244, v118, v119
v_lshlrev_b32 v245, 16, v139
v_and_b32 v246, 0xffff0000, v139
v_mul_f32 v245, v245, v23
v_mul_f32 v246, v246, v23
v_cvt_pk_bf16_f32 v247, v245, v246
v_lshlrev_b32 v245, 16, v244
v_and_b32 v246, 0xffff0000, v244
v_lshlrev_b32 v244, 16, v247
v_and_b32 v247, 0xffff0000, v247
v_add_f32 v245, v245, v244
v_add_f32 v246, v246, v247
v_cvt_pk_bf16_f32 v171, v245, v246
v_cvt_pk_bf16_f32 v244, v120, v121
v_lshlrev_b32 v245, 16, v140
v_and_b32 v246, 0xffff0000, v140
v_mul_f32 v245, v245, v23
v_mul_f32 v246, v246, v23
v_cvt_pk_bf16_f32 v247, v245, v246
v_lshlrev_b32 v245, 16, v244
v_and_b32 v246, 0xffff0000, v244
v_lshlrev_b32 v244, 16, v247
v_and_b32 v247, 0xffff0000, v247
v_add_f32 v245, v245, v244
v_add_f32 v246, v246, v247
v_cvt_pk_bf16_f32 v172, v245, v246
v_cvt_pk_bf16_f32 v244, v122, v123
v_lshlrev_b32 v245, 16, v141
v_and_b32 v246, 0xffff0000, v141
v_mul_f32 v245, v245, v23
v_mul_f32 v246, v246, v23
v_cvt_pk_bf16_f32 v247, v245, v246
v_lshlrev_b32 v245, 16, v244
v_and_b32 v246, 0xffff0000, v244
v_lshlrev_b32 v244, 16, v247
v_and_b32 v247, 0xffff0000, v247
v_add_f32 v245, v245, v244
v_add_f32 v246, v246, v247
v_cvt_pk_bf16_f32 v173, v245, v246
v_cvt_pk_bf16_f32 v244, v124, v125
v_lshlrev_b32 v245, 16, v142
v_and_b32 v246, 0xffff0000, v142
v_mul_f32 v245, v245, v23
v_mul_f32 v246, v246, v23
v_cvt_pk_bf16_f32 v247, v245, v246
v_lshlrev_b32 v245, 16, v244
v_and_b32 v246, 0xffff0000, v244
v_lshlrev_b32 v244, 16, v247
v_and_b32 v247, 0xffff0000, v247
v_add_f32 v245, v245, v244
v_add_f32 v246, v246, v247
v_cvt_pk_bf16_f32 v174, v245, v246
v_cvt_pk_bf16_f32 v244, v126, v127
v_lshlrev_b32 v245, 16, v143
v_and_b32 v246, 0xffff0000, v143
v_mul_f32 v245, v245, v23
v_mul_f32 v246, v246, v23
v_cvt_pk_bf16_f32 v247, v245, v246
v_lshlrev_b32 v245, 16, v244
v_and_b32 v246, 0xffff0000, v244
v_lshlrev_b32 v244, 16, v247
v_and_b32 v247, 0xffff0000, v247
v_add_f32 v245, v245, v244
v_add_f32 v246, v246, v247
v_cvt_pk_bf16_f32 v175, v245, v246
s_barrier
ds_write_b16 v19, v160 offset:0
ds_write_b16_d16_hi v19, v160 offset:8
ds_write_b16 v19, v161 offset:16
ds_write_b16_d16_hi v19, v161 offset:24
ds_write_b16 v19, v162 offset:64
ds_write_b16_d16_hi v19, v162 offset:72
ds_write_b16 v19, v163 offset:80
ds_write_b16_d16_hi v19, v163 offset:88
ds_write_b16 v19, v164 offset:128
ds_write_b16_d16_hi v19, v164 offset:136
ds_write_b16 v19, v165 offset:144
ds_write_b16_d16_hi v19, v165 offset:152
ds_write_b16 v19, v166 offset:192
ds_write_b16_d16_hi v19, v166 offset:200
ds_write_b16 v19, v167 offset:208
ds_write_b16_d16_hi v19, v167 offset:216
ds_write_b16 v19, v168 offset:8192
ds_write_b16_d16_hi v19, v168 offset:8200
ds_write_b16 v19, v169 offset:8208
ds_write_b16_d16_hi v19, v169 offset:8216
ds_write_b16 v19, v170 offset:8256
ds_write_b16_d16_hi v19, v170 offset:8264
ds_write_b16 v19, v171 offset:8272
ds_write_b16_d16_hi v19, v171 offset:8280
ds_write_b16 v19, v172 offset:8320
ds_write_b16_d16_hi v19, v172 offset:8328
ds_write_b16 v19, v173 offset:8336
ds_write_b16_d16_hi v19, v173 offset:8344
ds_write_b16 v19, v174 offset:8384
ds_write_b16_d16_hi v19, v174 offset:8392
ds_write_b16 v19, v175 offset:8400
ds_write_b16_d16_hi v19, v175 offset:8408
s_waitcnt lgkmcnt(0)
s_barrier
v_lshlrev_b32 v34, 3, v0
ds_read_b64 v[192:193], v34 offset:0
ds_read_b64 v[194:195], v34 offset:2048
ds_read_b64 v[196:197], v34 offset:4096
ds_read_b64 v[198:199], v34 offset:6144
ds_read_b64 v[200:201], v34 offset:8192
ds_read_b64 v[202:203], v34 offset:10240
ds_read_b64 v[204:205], v34 offset:12288
ds_read_b64 v[206:207], v34 offset:14336
v_mul_u32_u24 v34, 2560, v0
s_lshl_b32 s40, s31, 1
v_add_u32 v34, s40, v34
s_mov_b32 s42, s64
s_mov_b32 s43, s65
s_waitcnt lgkmcnt(0)
global_store_dwordx2 v34, v[192:193], s[42:43]
s_add_u32 s42, s42, 655360
s_addc_u32 s43, s43, 0
global_store_dwordx2 v34, v[194:195], s[42:43]
s_add_u32 s42, s42, 655360
s_addc_u32 s43, s43, 0
global_store_dwordx2 v34, v[196:197], s[42:43]
s_add_u32 s42, s42, 655360
s_addc_u32 s43, s43, 0
global_store_dwordx2 v34, v[198:199], s[42:43]
s_add_u32 s42, s42, 655360
s_addc_u32 s43, s43, 0
global_store_dwordx2 v34, v[200:201], s[42:43]
s_add_u32 s42, s42, 655360
s_addc_u32 s43, s43, 0
global_store_dwordx2 v34, v[202:203], s[42:43]
s_add_u32 s42, s42, 655360
s_addc_u32 s43, s43, 0
global_store_dwordx2 v34, v[204:205], s[42:43]
s_add_u32 s42, s42, 655360
s_addc_u32 s43, s43, 0
global_store_dwordx2 v34, v[206:207], s[42:43]
s_barrier
v_mov_b32 v104, 0
v_mov_b32 v105, 0
v_mov_b32 v106, 0
v_mov_b32 v107, 0
v_bfe_u32 v33, v1, 2, 3
v_mul_u32_u24 v33, 4160, v33
v_and_b32 v34, 3, v1
v_lshl_add_u32 v33, v34, 4, v33
v_add_u32 v33, s26, v33
ds_write_b128 v33, v[104:107] offset:4096
s_add_u32 s30, s30, 64
s_cmp_lt_u32 s30, 160
s_cbranch_scc1 Al_5
s_barrier
s_cmp_ge_u32 s29, 24
s_cbranch_scc1 L_e3
s_lshr_b32 s23, s29, 3
s_and_b32 s24, s29, 7
v_and_b32 v30, 15, v1
v_lshrrev_b32 v31, 4, v1
v_lshlrev_b32 v32, 9, v31
v_lshl_add_u32 v2, v30, 4, v32
v_add_u32 v2, 4096, v2
v_bfe_u32 v32, v30, 2, 1
v_lshlrev_b32 v32, 4, v32
v_lshrrev_b32 v33, 3, v30
v_lshl_add_u32 v32, v33, 3, v32
v_bfe_u32 v33, v30, 1, 1
v_lshl_add_u32 v32, v33, 2, v32
v_and_b32 v33, 1, v30
v_add_u32 v32, v32, v33
v_lshlrev_b32 v32, 4, v32
v_lshl_add_u32 v3, v31, 9, v32
v_add_u32 v3, 4096, v3
v_and_b32 v32, 7, v30
v_lshlrev_b32 v32, 4, v32
v_lshl_add_u32 v4, v31, 7, v32
v_and_b32 v32, 1, v31
v_lshlrev_b32 v32, 4, v32
v_lshrrev_b32 v33, 1, v31
v_lshl_add_u32 v32, v33, 3, v32
v_sub_u32 v5, v30, v32
v_lshlrev_b32 v6, 4, v1
v_lshlrev_b32 v32, 4, v30
v_and_b32 v33, 1, v31
v_lshl_add_u32 v32, v33, 3, v32
v_add_u32 v7, 2048, v32
v_mov_b32 v8, 0x05040c0c
v_mov_b32 v9, 0x07060c0c
v_mov_b32 v10, 0xff800000
s_mov_b32 s40, 0
s_mov_b32 s41, -1
v_mov_b32 v32, 0x03020100
v_cndmask_b32 v8, v8, v32, s[40:41]
v_cndmask_b32 v9, v9, v32, s[40:41]
s_mov_b32 s66, 1035273459
s_mov_b32 s67, 1035273459
s_mov_b32 s68, 1069066811
s_mov_b32 s64, -1
s_mov_b32 s65, 0
s_lshl_b32 s16, s24, 2
s_add_u32 s16, s16, s3
s_mov_b32 s30, s23
E2l_6:
s_lshl_b32 s44, s30, 5
s_add_u32 s44, s44, s16
s_lshl_b32 s44, s44, 2
s_add_u32 s44, s44, 46161920
v_mov_b32 v30, s44
s_lshl_b32 s44, s30, 8
s_lshr_b32 s45, s16, 1
s_lshl_b32 s45, s45, 2
s_add_u32 s44, s44, s45
s_add_u32 s44, s44, 46137344
v_mov_b32 v31, s44
e2w_8:
global_load_dword v32, v30, s[4:5] sc1
global_load_dword v33, v31, s[4:5] sc1
global_load_dword v34, v31, s[4:5] offset:64 sc1
s_waitcnt vmcnt(0)
v_min_u32 v32, v32, v33
v_min_u32 v32, v32, v34
v_cmp_eq_u32 vcc, 0, v32
s_nop 3
s_cbranch_vccz e2g_9
s_sleep 2
s_add_u32 s100, s100, 16
s_cmp_lt_u32 s100, 0x1000000
s_cbranch_scc1 e2w_8
s_endpgm
e2g_9:
s_lshl_b32 s44, s30, 5
s_add_u32 s44, s44, s16
s_lshl_b32 s45, s44, 13
s_add_u32 s46, s4, s45
s_addc_u32 s47, s5, 0
s_add_u32 s48, s46, 16777216
s_addc_u32 s49, s47, 0
s_lshl_b32 s45, s44, 11
s_add_u32 s45, s45, 33554432
s_add_u32 s50, s4, s45
s_addc_u32 s51, s5, 0
s_mul_i32 s45, s44, 2560
s_add_u32 s45, s45, 37748736
s_add_u32 s52, s4, s45
s_addc_u32 s53, s5, 0
global_load_dwordx4 v[68:71], v4, s[50:51] offset:0 sc1
global_load_dwordx4 v[84:87], v3, s[48:49] offset:-4096 sc1
global_load_dwordx4 v[100:103], v3, s[48:49] offset:-4064 sc1
global_load_dwordx4 v[36:39], v2, s[46:47] offset:-4096 sc1
global_load_dwordx4 v[52:55], v2, s[46:47] offset:-3840 sc1
global_load_dwordx4 v[72:75], v4, s[50:51] offset:512 sc1
global_load_dwordx4 v[88:91], v3, s[48:49] offset:-2048 sc1
global_load_dwordx4 v[104:107], v3, s[48:49] offset:-2016 sc1
global_load_dwordx4 v[40:43], v2, s[46:47] offset:-2048 sc1
global_load_dwordx4 v[56:59], v2, s[46:47] offset:-1792 sc1
global_load_dwordx4 v[76:79], v4, s[50:51] offset:1024 sc1
global_load_dwordx4 v[92:95], v3, s[48:49] offset:0 sc1
global_load_dwordx4 v[108:111], v3, s[48:49] offset:32 sc1
global_load_dwordx4 v[44:47], v2, s[46:47] offset:0 sc1
global_load_dwordx4 v[60:63], v2, s[46:47] offset:256 sc1
global_load_dwordx4 v[80:83], v4, s[50:51] offset:1536 sc1
global_load_dwordx4 v[96:99], v3, s[48:49] offset:2048 sc1
global_load_dwordx4 v[112:115], v3, s[48:49] offset:2080 sc1
global_load_dwordx4 v[48:51], v2, s[46:47] offset:2048 sc1
global_load_dwordx4 v[64:67], v2, s[46:47] offset:2304 sc1
s_waitcnt vmcnt(15)
v_mfma_f32_16x16x32_bf16 v[116:119], v[68:71], v[36:39], 0
v_mfma_f32_16x16x32_bf16 v[120:123], v[84:87], v[36:39], 0
v_mfma_f32_16x16x32_bf16 v[124:127], v[100:103], v[36:39], 0
v_mfma_f32_16x16x32_bf16 v[128:131], v[68:71], v[52:55], 0
v_mfma_f32_16x16x32_bf16 v[132:135], v[84:87], v[52:55], 0
v_mfma_f32_16x16x32_bf16 v[136:139], v[100:103], v[52:55], 0
s_waitcnt vmcnt(10)
v_mfma_f32_16x16x32_bf16 v[116:119], v[72:75], v[40:43], v[116:119]
v_mfma_f32_16x16x32_bf16 v[120:123], v[88:91], v[40:43], v[120:123]
v_mfma_f32_16x16x32_bf16 v[124:127], v[104:107], v[40:43], v[124:127]
v_mfma_f32_16x16x32_bf16 v[128:131], v[72:75], v[56:59], v[128:131]
v_mfma_f32_16x16x32_bf16 v[132:135], v[88:91], v[56:59], v[132:135]
v_mfma_f32_16x16x32_bf16 v[136:139], v[104:107], v[56:59], v[136:139]
s_waitcnt vmcnt(5)
v_mfma_f32_16x16x32_bf16 v[116:119], v[76:79], v[44:47], v[116:119]
v_mfma_f32_16x16x32_bf16 v[120:123], v[92:95], v[44:47], v[120:123]
v_mfma_f32_16x16x32_bf16 v[124:127], v[108:111], v[44:47], v[124:127]
v_mfma_f32_16x16x32_bf16 v[128:131], v[76:79], v[60:63], v[128:131]
v_mfma_f32_16x16x32_bf16 v[132:135], v[92:95], v[60:63], v[132:135]
v_mfma_f32_16x16x32_bf16 v[136:139], v[108:111], v[60:63], v[136:139]
s_waitcnt vmcnt(0)
v_mfma_f32_16x16x32_bf16 v[116:119], v[80:83], v[48:51], v[116:119]
v_mfma_f32_16x16x32_bf16 v[120:123], v[96:99], v[48:51], v[120:123]
v_mfma_f32_16x16x32_bf16 v[124:127], v[112:115], v[48:51], v[124:127]
v_mfma_f32_16x16x32_bf16 v[128:131], v[80:83], v[64:67], v[128:131]
v_mfma_f32_16x16x32_bf16 v[132:135], v[96:99], v[64:67], v[132:135]
v_mfma_f32_16x16x32_bf16 v[136:139], v[112:115], v[64:67], v[136:139]
s_nop 2
v_cvt_pk_bf16_f32 v30, v116, v117
v_lshlrev_b32 v140, 16, v30
v_and_b32 v141, 0xffff0000, v30
v_pk_mul_f32 v[140:141], v[140:141], s[66:67]
v_cvt_pk_bf16_f32 v30, v140, v141
v_perm_b32 v140, v30, v10, v8
v_perm_b32 v141, v30, v10, v9
v_cvt_pk_bf16_f32 v30, v118, v119
v_lshlrev_b32 v142, 16, v30
v_and_b32 v143, 0xffff0000, v30
v_pk_mul_f32 v[142:143], v[142:143], s[66:67]
v_cvt_pk_bf16_f32 v30, v142, v143
v_perm_b32 v142, v30, v10, v8
v_perm_b32 v143, v30, v10, v9
v_cvt_pk_bf16_f32 v30, v120, v121
v_lshlrev_b32 v144, 16, v30
v_and_b32 v145, 0xffff0000, v30
v_pk_mul_f32 v[144:145], v[144:145], s[66:67]
v_cvt_pk_bf16_f32 v30, v144, v145
v_lshlrev_b32 v144, 16, v30
v_and_b32 v145, 0xffff0000, v30
v_cvt_pk_bf16_f32 v30, v122, v123
v_lshlrev_b32 v146, 16, v30
v_and_b32 v147, 0xffff0000, v30
v_pk_mul_f32 v[146:147], v[146:147], s[66:67]
v_cvt_pk_bf16_f32 v30, v146, v147
v_lshlrev_b32 v146, 16, v30
v_and_b32 v147, 0xffff0000, v30
v_cvt_pk_bf16_f32 v30, v124, v125
v_lshlrev_b32 v148, 16, v30
v_and_b32 v149, 0xffff0000, v30
v_pk_mul_f32 v[148:149], v[148:149], s[66:67]
v_cvt_pk_bf16_f32 v30, v148, v149
v_lshlrev_b32 v148, 16, v30
v_and_b32 v149, 0xffff0000, v30
v_cvt_pk_bf16_f32 v30, v126, v127
v_lshlrev_b32 v150, 16, v30
v_and_b32 v151, 0xffff0000, v30
v_pk_mul_f32 v[150:151], v[150:151], s[66:67]
v_cvt_pk_bf16_f32 v30, v150, v151
v_lshlrev_b32 v150, 16, v30
v_and_b32 v151, 0xffff0000, v30
v_add_u32 v31, 0, v5
v_cmp_le_i32 vcc, 0, v31
s_nop 1
v_cndmask_b32 v144, v10, v144, vcc
v_cmp_le_i32 vcc, 1, v31
s_nop 1
v_cndmask_b32 v145, v10, v145, vcc
v_cmp_le_i32 vcc, 4, v31
s_nop 1
v_cndmask_b32 v146, v10, v146, vcc
v_cmp_le_i32 vcc, 5, v31
s_nop 1
v_cndmask_b32 v147, v10, v147, vcc
v_cmp_le_i32 vcc, 2, v31
s_nop 1
v_cndmask_b32 v148, v10, v148, vcc
v_cmp_le_i32 vcc, 3, v31
s_nop 1
v_cndmask_b32 v149, v10, v149, vcc
v_cmp_le_i32 vcc, 6, v31
s_nop 1
v_cndmask_b32 v150, v10, v150, vcc
v_cmp_le_i32 vcc, 7, v31
s_nop 1
v_cndmask_b32 v151, v10, v151, vcc
v_max3_f32 v32, v140, v141, v142
v_max3_f32 v32, v32, v143, v144
v_max3_f32 v32, v32, v145, v146
v_max3_f32 v32, v32, v147, v148
v_max3_f32 v32, v32, v149, v150
v_max_f32 v32, v32, v151
v_mov_b32 v33, v32
s_nop 1
v_permlane16_swap_b32 v32, v33
v_max_f32 v32, v32, v33
v_mov_b32 v33, v32
s_nop 1
v_permlane32_swap_b32 v32, v33
v_max_f32 v32, v32, v33
v_mul_f32 v32, s68, v32
v_fma_f32 v140, v140, s68, -v32
v_fma_f32 v141, v141, s68, -v32
v_fma_f32 v142, v142, s68, -v32
v_fma_f32 v143, v143, s68, -v32
v_fma_f32 v144, v144, s68, -v32
v_fma_f32 v145, v145, s68, -v32
v_fma_f32 v146, v146, s68, -v32
v_fma_f32 v147, v147, s68, -v32
v_fma_f32 v148, v148, s68, -v32
v_fma_f32 v149, v149, s68, -v32
v_fma_f32 v150, v150, s68, -v32
v_fma_f32 v151, v151, s68, -v32
v_exp_f32 v140, v140
v_exp_f32 v141, v141
v_exp_f32 v142, v142
v_exp_f32 v143, v143
v_exp_f32 v144, v144
v_exp_f32 v145, v145
v_exp_f32 v146, v146
v_exp_f32 v147, v147
v_exp_f32 v148, v148
v_exp_f32 v149, v149
v_exp_f32 v150, v150
v_exp_f32 v151, v151
v_add_f32 v34, v140, v141
v_add_f32 v34, v34, v142
v_add_f32 v34, v34, v143
v_add_f32 v34, v34, v144
v_add_f32 v34, v34, v145
v_add_f32 v34, v34, v146
v_add_f32 v34, v34, v147
v_add_f32 v34, v34, v148
v_add_f32 v34, v34, v149
v_add_f32 v34, v34, v150
v_add_f32 v34, v34, v151
v_mov_b32 v33, v34
s_nop 1
v_permlane16_swap_b32 v34, v33
v_add_f32 v34, v34, v33
v_mov_b32 v33, v34
s_nop 1
v_permlane32_swap_b32 v34, v33
v_add_f32 v34, v34, v33
v_rcp_f32 v34, v34
s_nop 0
v_mul_f32 v140, v140, v34
v_mul_f32 v141, v141, v34
v_mul_f32 v142, v142, v34
v_mul_f32 v143, v143, v34
v_mul_f32 v144, v144, v34
v_mul_f32 v145, v145, v34
v_mul_f32 v146, v146, v34
v_mul_f32 v147, v147, v34
v_mul_f32 v148, v148, v34
v_mul_f32 v149, v149, v34
v_mul_f32 v150, v150, v34
v_mul_f32 v151, v151, v34
v_cvt_pk_bf16_f32 v116, v140, v141
v_cvt_pk_bf16_f32 v117, v142, v143
v_cvt_pk_bf16_f32 v120, v144, v145
v_cvt_pk_bf16_f32 v121, v146, v147
v_cvt_pk_bf16_f32 v122, v148, v149
v_cvt_pk_bf16_f32 v123, v150, v151
global_store_dwordx4 v6, v[120:123], s[52:53] offset:0 sc1
s_mov_b64 exec, s[64:65]
global_store_dwordx2 v7, v[116:117], s[52:53] offset:0 sc1
s_mov_b64 exec, -1
v_cvt_pk_bf16_f32 v30, v128, v129
v_lshlrev_b32 v140, 16, v30
v_and_b32 v141, 0xffff0000, v30
v_pk_mul_f32 v[140:141], v[140:141], s[66:67]
v_cvt_pk_bf16_f32 v30, v140, v141
v_perm_b32 v140, v30, v10, v8
v_perm_b32 v141, v30, v10, v9
v_cvt_pk_bf16_f32 v30, v130, v131
v_lshlrev_b32 v142, 16, v30
v_and_b32 v143, 0xffff0000, v30
v_pk_mul_f32 v[142:143], v[142:143], s[66:67]
v_cvt_pk_bf16_f32 v30, v142, v143
v_perm_b32 v142, v30, v10, v8
v_perm_b32 v143, v30, v10, v9
v_cvt_pk_bf16_f32 v30, v132, v133
v_lshlrev_b32 v144, 16, v30
v_and_b32 v145, 0xffff0000, v30
v_pk_mul_f32 v[144:145], v[144:145], s[66:67]
v_cvt_pk_bf16_f32 v30, v144, v145
v_lshlrev_b32 v144, 16, v30
v_and_b32 v145, 0xffff0000, v30
v_cvt_pk_bf16_f32 v30, v134, v135
v_lshlrev_b32 v146, 16, v30
v_and_b32 v147, 0xffff0000, v30
v_pk_mul_f32 v[146:147], v[146:147], s[66:67]
v_cvt_pk_bf16_f32 v30, v146, v147
v_lshlrev_b32 v146, 16, v30
v_and_b32 v147, 0xffff0000, v30
v_cvt_pk_bf16_f32 v30, v136, v137
v_lshlrev_b32 v148, 16, v30
v_and_b32 v149, 0xffff0000, v30
v_pk_mul_f32 v[148:149], v[148:149], s[66:67]
v_cvt_pk_bf16_f32 v30, v148, v149
v_lshlrev_b32 v148, 16, v30
v_and_b32 v149, 0xffff0000, v30
v_cvt_pk_bf16_f32 v30, v138, v139
v_lshlrev_b32 v150, 16, v30
v_and_b32 v151, 0xffff0000, v30
v_pk_mul_f32 v[150:151], v[150:151], s[66:67]
v_cvt_pk_bf16_f32 v30, v150, v151
v_lshlrev_b32 v150, 16, v30
v_and_b32 v151, 0xffff0000, v30
v_add_u32 v31, 16, v5
v_cmp_le_i32 vcc, 0, v31
s_nop 1
v_cndmask_b32 v144, v10, v144, vcc
v_cmp_le_i32 vcc, 1, v31
s_nop 1
v_cndmask_b32 v145, v10, v145, vcc
v_cmp_le_i32 vcc, 4, v31
s_nop 1
v_cndmask_b32 v146, v10, v146, vcc
v_cmp_le_i32 vcc, 5, v31
s_nop 1
v_cndmask_b32 v147, v10, v147, vcc
v_cmp_le_i32 vcc, 2, v31
s_nop 1
v_cndmask_b32 v148, v10, v148, vcc
v_cmp_le_i32 vcc, 3, v31
s_nop 1
v_cndmask_b32 v149, v10, v149, vcc
v_cmp_le_i32 vcc, 6, v31
s_nop 1
v_cndmask_b32 v150, v10, v150, vcc
v_cmp_le_i32 vcc, 7, v31
s_nop 1
v_cndmask_b32 v151, v10, v151, vcc
v_max3_f32 v32, v140, v141, v142
v_max3_f32 v32, v32, v143, v144
v_max3_f32 v32, v32, v145, v146
v_max3_f32 v32, v32, v147, v148
v_max3_f32 v32, v32, v149, v150
v_max_f32 v32, v32, v151
v_mov_b32 v33, v32
s_nop 1
v_permlane16_swap_b32 v32, v33
v_max_f32 v32, v32, v33
v_mov_b32 v33, v32
s_nop 1
v_permlane32_swap_b32 v32, v33
v_max_f32 v32, v32, v33
v_mul_f32 v32, s68, v32
v_fma_f32 v140, v140, s68, -v32
v_fma_f32 v141, v141, s68, -v32
v_fma_f32 v142, v142, s68, -v32
v_fma_f32 v143, v143, s68, -v32
v_fma_f32 v144, v144, s68, -v32
v_fma_f32 v145, v145, s68, -v32
v_fma_f32 v146, v146, s68, -v32
v_fma_f32 v147, v147, s68, -v32
v_fma_f32 v148, v148, s68, -v32
v_fma_f32 v149, v149, s68, -v32
v_fma_f32 v150, v150, s68, -v32
v_fma_f32 v151, v151, s68, -v32
v_exp_f32 v140, v140
v_exp_f32 v141, v141
v_exp_f32 v142, v142
v_exp_f32 v143, v143
v_exp_f32 v144, v144
v_exp_f32 v145, v145
v_exp_f32 v146, v146
v_exp_f32 v147, v147
v_exp_f32 v148, v148
v_exp_f32 v149, v149
v_exp_f32 v150, v150
v_exp_f32 v151, v151
v_add_f32 v34, v140, v141
v_add_f32 v34, v34, v142
v_add_f32 v34, v34, v143
v_add_f32 v34, v34, v144
v_add_f32 v34, v34, v145
v_add_f32 v34, v34, v146
v_add_f32 v34, v34, v147
v_add_f32 v34, v34, v148
v_add_f32 v34, v34, v149
v_add_f32 v34, v34, v150
v_add_f32 v34, v34, v151
v_mov_b32 v33, v34
s_nop 1
v_permlane16_swap_b32 v34, v33
v_add_f32 v34, v34, v33
v_mov_b32 v33, v34
s_nop 1
v_permlane32_swap_b32 v34, v33
v_add_f32 v34, v34, v33
v_rcp_f32 v34, v34
s_nop 0
v_mul_f32 v140, v140, v34
v_mul_f32 v141, v141, v34
v_mul_f32 v142, v142, v34
v_mul_f32 v143, v143, v34
v_mul_f32 v144, v144, v34
v_mul_f32 v145, v145, v34
v_mul_f32 v146, v146, v34
v_mul_f32 v147, v147, v34
v_mul_f32 v148, v148, v34
v_mul_f32 v149, v149, v34
v_mul_f32 v150, v150, v34
v_mul_f32 v151, v151, v34
v_cvt_pk_bf16_f32 v128, v140, v141
v_cvt_pk_bf16_f32 v129, v142, v143
v_cvt_pk_bf16_f32 v132, v144, v145
v_cvt_pk_bf16_f32 v133, v146, v147
v_cvt_pk_bf16_f32 v134, v148, v149
v_cvt_pk_bf16_f32 v135, v150, v151
global_store_dwordx4 v6, v[132:135], s[52:53] offset:1024 sc1
s_mov_b64 exec, s[64:65]
global_store_dwordx2 v7, v[128:129], s[52:53] offset:256 sc1
s_mov_b64 exec, -1
s_waitcnt vmcnt(0)
s_lshl_b32 s44, s30, 5
s_add_u32 s44, s44, s16
s_lshl_b32 s44, s44, 2
s_add_u32 s44, s44, 46178304
v_mov_b32 v30, s44
v_mov_b32 v31, 1
global_store_dword v30, v31, s[4:5] sc1
s_add_u32 s30, s30, 3
s_cmp_lt_u32 s30, 64
s_cbranch_scc1 E2l_6
s_waitcnt vmcnt(0)
s_endpgm
L_e3:
s_sub_u32 s41, s29, 24
s_mul_hi_u32 s23, s41, 429496730
s_mul_i32 s40, s23, 10
s_sub_u32 s24, s41, s40
s_load_dwordx2 s[18:19], s[0:1], 128
v_and_b32 v30, 15, v1
v_lshrrev_b32 v31, 4, v1
s_lshl_b32 s25, s24, 2
s_add_u32 s25, s25, s3
s_and_b32 s26, s25, 15
s_lshr_b32 s27, s25, 4
s_mul_i32 s40, s26, 49152
s_lshl_b32 s41, s27, 10
s_add_u32 s40, s40, s41
v_lshlrev_b32 v7, 4, v1
v_add_u32 v2, s40, v7
s_mul_i32 s40, s26, 12288
s_lshl_b32 s41, s27, 8
s_add_u32 s40, s40, s41
v_mul_u32_u24 v32, 768, v31
v_lshl_add_u32 v32, v30, 4, v32
v_add_u32 v3, s40, v32
v_mov_b32 v4, v7
v_mul_u32_u24 v32, 2560, v31
v_lshl_add_u32 v32, v30, 4, v32
v_add_u32 v5, 2048, v32
v_mul_u32_u24 v32, 2560, v30
v_lshl_add_u32 v32, v31, 3, v32
s_lshl_b32 s40, s25, 5
s_add_u32 s40, s40, 1280
v_add_u32 v6, s40, v32
v_add_u32 v8, 65536, v4
v_add_u32 v9, 57344, v5
s_waitcnt lgkmcnt(0)
s_mov_b32 s30, s23
E3l_10:
s_lshl_b32 s44, s30, 7
v_and_b32 v30, 31, v1
v_lshlrev_b32 v30, 2, v30
v_add_u32 v30, s44, v30
v_add_u32 v31, 46153728, v30
e3w_11:
global_load_dword v33, v31, s[4:5] sc1
s_waitcnt vmcnt(0)
v_cmp_eq_u32 vcc, 0, v33
s_nop 3
s_cbranch_vccz e3g_12
s_sleep 2
s_add_u32 s100, s100, 16
s_cmp_lt_u32 s100, 0x1000000
s_cbranch_scc1 e3w_11
s_endpgm
e3g_12:
s_mul_i32 s44, s30, 1572864
s_add_u32 s48, s4, s44
s_addc_u32 s49, s5, 0
s_add_u32 s48, s48, 75497472
s_addc_u32 s49, s49, 0
s_add_u32 s52, s48, 0
s_addc_u32 s53, s49, 0
global_load_dwordx4 v[36:39], v2, s[52:53] sc1
s_add_u32 s52, s48, 3072
s_addc_u32 s53, s49, 0
global_load_dwordx4 v[40:43], v2, s[52:53] sc1
s_add_u32 s52, s48, 6144
s_addc_u32 s53, s49, 0
global_load_dwordx4 v[44:47], v2, s[52:53] sc1
s_add_u32 s52, s48, 9216
s_addc_u32 s53, s49, 0
global_load_dwordx4 v[48:51], v2, s[52:53] sc1
s_add_u32 s52, s48, 12288
s_addc_u32 s53, s49, 0
global_load_dwordx4 v[52:55], v2, s[52:53] sc1
s_add_u32 s52, s48, 15360
s_addc_u32 s53, s49, 0
global_load_dwordx4 v[56:59], v2, s[52:53] sc1
s_add_u32 s52, s48, 18432
s_addc_u32 s53, s49, 0
global_load_dwordx4 v[60:63], v2, s[52:53] sc1
s_add_u32 s52, s48, 21504
s_addc_u32 s53, s49, 0
global_load_dwordx4 v[64:67], v2, s[52:53] sc1
s_add_u32 s52, s48, 24576
s_addc_u32 s53, s49, 0
global_load_dwordx4 v[68:71], v2, s[52:53] sc1
s_add_u32 s52, s48, 27648
s_addc_u32 s53, s49, 0
global_load_dwordx4 v[72:75], v2, s[52:53] sc1
s_add_u32 s52, s48, 30720
s_addc_u32 s53, s49, 0
global_load_dwordx4 v[76:79], v2, s[52:53] sc1
s_add_u32 s52, s48, 33792
s_addc_u32 s53, s49, 0
global_load_dwordx4 v[80:83], v2, s[52:53] sc1
s_add_u32 s52, s48, 36864
s_addc_u32 s53, s49, 0
global_load_dwordx4 v[84:87], v2, s[52:53] sc1
s_add_u32 s52, s48, 39936
s_addc_u32 s53, s49, 0
global_load_dwordx4 v[88:91], v2, s[52:53] sc1
s_add_u32 s52, s48, 43008
s_addc_u32 s53, s49, 0
global_load_dwordx4 v[92:95], v2, s[52:53] sc1
s_add_u32 s52, s48, 46080
s_addc_u32 s53, s49, 0
global_load_dwordx4 v[96:99], v2, s[52:53] sc1
s_add_u32 s52, s48, 786432
s_addc_u32 s53, s49, 0
global_load_dwordx4 v[100:103], v2, s[52:53] sc1
s_add_u32 s52, s48, 789504
s_addc_u32 s53, s49, 0
global_load_dwordx4 v[104:107], v2, s[52:53] sc1
s_add_u32 s52, s48, 792576
s_addc_u32 s53, s49, 0
global_load_dwordx4 v[108:111], v2, s[52:53] sc1
s_add_u32 s52, s48, 795648
s_addc_u32 s53, s49, 0
global_load_dwordx4 v[112:115], v2, s[52:53] sc1
s_add_u32 s52, s48, 798720
s_addc_u32 s53, s49, 0
global_load_dwordx4 v[116:119], v2, s[52:53] sc1
s_add_u32 s52, s48, 801792
s_addc_u32 s53, s49, 0
global_load_dwordx4 v[120:123], v2, s[52:53] sc1
s_add_u32 s52, s48, 804864
s_addc_u32 s53, s49, 0
global_load_dwordx4 v[124:127], v2, s[52:53] sc1
s_add_u32 s52, s48, 807936
s_addc_u32 s53, s49, 0
global_load_dwordx4 v[128:131], v2, s[52:53] sc1
s_add_u32 s52, s48, 811008
s_addc_u32 s53, s49, 0
global_load_dwordx4 v[132:135], v2, s[52:53] sc1
s_add_u32 s52, s48, 814080
s_addc_u32 s53, s49, 0
global_load_dwordx4 v[136:139], v2, s[52:53] sc1
s_add_u32 s52, s48, 817152
s_addc_u32 s53, s49, 0
global_load_dwordx4 v[140:143], v2, s[52:53] sc1
s_add_u32 s52, s48, 820224
s_addc_u32 s53, s49, 0
global_load_dwordx4 v[144:147], v2, s[52:53] sc1
s_add_u32 s52, s48, 823296
s_addc_u32 s53, s49, 0
global_load_dwordx4 v[148:151], v2, s[52:53] sc1
s_add_u32 s52, s48, 826368
s_addc_u32 s53, s49, 0
global_load_dwordx4 v[152:155], v2, s[52:53] sc1
s_add_u32 s52, s48, 829440
s_addc_u32 s53, s49, 0
global_load_dwordx4 v[156:159], v2, s[52:53] sc1
s_add_u32 s52, s48, 832512
s_addc_u32 s53, s49, 0
global_load_dwordx4 v[160:163], v2, s[52:53] sc1
s_lshl_b32 s44, s30, 7
v_and_b32 v30, 31, v1
v_lshlrev_b32 v30, 2, v30
v_add_u32 v30, s44, v30
v_add_u32 v31, 46178304, v30
v_add_u32 v32, 46170112, v30
e3w_13:
global_load_dword v33, v31, s[4:5] sc1
global_load_dword v34, v32, s[4:5] sc1
s_waitcnt vmcnt(0)
v_min_u32 v33, v33, v34
v_cmp_eq_u32 vcc, 0, v33
s_nop 3
s_cbranch_vccz e3g_14
s_sleep 2
s_add_u32 s100, s100, 16
s_cmp_lt_u32 s100, 0x1000000
s_cbranch_scc1 e3w_13
s_endpgm
e3g_14:
s_barrier
s_mul_i32 s44, s30, 81920
s_add_u32 s44, s44, 37748736
s_mul_i32 s45, s3, 20480
s_add_u32 s44, s44, s45
s_add_u32 s46, s4, s44
s_addc_u32 s47, s5, 0
s_add_u32 m0, s45, 0
s_nop 0
global_load_lds_dwordx4 v7, s[46:47] offset:0 sc1
s_add_u32 m0, s45, 0
s_nop 0
global_load_lds_dwordx4 v7, s[46:47] offset:1024 sc1
s_add_u32 m0, s45, 0
s_nop 0
global_load_lds_dwordx4 v7, s[46:47] offset:2048 sc1
s_add_u32 m0, s45, 0
s_nop 0
global_load_lds_dwordx4 v7, s[46:47] offset:3072 sc1
s_add_u32 s46, s46, 4096
s_addc_u32 s47, s47, 0
s_add_u32 m0, s45, 4096
s_nop 0
global_load_lds_dwordx4 v7, s[46:47] offset:0 sc1
s_add_u32 m0, s45, 4096
s_nop 0
global_load_lds_dwordx4 v7, s[46:47] offset:1024 sc1
s_add_u32 m0, s45, 4096
s_nop 0
global_load_lds_dwordx4 v7, s[46:47] offset:2048 sc1
s_add_u32 m0, s45, 4096
s_nop 0
global_load_lds_dwordx4 v7, s[46:47] offset:3072 sc1
s_add_u32 s46, s46, 4096
s_addc_u32 s47, s47, 0
s_add_u32 m0, s45, 8192
s_nop 0
global_load_lds_dwordx4 v7, s[46:47] offset:0 sc1
s_add_u32 m0, s45, 8192
s_nop 0
global_load_lds_dwordx4 v7, s[46:47] offset:1024 sc1
s_add_u32 m0, s45, 8192
s_nop 0
global_load_lds_dwordx4 v7, s[46:47] offset:2048 sc1
s_add_u32 m0, s45, 8192
s_nop 0
global_load_lds_dwordx4 v7, s[46:47] offset:3072 sc1
s_add_u32 s46, s46, 4096
s_addc_u32 s47, s47, 0
s_add_u32 m0, s45, 12288
s_nop 0
global_load_lds_dwordx4 v7, s[46:47] offset:0 sc1
s_add_u32 m0, s45, 12288
s_nop 0
global_load_lds_dwordx4 v7, s[46:47] offset:1024 sc1
s_add_u32 m0, s45, 12288
s_nop 0
global_load_lds_dwordx4 v7, s[46:47] offset:2048 sc1
s_add_u32 m0, s45, 12288
s_nop 0
global_load_lds_dwordx4 v7, s[46:47] offset:3072 sc1
s_add_u32 s46, s46, 4096
s_addc_u32 s47, s47, 0
s_add_u32 m0, s45, 16384
s_nop 0
global_load_lds_dwordx4 v7, s[46:47] offset:0 sc1
s_add_u32 m0, s45, 16384
s_nop 0
global_load_lds_dwordx4 v7, s[46:47] offset:1024 sc1
s_add_u32 m0, s45, 16384
s_nop 0
global_load_lds_dwordx4 v7, s[46:47] offset:2048 sc1
s_add_u32 m0, s45, 16384
s_nop 0
global_load_lds_dwordx4 v7, s[46:47] offset:3072 sc1
s_mul_i32 s44, s30, 393216
s_add_u32 s50, s4, s44
s_addc_u32 s51, s5, 0
s_add_u32 s50, s50, 50331648
s_addc_u32 s51, s51, 0
s_add_u32 s52, s50, 0
s_addc_u32 s53, s51, 0
global_load_dwordx4 v[164:167], v3, s[52:53] sc1
s_add_u32 s52, s50, 3072
s_addc_u32 s53, s51, 0
global_load_dwordx4 v[168:171], v3, s[52:53] sc1
s_add_u32 s52, s50, 6144
s_addc_u32 s53, s51, 0
global_load_dwordx4 v[172:175], v3, s[52:53] sc1
s_add_u32 s52, s50, 9216
s_addc_u32 s53, s51, 0
global_load_dwordx4 v[176:179], v3, s[52:53] sc1
s_add_u32 s52, s50, 196608
s_addc_u32 s53, s51, 0
global_load_dwordx4 v[180:183], v3, s[52:53] sc1
s_add_u32 s52, s50, 199680
s_addc_u32 s53, s51, 0
global_load_dwordx4 v[184:187], v3, s[52:53] sc1
s_add_u32 s52, s50, 202752
s_addc_u32 s53, s51, 0
global_load_dwordx4 v[188:191], v3, s[52:53] sc1
s_add_u32 s52, s50, 205824
s_addc_u32 s53, s51, 0
global_load_dwordx4 v[192:195], v3, s[52:53] sc1
s_waitcnt vmcnt(8)
s_barrier
ds_read_b128 v[196:199], v4 offset:0
ds_read_b128 v[200:203], v4 offset:1024
ds_read_b128 v[204:207], v4 offset:2560
ds_read_b128 v[208:211], v4 offset:3584
ds_read_b128 v[212:215], v4 offset:5120
ds_read_b128 v[216:219], v4 offset:6144
ds_read_b128 v[220:223], v4 offset:7680
ds_read_b128 v[224:227], v4 offset:8704
s_waitcnt lgkmcnt(6)
v_mfma_f32_16x16x32_bf16 v[228:231], v[36:39], v[196:199], 0
v_mfma_f32_16x16x32_bf16 v[232:235], v[36:39], v[200:203], 0
ds_read_b128 v[196:199], v4 offset:10240
ds_read_b128 v[200:203], v4 offset:11264
s_waitcnt lgkmcnt(6)
v_mfma_f32_16x16x32_bf16 v[228:231], v[40:43], v[204:207], v[228:231]
v_mfma_f32_16x16x32_bf16 v[232:235], v[40:43], v[208:211], v[232:235]
ds_read_b128 v[204:207], v4 offset:12800
ds_read_b128 v[208:211], v4 offset:13824
s_waitcnt lgkmcnt(6)
v_mfma_f32_16x16x32_bf16 v[228:231], v[44:47], v[212:215], v[228:231]
v_mfma_f32_16x16x32_bf16 v[232:235], v[44:47], v[216:219], v[232:235]
ds_read_b128 v[212:215], v4 offset:15360
ds_read_b128 v[216:219], v4 offset:16384
s_waitcnt lgkmcnt(6)
v_mfma_f32_16x16x32_bf16 v[228:231], v[48:51], v[220:223], v[228:231]
v_mfma_f32_16x16x32_bf16 v[232:235], v[48:51], v[224:227], v[232:235]
ds_read_b128 v[220:223], v4 offset:17920
ds_read_b128 v[224:227], v4 offset:18944
s_waitcnt lgkmcnt(6)
v_mfma_f32_16x16x32_bf16 v[228:231], v[52:55], v[196:199], v[228:231]
v_mfma_f32_16x16x32_bf16 v[232:235], v[52:55], v[200:203], v[232:235]
ds_read_b128 v[196:199], v4 offset:20480
ds_read_b128 v[200:203], v4 offset:21504
s_waitcnt lgkmcnt(6)
v_mfma_f32_16x16x32_bf16 v[228:231], v[56:59], v[204:207], v[228:231]
v_mfma_f32_16x16x32_bf16 v[232:235], v[56:59], v[208:211], v[232:235]
ds_read_b128 v[204:207], v4 offset:23040
ds_read_b128 v[208:211], v4 offset:24064
s_waitcnt lgkmcnt(6)
v_mfma_f32_16x16x32_bf16 v[228:231], v[60:63], v[212:215], v[228:231]
v_mfma_f32_16x16x32_bf16 v[232:235], v[60:63], v[216:219], v[232:235]
ds_read_b128 v[212:215], v4 offset:25600
ds_read_b128 v[216:219], v4 offset:26624
s_waitcnt lgkmcnt(6)
v_mfma_f32_16x16x32_bf16 v[228:231], v[64:67], v[220:223], v[228:231]
v_mfma_f32_16x16x32_bf16 v[232:235], v[64:67], v[224:227], v[232:235]
ds_read_b128 v[220:223], v4 offset:28160
ds_read_b128 v[224:227], v4 offset:29184
s_waitcnt lgkmcnt(6)
v_mfma_f32_16x16x32_bf16 v[228:231], v[68:71], v[196:199], v[228:231]
v_mfma_f32_16x16x32_bf16 v[232:235], v[68:71], v[200:203], v[232:235]
ds_read_b128 v[196:199], v4 offset:30720
ds_read_b128 v[200:203], v4 offset:31744
s_waitcnt lgkmcnt(6)
v_mfma_f32_16x16x32_bf16 v[228:231], v[72:75], v[204:207], v[228:231]
v_mfma_f32_16x16x32_bf16 v[232:235], v[72:75], v[208:211], v[232:235]
ds_read_b128 v[204:207], v4 offset:33280
ds_read_b128 v[208:211], v4 offset:34304
s_waitcnt lgkmcnt(6)
v_mfma_f32_16x16x32_bf16 v[228:231], v[76:79], v[212:215], v[228:231]
v_mfma_f32_16x16x32_bf16 v[232:235], v[76:79], v[216:219], v[232:235]
ds_read_b128 v[212:215], v4 offset:35840
ds_read_b128 v[216:219], v4 offset:36864
s_waitcnt lgkmcnt(6)
v_mfma_f32_16x16x32_bf16 v[228:231], v[80:83], v[220:223], v[228:231]
v_mfma_f32_16x16x32_bf16 v[232:235], v[80:83], v[224:227], v[232:235]
ds_read_b128 v[220:223], v4 offset:38400
ds_read_b128 v[224:227], v4 offset:39424
s_waitcnt lgkmcnt(6)
v_mfma_f32_16x16x32_bf16 v[228:231], v[84:87], v[196:199], v[228:231]
v_mfma_f32_16x16x32_bf16 v[232:235], v[84:87], v[200:203], v[232:235]
ds_read_b128 v[196:199], v4 offset:40960
ds_read_b128 v[200:203], v4 offset:41984
s_waitcnt lgkmcnt(6)
v_mfma_f32_16x16x32_bf16 v[228:231], v[88:91], v[204:207], v[228:231]
v_mfma_f32_16x16x32_bf16 v[232:235], v[88:91], v[208:211], v[232:235]
ds_read_b128 v[204:207], v4 offset:43520
ds_read_b128 v[208:211], v4 offset:44544
s_waitcnt lgkmcnt(6)
v_mfma_f32_16x16x32_bf16 v[228:231], v[92:95], v[212:215], v[228:231]
v_mfma_f32_16x16x32_bf16 v[232:235], v[92:95], v[216:219], v[232:235]
ds_read_b128 v[212:215], v4 offset:46080
ds_read_b128 v[216:219], v4 offset:47104
s_waitcnt lgkmcnt(6)
v_mfma_f32_16x16x32_bf16 v[228:231], v[96:99], v[220:223], v[228:231]
v_mfma_f32_16x16x32_bf16 v[232:235], v[96:99], v[224:227], v[232:235]
ds_read_b128 v[220:223], v4 offset:48640
ds_read_b128 v[224:227], v4 offset:49664
s_waitcnt lgkmcnt(6)
v_mfma_f32_16x16x32_bf16 v[228:231], v[100:103], v[196:199], v[228:231]
v_mfma_f32_16x16x32_bf16 v[232:235], v[100:103], v[200:203], v[232:235]
ds_read_b128 v[196:199], v4 offset:51200
ds_read_b128 v[200:203], v4 offset:52224
s_waitcnt lgkmcnt(6)
v_mfma_f32_16x16x32_bf16 v[228:231], v[104:107], v[204:207], v[228:231]
v_mfma_f32_16x16x32_bf16 v[232:235], v[104:107], v[208:211], v[232:235]
ds_read_b128 v[204:207], v4 offset:53760
ds_read_b128 v[208:211], v4 offset:54784
s_waitcnt lgkmcnt(6)
v_mfma_f32_16x16x32_bf16 v[228:231], v[108:111], v[212:215], v[228:231]
v_mfma_f32_16x16x32_bf16 v[232:235], v[108:111], v[216:219], v[232:235]
ds_read_b128 v[212:215], v4 offset:56320
ds_read_b128 v[216:219], v4 offset:57344
s_waitcnt lgkmcnt(6)
v_mfma_f32_16x16x32_bf16 v[228:231], v[112:115], v[220:223], v[228:231]
v_mfma_f32_16x16x32_bf16 v[232:235], v[112:115], v[224:227], v[232:235]
ds_read_b128 v[220:223], v4 offset:58880
ds_read_b128 v[224:227], v4 offset:59904
s_waitcnt lgkmcnt(6)
v_mfma_f32_16x16x32_bf16 v[228:231], v[116:119], v[196:199], v[228:231]
v_mfma_f32_16x16x32_bf16 v[232:235], v[116:119], v[200:203], v[232:235]
ds_read_b128 v[196:199], v4 offset:61440
ds_read_b128 v[200:203], v4 offset:62464
s_waitcnt lgkmcnt(6)
v_mfma_f32_16x16x32_bf16 v[228:231], v[120:123], v[204:207], v[228:231]
v_mfma_f32_16x16x32_bf16 v[232:235], v[120:123], v[208:211], v[232:235]
ds_read_b128 v[204:207], v4 offset:64000
ds_read_b128 v[208:211], v4 offset:65024
s_waitcnt lgkmcnt(6)
v_mfma_f32_16x16x32_bf16 v[228:231], v[124:127], v[212:215], v[228:231]
v_mfma_f32_16x16x32_bf16 v[232:235], v[124:127], v[216:219], v[232:235]
ds_read_b128 v[212:215], v8 offset:1024
ds_read_b128 v[216:219], v8 offset:2048
s_waitcnt lgkmcnt(6)
v_mfma_f32_16x16x32_bf16 v[228:231], v[128:131], v[220:223], v[228:231]
v_mfma_f32_16x16x32_bf16 v[232:235], v[128:131], v[224:227], v[232:235]
ds_read_b128 v[220:223], v8 offset:3584
ds_read_b128 v[224:227], v8 offset:4608
s_waitcnt lgkmcnt(6)
v_mfma_f32_16x16x32_bf16 v[228:231], v[132:135], v[196:199], v[228:231]
v_mfma_f32_16x16x32_bf16 v[232:235], v[132:135], v[200:203], v[232:235]
ds_read_b128 v[196:199], v8 offset:6144
ds_read_b128 v[200:203], v8 offset:7168
s_waitcnt lgkmcnt(6)
v_mfma_f32_16x16x32_bf16 v[228:231], v[136:139], v[204:207], v[228:231]
v_mfma_f32_16x16x32_bf16 v[232:235], v[136:139], v[208:211], v[232:235]
ds_read_b128 v[204:207], v8 offset:8704
ds_read_b128 v[208:211], v8 offset:9728
s_waitcnt lgkmcnt(6)
v_mfma_f32_16x16x32_bf16 v[228:231], v[140:143], v[212:215], v[228:231]
v_mfma_f32_16x16x32_bf16 v[232:235], v[140:143], v[216:219], v[232:235]
ds_read_b128 v[212:215], v8 offset:11264
ds_read_b128 v[216:219], v8 offset:12288
s_waitcnt lgkmcnt(6)
v_mfma_f32_16x16x32_bf16 v[228:231], v[144:147], v[220:223], v[228:231]
v_mfma_f32_16x16x32_bf16 v[232:235], v[144:147], v[224:227], v[232:235]
ds_read_b128 v[220:223], v8 offset:13824
ds_read_b128 v[224:227], v8 offset:14848
s_waitcnt lgkmcnt(6)
v_mfma_f32_16x16x32_bf16 v[228:231], v[148:151], v[196:199], v[228:231]
v_mfma_f32_16x16x32_bf16 v[232:235], v[148:151], v[200:203], v[232:235]
ds_read_b128 v[196:199], v5 offset:0
ds_read_b128 v[200:203], v5 offset:256
s_waitcnt lgkmcnt(6)
v_mfma_f32_16x16x32_bf16 v[228:231], v[152:155], v[204:207], v[228:231]
v_mfma_f32_16x16x32_bf16 v[232:235], v[152:155], v[208:211], v[232:235]
ds_read_b128 v[204:207], v5 offset:10240
ds_read_b128 v[208:211], v5 offset:10496
s_waitcnt lgkmcnt(6)
v_mfma_f32_16x16x32_bf16 v[228:231], v[156:159], v[212:215], v[228:231]
v_mfma_f32_16x16x32_bf16 v[232:235], v[156:159], v[216:219], v[232:235]
ds_read_b128 v[212:215], v5 offset:20480
ds_read_b128 v[216:219], v5 offset:20736
s_waitcnt lgkmcnt(6)
v_mfma_f32_16x16x32_bf16 v[228:231], v[160:163], v[220:223], v[228:231]
v_mfma_f32_16x16x32_bf16 v[232:235], v[160:163], v[224:227], v[232:235]
ds_read_b128 v[220:223], v5 offset:30720
ds_read_b128 v[224:227], v5 offset:30976
s_waitcnt vmcnt(0)
s_waitcnt lgkmcnt(6)
v_mfma_f32_16x16x32_bf16 v[228:231], v[164:167], v[196:199], v[228:231]
v_mfma_f32_16x16x32_bf16 v[232:235], v[164:167], v[200:203], v[232:235]
ds_read_b128 v[196:199], v5 offset:40960
ds_read_b128 v[200:203], v5 offset:41216
s_waitcnt lgkmcnt(6)
v_mfma_f32_16x16x32_bf16 v[228:231], v[168:171], v[204:207], v[228:231]
v_mfma_f32_16x16x32_bf16 v[232:235], v[168:171], v[208:211], v[232:235]
ds_read_b128 v[204:207], v5 offset:51200
ds_read_b128 v[208:211], v5 offset:51456
s_waitcnt lgkmcnt(6)
v_mfma_f32_16x16x32_bf16 v[228:231], v[172:175], v[212:215], v[228:231]
v_mfma_f32_16x16x32_bf16 v[232:235], v[172:175], v[216:219], v[232:235]
ds_read_b128 v[212:215], v9 offset:4096
ds_read_b128 v[216:219], v9 offset:4352
s_waitcnt lgkmcnt(6)
v_mfma_f32_16x16x32_bf16 v[228:231], v[176:179], v[220:223], v[228:231]
v_mfma_f32_16x16x32_bf16 v[232:235], v[176:179], v[224:227], v[232:235]
ds_read_b128 v[220:223], v9 offset:14336
ds_read_b128 v[224:227], v9 offset:14592
s_waitcnt lgkmcnt(6)
v_mfma_f32_16x16x32_bf16 v[228:231], v[180:183], v[196:199], v[228:231]
v_mfma_f32_16x16x32_bf16 v[232:235], v[180:183], v[200:203], v[232:235]
s_waitcnt lgkmcnt(4)
v_mfma_f32_16x16x32_bf16 v[228:231], v[184:187], v[204:207], v[228:231]
v_mfma_f32_16x16x32_bf16 v[232:235], v[184:187], v[208:211], v[232:235]
s_waitcnt lgkmcnt(2)
v_mfma_f32_16x16x32_bf16 v[228:231], v[188:191], v[212:215], v[228:231]
v_mfma_f32_16x16x32_bf16 v[232:235], v[188:191], v[216:219], v[232:235]
s_waitcnt lgkmcnt(0)
v_mfma_f32_16x16x32_bf16 v[228:231], v[192:195], v[220:223], v[228:231]
v_mfma_f32_16x16x32_bf16 v[232:235], v[192:195], v[224:227], v[232:235]
s_mul_i32 s44, s30, 81920
s_add_u32 s52, s18, s44
s_addc_u32 s53, s19, 0
s_nop 3
v_cvt_pk_bf16_f32 v30, v228, v229
v_cvt_pk_bf16_f32 v31, v230, v231
v_cvt_pk_bf16_f32 v32, v232, v233
v_cvt_pk_bf16_f32 v33, v234, v235
global_store_dwordx2 v6, v[30:31], s[52:53]
v_add_u32 v34, 40960, v6
global_store_dwordx2 v34, v[32:33], s[52:53]
s_add_u32 s30, s30, 4
s_cmp_lt_u32 s30, 64
s_cbranch_scc1 E3l_10
s_waitcnt vmcnt(0)
s_endpgm
L_odd:
s_cmp_lg_u32 s101, 0
s_cbranch_scc1 arr_15
s_cmp_lg_u32 s99, 0
s_cbranch_scc1 arr_15
s_waitcnt vmcnt(0)
s_barrier
s_cmp_lg_u32 s3, 0
s_cbranch_scc1 arr_15
v_mov_b32 v30, 64
v_mov_b32 v31, 1
s_mov_b64 exec, 1
global_atomic_add v30, v31, s[6:7]
s_mov_b64 exec, -1
arr_15:
v_mov_b32 v30, 64
sc_16:
global_load_dword v31, v30, s[6:7] sc1
s_waitcnt vmcnt(0)
v_readfirstlane_b32 s40, v31
s_cmp_ge_u32 s40, 256
s_nop 2
s_cbranch_scc1 scg_18
s_sleep 4
s_add_u32 s100, s100, 64
s_cmp_lt_u32 s100, 0x1000000
s_cbranch_scc1 sc_16
s_endpgm
scg_18:
s_cmp_lg_u32 s101, 0
s_cbranch_scc1 sco_17
v_and_b32 v30, 7, v1
v_lshlrev_b32 v30, 2, v30
global_load_dword v31, v30, s[6:7] sc1
s_waitcnt vmcnt(0)
v_cmp_ne_u32 vcc, 32, v31
s_nop 3
s_cbranch_vccz sco_17
s_mov_b32 s101, 1
s_lshr_b32 s12, s2, 5
s_and_b32 s17, s2, 31
s_barrier
s_branch L_dispatch
sco_17:
s_endpgm
L_e1:
s_and_b32 s17, s17, 31
s_lshr_b32 s14, s17, 1
s_cmp_eq_u32 s12, 2
s_cselect_b32 s40, 16, 0
s_add_u32 s14, s14, s40
s_and_b32 s15, s17, 1
s_cmp_ge_u32 s14, 16
s_cbranch_scc1 qdo_20
s_cmp_lg_u32 s101, 0
s_cbranch_scc1 qdo_20
s_cmp_lg_u32 s101, 0
s_cbranch_scc1 arr_21
s_cmp_lg_u32 s99, 0
s_cbranch_scc1 arr_21
s_waitcnt vmcnt(0)
s_barrier
s_cmp_lg_u32 s3, 0
s_cbranch_scc1 arr_21
v_mov_b32 v30, 64
v_mov_b32 v31, 1
s_mov_b64 exec, 1
global_atomic_add v30, v31, s[6:7]
s_mov_b64 exec, -1
arr_21:
s_mov_b32 s99, 1
v_mov_b32 v30, 192
qd_19:
global_load_dword v31, v30, s[6:7] sc1
s_waitcnt vmcnt(0)
v_readfirstlane_b32 s40, v31
s_cmp_ge_u32 s40, 64
s_nop 2
s_cbranch_scc1 qdo_20
s_sleep 32
s_add_u32 s100, s100, 256
s_cmp_lt_u32 s100, 0x40000
s_cbranch_scc1 qd_19
qdo_20:
s_load_dwordx2 s[18:19], s[0:1], 72
s_waitcnt lgkmcnt(0)
s_mul_i32 s40, s15, 40960
s_add_u32 s40, s18, s40
s_addc_u32 s41, s19, 0
s_mul_i32 s42, s3, 192
v_add_u32 v30, s42, v1
v_min_u32 v31, 639, v30
v_lshlrev_b32 v31, 6, v31
global_load_dword v28, v31, s[40:41]
v_add_u32 v30, 64, v30
v_min_u32 v31, 639, v30
v_lshlrev_b32 v31, 6, v31
global_load_dword v28, v31, s[40:41]
v_add_u32 v30, 64, v30
v_min_u32 v31, 639, v30
v_lshlrev_b32 v31, 6, v31
global_load_dword v28, v31, s[40:41]
v_add_u32 v30, 64, v30
s_load_dwordx2 s[8:9], s[0:1], 88
s_load_dwordx2 s[10:11], s[0:1], 96
s_load_dwordx2 s[18:19], s[0:1], 72
s_waitcnt lgkmcnt(0)
s_cmp_lt_u32 s14, 16
s_cselect_b32 s12, s8, s10
s_cselect_b32 s13, s9, s11
s_and_b32 s40, s14, 15
s_lshl_b32 s40, s40, 9
s_lshr_b32 s41, s3, 1
s_lshl_b32 s41, s41, 8
s_add_u32 s40, s40, s41
s_and_b32 s41, s3, 1
s_lshl_b32 s41, s41, 18
s_add_u32 s40, s40, s41
s_add_u32 s12, s12, s40
s_addc_u32 s13, s13, 0
v_lshrrev_b32 v34, 4, v1
v_lshlrev_b32 v34, 13, v34
v_and_b32 v35, 15, v1
v_lshl_add_u32 v34, v35, 4, v34
s_mov_b32 s43, 32768
v_lshrrev_b32 v30, 5, v1
v_lshlrev_b32 v30, 1, v30
s_lshr_b32 s40, s3, 1
s_lshl_b32 s40, s40, 4
v_add_u32 v30, s40, v30
v_mul_u32_u24 v9, 1088, v30
v_bfe_u32 v30, v1, 2, 2
v_lshl_add_u32 v9, v30, 8, v9
v_bfe_u32 v30, v1, 4, 1
v_lshl_add_u32 v9, v30, 5, v9
v_and_b32 v30, 3, v1
v_lshl_add_u32 v9, v30, 3, v9
s_and_b32 s40, s3, 1
s_lshl_b32 s40, s40, 7
v_add_u32 v9, s40, v9
s_add_u32 s40, s12, 0
s_addc_u32 s41, s13, 0
s_mul_i32 s44, s3, 8704
s_add_u32 s44, s44, 0
v_mov_b32 v35, v34
s_add_u32 m0, s44, 0
s_nop 0
global_load_lds_dwordx4 v35, s[40:41]
v_add_u32 v35, s43, v35
s_add_u32 m0, s44, 1088
s_nop 0
global_load_lds_dwordx4 v35, s[40:41]
v_add_u32 v35, s43, v35
s_add_u32 m0, s44, 2176
s_nop 0
global_load_lds_dwordx4 v35, s[40:41]
v_add_u32 v35, s43, v35
s_add_u32 m0, s44, 3264
s_nop 0
global_load_lds_dwordx4 v35, s[40:41]
v_add_u32 v35, s43, v35
s_add_u32 m0, s44, 4352
s_nop 0
global_load_lds_dwordx4 v35, s[40:41]
v_add_u32 v35, s43, v35
s_add_u32 m0, s44, 5440
s_nop 0
global_load_lds_dwordx4 v35, s[40:41]
v_add_u32 v35, s43, v35
s_add_u32 m0, s44, 6528
s_nop 0
global_load_lds_dwordx4 v35, s[40:41]
v_add_u32 v35, s43, v35
s_add_u32 m0, s44, 7616
s_nop 0
global_load_lds_dwordx4 v35, s[40:41]
s_add_u32 s40, s12, 524288
s_addc_u32 s41, s13, 0
s_mul_i32 s44, s3, 8704
s_add_u32 s44, s44, 34816
v_mov_b32 v35, v34
s_add_u32 m0, s44, 0
s_nop 0
global_load_lds_dwordx4 v35, s[40:41]
v_add_u32 v35, s43, v35
s_add_u32 m0, s44, 1088
s_nop 0
global_load_lds_dwordx4 v35, s[40:41]
v_add_u32 v35, s43, v35
s_add_u32 m0, s44, 2176
s_nop 0
global_load_lds_dwordx4 v35, s[40:41]
v_add_u32 v35, s43, v35
s_add_u32 m0, s44, 3264
s_nop 0
global_load_lds_dwordx4 v35, s[40:41]
v_add_u32 v35, s43, v35
s_add_u32 m0, s44, 4352
s_nop 0
global_load_lds_dwordx4 v35, s[40:41]
v_add_u32 v35, s43, v35
s_add_u32 m0, s44, 5440
s_nop 0
global_load_lds_dwordx4 v35, s[40:41]
v_add_u32 v35, s43, v35
s_add_u32 m0, s44, 6528
s_nop 0
global_load_lds_dwordx4 v35, s[40:41]
v_add_u32 v35, s43, v35
s_add_u32 m0, s44, 7616
s_nop 0
global_load_lds_dwordx4 v35, s[40:41]
s_add_u32 s40, s12, 1048576
s_addc_u32 s41, s13, 0
s_mul_i32 s44, s3, 8704
s_add_u32 s44, s44, 69632
v_mov_b32 v35, v34
s_add_u32 m0, s44, 0
s_nop 0
global_load_lds_dwordx4 v35, s[40:41]
v_add_u32 v35, s43, v35
s_add_u32 m0, s44, 1088
s_nop 0
global_load_lds_dwordx4 v35, s[40:41]
v_add_u32 v35, s43, v35
s_add_u32 m0, s44, 2176
s_nop 0
global_load_lds_dwordx4 v35, s[40:41]
v_add_u32 v35, s43, v35
s_add_u32 m0, s44, 3264
s_nop 0
global_load_lds_dwordx4 v35, s[40:41]
v_add_u32 v35, s43, v35
s_add_u32 m0, s44, 4352
s_nop 0
global_load_lds_dwordx4 v35, s[40:41]
v_add_u32 v35, s43, v35
s_add_u32 m0, s44, 5440
s_nop 0
global_load_lds_dwordx4 v35, s[40:41]
v_add_u32 v35, s43, v35
s_add_u32 m0, s44, 6528
s_nop 0
global_load_lds_dwordx4 v35, s[40:41]
v_add_u32 v35, s43, v35
s_add_u32 m0, s44, 7616
s_nop 0
global_load_lds_dwordx4 v35, s[40:41]
s_add_u32 s40, s12, 1572864
s_addc_u32 s41, s13, 0
s_mul_i32 s44, s3, 8704
s_add_u32 s44, s44, 104448
v_mov_b32 v35, v34
s_add_u32 m0, s44, 0
s_nop 0
global_load_lds_dwordx4 v35, s[40:41]
v_add_u32 v35, s43, v35
s_add_u32 m0, s44, 1088
s_nop 0
global_load_lds_dwordx4 v35, s[40:41]
v_add_u32 v35, s43, v35
s_add_u32 m0, s44, 2176
s_nop 0
global_load_lds_dwordx4 v35, s[40:41]
v_add_u32 v35, s43, v35
s_add_u32 m0, s44, 3264
s_nop 0
global_load_lds_dwordx4 v35, s[40:41]
v_add_u32 v35, s43, v35
s_add_u32 m0, s44, 4352
s_nop 0
global_load_lds_dwordx4 v35, s[40:41]
v_add_u32 v35, s43, v35
s_add_u32 m0, s44, 5440
s_nop 0
global_load_lds_dwordx4 v35, s[40:41]
v_add_u32 v35, s43, v35
s_add_u32 m0, s44, 6528
s_nop 0
global_load_lds_dwordx4 v35, s[40:41]
v_add_u32 v35, s43, v35
s_add_u32 m0, s44, 7616
s_nop 0
global_load_lds_dwordx4 v35, s[40:41]
s_cmp_lg_u32 s101, 0
s_cbranch_scc1 arr_22
s_cmp_lg_u32 s99, 0
s_cbranch_scc1 arr_22
s_waitcnt vmcnt(32)
s_barrier
s_cmp_lg_u32 s3, 0
s_cbranch_scc1 arr_22
v_mov_b32 v30, 64
v_mov_b32 v31, 1
s_mov_b64 exec, 1
global_atomic_add v30, v31, s[6:7]
s_mov_b64 exec, -1
arr_22:
s_waitcnt vmcnt(24)
s_barrier
v_add_u32 v33, 0, v9
ds_read_b64_tr_b16 a[0:1], v33 offset:0
ds_read_b64_tr_b16 a[2:3], v33 offset:1088
ds_read_b64_tr_b16 a[4:5], v33 offset:4352
ds_read_b64_tr_b16 a[6:7], v33 offset:5440
ds_read_b64_tr_b16 a[8:9], v33 offset:8704
ds_read_b64_tr_b16 a[10:11], v33 offset:9792
ds_read_b64_tr_b16 a[12:13], v33 offset:13056
ds_read_b64_tr_b16 a[14:15], v33 offset:14144
ds_read_b64_tr_b16 a[160:161], v33 offset:64
ds_read_b64_tr_b16 a[162:163], v33 offset:1152
ds_read_b64_tr_b16 a[164:165], v33 offset:4416
ds_read_b64_tr_b16 a[166:167], v33 offset:5504
ds_read_b64_tr_b16 a[168:169], v33 offset:8768
ds_read_b64_tr_b16 a[170:171], v33 offset:9856
ds_read_b64_tr_b16 a[172:173], v33 offset:13120
ds_read_b64_tr_b16 a[174:175], v33 offset:14208
s_waitcnt lgkmcnt(0)
s_barrier
s_add_u32 s40, s12, 2097152
s_addc_u32 s41, s13, 0
s_mul_i32 s44, s3, 8704
s_add_u32 s44, s44, 0
v_mov_b32 v35, v34
s_add_u32 m0, s44, 0
s_nop 0
global_load_lds_dwordx4 v35, s[40:41]
v_add_u32 v35, s43, v35
s_add_u32 m0, s44, 1088
s_nop 0
global_load_lds_dwordx4 v35, s[40:41]
v_add_u32 v35, s43, v35
s_add_u32 m0, s44, 2176
s_nop 0
global_load_lds_dwordx4 v35, s[40:41]
v_add_u32 v35, s43, v35
s_add_u32 m0, s44, 3264
s_nop 0
global_load_lds_dwordx4 v35, s[40:41]
v_add_u32 v35, s43, v35
s_add_u32 m0, s44, 4352
s_nop 0
global_load_lds_dwordx4 v35, s[40:41]
v_add_u32 v35, s43, v35
s_add_u32 m0, s44, 5440
s_nop 0
global_load_lds_dwordx4 v35, s[40:41]
v_add_u32 v35, s43, v35
s_add_u32 m0, s44, 6528
s_nop 0
global_load_lds_dwordx4 v35, s[40:41]
v_add_u32 v35, s43, v35
s_add_u32 m0, s44, 7616
s_nop 0
global_load_lds_dwordx4 v35, s[40:41]
s_waitcnt vmcnt(24)
s_barrier
v_add_u32 v33, 34816, v9
ds_read_b64_tr_b16 a[16:17], v33 offset:0
ds_read_b64_tr_b16 a[18:19], v33 offset:1088
ds_read_b64_tr_b16 a[20:21], v33 offset:4352
ds_read_b64_tr_b16 a[22:23], v33 offset:5440
ds_read_b64_tr_b16 a[24:25], v33 offset:8704
ds_read_b64_tr_b16 a[26:27], v33 offset:9792
ds_read_b64_tr_b16 a[28:29], v33 offset:13056
ds_read_b64_tr_b16 a[30:31], v33 offset:14144
ds_read_b64_tr_b16 a[176:177], v33 offset:64
ds_read_b64_tr_b16 a[178:179], v33 offset:1152
ds_read_b64_tr_b16 a[180:181], v33 offset:4416
ds_read_b64_tr_b16 a[182:183], v33 offset:5504
ds_read_b64_tr_b16 a[184:185], v33 offset:8768
ds_read_b64_tr_b16 a[186:187], v33 offset:9856
ds_read_b64_tr_b16 a[188:189], v33 offset:13120
ds_read_b64_tr_b16 a[190:191], v33 offset:14208
s_waitcnt lgkmcnt(0)
s_barrier
s_add_u32 s40, s12, 2621440
s_addc_u32 s41, s13, 0
s_mul_i32 s44, s3, 8704
s_add_u32 s44, s44, 34816
v_mov_b32 v35, v34
s_add_u32 m0, s44, 0
s_nop 0
global_load_lds_dwordx4 v35, s[40:41]
v_add_u32 v35, s43, v35
s_add_u32 m0, s44, 1088
s_nop 0
global_load_lds_dwordx4 v35, s[40:41]
v_add_u32 v35, s43, v35
s_add_u32 m0, s44, 2176
s_nop 0
global_load_lds_dwordx4 v35, s[40:41]
v_add_u32 v35, s43, v35
s_add_u32 m0, s44, 3264
s_nop 0
global_load_lds_dwordx4 v35, s[40:41]
v_add_u32 v35, s43, v35
s_add_u32 m0, s44, 4352
s_nop 0
global_load_lds_dwordx4 v35, s[40:41]
v_add_u32 v35, s43, v35
s_add_u32 m0, s44, 5440
s_nop 0
global_load_lds_dwordx4 v35, s[40:41]
v_add_u32 v35, s43, v35
s_add_u32 m0, s44, 6528
s_nop 0
global_load_lds_dwordx4 v35, s[40:41]
v_add_u32 v35, s43, v35
s_add_u32 m0, s44, 7616
s_nop 0
global_load_lds_dwordx4 v35, s[40:41]
s_waitcnt vmcnt(24)
s_barrier
v_add_u32 v33, 69632, v9
ds_read_b64_tr_b16 a[32:33], v33 offset:0
ds_read_b64_tr_b16 a[34:35], v33 offset:1088
ds_read_b64_tr_b16 a[36:37], v33 offset:4352
ds_read_b64_tr_b16 a[38:39], v33 offset:5440
ds_read_b64_tr_b16 a[40:41], v33 offset:8704
ds_read_b64_tr_b16 a[42:43], v33 offset:9792
ds_read_b64_tr_b16 a[44:45], v33 offset:13056
ds_read_b64_tr_b16 a[46:47], v33 offset:14144
ds_read_b64_tr_b16 a[192:193], v33 offset:64
ds_read_b64_tr_b16 a[194:195], v33 offset:1152
ds_read_b64_tr_b16 a[196:197], v33 offset:4416
ds_read_b64_tr_b16 a[198:199], v33 offset:5504
ds_read_b64_tr_b16 a[200:201], v33 offset:8768
ds_read_b64_tr_b16 a[202:203], v33 offset:9856
ds_read_b64_tr_b16 a[204:205], v33 offset:13120
ds_read_b64_tr_b16 a[206:207], v33 offset:14208
s_waitcnt lgkmcnt(0)
s_barrier
s_add_u32 s40, s12, 3145728
s_addc_u32 s41, s13, 0
s_mul_i32 s44, s3, 8704
s_add_u32 s44, s44, 69632
v_mov_b32 v35, v34
s_add_u32 m0, s44, 0
s_nop 0
global_load_lds_dwordx4 v35, s[40:41]
v_add_u32 v35, s43, v35
s_add_u32 m0, s44, 1088
s_nop 0
global_load_lds_dwordx4 v35, s[40:41]
v_add_u32 v35, s43, v35
s_add_u32 m0, s44, 2176
s_nop 0
global_load_lds_dwordx4 v35, s[40:41]
v_add_u32 v35, s43, v35
s_add_u32 m0, s44, 3264
s_nop 0
global_load_lds_dwordx4 v35, s[40:41]
v_add_u32 v35, s43, v35
s_add_u32 m0, s44, 4352
s_nop 0
global_load_lds_dwordx4 v35, s[40:41]
v_add_u32 v35, s43, v35
s_add_u32 m0, s44, 5440
s_nop 0
global_load_lds_dwordx4 v35, s[40:41]
v_add_u32 v35, s43, v35
s_add_u32 m0, s44, 6528
s_nop 0
global_load_lds_dwordx4 v35, s[40:41]
v_add_u32 v35, s43, v35
s_add_u32 m0, s44, 7616
s_nop 0
global_load_lds_dwordx4 v35, s[40:41]
s_waitcnt vmcnt(24)
s_barrier
v_add_u32 v33, 104448, v9
ds_read_b64_tr_b16 a[48:49], v33 offset:0
ds_read_b64_tr_b16 a[50:51], v33 offset:1088
ds_read_b64_tr_b16 a[52:53], v33 offset:4352
ds_read_b64_tr_b16 a[54:55], v33 offset:5440
ds_read_b64_tr_b16 a[56:57], v33 offset:8704
ds_read_b64_tr_b16 a[58:59], v33 offset:9792
ds_read_b64_tr_b16 a[60:61], v33 offset:13056
ds_read_b64_tr_b16 a[62:63], v33 offset:14144
ds_read_b64_tr_b16 a[208:209], v33 offset:64
ds_read_b64_tr_b16 a[210:211], v33 offset:1152
ds_read_b64_tr_b16 a[212:213], v33 offset:4416
ds_read_b64_tr_b16 a[214:215], v33 offset:5504
ds_read_b64_tr_b16 a[216:217], v33 offset:8768
ds_read_b64_tr_b16 a[218:219], v33 offset:9856
ds_read_b64_tr_b16 a[220:221], v33 offset:13120
ds_read_b64_tr_b16 a[222:223], v33 offset:14208
s_waitcnt lgkmcnt(0)
s_barrier
s_add_u32 s40, s12, 3670016
s_addc_u32 s41, s13, 0
s_mul_i32 s44, s3, 8704
s_add_u32 s44, s44, 104448
v_mov_b32 v35, v34
s_add_u32 m0, s44, 0
s_nop 0
global_load_lds_dwordx4 v35, s[40:41]
v_add_u32 v35, s43, v35
s_add_u32 m0, s44, 1088
s_nop 0
global_load_lds_dwordx4 v35, s[40:41]
v_add_u32 v35, s43, v35
s_add_u32 m0, s44, 2176
s_nop 0
global_load_lds_dwordx4 v35, s[40:41]
v_add_u32 v35, s43, v35
s_add_u32 m0, s44, 3264
s_nop 0
global_load_lds_dwordx4 v35, s[40:41]
v_add_u32 v35, s43, v35
s_add_u32 m0, s44, 4352
s_nop 0
global_load_lds_dwordx4 v35, s[40:41]
v_add_u32 v35, s43, v35
s_add_u32 m0, s44, 5440
s_nop 0
global_load_lds_dwordx4 v35, s[40:41]
v_add_u32 v35, s43, v35
s_add_u32 m0, s44, 6528
s_nop 0
global_load_lds_dwordx4 v35, s[40:41]
v_add_u32 v35, s43, v35
s_add_u32 m0, s44, 7616
s_nop 0
global_load_lds_dwordx4 v35, s[40:41]
s_waitcnt vmcnt(24)
s_barrier
v_add_u32 v33, 0, v9
ds_read_b64_tr_b16 a[64:65], v33 offset:0
ds_read_b64_tr_b16 a[66:67], v33 offset:1088
ds_read_b64_tr_b16 a[68:69], v33 offset:4352
ds_read_b64_tr_b16 a[70:71], v33 offset:5440
ds_read_b64_tr_b16 a[72:73], v33 offset:8704
ds_read_b64_tr_b16 a[74:75], v33 offset:9792
ds_read_b64_tr_b16 a[76:77], v33 offset:13056
ds_read_b64_tr_b16 a[78:79], v33 offset:14144
ds_read_b64_tr_b16 a[224:225], v33 offset:64
ds_read_b64_tr_b16 a[226:227], v33 offset:1152
ds_read_b64_tr_b16 a[228:229], v33 offset:4416
ds_read_b64_tr_b16 a[230:231], v33 offset:5504
ds_read_b64_tr_b16 a[232:233], v33 offset:8768
ds_read_b64_tr_b16 a[234:235], v33 offset:9856
ds_read_b64_tr_b16 a[236:237], v33 offset:13120
ds_read_b64_tr_b16 a[238:239], v33 offset:14208
s_waitcnt lgkmcnt(0)
s_barrier
s_add_u32 s40, s12, 4194304
s_addc_u32 s41, s13, 0
s_mul_i32 s44, s3, 8704
s_add_u32 s44, s44, 0
v_mov_b32 v35, v34
s_add_u32 m0, s44, 0
s_nop 0
global_load_lds_dwordx4 v35, s[40:41]
v_add_u32 v35, s43, v35
s_add_u32 m0, s44, 1088
s_nop 0
global_load_lds_dwordx4 v35, s[40:41]
v_add_u32 v35, s43, v35
s_add_u32 m0, s44, 2176
s_nop 0
global_load_lds_dwordx4 v35, s[40:41]
v_add_u32 v35, s43, v35
s_add_u32 m0, s44, 3264
s_nop 0
global_load_lds_dwordx4 v35, s[40:41]
v_add_u32 v35, s43, v35
s_add_u32 m0, s44, 4352
s_nop 0
global_load_lds_dwordx4 v35, s[40:41]
v_add_u32 v35, s43, v35
s_add_u32 m0, s44, 5440
s_nop 0
global_load_lds_dwordx4 v35, s[40:41]
v_add_u32 v35, s43, v35
s_add_u32 m0, s44, 6528
s_nop 0
global_load_lds_dwordx4 v35, s[40:41]
v_add_u32 v35, s43, v35
s_add_u32 m0, s44, 7616
s_nop 0
global_load_lds_dwordx4 v35, s[40:41]
s_waitcnt vmcnt(24)
s_barrier
v_add_u32 v33, 34816, v9
ds_read_b64_tr_b16 a[80:81], v33 offset:0
ds_read_b64_tr_b16 a[82:83], v33 offset:1088
ds_read_b64_tr_b16 a[84:85], v33 offset:4352
ds_read_b64_tr_b16 a[86:87], v33 offset:5440
ds_read_b64_tr_b16 a[88:89], v33 offset:8704
ds_read_b64_tr_b16 a[90:91], v33 offset:9792
ds_read_b64_tr_b16 a[92:93], v33 offset:13056
ds_read_b64_tr_b16 a[94:95], v33 offset:14144
ds_read_b64_tr_b16 a[240:241], v33 offset:64
ds_read_b64_tr_b16 a[242:243], v33 offset:1152
ds_read_b64_tr_b16 a[244:245], v33 offset:4416
ds_read_b64_tr_b16 a[246:247], v33 offset:5504
ds_read_b64_tr_b16 a[248:249], v33 offset:8768
ds_read_b64_tr_b16 a[250:251], v33 offset:9856
ds_read_b64_tr_b16 a[252:253], v33 offset:13120
ds_read_b64_tr_b16 a[254:255], v33 offset:14208
s_waitcnt lgkmcnt(0)
s_barrier
s_add_u32 s40, s12, 4718592
s_addc_u32 s41, s13, 0
s_mul_i32 s44, s3, 8704
s_add_u32 s44, s44, 34816
v_mov_b32 v35, v34
s_add_u32 m0, s44, 0
s_nop 0
global_load_lds_dwordx4 v35, s[40:41]
v_add_u32 v35, s43, v35
s_add_u32 m0, s44, 1088
s_nop 0
global_load_lds_dwordx4 v35, s[40:41]
v_add_u32 v35, s43, v35
s_add_u32 m0, s44, 2176
s_nop 0
global_load_lds_dwordx4 v35, s[40:41]
v_add_u32 v35, s43, v35
s_add_u32 m0, s44, 3264
s_nop 0
global_load_lds_dwordx4 v35, s[40:41]
v_add_u32 v35, s43, v35
s_add_u32 m0, s44, 4352
s_nop 0
global_load_lds_dwordx4 v35, s[40:41]
v_add_u32 v35, s43, v35
s_add_u32 m0, s44, 5440
s_nop 0
global_load_lds_dwordx4 v35, s[40:41]
v_add_u32 v35, s43, v35
s_add_u32 m0, s44, 6528
s_nop 0
global_load_lds_dwordx4 v35, s[40:41]
v_add_u32 v35, s43, v35
s_add_u32 m0, s44, 7616
s_nop 0
global_load_lds_dwordx4 v35, s[40:41]
s_waitcnt vmcnt(24)
s_barrier
v_add_u32 v33, 69632, v9
ds_read_b64_tr_b16 a[96:97], v33 offset:0
ds_read_b64_tr_b16 a[98:99], v33 offset:1088
ds_read_b64_tr_b16 a[100:101], v33 offset:4352
ds_read_b64_tr_b16 a[102:103], v33 offset:5440
ds_read_b64_tr_b16 a[104:105], v33 offset:8704
ds_read_b64_tr_b16 a[106:107], v33 offset:9792
ds_read_b64_tr_b16 a[108:109], v33 offset:13056
ds_read_b64_tr_b16 a[110:111], v33 offset:14144
ds_read_b64_tr_b16 v[192:193], v33 offset:64
ds_read_b64_tr_b16 v[194:195], v33 offset:1152
ds_read_b64_tr_b16 v[196:197], v33 offset:4416
ds_read_b64_tr_b16 v[198:199], v33 offset:5504
ds_read_b64_tr_b16 v[200:201], v33 offset:8768
ds_read_b64_tr_b16 v[202:203], v33 offset:9856
ds_read_b64_tr_b16 v[204:205], v33 offset:13120
ds_read_b64_tr_b16 v[206:207], v33 offset:14208
s_waitcnt lgkmcnt(0)
s_barrier
s_waitcnt vmcnt(16)
s_barrier
v_add_u32 v33, 104448, v9
ds_read_b64_tr_b16 a[112:113], v33 offset:0
ds_read_b64_tr_b16 a[114:115], v33 offset:1088
ds_read_b64_tr_b16 a[116:117], v33 offset:4352
ds_read_b64_tr_b16 a[118:119], v33 offset:5440
ds_read_b64_tr_b16 a[120:121], v33 offset:8704
ds_read_b64_tr_b16 a[122:123], v33 offset:9792
ds_read_b64_tr_b16 a[124:125], v33 offset:13056
ds_read_b64_tr_b16 a[126:127], v33 offset:14144
ds_read_b64_tr_b16 v[208:209], v33 offset:64
ds_read_b64_tr_b16 v[210:211], v33 offset:1152
ds_read_b64_tr_b16 v[212:213], v33 offset:4416
ds_read_b64_tr_b16 v[214:215], v33 offset:5504
ds_read_b64_tr_b16 v[216:217], v33 offset:8768
ds_read_b64_tr_b16 v[218:219], v33 offset:9856
ds_read_b64_tr_b16 v[220:221], v33 offset:13120
ds_read_b64_tr_b16 v[222:223], v33 offset:14208
s_waitcnt lgkmcnt(0)
s_barrier
s_waitcnt vmcnt(8)
s_barrier
v_add_u32 v33, 0, v9
ds_read_b64_tr_b16 a[128:129], v33 offset:0
ds_read_b64_tr_b16 a[130:131], v33 offset:1088
ds_read_b64_tr_b16 a[132:133], v33 offset:4352
ds_read_b64_tr_b16 a[134:135], v33 offset:5440
ds_read_b64_tr_b16 a[136:137], v33 offset:8704
ds_read_b64_tr_b16 a[138:139], v33 offset:9792
ds_read_b64_tr_b16 a[140:141], v33 offset:13056
ds_read_b64_tr_b16 a[142:143], v33 offset:14144
ds_read_b64_tr_b16 v[224:225], v33 offset:64
ds_read_b64_tr_b16 v[226:227], v33 offset:1152
ds_read_b64_tr_b16 v[228:229], v33 offset:4416
ds_read_b64_tr_b16 v[230:231], v33 offset:5504
ds_read_b64_tr_b16 v[232:233], v33 offset:8768
ds_read_b64_tr_b16 v[234:235], v33 offset:9856
ds_read_b64_tr_b16 v[236:237], v33 offset:13120
ds_read_b64_tr_b16 v[238:239], v33 offset:14208
s_waitcnt lgkmcnt(0)
s_barrier
s_waitcnt vmcnt(0)
s_barrier
v_add_u32 v33, 34816, v9
ds_read_b64_tr_b16 a[144:145], v33 offset:0
ds_read_b64_tr_b16 a[146:147], v33 offset:1088
ds_read_b64_tr_b16 a[148:149], v33 offset:4352
ds_read_b64_tr_b16 a[150:151], v33 offset:5440
ds_read_b64_tr_b16 a[152:153], v33 offset:8704
ds_read_b64_tr_b16 a[154:155], v33 offset:9792
ds_read_b64_tr_b16 a[156:157], v33 offset:13056
ds_read_b64_tr_b16 a[158:159], v33 offset:14144
ds_read_b64_tr_b16 v[240:241], v33 offset:64
ds_read_b64_tr_b16 v[242:243], v33 offset:1152
ds_read_b64_tr_b16 v[244:245], v33 offset:4416
ds_read_b64_tr_b16 v[246:247], v33 offset:5504
ds_read_b64_tr_b16 v[248:249], v33 offset:8768
ds_read_b64_tr_b16 v[250:251], v33 offset:9856
ds_read_b64_tr_b16 v[252:253], v33 offset:13120
ds_read_b64_tr_b16 v[254:255], v33 offset:14208
s_waitcnt lgkmcnt(0)
s_barrier
v_mov_b32 v30, 64
sc_23:
global_load_dword v31, v30, s[6:7] sc1
s_waitcnt vmcnt(0)
v_readfirstlane_b32 s40, v31
s_cmp_ge_u32 s40, 256
s_nop 2
s_cbranch_scc1 scg_25
s_sleep 4
s_add_u32 s100, s100, 64
s_cmp_lt_u32 s100, 0x1000000
s_cbranch_scc1 sc_23
s_endpgm
scg_25:
s_cmp_lg_u32 s101, 0
s_cbranch_scc1 sco_24
v_and_b32 v30, 7, v1
v_lshlrev_b32 v30, 2, v30
global_load_dword v31, v30, s[6:7] sc1
s_waitcnt vmcnt(0)
v_cmp_ne_u32 vcc, 32, v31
s_nop 3
s_cbranch_vccz sco_24
s_mov_b32 s101, 1
s_lshr_b32 s12, s2, 5
s_and_b32 s17, s2, 31
s_barrier
s_branch L_dispatch
sco_24:
v_lshrrev_b32 v30, 3, v1
s_lshl_b32 s40, s3, 3
v_add_u32 v30, s40, v30
v_bfe_u32 v31, v30, 1, 3
v_and_b32 v32, 7, v1
v_xor_b32 v31, v31, v32
v_mul_u32_u24 v30, 1280, v30
v_lshl_add_u32 v2, v31, 4, v30
v_and_b32 v30, 31, v1
v_lshrrev_b32 v31, 5, v1
v_bfe_u32 v32, v30, 1, 3
v_add_u32 v33, 0, v31
v_xor_b32 v33, v33, v32
v_lshlrev_b32 v33, 4, v33
v_lshl_add_u32 v4, v30, 7, v33
v_add_u32 v12, 40960, v4
v_add_u32 v33, 2, v31
v_xor_b32 v33, v33, v32
v_lshlrev_b32 v33, 4, v33
v_lshl_add_u32 v5, v30, 7, v33
v_add_u32 v13, 40960, v5
v_add_u32 v33, 4, v31
v_xor_b32 v33, v33, v32
v_lshlrev_b32 v33, 4, v33
v_lshl_add_u32 v6, v30, 7, v33
v_add_u32 v14, 40960, v6
v_add_u32 v33, 6, v31
v_xor_b32 v33, v33, v32
v_lshlrev_b32 v33, 4, v33
v_lshl_add_u32 v7, v30, 7, v33
v_add_u32 v15, 40960, v7
s_lshr_b32 s40, s3, 1
s_lshl_b32 s40, s40, 13
s_and_b32 s41, s3, 1
s_lshl_b32 s41, s41, 12
s_add_u32 s40, s40, s41
v_lshlrev_b32 v33, 9, v31
v_lshl_add_u32 v33, v30, 4, v33
v_add_u32 v8, s40, v33
s_cmp_lt_u32 s14, 16
s_mov_b32 s41, 16777216
s_cselect_b32 s20, 0, s41
s_and_b32 s40, s14, 15
s_lshl_b32 s40, s40, 14
s_add_u32 s20, s20, s40
s_lshl_b32 s21, s3, 10
s_mov_b32 s30, s15
s_mul_i32 s44, s30, 40960
s_add_u32 s46, s18, s44
s_addc_u32 s47, s19, 0
s_add_u32 s45, s21, 0
s_add_u32 m0, s45, 0
s_nop 0
global_load_lds_dwordx4 v2, s[46:47] offset:0
s_add_u32 m0, s45, 3968
s_nop 0
global_load_lds_dwordx4 v2, s[46:47] offset:128
s_add_u32 m0, s45, 7936
s_nop 0
global_load_lds_dwordx4 v2, s[46:47] offset:256
s_add_u32 m0, s45, 11904
s_nop 0
global_load_lds_dwordx4 v2, s[46:47] offset:384
s_add_u32 m0, s45, 15872
s_nop 0
global_load_lds_dwordx4 v2, s[46:47] offset:512
s_add_u32 m0, s45, 19840
s_nop 0
global_load_lds_dwordx4 v2, s[46:47] offset:640
s_add_u32 m0, s45, 23808
s_nop 0
global_load_lds_dwordx4 v2, s[46:47] offset:768
s_add_u32 m0, s45, 27776
s_nop 0
global_load_lds_dwordx4 v2, s[46:47] offset:896
s_add_u32 m0, s45, 31744
s_nop 0
global_load_lds_dwordx4 v2, s[46:47] offset:1024
s_add_u32 m0, s45, 35712
s_nop 0
global_load_lds_dwordx4 v2, s[46:47] offset:1152
s_waitcnt vmcnt(0)
s_barrier
s_add_u32 s31, s30, 2
ds_read_b128 v[100:103], v4 offset:0
ds_read_b128 v[104:107], v5 offset:0
ds_read_b128 v[108:111], v6 offset:0
ds_read_b128 v[112:115], v7 offset:0
s_waitcnt lgkmcnt(3)
v_mfma_f32_32x32x16_bf16 v[36:51], a[0:3], v[100:103], 0
v_mfma_f32_32x32x16_bf16 v[52:67], a[160:163], v[100:103], 0
ds_read_b128 v[100:103], v4 offset:4096
s_waitcnt lgkmcnt(3)
v_mfma_f32_32x32x16_bf16 v[36:51], a[4:7], v[104:107], v[36:51]
s_mul_i32 s44, s31, 40960
v_mfma_f32_32x32x16_bf16 v[52:67], a[164:167], v[104:107], v[52:67]
s_add_u32 s46, s18, s44
ds_read_b128 v[104:107], v5 offset:4096
s_waitcnt lgkmcnt(3)
v_mfma_f32_32x32x16_bf16 v[36:51], a[8:11], v[108:111], v[36:51]
s_addc_u32 s47, s19, 0
v_mfma_f32_32x32x16_bf16 v[52:67], a[168:171], v[108:111], v[52:67]
s_add_u32 s45, s21, 40960
ds_read_b128 v[108:111], v6 offset:4096
s_waitcnt lgkmcnt(3)
v_mfma_f32_32x32x16_bf16 v[36:51], a[12:15], v[112:115], v[36:51]
s_add_u32 m0, s45, 0
v_mfma_f32_32x32x16_bf16 v[52:67], a[172:175], v[112:115], v[52:67]
global_load_lds_dwordx4 v2, s[46:47] offset:0
ds_read_b128 v[112:115], v7 offset:4096
s_waitcnt lgkmcnt(3)
v_mfma_f32_32x32x16_bf16 v[36:51], a[16:19], v[100:103], v[36:51]
s_add_u32 m0, s45, 3968
v_mfma_f32_32x32x16_bf16 v[52:67], a[176:179], v[100:103], v[52:67]
global_load_lds_dwordx4 v2, s[46:47] offset:128
ds_read_b128 v[100:103], v4 offset:8192
s_waitcnt lgkmcnt(3)
v_mfma_f32_32x32x16_bf16 v[36:51], a[20:23], v[104:107], v[36:51]
s_add_u32 m0, s45, 7936
v_mfma_f32_32x32x16_bf16 v[52:67], a[180:183], v[104:107], v[52:67]
global_load_lds_dwordx4 v2, s[46:47] offset:256
ds_read_b128 v[104:107], v5 offset:8192
s_waitcnt lgkmcnt(3)
v_mfma_f32_32x32x16_bf16 v[36:51], a[24:27], v[108:111], v[36:51]
s_add_u32 m0, s45, 11904
v_mfma_f32_32x32x16_bf16 v[52:67], a[184:187], v[108:111], v[52:67]
global_load_lds_dwordx4 v2, s[46:47] offset:384
ds_read_b128 v[108:111], v6 offset:8192
s_waitcnt lgkmcnt(3)
v_mfma_f32_32x32x16_bf16 v[36:51], a[28:31], v[112:115], v[36:51]
s_add_u32 m0, s45, 15872
v_mfma_f32_32x32x16_bf16 v[52:67], a[188:191], v[112:115], v[52:67]
global_load_lds_dwordx4 v2, s[46:47] offset:512
ds_read_b128 v[112:115], v7 offset:8192
s_waitcnt lgkmcnt(3)
v_mfma_f32_32x32x16_bf16 v[36:51], a[32:35], v[100:103], v[36:51]
s_add_u32 m0, s45, 19840
v_mfma_f32_32x32x16_bf16 v[52:67], a[192:195], v[100:103], v[52:67]
global_load_lds_dwordx4 v2, s[46:47] offset:640
ds_read_b128 v[100:103], v4 offset:12288
s_waitcnt lgkmcnt(3)
v_mfma_f32_32x32x16_bf16 v[36:51], a[36:39], v[104:107], v[36:51]
s_add_u32 m0, s45, 23808
v_mfma_f32_32x32x16_bf16 v[52:67], a[196:199], v[104:107], v[52:67]
global_load_lds_dwordx4 v2, s[46:47] offset:768
ds_read_b128 v[104:107], v5 offset:12288
s_waitcnt lgkmcnt(3)
v_mfma_f32_32x32x16_bf16 v[36:51], a[40:43], v[108:111], v[36:51]
s_add_u32 m0, s45, 27776
v_mfma_f32_32x32x16_bf16 v[52:67], a[200:203], v[108:111], v[52:67]
global_load_lds_dwordx4 v2, s[46:47] offset:896
ds_read_b128 v[108:111], v6 offset:12288
s_waitcnt lgkmcnt(3)
v_mfma_f32_32x32x16_bf16 v[36:51], a[44:47], v[112:115], v[36:51]
s_add_u32 m0, s45, 31744
v_mfma_f32_32x32x16_bf16 v[52:67], a[204:207], v[112:115], v[52:67]
global_load_lds_dwordx4 v2, s[46:47] offset:1024
ds_read_b128 v[112:115], v7 offset:12288
s_waitcnt lgkmcnt(3)
v_mfma_f32_32x32x16_bf16 v[36:51], a[48:51], v[100:103], v[36:51]
s_add_u32 m0, s45, 35712
v_mfma_f32_32x32x16_bf16 v[52:67], a[208:211], v[100:103], v[52:67]
global_load_lds_dwordx4 v2, s[46:47] offset:1152
ds_read_b128 v[100:103], v4 offset:16384
s_waitcnt lgkmcnt(3)
v_mfma_f32_32x32x16_bf16 v[36:51], a[52:55], v[104:107], v[36:51]
v_mfma_f32_32x32x16_bf16 v[52:67], a[212:215], v[104:107], v[52:67]
ds_read_b128 v[104:107], v5 offset:16384
s_waitcnt lgkmcnt(3)
v_mfma_f32_32x32x16_bf16 v[36:51], a[56:59], v[108:111], v[36:51]
v_mfma_f32_32x32x16_bf16 v[52:67], a[216:219], v[108:111], v[52:67]
ds_read_b128 v[108:111], v6 offset:16384
s_waitcnt lgkmcnt(3)
v_mfma_f32_32x32x16_bf16 v[36:51], a[60:63], v[112:115], v[36:51]
v_mfma_f32_32x32x16_bf16 v[52:67], a[220:223], v[112:115], v[52:67]
ds_read_b128 v[112:115], v7 offset:16384
s_waitcnt lgkmcnt(3)
v_mfma_f32_32x32x16_bf16 v[36:51], a[64:67], v[100:103], v[36:51]
v_mfma_f32_32x32x16_bf16 v[52:67], a[224:227], v[100:103], v[52:67]
ds_read_b128 v[100:103], v4 offset:20480
s_waitcnt lgkmcnt(3)
v_mfma_f32_32x32x16_bf16 v[36:51], a[68:71], v[104:107], v[36:51]
v_mfma_f32_32x32x16_bf16 v[52:67], a[228:231], v[104:107], v[52:67]
ds_read_b128 v[104:107], v5 offset:20480
s_waitcnt lgkmcnt(3)
v_mfma_f32_32x32x16_bf16 v[36:51], a[72:75], v[108:111], v[36:51]
v_mfma_f32_32x32x16_bf16 v[52:67], a[232:235], v[108:111], v[52:67]
ds_read_b128 v[108:111], v6 offset:20480
s_waitcnt lgkmcnt(3)
v_mfma_f32_32x32x16_bf16 v[36:51], a[76:79], v[112:115], v[36:51]
v_mfma_f32_32x32x16_bf16 v[52:67], a[236:239], v[112:115], v[52:67]
ds_read_b128 v[112:115], v7 offset:20480
s_waitcnt lgkmcnt(3)
v_mfma_f32_32x32x16_bf16 v[36:51], a[80:83], v[100:103], v[36:51]
v_mfma_f32_32x32x16_bf16 v[52:67], a[240:243], v[100:103], v[52:67]
ds_read_b128 v[100:103], v4 offset:24576
s_waitcnt lgkmcnt(3)
v_mfma_f32_32x32x16_bf16 v[36:51], a[84:87], v[104:107], v[36:51]
v_mfma_f32_32x32x16_bf16 v[52:67], a[244:247], v[104:107], v[52:67]
ds_read_b128 v[104:107], v5 offset:24576
s_waitcnt lgkmcnt(3)
v_mfma_f32_32x32x16_bf16 v[36:51], a[88:91], v[108:111], v[36:51]
v_mfma_f32_32x32x16_bf16 v[52:67], a[248:251], v[108:111], v[52:67]
ds_read_b128 v[108:111], v6 offset:24576
s_waitcnt lgkmcnt(3)
v_mfma_f32_32x32x16_bf16 v[36:51], a[92:95], v[112:115], v[36:51]
v_mfma_f32_32x32x16_bf16 v[52:67], a[252:255], v[112:115], v[52:67]
ds_read_b128 v[112:115], v7 offset:24576
s_waitcnt lgkmcnt(3)
v_mfma_f32_32x32x16_bf16 v[36:51], a[96:99], v[100:103], v[36:51]
v_mfma_f32_32x32x16_bf16 v[52:67], v[192:195], v[100:103], v[52:67]
ds_read_b128 v[100:103], v4 offset:28672
s_waitcnt lgkmcnt(3)
v_mfma_f32_32x32x16_bf16 v[36:51], a[100:103], v[104:107], v[36:51]
v_mfma_f32_32x32x16_bf16 v[52:67], v[196:199], v[104:107], v[52:67]
ds_read_b128 v[104:107], v5 offset:28672
s_waitcnt lgkmcnt(3)
v_mfma_f32_32x32x16_bf16 v[36:51], a[104:107], v[108:111], v[36:51]
v_mfma_f32_32x32x16_bf16 v[52:67], v[200:203], v[108:111], v[52:67]
ds_read_b128 v[108:111], v6 offset:28672
s_waitcnt lgkmcnt(3)
v_mfma_f32_32x32x16_bf16 v[36:51], a[108:111], v[112:115], v[36:51]
v_mfma_f32_32x32x16_bf16 v[52:67], v[204:207], v[112:115], v[52:67]
ds_read_b128 v[112:115], v7 offset:28672
s_waitcnt lgkmcnt(3)
v_mfma_f32_32x32x16_bf16 v[36:51], a[112:115], v[100:103], v[36:51]
v_mfma_f32_32x32x16_bf16 v[52:67], v[208:211], v[100:103], v[52:67]
ds_read_b128 v[100:103], v4 offset:32768
s_waitcnt lgkmcnt(3)
v_mfma_f32_32x32x16_bf16 v[36:51], a[116:119], v[104:107], v[36:51]
v_mfma_f32_32x32x16_bf16 v[52:67], v[212:215], v[104:107], v[52:67]
ds_read_b128 v[104:107], v5 offset:32768
s_waitcnt lgkmcnt(3)
v_mfma_f32_32x32x16_bf16 v[36:51], a[120:123], v[108:111], v[36:51]
v_mfma_f32_32x32x16_bf16 v[52:67], v[216:219], v[108:111], v[52:67]
ds_read_b128 v[108:111], v6 offset:32768
s_waitcnt lgkmcnt(3)
v_mfma_f32_32x32x16_bf16 v[36:51], a[124:127], v[112:115], v[36:51]
v_mfma_f32_32x32x16_bf16 v[52:67], v[220:223], v[112:115], v[52:67]
ds_read_b128 v[112:115], v7 offset:32768
s_waitcnt lgkmcnt(3)
v_mfma_f32_32x32x16_bf16 v[36:51], a[128:131], v[100:103], v[36:51]
v_mfma_f32_32x32x16_bf16 v[52:67], v[224:227], v[100:103], v[52:67]
ds_read_b128 v[100:103], v4 offset:36864
s_waitcnt lgkmcnt(3)
v_mfma_f32_32x32x16_bf16 v[36:51], a[132:135], v[104:107], v[36:51]
v_mfma_f32_32x32x16_bf16 v[52:67], v[228:231], v[104:107], v[52:67]
ds_read_b128 v[104:107], v5 offset:36864
s_waitcnt lgkmcnt(3)
v_mfma_f32_32x32x16_bf16 v[36:51], a[136:139], v[108:111], v[36:51]
v_mfma_f32_32x32x16_bf16 v[52:67], v[232:235], v[108:111], v[52:67]
ds_read_b128 v[108:111], v6 offset:36864
s_waitcnt lgkmcnt(3)
v_mfma_f32_32x32x16_bf16 v[36:51], a[140:143], v[112:115], v[36:51]
v_mfma_f32_32x32x16_bf16 v[52:67], v[236:239], v[112:115], v[52:67]
ds_read_b128 v[112:115], v7 offset:36864
s_waitcnt lgkmcnt(3)
v_mfma_f32_32x32x16_bf16 v[36:51], a[144:147], v[100:103], v[36:51]
v_mfma_f32_32x32x16_bf16 v[52:67], v[240:243], v[100:103], v[52:67]
s_waitcnt lgkmcnt(2)
v_mfma_f32_32x32x16_bf16 v[36:51], a[148:151], v[104:107], v[36:51]
v_mfma_f32_32x32x16_bf16 v[52:67], v[244:247], v[104:107], v[52:67]
s_waitcnt lgkmcnt(1)
v_mfma_f32_32x32x16_bf16 v[36:51], a[152:155], v[108:111], v[36:51]
v_mfma_f32_32x32x16_bf16 v[52:67], v[248:251], v[108:111], v[52:67]
s_waitcnt lgkmcnt(0)
v_mfma_f32_32x32x16_bf16 v[36:51], a[156:159], v[112:115], v[36:51]
v_mfma_f32_32x32x16_bf16 v[52:67], v[252:255], v[112:115], v[52:67]
s_lshl_b32 s44, s30, 18
s_add_u32 s44, s44, s20
s_add_u32 s48, s4, s44
s_addc_u32 s49, s5, 0
s_nop 6
v_cvt_pk_bf16_f32 v116, v36, v37
v_cvt_pk_bf16_f32 v117, v38, v39
v_cvt_pk_bf16_f32 v118, v40, v41
v_cvt_pk_bf16_f32 v119, v42, v43
v_cvt_pk_bf16_f32 v120, v44, v45
v_cvt_pk_bf16_f32 v121, v46, v47
v_cvt_pk_bf16_f32 v122, v48, v49
v_cvt_pk_bf16_f32 v123, v50, v51
v_permlane32_swap_b32 v116, v118
v_permlane32_swap_b32 v117, v119
v_permlane32_swap_b32 v120, v122
v_permlane32_swap_b32 v121, v123
global_store_dwordx4 v8, v[116:119], s[48:49] offset:0 sc1
global_store_dwordx4 v8, v[120:123], s[48:49] offset:1024 sc1
v_cvt_pk_bf16_f32 v124, v52, v53
v_cvt_pk_bf16_f32 v125, v54, v55
v_cvt_pk_bf16_f32 v126, v56, v57
v_cvt_pk_bf16_f32 v127, v58, v59
v_cvt_pk_bf16_f32 v128, v60, v61
v_cvt_pk_bf16_f32 v129, v62, v63
v_cvt_pk_bf16_f32 v130, v64, v65
v_cvt_pk_bf16_f32 v131, v66, v67
v_permlane32_swap_b32 v124, v126
v_permlane32_swap_b32 v125, v127
v_permlane32_swap_b32 v128, v130
v_permlane32_swap_b32 v129, v131
global_store_dwordx4 v8, v[124:127], s[48:49] offset:2048 sc1
global_store_dwordx4 v8, v[128:131], s[48:49] offset:3072 sc1
s_waitcnt vmcnt(0)
s_barrier
s_cmp_lg_u32 s3, 0
s_cbranch_scc1 ef_28
s_lshl_b32 s44, s30, 8
s_lshl_b32 s45, s14, 2
s_add_u32 s44, s44, s45
s_add_u32 s44, s44, 46137344
v_mov_b32 v30, s44
v_mov_b32 v31, 1
global_store_dword v30, v31, s[4:5] sc1
ef_28:
E1l_26:
s_add_u32 s32, s31, 2
s_min_u32 s32, s32, 63
ds_read_b128 v[100:103], v12 offset:0
ds_read_b128 v[104:107], v13 offset:0
ds_read_b128 v[108:111], v14 offset:0
ds_read_b128 v[112:115], v15 offset:0
s_waitcnt lgkmcnt(3)
v_mfma_f32_32x32x16_bf16 v[68:83], a[0:3], v[100:103], 0
v_mfma_f32_32x32x16_bf16 v[84:99], a[160:163], v[100:103], 0
ds_read_b128 v[100:103], v12 offset:4096
s_waitcnt lgkmcnt(3)
v_mfma_f32_32x32x16_bf16 v[68:83], a[4:7], v[104:107], v[68:83]
s_lshl_b32 s44, s30, 18
v_mfma_f32_32x32x16_bf16 v[84:99], a[164:167], v[104:107], v[84:99]
s_add_u32 s44, s44, s20
ds_read_b128 v[104:107], v13 offset:4096
s_waitcnt lgkmcnt(3)
v_mfma_f32_32x32x16_bf16 v[68:83], a[8:11], v[108:111], v[68:83]
s_add_u32 s48, s4, s44
v_mfma_f32_32x32x16_bf16 v[84:99], a[168:171], v[108:111], v[84:99]
s_addc_u32 s49, s5, 0
ds_read_b128 v[108:111], v14 offset:4096
s_waitcnt lgkmcnt(3)
v_mfma_f32_32x32x16_bf16 v[68:83], a[12:15], v[112:115], v[68:83]
v_cvt_pk_bf16_f32 v116, v36, v37
v_mfma_f32_32x32x16_bf16 v[84:99], a[172:175], v[112:115], v[84:99]
v_cvt_pk_bf16_f32 v117, v38, v39
ds_read_b128 v[112:115], v15 offset:4096
s_waitcnt lgkmcnt(3)
v_mfma_f32_32x32x16_bf16 v[68:83], a[16:19], v[100:103], v[68:83]
v_cvt_pk_bf16_f32 v118, v40, v41
v_mfma_f32_32x32x16_bf16 v[84:99], a[176:179], v[100:103], v[84:99]
v_cvt_pk_bf16_f32 v119, v42, v43
ds_read_b128 v[100:103], v12 offset:8192
s_waitcnt lgkmcnt(3)
v_mfma_f32_32x32x16_bf16 v[68:83], a[20:23], v[104:107], v[68:83]
v_cvt_pk_bf16_f32 v120, v44, v45
v_mfma_f32_32x32x16_bf16 v[84:99], a[180:183], v[104:107], v[84:99]
v_cvt_pk_bf16_f32 v121, v46, v47
ds_read_b128 v[104:107], v13 offset:8192
s_waitcnt lgkmcnt(3)
v_mfma_f32_32x32x16_bf16 v[68:83], a[24:27], v[108:111], v[68:83]
v_cvt_pk_bf16_f32 v122, v48, v49
v_mfma_f32_32x32x16_bf16 v[84:99], a[184:187], v[108:111], v[84:99]
v_cvt_pk_bf16_f32 v123, v50, v51
ds_read_b128 v[108:111], v14 offset:8192
s_waitcnt lgkmcnt(3)
v_mfma_f32_32x32x16_bf16 v[68:83], a[28:31], v[112:115], v[68:83]
v_permlane32_swap_b32 v116, v118
v_mfma_f32_32x32x16_bf16 v[84:99], a[188:191], v[112:115], v[84:99]
v_permlane32_swap_b32 v117, v119
ds_read_b128 v[112:115], v15 offset:8192
s_waitcnt lgkmcnt(3)
v_mfma_f32_32x32x16_bf16 v[68:83], a[32:35], v[100:103], v[68:83]
v_permlane32_swap_b32 v120, v122
v_mfma_f32_32x32x16_bf16 v[84:99], a[192:195], v[100:103], v[84:99]
v_permlane32_swap_b32 v121, v123
ds_read_b128 v[100:103], v12 offset:12288
s_waitcnt lgkmcnt(3)
v_mfma_f32_32x32x16_bf16 v[68:83], a[36:39], v[104:107], v[68:83]
global_store_dwordx4 v8, v[116:119], s[48:49] offset:0 sc1
v_mfma_f32_32x32x16_bf16 v[84:99], a[196:199], v[104:107], v[84:99]
global_store_dwordx4 v8, v[120:123], s[48:49] offset:1024 sc1
ds_read_b128 v[104:107], v13 offset:12288
s_waitcnt lgkmcnt(3)
v_mfma_f32_32x32x16_bf16 v[68:83], a[40:43], v[108:111], v[68:83]
v_cvt_pk_bf16_f32 v124, v52, v53
v_mfma_f32_32x32x16_bf16 v[84:99], a[200:203], v[108:111], v[84:99]
v_cvt_pk_bf16_f32 v125, v54, v55
ds_read_b128 v[108:111], v14 offset:12288
s_waitcnt lgkmcnt(3)
v_mfma_f32_32x32x16_bf16 v[68:83], a[44:47], v[112:115], v[68:83]
v_cvt_pk_bf16_f32 v126, v56, v57
v_mfma_f32_32x32x16_bf16 v[84:99], a[204:207], v[112:115], v[84:99]
v_cvt_pk_bf16_f32 v127, v58, v59
ds_read_b128 v[112:115], v15 offset:12288
s_waitcnt lgkmcnt(3)
v_mfma_f32_32x32x16_bf16 v[68:83], a[48:51], v[100:103], v[68:83]
v_cvt_pk_bf16_f32 v128, v60, v61
v_mfma_f32_32x32x16_bf16 v[84:99], a[208:211], v[100:103], v[84:99]
v_cvt_pk_bf16_f32 v129, v62, v63
ds_read_b128 v[100:103], v12 offset:16384
s_waitcnt lgkmcnt(3)
v_mfma_f32_32x32x16_bf16 v[68:83], a[52:55], v[104:107], v[68:83]
v_cvt_pk_bf16_f32 v130, v64, v65
v_mfma_f32_32x32x16_bf16 v[84:99], a[212:215], v[104:107], v[84:99]
v_cvt_pk_bf16_f32 v131, v66, v67
ds_read_b128 v[104:107], v13 offset:16384
s_waitcnt lgkmcnt(3)
v_mfma_f32_32x32x16_bf16 v[68:83], a[56:59], v[108:111], v[68:83]
v_permlane32_swap_b32 v124, v126
v_mfma_f32_32x32x16_bf16 v[84:99], a[216:219], v[108:111], v[84:99]
v_permlane32_swap_b32 v125, v127
ds_read_b128 v[108:111], v14 offset:16384
s_waitcnt lgkmcnt(3)
v_mfma_f32_32x32x16_bf16 v[68:83], a[60:63], v[112:115], v[68:83]
v_permlane32_swap_b32 v128, v130
v_mfma_f32_32x32x16_bf16 v[84:99], a[220:223], v[112:115], v[84:99]
v_permlane32_swap_b32 v129, v131
ds_read_b128 v[112:115], v15 offset:16384
s_waitcnt lgkmcnt(3)
v_mfma_f32_32x32x16_bf16 v[68:83], a[64:67], v[100:103], v[68:83]
global_store_dwordx4 v8, v[124:127], s[48:49] offset:2048 sc1
v_mfma_f32_32x32x16_bf16 v[84:99], a[224:227], v[100:103], v[84:99]
global_store_dwordx4 v8, v[128:131], s[48:49] offset:3072 sc1
ds_read_b128 v[100:103], v12 offset:20480
s_waitcnt lgkmcnt(3)
v_mfma_f32_32x32x16_bf16 v[68:83], a[68:71], v[104:107], v[68:83]
s_mul_i32 s44, s32, 40960
v_mfma_f32_32x32x16_bf16 v[84:99], a[228:231], v[104:107], v[84:99]
s_add_u32 s46, s18, s44
ds_read_b128 v[104:107], v13 offset:20480
s_waitcnt lgkmcnt(3)
v_mfma_f32_32x32x16_bf16 v[68:83], a[72:75], v[108:111], v[68:83]
s_addc_u32 s47, s19, 0
v_mfma_f32_32x32x16_bf16 v[84:99], a[232:235], v[108:111], v[84:99]
s_add_u32 s45, s21, 0
ds_read_b128 v[108:111], v14 offset:20480
s_waitcnt lgkmcnt(3)
v_mfma_f32_32x32x16_bf16 v[68:83], a[76:79], v[112:115], v[68:83]
s_add_u32 m0, s45, 0
v_mfma_f32_32x32x16_bf16 v[84:99], a[236:239], v[112:115], v[84:99]
global_load_lds_dwordx4 v2, s[46:47] offset:0
ds_read_b128 v[112:115], v15 offset:20480
s_waitcnt lgkmcnt(3)
v_mfma_f32_32x32x16_bf16 v[68:83], a[80:83], v[100:103], v[68:83]
s_add_u32 m0, s45, 3968
v_mfma_f32_32x32x16_bf16 v[84:99], a[240:243], v[100:103], v[84:99]
global_load_lds_dwordx4 v2, s[46:47] offset:128
ds_read_b128 v[100:103], v12 offset:24576
s_waitcnt lgkmcnt(3)
v_mfma_f32_32x32x16_bf16 v[68:83], a[84:87], v[104:107], v[68:83]
s_add_u32 m0, s45, 7936
v_mfma_f32_32x32x16_bf16 v[84:99], a[244:247], v[104:107], v[84:99]
global_load_lds_dwordx4 v2, s[46:47] offset:256
ds_read_b128 v[104:107], v13 offset:24576
s_waitcnt lgkmcnt(3)
v_mfma_f32_32x32x16_bf16 v[68:83], a[88:91], v[108:111], v[68:83]
s_add_u32 m0, s45, 11904
v_mfma_f32_32x32x16_bf16 v[84:99], a[248:251], v[108:111], v[84:99]
global_load_lds_dwordx4 v2, s[46:47] offset:384
ds_read_b128 v[108:111], v14 offset:24576
s_waitcnt lgkmcnt(3)
v_mfma_f32_32x32x16_bf16 v[68:83], a[92:95], v[112:115], v[68:83]
s_add_u32 m0, s45, 15872
v_mfma_f32_32x32x16_bf16 v[84:99], a[252:255], v[112:115], v[84:99]
global_load_lds_dwordx4 v2, s[46:47] offset:512
ds_read_b128 v[112:115], v15 offset:24576
s_waitcnt lgkmcnt(3)
v_mfma_f32_32x32x16_bf16 v[68:83], a[96:99], v[100:103], v[68:83]
s_add_u32 m0, s45, 19840
v_mfma_f32_32x32x16_bf16 v[84:99], v[192:195], v[100:103], v[84:99]
global_load_lds_dwordx4 v2, s[46:47] offset:640
ds_read_b128 v[100:103], v12 offset:28672
s_waitcnt lgkmcnt(3)
v_mfma_f32_32x32x16_bf16 v[68:83], a[100:103], v[104:107], v[68:83]
s_add_u32 m0, s45, 23808
v_mfma_f32_32x32x16_bf16 v[84:99], v[196:199], v[104:107], v[84:99]
global_load_lds_dwordx4 v2, s[46:47] offset:768
ds_read_b128 v[104:107], v13 offset:28672
s_waitcnt lgkmcnt(3)
v_mfma_f32_32x32x16_bf16 v[68:83], a[104:107], v[108:111], v[68:83]
s_add_u32 m0, s45, 27776
v_mfma_f32_32x32x16_bf16 v[84:99], v[200:203], v[108:111], v[84:99]
global_load_lds_dwordx4 v2, s[46:47] offset:896
ds_read_b128 v[108:111], v14 offset:28672
s_waitcnt lgkmcnt(3)
v_mfma_f32_32x32x16_bf16 v[68:83], a[108:111], v[112:115], v[68:83]
s_add_u32 m0, s45, 31744
v_mfma_f32_32x32x16_bf16 v[84:99], v[204:207], v[112:115], v[84:99]
global_load_lds_dwordx4 v2, s[46:47] offset:1024
ds_read_b128 v[112:115], v15 offset:28672
s_waitcnt lgkmcnt(3)
v_mfma_f32_32x32x16_bf16 v[68:83], a[112:115], v[100:103], v[68:83]
s_add_u32 m0, s45, 35712
v_mfma_f32_32x32x16_bf16 v[84:99], v[208:211], v[100:103], v[84:99]
global_load_lds_dwordx4 v2, s[46:47] offset:1152
ds_read_b128 v[100:103], v12 offset:32768
s_waitcnt lgkmcnt(3)
v_mfma_f32_32x32x16_bf16 v[68:83], a[116:119], v[104:107], v[68:83]
v_mfma_f32_32x32x16_bf16 v[84:99], v[212:215], v[104:107], v[84:99]
ds_read_b128 v[104:107], v13 offset:32768
s_waitcnt lgkmcnt(3)
v_mfma_f32_32x32x16_bf16 v[68:83], a[120:123], v[108:111], v[68:83]
v_mfma_f32_32x32x16_bf16 v[84:99], v[216:219], v[108:111], v[84:99]
ds_read_b128 v[108:111], v14 offset:32768
s_waitcnt lgkmcnt(3)
v_mfma_f32_32x32x16_bf16 v[68:83], a[124:127], v[112:115], v[68:83]
v_mfma_f32_32x32x16_bf16 v[84:99], v[220:223], v[112:115], v[84:99]
ds_read_b128 v[112:115], v15 offset:32768
s_waitcnt lgkmcnt(3)
v_mfma_f32_32x32x16_bf16 v[68:83], a[128:131], v[100:103], v[68:83]
v_mfma_f32_32x32x16_bf16 v[84:99], v[224:227], v[100:103], v[84:99]
ds_read_b128 v[100:103], v12 offset:36864
s_waitcnt lgkmcnt(3)
v_mfma_f32_32x32x16_bf16 v[68:83], a[132:135], v[104:107], v[68:83]
v_mfma_f32_32x32x16_bf16 v[84:99], v[228:231], v[104:107], v[84:99]
ds_read_b128 v[104:107], v13 offset:36864
s_waitcnt lgkmcnt(3)
v_mfma_f32_32x32x16_bf16 v[68:83], a[136:139], v[108:111], v[68:83]
v_mfma_f32_32x32x16_bf16 v[84:99], v[232:235], v[108:111], v[84:99]
ds_read_b128 v[108:111], v14 offset:36864
s_waitcnt lgkmcnt(3)
v_mfma_f32_32x32x16_bf16 v[68:83], a[140:143], v[112:115], v[68:83]
v_mfma_f32_32x32x16_bf16 v[84:99], v[236:239], v[112:115], v[84:99]
ds_read_b128 v[112:115], v15 offset:36864
s_waitcnt lgkmcnt(3)
v_mfma_f32_32x32x16_bf16 v[68:83], a[144:147], v[100:103], v[68:83]
v_mfma_f32_32x32x16_bf16 v[84:99], v[240:243], v[100:103], v[84:99]
s_waitcnt lgkmcnt(2)
v_mfma_f32_32x32x16_bf16 v[68:83], a[148:151], v[104:107], v[68:83]
v_mfma_f32_32x32x16_bf16 v[84:99], v[244:247], v[104:107], v[84:99]
s_waitcnt lgkmcnt(1)
v_mfma_f32_32x32x16_bf16 v[68:83], a[152:155], v[108:111], v[68:83]
v_mfma_f32_32x32x16_bf16 v[84:99], v[248:251], v[108:111], v[84:99]
s_waitcnt lgkmcnt(0)
v_mfma_f32_32x32x16_bf16 v[68:83], a[156:159], v[112:115], v[68:83]
v_mfma_f32_32x32x16_bf16 v[84:99], v[252:255], v[112:115], v[84:99]
s_waitcnt vmcnt(0)
s_barrier
s_cmp_lg_u32 s3, 0
s_nop 7
s_cbranch_scc1 ef_29
s_lshl_b32 s44, s30, 8
s_lshl_b32 s45, s14, 2
s_add_u32 s44, s44, s45
s_add_u32 s44, s44, 46137344
v_mov_b32 v30, s44
v_mov_b32 v31, 1
global_store_dword v30, v31, s[4:5] sc1
ef_29:
s_mov_b32 s30, s31
s_add_u32 s31, s31, 2
s_cmp_ge_u32 s31, 64
s_cbranch_scc1 E1e_27_0
s_add_u32 s32, s31, 2
s_min_u32 s32, s32, 63
ds_read_b128 v[100:103], v4 offset:0
ds_read_b128 v[104:107], v5 offset:0
ds_read_b128 v[108:111], v6 offset:0
ds_read_b128 v[112:115], v7 offset:0
s_waitcnt lgkmcnt(3)
v_mfma_f32_32x32x16_bf16 v[36:51], a[0:3], v[100:103], 0
v_mfma_f32_32x32x16_bf16 v[52:67], a[160:163], v[100:103], 0
ds_read_b128 v[100:103], v4 offset:4096
s_waitcnt lgkmcnt(3)
v_mfma_f32_32x32x16_bf16 v[36:51], a[4:7], v[104:107], v[36:51]
s_lshl_b32 s44, s30, 18
v_mfma_f32_32x32x16_bf16 v[52:67], a[164:167], v[104:107], v[52:67]
s_add_u32 s44, s44, s20
ds_read_b128 v[104:107], v5 offset:4096
s_waitcnt lgkmcnt(3)
v_mfma_f32_32x32x16_bf16 v[36:51], a[8:11], v[108:111], v[36:51]
s_add_u32 s48, s4, s44
v_mfma_f32_32x32x16_bf16 v[52:67], a[168:171], v[108:111], v[52:67]
s_addc_u32 s49, s5, 0
ds_read_b128 v[108:111], v6 offset:4096
s_waitcnt lgkmcnt(3)
v_mfma_f32_32x32x16_bf16 v[36:51], a[12:15], v[112:115], v[36:51]
v_cvt_pk_bf16_f32 v116, v68, v69
v_mfma_f32_32x32x16_bf16 v[52:67], a[172:175], v[112:115], v[52:67]
v_cvt_pk_bf16_f32 v117, v70, v71
ds_read_b128 v[112:115], v7 offset:4096
s_waitcnt lgkmcnt(3)
v_mfma_f32_32x32x16_bf16 v[36:51], a[16:19], v[100:103], v[36:51]
v_cvt_pk_bf16_f32 v118, v72, v73
v_mfma_f32_32x32x16_bf16 v[52:67], a[176:179], v[100:103], v[52:67]
v_cvt_pk_bf16_f32 v119, v74, v75
ds_read_b128 v[100:103], v4 offset:8192
s_waitcnt lgkmcnt(3)
v_mfma_f32_32x32x16_bf16 v[36:51], a[20:23], v[104:107], v[36:51]
v_cvt_pk_bf16_f32 v120, v76, v77
v_mfma_f32_32x32x16_bf16 v[52:67], a[180:183], v[104:107], v[52:67]
v_cvt_pk_bf16_f32 v121, v78, v79
ds_read_b128 v[104:107], v5 offset:8192
s_waitcnt lgkmcnt(3)
v_mfma_f32_32x32x16_bf16 v[36:51], a[24:27], v[108:111], v[36:51]
v_cvt_pk_bf16_f32 v122, v80, v81
v_mfma_f32_32x32x16_bf16 v[52:67], a[184:187], v[108:111], v[52:67]
v_cvt_pk_bf16_f32 v123, v82, v83
ds_read_b128 v[108:111], v6 offset:8192
s_waitcnt lgkmcnt(3)
v_mfma_f32_32x32x16_bf16 v[36:51], a[28:31], v[112:115], v[36:51]
v_permlane32_swap_b32 v116, v118
v_mfma_f32_32x32x16_bf16 v[52:67], a[188:191], v[112:115], v[52:67]
v_permlane32_swap_b32 v117, v119
ds_read_b128 v[112:115], v7 offset:8192
s_waitcnt lgkmcnt(3)
v_mfma_f32_32x32x16_bf16 v[36:51], a[32:35], v[100:103], v[36:51]
v_permlane32_swap_b32 v120, v122
v_mfma_f32_32x32x16_bf16 v[52:67], a[192:195], v[100:103], v[52:67]
v_permlane32_swap_b32 v121, v123
ds_read_b128 v[100:103], v4 offset:12288
s_waitcnt lgkmcnt(3)
v_mfma_f32_32x32x16_bf16 v[36:51], a[36:39], v[104:107], v[36:51]
global_store_dwordx4 v8, v[116:119], s[48:49] offset:0 sc1
v_mfma_f32_32x32x16_bf16 v[52:67], a[196:199], v[104:107], v[52:67]
global_store_dwordx4 v8, v[120:123], s[48:49] offset:1024 sc1
ds_read_b128 v[104:107], v5 offset:12288
s_waitcnt lgkmcnt(3)
v_mfma_f32_32x32x16_bf16 v[36:51], a[40:43], v[108:111], v[36:51]
v_cvt_pk_bf16_f32 v124, v84, v85
v_mfma_f32_32x32x16_bf16 v[52:67], a[200:203], v[108:111], v[52:67]
v_cvt_pk_bf16_f32 v125, v86, v87
ds_read_b128 v[108:111], v6 offset:12288
s_waitcnt lgkmcnt(3)
v_mfma_f32_32x32x16_bf16 v[36:51], a[44:47], v[112:115], v[36:51]
v_cvt_pk_bf16_f32 v126, v88, v89
v_mfma_f32_32x32x16_bf16 v[52:67], a[204:207], v[112:115], v[52:67]
v_cvt_pk_bf16_f32 v127, v90, v91
ds_read_b128 v[112:115], v7 offset:12288
s_waitcnt lgkmcnt(3)
v_mfma_f32_32x32x16_bf16 v[36:51], a[48:51], v[100:103], v[36:51]
v_cvt_pk_bf16_f32 v128, v92, v93
v_mfma_f32_32x32x16_bf16 v[52:67], a[208:211], v[100:103], v[52:67]
v_cvt_pk_bf16_f32 v129, v94, v95
ds_read_b128 v[100:103], v4 offset:16384
s_waitcnt lgkmcnt(3)
v_mfma_f32_32x32x16_bf16 v[36:51], a[52:55], v[104:107], v[36:51]
v_cvt_pk_bf16_f32 v130, v96, v97
v_mfma_f32_32x32x16_bf16 v[52:67], a[212:215], v[104:107], v[52:67]
v_cvt_pk_bf16_f32 v131, v98, v99
ds_read_b128 v[104:107], v5 offset:16384
s_waitcnt lgkmcnt(3)
v_mfma_f32_32x32x16_bf16 v[36:51], a[56:59], v[108:111], v[36:51]
v_permlane32_swap_b32 v124, v126
v_mfma_f32_32x32x16_bf16 v[52:67], a[216:219], v[108:111], v[52:67]
v_permlane32_swap_b32 v125, v127
ds_read_b128 v[108:111], v6 offset:16384
s_waitcnt lgkmcnt(3)
v_mfma_f32_32x32x16_bf16 v[36:51], a[60:63], v[112:115], v[36:51]
v_permlane32_swap_b32 v128, v130
v_mfma_f32_32x32x16_bf16 v[52:67], a[220:223], v[112:115], v[52:67]
v_permlane32_swap_b32 v129, v131
ds_read_b128 v[112:115], v7 offset:16384
s_waitcnt lgkmcnt(3)
v_mfma_f32_32x32x16_bf16 v[36:51], a[64:67], v[100:103], v[36:51]
global_store_dwordx4 v8, v[124:127], s[48:49] offset:2048 sc1
v_mfma_f32_32x32x16_bf16 v[52:67], a[224:227], v[100:103], v[52:67]
global_store_dwordx4 v8, v[128:131], s[48:49] offset:3072 sc1
ds_read_b128 v[100:103], v4 offset:20480
s_waitcnt lgkmcnt(3)
v_mfma_f32_32x32x16_bf16 v[36:51], a[68:71], v[104:107], v[36:51]
s_mul_i32 s44, s32, 40960
v_mfma_f32_32x32x16_bf16 v[52:67], a[228:231], v[104:107], v[52:67]
s_add_u32 s46, s18, s44
ds_read_b128 v[104:107], v5 offset:20480
s_waitcnt lgkmcnt(3)
v_mfma_f32_32x32x16_bf16 v[36:51], a[72:75], v[108:111], v[36:51]
s_addc_u32 s47, s19, 0
v_mfma_f32_32x32x16_bf16 v[52:67], a[232:235], v[108:111], v[52:67]
s_add_u32 s45, s21, 40960
ds_read_b128 v[108:111], v6 offset:20480
s_waitcnt lgkmcnt(3)
v_mfma_f32_32x32x16_bf16 v[36:51], a[76:79], v[112:115], v[36:51]
s_add_u32 m0, s45, 0
v_mfma_f32_32x32x16_bf16 v[52:67], a[236:239], v[112:115], v[52:67]
global_load_lds_dwordx4 v2, s[46:47] offset:0
ds_read_b128 v[112:115], v7 offset:20480
s_waitcnt lgkmcnt(3)
v_mfma_f32_32x32x16_bf16 v[36:51], a[80:83], v[100:103], v[36:51]
s_add_u32 m0, s45, 3968
v_mfma_f32_32x32x16_bf16 v[52:67], a[240:243], v[100:103], v[52:67]
global_load_lds_dwordx4 v2, s[46:47] offset:128
ds_read_b128 v[100:103], v4 offset:24576
s_waitcnt lgkmcnt(3)
v_mfma_f32_32x32x16_bf16 v[36:51], a[84:87], v[104:107], v[36:51]
s_add_u32 m0, s45, 7936
v_mfma_f32_32x32x16_bf16 v[52:67], a[244:247], v[104:107], v[52:67]
global_load_lds_dwordx4 v2, s[46:47] offset:256
ds_read_b128 v[104:107], v5 offset:24576
s_waitcnt lgkmcnt(3)
v_mfma_f32_32x32x16_bf16 v[36:51], a[88:91], v[108:111], v[36:51]
s_add_u32 m0, s45, 11904
v_mfma_f32_32x32x16_bf16 v[52:67], a[248:251], v[108:111], v[52:67]
global_load_lds_dwordx4 v2, s[46:47] offset:384
ds_read_b128 v[108:111], v6 offset:24576
s_waitcnt lgkmcnt(3)
v_mfma_f32_32x32x16_bf16 v[36:51], a[92:95], v[112:115], v[36:51]
s_add_u32 m0, s45, 15872
v_mfma_f32_32x32x16_bf16 v[52:67], a[252:255], v[112:115], v[52:67]
global_load_lds_dwordx4 v2, s[46:47] offset:512
ds_read_b128 v[112:115], v7 offset:24576
s_waitcnt lgkmcnt(3)
v_mfma_f32_32x32x16_bf16 v[36:51], a[96:99], v[100:103], v[36:51]
s_add_u32 m0, s45, 19840
v_mfma_f32_32x32x16_bf16 v[52:67], v[192:195], v[100:103], v[52:67]
global_load_lds_dwordx4 v2, s[46:47] offset:640
ds_read_b128 v[100:103], v4 offset:28672
s_waitcnt lgkmcnt(3)
v_mfma_f32_32x32x16_bf16 v[36:51], a[100:103], v[104:107], v[36:51]
s_add_u32 m0, s45, 23808
v_mfma_f32_32x32x16_bf16 v[52:67], v[196:199], v[104:107], v[52:67]
global_load_lds_dwordx4 v2, s[46:47] offset:768
ds_read_b128 v[104:107], v5 offset:28672
s_waitcnt lgkmcnt(3)
v_mfma_f32_32x32x16_bf16 v[36:51], a[104:107], v[108:111], v[36:51]
s_add_u32 m0, s45, 27776
v_mfma_f32_32x32x16_bf16 v[52:67], v[200:203], v[108:111], v[52:67]
global_load_lds_dwordx4 v2, s[46:47] offset:896
ds_read_b128 v[108:111], v6 offset:28672
s_waitcnt lgkmcnt(3)
v_mfma_f32_32x32x16_bf16 v[36:51], a[108:111], v[112:115], v[36:51]
s_add_u32 m0, s45, 31744
v_mfma_f32_32x32x16_bf16 v[52:67], v[204:207], v[112:115], v[52:67]
global_load_lds_dwordx4 v2, s[46:47] offset:1024
ds_read_b128 v[112:115], v7 offset:28672
s_waitcnt lgkmcnt(3)
v_mfma_f32_32x32x16_bf16 v[36:51], a[112:115], v[100:103], v[36:51]
s_add_u32 m0, s45, 35712
v_mfma_f32_32x32x16_bf16 v[52:67], v[208:211], v[100:103], v[52:67]
global_load_lds_dwordx4 v2, s[46:47] offset:1152
ds_read_b128 v[100:103], v4 offset:32768
s_waitcnt lgkmcnt(3)
v_mfma_f32_32x32x16_bf16 v[36:51], a[116:119], v[104:107], v[36:51]
v_mfma_f32_32x32x16_bf16 v[52:67], v[212:215], v[104:107], v[52:67]
ds_read_b128 v[104:107], v5 offset:32768
s_waitcnt lgkmcnt(3)
v_mfma_f32_32x32x16_bf16 v[36:51], a[120:123], v[108:111], v[36:51]
v_mfma_f32_32x32x16_bf16 v[52:67], v[216:219], v[108:111], v[52:67]
ds_read_b128 v[108:111], v6 offset:32768
s_waitcnt lgkmcnt(3)
v_mfma_f32_32x32x16_bf16 v[36:51], a[124:127], v[112:115], v[36:51]
v_mfma_f32_32x32x16_bf16 v[52:67], v[220:223], v[112:115], v[52:67]
ds_read_b128 v[112:115], v7 offset:32768
s_waitcnt lgkmcnt(3)
v_mfma_f32_32x32x16_bf16 v[36:51], a[128:131], v[100:103], v[36:51]
v_mfma_f32_32x32x16_bf16 v[52:67], v[224:227], v[100:103], v[52:67]
ds_read_b128 v[100:103], v4 offset:36864
s_waitcnt lgkmcnt(3)
v_mfma_f32_32x32x16_bf16 v[36:51], a[132:135], v[104:107], v[36:51]
v_mfma_f32_32x32x16_bf16 v[52:67], v[228:231], v[104:107], v[52:67]
ds_read_b128 v[104:107], v5 offset:36864
s_waitcnt lgkmcnt(3)
v_mfma_f32_32x32x16_bf16 v[36:51], a[136:139], v[108:111], v[36:51]
v_mfma_f32_32x32x16_bf16 v[52:67], v[232:235], v[108:111], v[52:67]
ds_read_b128 v[108:111], v6 offset:36864
s_waitcnt lgkmcnt(3)
v_mfma_f32_32x32x16_bf16 v[36:51], a[140:143], v[112:115], v[36:51]
v_mfma_f32_32x32x16_bf16 v[52:67], v[236:239], v[112:115], v[52:67]
ds_read_b128 v[112:115], v7 offset:36864
s_waitcnt lgkmcnt(3)
v_mfma_f32_32x32x16_bf16 v[36:51], a[144:147], v[100:103], v[36:51]
v_mfma_f32_32x32x16_bf16 v[52:67], v[240:243], v[100:103], v[52:67]
s_waitcnt lgkmcnt(2)
v_mfma_f32_32x32x16_bf16 v[36:51], a[148:151], v[104:107], v[36:51]
v_mfma_f32_32x32x16_bf16 v[52:67], v[244:247], v[104:107], v[52:67]
s_waitcnt lgkmcnt(1)
v_mfma_f32_32x32x16_bf16 v[36:51], a[152:155], v[108:111], v[36:51]
v_mfma_f32_32x32x16_bf16 v[52:67], v[248:251], v[108:111], v[52:67]
s_waitcnt lgkmcnt(0)
v_mfma_f32_32x32x16_bf16 v[36:51], a[156:159], v[112:115], v[36:51]
v_mfma_f32_32x32x16_bf16 v[52:67], v[252:255], v[112:115], v[52:67]
s_waitcnt vmcnt(0)
s_barrier
s_cmp_lg_u32 s3, 0
s_nop 7
s_cbranch_scc1 ef_31
s_lshl_b32 s44, s30, 8
s_lshl_b32 s45, s14, 2
s_add_u32 s44, s44, s45
s_add_u32 s44, s44, 46137344
v_mov_b32 v30, s44
v_mov_b32 v31, 1
global_store_dword v30, v31, s[4:5] sc1
ef_31:
s_mov_b32 s30, s31
s_add_u32 s31, s31, 2
s_cmp_ge_u32 s31, 64
s_cbranch_scc1 E1e_27_1
s_branch E1l_26
E1e_27_0:
s_lshl_b32 s44, s30, 18
s_add_u32 s44, s44, s20
s_add_u32 s48, s4, s44
s_addc_u32 s49, s5, 0
v_cvt_pk_bf16_f32 v116, v68, v69
v_cvt_pk_bf16_f32 v117, v70, v71
v_cvt_pk_bf16_f32 v118, v72, v73
v_cvt_pk_bf16_f32 v119, v74, v75
v_cvt_pk_bf16_f32 v120, v76, v77
v_cvt_pk_bf16_f32 v121, v78, v79
v_cvt_pk_bf16_f32 v122, v80, v81
v_cvt_pk_bf16_f32 v123, v82, v83
v_permlane32_swap_b32 v116, v118
v_permlane32_swap_b32 v117, v119
v_permlane32_swap_b32 v120, v122
v_permlane32_swap_b32 v121, v123
global_store_dwordx4 v8, v[116:119], s[48:49] offset:0 sc1
global_store_dwordx4 v8, v[120:123], s[48:49] offset:1024 sc1
v_cvt_pk_bf16_f32 v124, v84, v85
v_cvt_pk_bf16_f32 v125, v86, v87
v_cvt_pk_bf16_f32 v126, v88, v89
v_cvt_pk_bf16_f32 v127, v90, v91
v_cvt_pk_bf16_f32 v128, v92, v93
v_cvt_pk_bf16_f32 v129, v94, v95
v_cvt_pk_bf16_f32 v130, v96, v97
v_cvt_pk_bf16_f32 v131, v98, v99
v_permlane32_swap_b32 v124, v126
v_permlane32_swap_b32 v125, v127
v_permlane32_swap_b32 v128, v130
v_permlane32_swap_b32 v129, v131
global_store_dwordx4 v8, v[124:127], s[48:49] offset:2048 sc1
global_store_dwordx4 v8, v[128:131], s[48:49] offset:3072 sc1
s_waitcnt vmcnt(0)
s_barrier
s_cmp_lg_u32 s3, 0
s_cbranch_scc1 ef_33
s_lshl_b32 s44, s30, 8
s_lshl_b32 s45, s14, 2
s_add_u32 s44, s44, s45
s_add_u32 s44, s44, 46137344
v_mov_b32 v30, s44
v_mov_b32 v31, 1
global_store_dword v30, v31, s[4:5] sc1
ef_33:
s_waitcnt vmcnt(0)
s_endpgm
E1e_27_1:
s_lshl_b32 s44, s30, 18
s_add_u32 s44, s44, s20
s_add_u32 s48, s4, s44
s_addc_u32 s49, s5, 0
v_cvt_pk_bf16_f32 v116, v36, v37
v_cvt_pk_bf16_f32 v117, v38, v39
v_cvt_pk_bf16_f32 v118, v40, v41
v_cvt_pk_bf16_f32 v119, v42, v43
v_cvt_pk_bf16_f32 v120, v44, v45
v_cvt_pk_bf16_f32 v121, v46, v47
v_cvt_pk_bf16_f32 v122, v48, v49
v_cvt_pk_bf16_f32 v123, v50, v51
v_permlane32_swap_b32 v116, v118
v_permlane32_swap_b32 v117, v119
v_permlane32_swap_b32 v120, v122
v_permlane32_swap_b32 v121, v123
global_store_dwordx4 v8, v[116:119], s[48:49] offset:0 sc1
global_store_dwordx4 v8, v[120:123], s[48:49] offset:1024 sc1
v_cvt_pk_bf16_f32 v124, v52, v53
v_cvt_pk_bf16_f32 v125, v54, v55
v_cvt_pk_bf16_f32 v126, v56, v57
v_cvt_pk_bf16_f32 v127, v58, v59
v_cvt_pk_bf16_f32 v128, v60, v61
v_cvt_pk_bf16_f32 v129, v62, v63
v_cvt_pk_bf16_f32 v130, v64, v65
v_cvt_pk_bf16_f32 v131, v66, v67
v_permlane32_swap_b32 v124, v126
v_permlane32_swap_b32 v125, v127
v_permlane32_swap_b32 v128, v130
v_permlane32_swap_b32 v129, v131
global_store_dwordx4 v8, v[124:127], s[48:49] offset:2048 sc1
global_store_dwordx4 v8, v[128:131], s[48:49] offset:3072 sc1
s_waitcnt vmcnt(0)
s_barrier
s_cmp_lg_u32 s3, 0
s_cbranch_scc1 ef_34
s_lshl_b32 s44, s30, 8
s_lshl_b32 s45, s14, 2
s_add_u32 s44, s44, s45
s_add_u32 s44, s44, 46137344
v_mov_b32 v30, s44
v_mov_b32 v31, 1
global_store_dword v30, v31, s[4:5] sc1
ef_34:
s_waitcnt vmcnt(0)
s_endpgm
L_vu:
s_and_b32 s17, s17, 31
s_sub_u32 s15, s12, 4
s_lshr_b32 s14, s17, 1
s_lshl_b32 s16, s15, 4
s_add_u32 s16, s16, s14
s_and_b32 s17, s17, 1
s_load_dwordx2 s[18:19], s[0:1], 72
s_waitcnt lgkmcnt(0)
s_mul_i32 s40, s17, 40960
s_add_u32 s40, s18, s40
s_addc_u32 s41, s19, 0
s_mul_i32 s42, s3, 192
v_add_u32 v30, s42, v1
v_min_u32 v31, 639, v30
v_lshlrev_b32 v31, 6, v31
global_load_dword v28, v31, s[40:41]
v_add_u32 v30, 64, v30
v_min_u32 v31, 639, v30
v_lshlrev_b32 v31, 6, v31
global_load_dword v28, v31, s[40:41]
v_add_u32 v30, 64, v30
v_min_u32 v31, 639, v30
v_lshlrev_b32 v31, 6, v31
global_load_dword v28, v31, s[40:41]
v_add_u32 v30, 64, v30
s_load_dwordx2 s[8:9], s[0:1], 104
s_load_dwordx2 s[10:11], s[0:1], 112
s_waitcnt lgkmcnt(0)
s_lshl_b32 s40, s3, 18
s_lshl_b32 s41, s16, 8
s_add_u32 s40, s40, s41
s_add_u32 s8, s8, s40
s_addc_u32 s9, s9, 0
s_mul_i32 s40, s16, 163840
s_mul_i32 s41, s3, 40960
s_add_u32 s40, s40, s41
s_add_u32 s10, s10, s40
s_addc_u32 s11, s11, 0
v_lshrrev_b32 v30, 4, v1
v_mul_u32_u24 v11, 2176, v30
v_bfe_u32 v30, v1, 2, 2
v_lshl_add_u32 v11, v30, 8, v11
v_and_b32 v30, 3, v1
v_lshl_add_u32 v11, v30, 3, v11
s_lshl_b32 s40, s3, 6
v_add_u32 v11, s40, v11
s_add_u32 s40, s8, 0
s_addc_u32 s41, s9, 0
s_mov_b32 s43, 32768
v_lshrrev_b32 v34, 4, v1
v_lshlrev_b32 v34, 13, v34
v_and_b32 v35, 15, v1
v_lshl_add_u32 v34, v35, 4, v34
s_mul_i32 s44, s3, 8704
s_add_u32 s44, s44, 0
v_mov_b32 v35, v34
s_add_u32 m0, s44, 0
s_nop 0
global_load_lds_dwordx4 v35, s[40:41]
v_add_u32 v35, s43, v35
s_add_u32 m0, s44, 1088
s_nop 0
global_load_lds_dwordx4 v35, s[40:41]
v_add_u32 v35, s43, v35
s_add_u32 m0, s44, 2176
s_nop 0
global_load_lds_dwordx4 v35, s[40:41]
v_add_u32 v35, s43, v35
s_add_u32 m0, s44, 3264
s_nop 0
global_load_lds_dwordx4 v35, s[40:41]
v_add_u32 v35, s43, v35
s_add_u32 m0, s44, 4352
s_nop 0
global_load_lds_dwordx4 v35, s[40:41]
v_add_u32 v35, s43, v35
s_add_u32 m0, s44, 5440
s_nop 0
global_load_lds_dwordx4 v35, s[40:41]
v_add_u32 v35, s43, v35
s_add_u32 m0, s44, 6528
s_nop 0
global_load_lds_dwordx4 v35, s[40:41]
v_add_u32 v35, s43, v35
s_add_u32 m0, s44, 7616
s_nop 0
global_load_lds_dwordx4 v35, s[40:41]
s_add_u32 s40, s8, 1048576
s_addc_u32 s41, s9, 0
s_mov_b32 s43, 32768
v_lshrrev_b32 v34, 4, v1
v_lshlrev_b32 v34, 13, v34
v_and_b32 v35, 15, v1
v_lshl_add_u32 v34, v35, 4, v34
s_mul_i32 s44, s3, 8704
s_add_u32 s44, s44, 34816
v_mov_b32 v35, v34
s_add_u32 m0, s44, 0
s_nop 0
global_load_lds_dwordx4 v35, s[40:41]
v_add_u32 v35, s43, v35
s_add_u32 m0, s44, 1088
s_nop 0
global_load_lds_dwordx4 v35, s[40:41]
v_add_u32 v35, s43, v35
s_add_u32 m0, s44, 2176
s_nop 0
global_load_lds_dwordx4 v35, s[40:41]
v_add_u32 v35, s43, v35
s_add_u32 m0, s44, 3264
s_nop 0
global_load_lds_dwordx4 v35, s[40:41]
v_add_u32 v35, s43, v35
s_add_u32 m0, s44, 4352
s_nop 0
global_load_lds_dwordx4 v35, s[40:41]
v_add_u32 v35, s43, v35
s_add_u32 m0, s44, 5440
s_nop 0
global_load_lds_dwordx4 v35, s[40:41]
v_add_u32 v35, s43, v35
s_add_u32 m0, s44, 6528
s_nop 0
global_load_lds_dwordx4 v35, s[40:41]
v_add_u32 v35, s43, v35
s_add_u32 m0, s44, 7616
s_nop 0
global_load_lds_dwordx4 v35, s[40:41]
s_add_u32 s40, s8, 2097152
s_addc_u32 s41, s9, 0
s_mov_b32 s43, 32768
v_lshrrev_b32 v34, 4, v1
v_lshlrev_b32 v34, 13, v34
v_and_b32 v35, 15, v1
v_lshl_add_u32 v34, v35, 4, v34
s_mul_i32 s44, s3, 8704
s_add_u32 s44, s44, 69632
v_mov_b32 v35, v34
s_add_u32 m0, s44, 0
s_nop 0
global_load_lds_dwordx4 v35, s[40:41]
v_add_u32 v35, s43, v35
s_add_u32 m0, s44, 1088
s_nop 0
global_load_lds_dwordx4 v35, s[40:41]
v_add_u32 v35, s43, v35
s_add_u32 m0, s44, 2176
s_nop 0
global_load_lds_dwordx4 v35, s[40:41]
v_add_u32 v35, s43, v35
s_add_u32 m0, s44, 3264
s_nop 0
global_load_lds_dwordx4 v35, s[40:41]
v_add_u32 v35, s43, v35
s_add_u32 m0, s44, 4352
s_nop 0
global_load_lds_dwordx4 v35, s[40:41]
v_add_u32 v35, s43, v35
s_add_u32 m0, s44, 5440
s_nop 0
global_load_lds_dwordx4 v35, s[40:41]
v_add_u32 v35, s43, v35
s_add_u32 m0, s44, 6528
s_nop 0
global_load_lds_dwordx4 v35, s[40:41]
v_add_u32 v35, s43, v35
s_add_u32 m0, s44, 7616
s_nop 0
global_load_lds_dwordx4 v35, s[40:41]
s_add_u32 s40, s8, 3145728
s_addc_u32 s41, s9, 0
s_mov_b32 s43, 32768
v_lshrrev_b32 v34, 4, v1
v_lshlrev_b32 v34, 13, v34
v_and_b32 v35, 15, v1
v_lshl_add_u32 v34, v35, 4, v34
s_mul_i32 s44, s3, 8704
s_add_u32 s44, s44, 104448
v_mov_b32 v35, v34
s_add_u32 m0, s44, 0
s_nop 0
global_load_lds_dwordx4 v35, s[40:41]
v_add_u32 v35, s43, v35
s_add_u32 m0, s44, 1088
s_nop 0
global_load_lds_dwordx4 v35, s[40:41]
v_add_u32 v35, s43, v35
s_add_u32 m0, s44, 2176
s_nop 0
global_load_lds_dwordx4 v35, s[40:41]
v_add_u32 v35, s43, v35
s_add_u32 m0, s44, 3264
s_nop 0
global_load_lds_dwordx4 v35, s[40:41]
v_add_u32 v35, s43, v35
s_add_u32 m0, s44, 4352
s_nop 0
global_load_lds_dwordx4 v35, s[40:41]
v_add_u32 v35, s43, v35
s_add_u32 m0, s44, 5440
s_nop 0
global_load_lds_dwordx4 v35, s[40:41]
v_add_u32 v35, s43, v35
s_add_u32 m0, s44, 6528
s_nop 0
global_load_lds_dwordx4 v35, s[40:41]
v_add_u32 v35, s43, v35
s_add_u32 m0, s44, 7616
s_nop 0
global_load_lds_dwordx4 v35, s[40:41]
s_cmp_lg_u32 s101, 0
s_cbranch_scc1 arr_35
s_cmp_lg_u32 s99, 0
s_cbranch_scc1 arr_35
s_waitcnt vmcnt(32)
s_barrier
s_cmp_lg_u32 s3, 0
s_cbranch_scc1 arr_35
v_mov_b32 v30, 64
v_mov_b32 v31, 1
s_mov_b64 exec, 1
global_atomic_add v30, v31, s[6:7]
s_mov_b64 exec, -1
arr_35:
s_waitcnt vmcnt(24)
s_barrier
v_add_u32 v33, 0, v11
ds_read_b64_tr_b16 a[0:1], v33 offset:0
ds_read_b64_tr_b16 a[2:3], v33 offset:1088
ds_read_b64_tr_b16 a[4:5], v33 offset:8704
ds_read_b64_tr_b16 a[6:7], v33 offset:9792
ds_read_b64_tr_b16 a[80:81], v33 offset:32
ds_read_b64_tr_b16 a[82:83], v33 offset:1120
ds_read_b64_tr_b16 a[84:85], v33 offset:8736
ds_read_b64_tr_b16 a[86:87], v33 offset:9824
ds_read_b64_tr_b16 a[8:9], v33 offset:17408
ds_read_b64_tr_b16 a[10:11], v33 offset:18496
ds_read_b64_tr_b16 a[12:13], v33 offset:26112
ds_read_b64_tr_b16 a[14:15], v33 offset:27200
ds_read_b64_tr_b16 a[88:89], v33 offset:17440
ds_read_b64_tr_b16 a[90:91], v33 offset:18528
ds_read_b64_tr_b16 a[92:93], v33 offset:26144
ds_read_b64_tr_b16 a[94:95], v33 offset:27232
s_waitcnt lgkmcnt(0)
s_barrier
s_add_u32 s40, s8, 4194304
s_addc_u32 s41, s9, 0
s_mov_b32 s43, 32768
v_lshrrev_b32 v34, 4, v1
v_lshlrev_b32 v34, 13, v34
v_and_b32 v35, 15, v1
v_lshl_add_u32 v34, v35, 4, v34
s_mul_i32 s44, s3, 8704
s_add_u32 s44, s44, 0
v_mov_b32 v35, v34
s_add_u32 m0, s44, 0
s_nop 0
global_load_lds_dwordx4 v35, s[40:41]
v_add_u32 v35, s43, v35
s_add_u32 m0, s44, 1088
s_nop 0
global_load_lds_dwordx4 v35, s[40:41]
v_add_u32 v35, s43, v35
s_add_u32 m0, s44, 2176
s_nop 0
global_load_lds_dwordx4 v35, s[40:41]
v_add_u32 v35, s43, v35
s_add_u32 m0, s44, 3264
s_nop 0
global_load_lds_dwordx4 v35, s[40:41]
v_add_u32 v35, s43, v35
s_add_u32 m0, s44, 4352
s_nop 0
global_load_lds_dwordx4 v35, s[40:41]
v_add_u32 v35, s43, v35
s_add_u32 m0, s44, 5440
s_nop 0
global_load_lds_dwordx4 v35, s[40:41]
v_add_u32 v35, s43, v35
s_add_u32 m0, s44, 6528
s_nop 0
global_load_lds_dwordx4 v35, s[40:41]
v_add_u32 v35, s43, v35
s_add_u32 m0, s44, 7616
s_nop 0
global_load_lds_dwordx4 v35, s[40:41]
s_waitcnt vmcnt(24)
s_barrier
v_add_u32 v33, 34816, v11
ds_read_b64_tr_b16 a[16:17], v33 offset:0
ds_read_b64_tr_b16 a[18:19], v33 offset:1088
ds_read_b64_tr_b16 a[20:21], v33 offset:8704
ds_read_b64_tr_b16 a[22:23], v33 offset:9792
ds_read_b64_tr_b16 a[96:97], v33 offset:32
ds_read_b64_tr_b16 a[98:99], v33 offset:1120
ds_read_b64_tr_b16 a[100:101], v33 offset:8736
ds_read_b64_tr_b16 a[102:103], v33 offset:9824
ds_read_b64_tr_b16 a[24:25], v33 offset:17408
ds_read_b64_tr_b16 a[26:27], v33 offset:18496
ds_read_b64_tr_b16 a[28:29], v33 offset:26112
ds_read_b64_tr_b16 a[30:31], v33 offset:27200
ds_read_b64_tr_b16 a[104:105], v33 offset:17440
ds_read_b64_tr_b16 a[106:107], v33 offset:18528
ds_read_b64_tr_b16 a[108:109], v33 offset:26144
ds_read_b64_tr_b16 a[110:111], v33 offset:27232
s_waitcnt lgkmcnt(0)
s_barrier
s_add_u32 s40, s10, 0
s_addc_u32 s41, s11, 0
s_mov_b32 s43, 5120
v_lshrrev_b32 v34, 4, v1
v_mul_u32_u24 v34, 1280, v34
v_and_b32 v35, 15, v1
v_lshl_add_u32 v34, v35, 4, v34
s_mul_i32 s44, s3, 8704
s_add_u32 s44, s44, 34816
v_mov_b32 v35, v34
s_add_u32 m0, s44, 0
s_nop 0
global_load_lds_dwordx4 v35, s[40:41]
v_add_u32 v35, s43, v35
s_add_u32 m0, s44, 1088
s_nop 0
global_load_lds_dwordx4 v35, s[40:41]
v_add_u32 v35, s43, v35
s_add_u32 m0, s44, 2176
s_nop 0
global_load_lds_dwordx4 v35, s[40:41]
v_add_u32 v35, s43, v35
s_add_u32 m0, s44, 3264
s_nop 0
global_load_lds_dwordx4 v35, s[40:41]
v_add_u32 v35, s43, v35
s_add_u32 m0, s44, 4352
s_nop 0
global_load_lds_dwordx4 v35, s[40:41]
v_add_u32 v35, s43, v35
s_add_u32 m0, s44, 5440
s_nop 0
global_load_lds_dwordx4 v35, s[40:41]
v_add_u32 v35, s43, v35
s_add_u32 m0, s44, 6528
s_nop 0
global_load_lds_dwordx4 v35, s[40:41]
v_add_u32 v35, s43, v35
s_add_u32 m0, s44, 7616
s_nop 0
global_load_lds_dwordx4 v35, s[40:41]
s_waitcnt vmcnt(24)
s_barrier
v_add_u32 v33, 69632, v11
ds_read_b64_tr_b16 a[32:33], v33 offset:0
ds_read_b64_tr_b16 a[34:35], v33 offset:1088
ds_read_b64_tr_b16 a[36:37], v33 offset:8704
ds_read_b64_tr_b16 a[38:39], v33 offset:9792
ds_read_b64_tr_b16 a[112:113], v33 offset:32
ds_read_b64_tr_b16 a[114:115], v33 offset:1120
ds_read_b64_tr_b16 a[116:117], v33 offset:8736
ds_read_b64_tr_b16 a[118:119], v33 offset:9824
ds_read_b64_tr_b16 a[40:41], v33 offset:17408
ds_read_b64_tr_b16 a[42:43], v33 offset:18496
ds_read_b64_tr_b16 a[44:45], v33 offset:26112
ds_read_b64_tr_b16 a[46:47], v33 offset:27200
ds_read_b64_tr_b16 a[120:121], v33 offset:17440
ds_read_b64_tr_b16 a[122:123], v33 offset:18528
ds_read_b64_tr_b16 a[124:125], v33 offset:26144
ds_read_b64_tr_b16 a[126:127], v33 offset:27232
s_waitcnt lgkmcnt(0)
s_barrier
s_add_u32 s40, s10, 256
s_addc_u32 s41, s11, 0
s_mov_b32 s43, 5120
v_lshrrev_b32 v34, 4, v1
v_mul_u32_u24 v34, 1280, v34
v_and_b32 v35, 15, v1
v_lshl_add_u32 v34, v35, 4, v34
s_mul_i32 s44, s3, 8704
s_add_u32 s44, s44, 69632
v_mov_b32 v35, v34
s_add_u32 m0, s44, 0
s_nop 0
global_load_lds_dwordx4 v35, s[40:41]
v_add_u32 v35, s43, v35
s_add_u32 m0, s44, 1088
s_nop 0
global_load_lds_dwordx4 v35, s[40:41]
v_add_u32 v35, s43, v35
s_add_u32 m0, s44, 2176
s_nop 0
global_load_lds_dwordx4 v35, s[40:41]
v_add_u32 v35, s43, v35
s_add_u32 m0, s44, 3264
s_nop 0
global_load_lds_dwordx4 v35, s[40:41]
v_add_u32 v35, s43, v35
s_add_u32 m0, s44, 4352
s_nop 0
global_load_lds_dwordx4 v35, s[40:41]
v_add_u32 v35, s43, v35
s_add_u32 m0, s44, 5440
s_nop 0
global_load_lds_dwordx4 v35, s[40:41]
v_add_u32 v35, s43, v35
s_add_u32 m0, s44, 6528
s_nop 0
global_load_lds_dwordx4 v35, s[40:41]
v_add_u32 v35, s43, v35
s_add_u32 m0, s44, 7616
s_nop 0
global_load_lds_dwordx4 v35, s[40:41]
s_waitcnt vmcnt(24)
s_barrier
v_add_u32 v33, 104448, v11
ds_read_b64_tr_b16 a[48:49], v33 offset:0
ds_read_b64_tr_b16 a[50:51], v33 offset:1088
ds_read_b64_tr_b16 a[52:53], v33 offset:8704
ds_read_b64_tr_b16 a[54:55], v33 offset:9792
ds_read_b64_tr_b16 a[128:129], v33 offset:32
ds_read_b64_tr_b16 a[130:131], v33 offset:1120
ds_read_b64_tr_b16 a[132:133], v33 offset:8736
ds_read_b64_tr_b16 a[134:135], v33 offset:9824
ds_read_b64_tr_b16 a[56:57], v33 offset:17408
ds_read_b64_tr_b16 a[58:59], v33 offset:18496
ds_read_b64_tr_b16 a[60:61], v33 offset:26112
ds_read_b64_tr_b16 a[62:63], v33 offset:27200
ds_read_b64_tr_b16 a[136:137], v33 offset:17440
ds_read_b64_tr_b16 a[138:139], v33 offset:18528
ds_read_b64_tr_b16 a[140:141], v33 offset:26144
ds_read_b64_tr_b16 a[142:143], v33 offset:27232
s_waitcnt lgkmcnt(0)
s_barrier
s_add_u32 s40, s10, 512
s_addc_u32 s41, s11, 0
s_mov_b32 s43, 5120
v_lshrrev_b32 v34, 4, v1
v_mul_u32_u24 v34, 1280, v34
v_and_b32 v35, 15, v1
v_lshl_add_u32 v34, v35, 4, v34
s_mul_i32 s44, s3, 8704
s_add_u32 s44, s44, 104448
v_mov_b32 v35, v34
s_add_u32 m0, s44, 0
s_nop 0
global_load_lds_dwordx4 v35, s[40:41]
v_add_u32 v35, s43, v35
s_add_u32 m0, s44, 1088
s_nop 0
global_load_lds_dwordx4 v35, s[40:41]
v_add_u32 v35, s43, v35
s_add_u32 m0, s44, 2176
s_nop 0
global_load_lds_dwordx4 v35, s[40:41]
v_add_u32 v35, s43, v35
s_add_u32 m0, s44, 3264
s_nop 0
global_load_lds_dwordx4 v35, s[40:41]
v_add_u32 v35, s43, v35
s_add_u32 m0, s44, 4352
s_nop 0
global_load_lds_dwordx4 v35, s[40:41]
v_add_u32 v35, s43, v35
s_add_u32 m0, s44, 5440
s_nop 0
global_load_lds_dwordx4 v35, s[40:41]
v_add_u32 v35, s43, v35
s_add_u32 m0, s44, 6528
s_nop 0
global_load_lds_dwordx4 v35, s[40:41]
v_add_u32 v35, s43, v35
s_add_u32 m0, s44, 7616
s_nop 0
global_load_lds_dwordx4 v35, s[40:41]
s_waitcnt vmcnt(24)
s_barrier
v_add_u32 v33, 0, v11
ds_read_b64_tr_b16 a[64:65], v33 offset:0
ds_read_b64_tr_b16 a[66:67], v33 offset:1088
ds_read_b64_tr_b16 a[68:69], v33 offset:8704
ds_read_b64_tr_b16 a[70:71], v33 offset:9792
ds_read_b64_tr_b16 a[144:145], v33 offset:32
ds_read_b64_tr_b16 a[146:147], v33 offset:1120
ds_read_b64_tr_b16 a[148:149], v33 offset:8736
ds_read_b64_tr_b16 a[150:151], v33 offset:9824
ds_read_b64_tr_b16 a[72:73], v33 offset:17408
ds_read_b64_tr_b16 a[74:75], v33 offset:18496
ds_read_b64_tr_b16 a[76:77], v33 offset:26112
ds_read_b64_tr_b16 a[78:79], v33 offset:27200
ds_read_b64_tr_b16 a[152:153], v33 offset:17440
ds_read_b64_tr_b16 a[154:155], v33 offset:18528
ds_read_b64_tr_b16 a[156:157], v33 offset:26144
ds_read_b64_tr_b16 a[158:159], v33 offset:27232
s_waitcnt lgkmcnt(0)
s_barrier
s_add_u32 s40, s10, 768
s_addc_u32 s41, s11, 0
s_mov_b32 s43, 5120
v_lshrrev_b32 v34, 4, v1
v_mul_u32_u24 v34, 1280, v34
v_and_b32 v35, 15, v1
v_lshl_add_u32 v34, v35, 4, v34
s_mul_i32 s44, s3, 8704
s_add_u32 s44, s44, 0
v_mov_b32 v35, v34
s_add_u32 m0, s44, 0
s_nop 0
global_load_lds_dwordx4 v35, s[40:41]
v_add_u32 v35, s43, v35
s_add_u32 m0, s44, 1088
s_nop 0
global_load_lds_dwordx4 v35, s[40:41]
v_add_u32 v35, s43, v35
s_add_u32 m0, s44, 2176
s_nop 0
global_load_lds_dwordx4 v35, s[40:41]
v_add_u32 v35, s43, v35
s_add_u32 m0, s44, 3264
s_nop 0
global_load_lds_dwordx4 v35, s[40:41]
v_add_u32 v35, s43, v35
s_add_u32 m0, s44, 4352
s_nop 0
global_load_lds_dwordx4 v35, s[40:41]
v_add_u32 v35, s43, v35
s_add_u32 m0, s44, 5440
s_nop 0
global_load_lds_dwordx4 v35, s[40:41]
v_add_u32 v35, s43, v35
s_add_u32 m0, s44, 6528
s_nop 0
global_load_lds_dwordx4 v35, s[40:41]
v_add_u32 v35, s43, v35
s_add_u32 m0, s44, 7616
s_nop 0
global_load_lds_dwordx4 v35, s[40:41]
s_waitcnt vmcnt(24)
s_barrier
v_add_u32 v33, 34816, v11
ds_read_b64_tr_b16 a[160:161], v33 offset:0
ds_read_b64_tr_b16 a[162:163], v33 offset:1088
ds_read_b64_tr_b16 a[164:165], v33 offset:8704
ds_read_b64_tr_b16 a[166:167], v33 offset:9792
ds_read_b64_tr_b16 a[176:177], v33 offset:32
ds_read_b64_tr_b16 a[178:179], v33 offset:1120
ds_read_b64_tr_b16 a[180:181], v33 offset:8736
ds_read_b64_tr_b16 a[182:183], v33 offset:9824
ds_read_b64_tr_b16 a[168:169], v33 offset:17408
ds_read_b64_tr_b16 a[170:171], v33 offset:18496
ds_read_b64_tr_b16 a[172:173], v33 offset:26112
ds_read_b64_tr_b16 a[174:175], v33 offset:27200
ds_read_b64_tr_b16 a[184:185], v33 offset:17440
ds_read_b64_tr_b16 a[186:187], v33 offset:18528
ds_read_b64_tr_b16 a[188:189], v33 offset:26144
ds_read_b64_tr_b16 a[190:191], v33 offset:27232
s_waitcnt lgkmcnt(0)
s_barrier
s_add_u32 s40, s10, 1024
s_addc_u32 s41, s11, 0
s_mov_b32 s43, 5120
v_lshrrev_b32 v34, 4, v1
v_mul_u32_u24 v34, 1280, v34
v_and_b32 v35, 15, v1
v_lshl_add_u32 v34, v35, 4, v34
s_mul_i32 s44, s3, 8704
s_add_u32 s44, s44, 34816
v_mov_b32 v35, v34
s_add_u32 m0, s44, 0
s_nop 0
global_load_lds_dwordx4 v35, s[40:41]
v_add_u32 v35, s43, v35
s_add_u32 m0, s44, 1088
s_nop 0
global_load_lds_dwordx4 v35, s[40:41]
v_add_u32 v35, s43, v35
s_add_u32 m0, s44, 2176
s_nop 0
global_load_lds_dwordx4 v35, s[40:41]
v_add_u32 v35, s43, v35
s_add_u32 m0, s44, 3264
s_nop 0
global_load_lds_dwordx4 v35, s[40:41]
v_add_u32 v35, s43, v35
s_add_u32 m0, s44, 4352
s_nop 0
global_load_lds_dwordx4 v35, s[40:41]
v_add_u32 v35, s43, v35
s_add_u32 m0, s44, 5440
s_nop 0
global_load_lds_dwordx4 v35, s[40:41]
v_add_u32 v35, s43, v35
s_add_u32 m0, s44, 6528
s_nop 0
global_load_lds_dwordx4 v35, s[40:41]
v_add_u32 v35, s43, v35
s_add_u32 m0, s44, 7616
s_nop 0
global_load_lds_dwordx4 v35, s[40:41]
s_waitcnt vmcnt(24)
s_barrier
v_add_u32 v33, 69632, v11
ds_read_b64_tr_b16 a[192:193], v33 offset:0
ds_read_b64_tr_b16 a[194:195], v33 offset:1088
ds_read_b64_tr_b16 a[196:197], v33 offset:8704
ds_read_b64_tr_b16 a[198:199], v33 offset:9792
ds_read_b64_tr_b16 a[208:209], v33 offset:32
ds_read_b64_tr_b16 a[210:211], v33 offset:1120
ds_read_b64_tr_b16 a[212:213], v33 offset:8736
ds_read_b64_tr_b16 a[214:215], v33 offset:9824
ds_read_b64_tr_b16 a[200:201], v33 offset:17408
ds_read_b64_tr_b16 a[202:203], v33 offset:18496
ds_read_b64_tr_b16 a[204:205], v33 offset:26112
ds_read_b64_tr_b16 a[206:207], v33 offset:27200
ds_read_b64_tr_b16 a[216:217], v33 offset:17440
ds_read_b64_tr_b16 a[218:219], v33 offset:18528
ds_read_b64_tr_b16 a[220:221], v33 offset:26144
ds_read_b64_tr_b16 a[222:223], v33 offset:27232
s_waitcnt lgkmcnt(0)
s_barrier
s_waitcnt vmcnt(16)
s_barrier
v_add_u32 v33, 104448, v11
ds_read_b64_tr_b16 a[224:225], v33 offset:0
ds_read_b64_tr_b16 a[226:227], v33 offset:1088
ds_read_b64_tr_b16 a[228:229], v33 offset:8704
ds_read_b64_tr_b16 a[230:231], v33 offset:9792
ds_read_b64_tr_b16 a[240:241], v33 offset:32
ds_read_b64_tr_b16 a[242:243], v33 offset:1120
ds_read_b64_tr_b16 a[244:245], v33 offset:8736
ds_read_b64_tr_b16 a[246:247], v33 offset:9824
ds_read_b64_tr_b16 a[232:233], v33 offset:17408
ds_read_b64_tr_b16 a[234:235], v33 offset:18496
ds_read_b64_tr_b16 a[236:237], v33 offset:26112
ds_read_b64_tr_b16 a[238:239], v33 offset:27200
ds_read_b64_tr_b16 a[248:249], v33 offset:17440
ds_read_b64_tr_b16 a[250:251], v33 offset:18528
ds_read_b64_tr_b16 a[252:253], v33 offset:26144
ds_read_b64_tr_b16 a[254:255], v33 offset:27232
s_waitcnt lgkmcnt(0)
s_barrier
s_waitcnt vmcnt(8)
s_barrier
v_add_u32 v33, 0, v11
ds_read_b64_tr_b16 v[192:193], v33 offset:0
ds_read_b64_tr_b16 v[194:195], v33 offset:1088
ds_read_b64_tr_b16 v[196:197], v33 offset:8704
ds_read_b64_tr_b16 v[198:199], v33 offset:9792
ds_read_b64_tr_b16 v[208:209], v33 offset:32
ds_read_b64_tr_b16 v[210:211], v33 offset:1120
ds_read_b64_tr_b16 v[212:213], v33 offset:8736
ds_read_b64_tr_b16 v[214:215], v33 offset:9824
ds_read_b64_tr_b16 v[200:201], v33 offset:17408
ds_read_b64_tr_b16 v[202:203], v33 offset:18496
ds_read_b64_tr_b16 v[204:205], v33 offset:26112
ds_read_b64_tr_b16 v[206:207], v33 offset:27200
ds_read_b64_tr_b16 v[216:217], v33 offset:17440
ds_read_b64_tr_b16 v[218:219], v33 offset:18528
ds_read_b64_tr_b16 v[220:221], v33 offset:26144
ds_read_b64_tr_b16 v[222:223], v33 offset:27232
s_waitcnt lgkmcnt(0)
s_barrier
s_waitcnt vmcnt(0)
s_barrier
v_add_u32 v33, 34816, v11
ds_read_b64_tr_b16 v[224:225], v33 offset:0
ds_read_b64_tr_b16 v[226:227], v33 offset:1088
ds_read_b64_tr_b16 v[228:229], v33 offset:8704
ds_read_b64_tr_b16 v[230:231], v33 offset:9792
ds_read_b64_tr_b16 v[240:241], v33 offset:32
ds_read_b64_tr_b16 v[242:243], v33 offset:1120
ds_read_b64_tr_b16 v[244:245], v33 offset:8736
ds_read_b64_tr_b16 v[246:247], v33 offset:9824
ds_read_b64_tr_b16 v[232:233], v33 offset:17408
ds_read_b64_tr_b16 v[234:235], v33 offset:18496
ds_read_b64_tr_b16 v[236:237], v33 offset:26112
ds_read_b64_tr_b16 v[238:239], v33 offset:27200
ds_read_b64_tr_b16 v[248:249], v33 offset:17440
ds_read_b64_tr_b16 v[250:251], v33 offset:18528
ds_read_b64_tr_b16 v[252:253], v33 offset:26144
ds_read_b64_tr_b16 v[254:255], v33 offset:27232
s_waitcnt lgkmcnt(0)
s_barrier
v_mov_b32 v30, 64
sc_36:
global_load_dword v31, v30, s[6:7] sc1
s_waitcnt vmcnt(0)
v_readfirstlane_b32 s40, v31
s_cmp_ge_u32 s40, 256
s_nop 2
s_cbranch_scc1 scg_38
s_sleep 4
s_add_u32 s100, s100, 64
s_cmp_lt_u32 s100, 0x1000000
s_cbranch_scc1 sc_36
s_endpgm
scg_38:
s_cmp_lg_u32 s101, 0
s_cbranch_scc1 sco_37
v_and_b32 v30, 7, v1
v_lshlrev_b32 v30, 2, v30
global_load_dword v31, v30, s[6:7] sc1
s_waitcnt vmcnt(0)
v_cmp_ne_u32 vcc, 32, v31
s_nop 3
s_cbranch_vccz sco_37
s_mov_b32 s101, 1
s_lshr_b32 s12, s2, 5
s_and_b32 s17, s2, 31
s_barrier
s_branch L_dispatch
sco_37:
s_load_dwordx2 s[18:19], s[0:1], 72
v_lshrrev_b32 v30, 3, v1
s_lshl_b32 s40, s3, 3
v_add_u32 v30, s40, v30
v_bfe_u32 v31, v30, 1, 3
v_and_b32 v32, 7, v1
v_xor_b32 v31, v31, v32
v_mul_u32_u24 v30, 1280, v30
v_lshl_add_u32 v2, v31, 4, v30
v_and_b32 v30, 15, v1
v_lshrrev_b32 v31, 4, v1
v_bfe_u32 v32, v30, 2, 1
v_lshlrev_b32 v32, 4, v32
v_lshrrev_b32 v33, 3, v30
v_lshl_add_u32 v32, v33, 3, v32
v_bfe_u32 v33, v30, 1, 1
v_lshl_add_u32 v32, v33, 2, v32
v_and_b32 v33, 1, v30
v_add_u32 v32, v32, v33
v_add_u32 v33, 0, v32
v_bfe_u32 v34, v33, 1, 3
v_add_u32 v35, 0, v31
v_xor_b32 v34, v34, v35
v_lshlrev_b32 v34, 4, v34
v_lshl_add_u32 v4, v33, 7, v34
v_add_u32 v12, 40960, v4
v_add_u32 v33, 0, v32
v_bfe_u32 v34, v33, 1, 3
v_add_u32 v35, 4, v31
v_xor_b32 v34, v34, v35
v_lshlrev_b32 v34, 4, v34
v_lshl_add_u32 v5, v33, 7, v34
v_add_u32 v13, 40960, v5
v_add_u32 v33, 2, v32
v_bfe_u32 v34, v33, 1, 3
v_add_u32 v35, 0, v31
v_xor_b32 v34, v34, v35
v_lshlrev_b32 v34, 4, v34
v_lshl_add_u32 v6, v33, 7, v34
v_add_u32 v14, 40960, v6
v_add_u32 v33, 2, v32
v_bfe_u32 v34, v33, 1, 3
v_add_u32 v35, 4, v31
v_xor_b32 v34, v34, v35
v_lshlrev_b32 v34, 4, v34
v_lshl_add_u32 v7, v33, 7, v34
v_add_u32 v15, 40960, v7
v_lshrrev_b32 v32, 1, v31
v_lshl_add_u32 v32, v32, 4, v30
v_lshlrev_b32 v32, 4, v32
v_and_b32 v33, 1, v31
v_lshl_add_u32 v32, v33, 3, v32
s_lshl_b32 s40, s3, 11
s_add_u32 s40, s40, 81920
v_add_u32 v8, s40, v32
v_lshlrev_b32 v32, 4, v1
v_add_u32 v9, 81920, v32
s_mul_i32 s40, s15, 786432
s_mul_i32 s41, s3, 98304
s_add_u32 s40, s40, s41
s_mul_i32 s41, s14, 3072
s_add_u32 s40, s40, s41
v_add_u32 v10, s40, v32
s_lshl_b32 s21, s3, 10
s_waitcnt lgkmcnt(0)
s_mov_b32 s30, s17
s_mul_i32 s44, s30, 40960
s_add_u32 s46, s18, s44
s_addc_u32 s47, s19, 0
s_add_u32 s45, s21, 0
s_add_u32 m0, s45, 0
s_nop 0
global_load_lds_dwordx4 v2, s[46:47] offset:0
s_add_u32 m0, s45, 3968
s_nop 0
global_load_lds_dwordx4 v2, s[46:47] offset:128
s_add_u32 m0, s45, 7936
s_nop 0
global_load_lds_dwordx4 v2, s[46:47] offset:256
s_add_u32 m0, s45, 11904
s_nop 0
global_load_lds_dwordx4 v2, s[46:47] offset:384
s_add_u32 m0, s45, 15872
s_nop 0
global_load_lds_dwordx4 v2, s[46:47] offset:512
s_add_u32 m0, s45, 19840
s_nop 0
global_load_lds_dwordx4 v2, s[46:47] offset:640
s_add_u32 m0, s45, 23808
s_nop 0
global_load_lds_dwordx4 v2, s[46:47] offset:768
s_add_u32 m0, s45, 27776
s_nop 0
global_load_lds_dwordx4 v2, s[46:47] offset:896
s_add_u32 m0, s45, 31744
s_nop 0
global_load_lds_dwordx4 v2, s[46:47] offset:1024
s_add_u32 m0, s45, 35712
s_nop 0
global_load_lds_dwordx4 v2, s[46:47] offset:1152
s_waitcnt vmcnt(0)
s_barrier
VUl_39:
s_add_u32 s32, s30, 2
s_min_u32 s32, s32, 63
ds_read_b128 v[52:55], v4 offset:0
ds_read_b128 v[56:59], v6 offset:0
ds_read_b128 v[60:63], v5 offset:0
ds_read_b128 v[64:67], v7 offset:0
s_waitcnt lgkmcnt(2)
v_mfma_f32_16x16x32_bf16 v[36:39], a[0:3], v[52:55], 0
v_mfma_f32_16x16x32_bf16 v[40:43], a[0:3], v[56:59], 0
s_mul_i32 s44, s32, 40960
s_add_u32 s46, s18, s44
v_mfma_f32_16x16x32_bf16 v[44:47], a[80:83], v[52:55], 0
v_mfma_f32_16x16x32_bf16 v[48:51], a[80:83], v[56:59], 0
s_addc_u32 s47, s19, 0
s_add_u32 s45, s21, 40960
ds_read_b128 v[52:55], v4 offset:4096
ds_read_b128 v[56:59], v6 offset:4096
s_waitcnt lgkmcnt(2)
v_mfma_f32_16x16x32_bf16 v[36:39], a[4:7], v[60:63], v[36:39]
v_mfma_f32_16x16x32_bf16 v[40:43], a[4:7], v[64:67], v[40:43]
s_add_u32 m0, s45, 0
s_nop 0
global_load_lds_dwordx4 v2, s[46:47] offset:0
v_mfma_f32_16x16x32_bf16 v[44:47], a[84:87], v[60:63], v[44:47]
v_mfma_f32_16x16x32_bf16 v[48:51], a[84:87], v[64:67], v[48:51]
s_add_u32 m0, s45, 3968
s_nop 0
global_load_lds_dwordx4 v2, s[46:47] offset:128
ds_read_b128 v[60:63], v5 offset:4096
ds_read_b128 v[64:67], v7 offset:4096
s_waitcnt lgkmcnt(2)
v_mfma_f32_16x16x32_bf16 v[36:39], a[8:11], v[52:55], v[36:39]
v_mfma_f32_16x16x32_bf16 v[40:43], a[8:11], v[56:59], v[40:43]
s_add_u32 m0, s45, 7936
s_nop 0
global_load_lds_dwordx4 v2, s[46:47] offset:256
v_mfma_f32_16x16x32_bf16 v[44:47], a[88:91], v[52:55], v[44:47]
v_mfma_f32_16x16x32_bf16 v[48:51], a[88:91], v[56:59], v[48:51]
s_add_u32 m0, s45, 11904
s_nop 0
global_load_lds_dwordx4 v2, s[46:47] offset:384
ds_read_b128 v[52:55], v4 offset:8192
ds_read_b128 v[56:59], v6 offset:8192
s_waitcnt lgkmcnt(2)
v_mfma_f32_16x16x32_bf16 v[36:39], a[12:15], v[60:63], v[36:39]
v_mfma_f32_16x16x32_bf16 v[40:43], a[12:15], v[64:67], v[40:43]
s_add_u32 m0, s45, 15872
s_nop 0
global_load_lds_dwordx4 v2, s[46:47] offset:512
v_mfma_f32_16x16x32_bf16 v[44:47], a[92:95], v[60:63], v[44:47]
v_mfma_f32_16x16x32_bf16 v[48:51], a[92:95], v[64:67], v[48:51]
s_add_u32 m0, s45, 19840
s_nop 0
global_load_lds_dwordx4 v2, s[46:47] offset:640
ds_read_b128 v[60:63], v5 offset:8192
ds_read_b128 v[64:67], v7 offset:8192
s_waitcnt lgkmcnt(2)
v_mfma_f32_16x16x32_bf16 v[36:39], a[16:19], v[52:55], v[36:39]
v_mfma_f32_16x16x32_bf16 v[40:43], a[16:19], v[56:59], v[40:43]
s_add_u32 m0, s45, 23808
s_nop 0
global_load_lds_dwordx4 v2, s[46:47] offset:768
v_mfma_f32_16x16x32_bf16 v[44:47], a[96:99], v[52:55], v[44:47]
v_mfma_f32_16x16x32_bf16 v[48:51], a[96:99], v[56:59], v[48:51]
s_add_u32 m0, s45, 27776
s_nop 0
global_load_lds_dwordx4 v2, s[46:47] offset:896
ds_read_b128 v[52:55], v4 offset:12288
ds_read_b128 v[56:59], v6 offset:12288
s_waitcnt lgkmcnt(2)
v_mfma_f32_16x16x32_bf16 v[36:39], a[20:23], v[60:63], v[36:39]
v_mfma_f32_16x16x32_bf16 v[40:43], a[20:23], v[64:67], v[40:43]
s_add_u32 m0, s45, 31744
s_nop 0
global_load_lds_dwordx4 v2, s[46:47] offset:1024
v_mfma_f32_16x16x32_bf16 v[44:47], a[100:103], v[60:63], v[44:47]
v_mfma_f32_16x16x32_bf16 v[48:51], a[100:103], v[64:67], v[48:51]
s_add_u32 m0, s45, 35712
s_nop 0
global_load_lds_dwordx4 v2, s[46:47] offset:1152
ds_read_b128 v[60:63], v5 offset:12288
ds_read_b128 v[64:67], v7 offset:12288
s_waitcnt lgkmcnt(2)
v_mfma_f32_16x16x32_bf16 v[36:39], a[24:27], v[52:55], v[36:39]
v_mfma_f32_16x16x32_bf16 v[40:43], a[24:27], v[56:59], v[40:43]
v_mfma_f32_16x16x32_bf16 v[44:47], a[104:107], v[52:55], v[44:47]
v_mfma_f32_16x16x32_bf16 v[48:51], a[104:107], v[56:59], v[48:51]
ds_read_b128 v[52:55], v4 offset:16384
ds_read_b128 v[56:59], v6 offset:16384
s_waitcnt lgkmcnt(2)
v_mfma_f32_16x16x32_bf16 v[36:39], a[28:31], v[60:63], v[36:39]
v_mfma_f32_16x16x32_bf16 v[40:43], a[28:31], v[64:67], v[40:43]
v_mfma_f32_16x16x32_bf16 v[44:47], a[108:111], v[60:63], v[44:47]
v_mfma_f32_16x16x32_bf16 v[48:51], a[108:111], v[64:67], v[48:51]
ds_read_b128 v[60:63], v5 offset:16384
ds_read_b128 v[64:67], v7 offset:16384
s_waitcnt lgkmcnt(2)
v_mfma_f32_16x16x32_bf16 v[36:39], a[32:35], v[52:55], v[36:39]
v_mfma_f32_16x16x32_bf16 v[40:43], a[32:35], v[56:59], v[40:43]
v_mfma_f32_16x16x32_bf16 v[44:47], a[112:115], v[52:55], v[44:47]
v_mfma_f32_16x16x32_bf16 v[48:51], a[112:115], v[56:59], v[48:51]
ds_read_b128 v[52:55], v4 offset:20480
ds_read_b128 v[56:59], v6 offset:20480
s_waitcnt lgkmcnt(2)
v_mfma_f32_16x16x32_bf16 v[36:39], a[36:39], v[60:63], v[36:39]
v_mfma_f32_16x16x32_bf16 v[40:43], a[36:39], v[64:67], v[40:43]
v_mfma_f32_16x16x32_bf16 v[44:47], a[116:119], v[60:63], v[44:47]
v_mfma_f32_16x16x32_bf16 v[48:51], a[116:119], v[64:67], v[48:51]
ds_read_b128 v[60:63], v5 offset:20480
ds_read_b128 v[64:67], v7 offset:20480
s_waitcnt lgkmcnt(2)
v_mfma_f32_16x16x32_bf16 v[36:39], a[40:43], v[52:55], v[36:39]
v_mfma_f32_16x16x32_bf16 v[40:43], a[40:43], v[56:59], v[40:43]
v_mfma_f32_16x16x32_bf16 v[44:47], a[120:123], v[52:55], v[44:47]
v_mfma_f32_16x16x32_bf16 v[48:51], a[120:123], v[56:59], v[48:51]
ds_read_b128 v[52:55], v4 offset:24576
ds_read_b128 v[56:59], v6 offset:24576
s_waitcnt lgkmcnt(2)
v_mfma_f32_16x16x32_bf16 v[36:39], a[44:47], v[60:63], v[36:39]
v_mfma_f32_16x16x32_bf16 v[40:43], a[44:47], v[64:67], v[40:43]
v_mfma_f32_16x16x32_bf16 v[44:47], a[124:127], v[60:63], v[44:47]
v_mfma_f32_16x16x32_bf16 v[48:51], a[124:127], v[64:67], v[48:51]
ds_read_b128 v[60:63], v5 offset:24576
ds_read_b128 v[64:67], v7 offset:24576
s_waitcnt lgkmcnt(2)
v_mfma_f32_16x16x32_bf16 v[36:39], a[48:51], v[52:55], v[36:39]
v_mfma_f32_16x16x32_bf16 v[40:43], a[48:51], v[56:59], v[40:43]
v_mfma_f32_16x16x32_bf16 v[44:47], a[128:131], v[52:55], v[44:47]
v_mfma_f32_16x16x32_bf16 v[48:51], a[128:131], v[56:59], v[48:51]
ds_read_b128 v[52:55], v4 offset:28672
ds_read_b128 v[56:59], v6 offset:28672
s_waitcnt lgkmcnt(2)
v_mfma_f32_16x16x32_bf16 v[36:39], a[52:55], v[60:63], v[36:39]
v_mfma_f32_16x16x32_bf16 v[40:43], a[52:55], v[64:67], v[40:43]
v_mfma_f32_16x16x32_bf16 v[44:47], a[132:135], v[60:63], v[44:47]
v_mfma_f32_16x16x32_bf16 v[48:51], a[132:135], v[64:67], v[48:51]
ds_read_b128 v[60:63], v5 offset:28672
ds_read_b128 v[64:67], v7 offset:28672
s_waitcnt lgkmcnt(2)
v_mfma_f32_16x16x32_bf16 v[36:39], a[56:59], v[52:55], v[36:39]
v_mfma_f32_16x16x32_bf16 v[40:43], a[56:59], v[56:59], v[40:43]
v_mfma_f32_16x16x32_bf16 v[44:47], a[136:139], v[52:55], v[44:47]
v_mfma_f32_16x16x32_bf16 v[48:51], a[136:139], v[56:59], v[48:51]
ds_read_b128 v[52:55], v4 offset:32768
ds_read_b128 v[56:59], v6 offset:32768
s_waitcnt lgkmcnt(2)
v_mfma_f32_16x16x32_bf16 v[36:39], a[60:63], v[60:63], v[36:39]
v_mfma_f32_16x16x32_bf16 v[40:43], a[60:63], v[64:67], v[40:43]
v_mfma_f32_16x16x32_bf16 v[44:47], a[140:143], v[60:63], v[44:47]
v_mfma_f32_16x16x32_bf16 v[48:51], a[140:143], v[64:67], v[48:51]
ds_read_b128 v[60:63], v5 offset:32768
ds_read_b128 v[64:67], v7 offset:32768
s_waitcnt lgkmcnt(2)
v_mfma_f32_16x16x32_bf16 v[36:39], a[64:67], v[52:55], v[36:39]
v_mfma_f32_16x16x32_bf16 v[40:43], a[64:67], v[56:59], v[40:43]
v_mfma_f32_16x16x32_bf16 v[44:47], a[144:147], v[52:55], v[44:47]
v_mfma_f32_16x16x32_bf16 v[48:51], a[144:147], v[56:59], v[48:51]
ds_read_b128 v[52:55], v4 offset:36864
ds_read_b128 v[56:59], v6 offset:36864
s_waitcnt lgkmcnt(2)
v_mfma_f32_16x16x32_bf16 v[36:39], a[68:71], v[60:63], v[36:39]
v_mfma_f32_16x16x32_bf16 v[40:43], a[68:71], v[64:67], v[40:43]
v_mfma_f32_16x16x32_bf16 v[44:47], a[148:151], v[60:63], v[44:47]
v_mfma_f32_16x16x32_bf16 v[48:51], a[148:151], v[64:67], v[48:51]
ds_read_b128 v[60:63], v5 offset:36864
ds_read_b128 v[64:67], v7 offset:36864
s_waitcnt lgkmcnt(2)
v_mfma_f32_16x16x32_bf16 v[36:39], a[72:75], v[52:55], v[36:39]
v_mfma_f32_16x16x32_bf16 v[40:43], a[72:75], v[56:59], v[40:43]
v_mfma_f32_16x16x32_bf16 v[44:47], a[152:155], v[52:55], v[44:47]
v_mfma_f32_16x16x32_bf16 v[48:51], a[152:155], v[56:59], v[48:51]
s_waitcnt lgkmcnt(0)
v_mfma_f32_16x16x32_bf16 v[36:39], a[76:79], v[60:63], v[36:39]
v_mfma_f32_16x16x32_bf16 v[40:43], a[76:79], v[64:67], v[40:43]
v_mfma_f32_16x16x32_bf16 v[44:47], a[156:159], v[60:63], v[44:47]
v_mfma_f32_16x16x32_bf16 v[48:51], a[156:159], v[64:67], v[48:51]
s_nop 4
v_cvt_pk_bf16_f32 v30, v36, v37
v_cvt_pk_bf16_f32 v31, v38, v39
ds_write_b64 v8, v[30:31] offset:0
v_cvt_pk_bf16_f32 v30, v40, v41
v_cvt_pk_bf16_f32 v31, v42, v43
ds_write_b64 v8, v[30:31] offset:1024
v_cvt_pk_bf16_f32 v30, v44, v45
v_cvt_pk_bf16_f32 v31, v46, v47
ds_write_b64 v8, v[30:31] offset:512
v_cvt_pk_bf16_f32 v30, v48, v49
v_cvt_pk_bf16_f32 v31, v50, v51
ds_write_b64 v8, v[30:31] offset:1536
s_waitcnt lgkmcnt(0)
s_barrier
ds_read_b128 v[68:71], v9 offset:0
ds_read_b128 v[72:75], v9 offset:1024
ds_read_b128 v[76:79], v9 offset:2048
ds_read_b128 v[80:83], v9 offset:3072
ds_read_b128 v[84:87], v9 offset:4096
ds_read_b128 v[88:91], v9 offset:5120
ds_read_b128 v[92:95], v9 offset:6144
ds_read_b128 v[96:99], v9 offset:7168
s_mul_i32 s44, s30, 1572864
s_add_u32 s50, s4, s44
s_addc_u32 s51, s5, 0
s_add_u32 s50, s50, 75497472
s_addc_u32 s51, s51, 0
s_waitcnt lgkmcnt(0)
v_mfma_f32_16x16x32_bf16 v[100:103], v[68:71], a[160:163], 0
v_mfma_f32_16x16x32_bf16 v[104:107], v[72:75], a[160:163], 0
v_mfma_f32_16x16x32_bf16 v[100:103], v[76:79], a[164:167], v[100:103]
v_mfma_f32_16x16x32_bf16 v[104:107], v[80:83], a[164:167], v[104:107]
v_mfma_f32_16x16x32_bf16 v[100:103], v[84:87], a[168:171], v[100:103]
v_mfma_f32_16x16x32_bf16 v[104:107], v[88:91], a[168:171], v[104:107]
v_mfma_f32_16x16x32_bf16 v[100:103], v[92:95], a[172:175], v[100:103]
v_mfma_f32_16x16x32_bf16 v[104:107], v[96:99], a[172:175], v[104:107]
v_mfma_f32_16x16x32_bf16 v[108:111], v[68:71], a[176:179], 0
v_mfma_f32_16x16x32_bf16 v[112:115], v[72:75], a[176:179], 0
v_mfma_f32_16x16x32_bf16 v[108:111], v[76:79], a[180:183], v[108:111]
v_mfma_f32_16x16x32_bf16 v[112:115], v[80:83], a[180:183], v[112:115]
s_nop 2
v_cvt_pk_bf16_f32 v116, v100, v101
v_cvt_pk_bf16_f32 v117, v102, v103
v_cvt_pk_bf16_f32 v118, v104, v105
v_cvt_pk_bf16_f32 v119, v106, v107
s_add_u32 s52, s50, 0
s_addc_u32 s53, s51, 0
global_store_dwordx4 v10, v[116:119], s[52:53] sc1
v_mfma_f32_16x16x32_bf16 v[108:111], v[84:87], a[184:187], v[108:111]
v_mfma_f32_16x16x32_bf16 v[112:115], v[88:91], a[184:187], v[112:115]
v_mfma_f32_16x16x32_bf16 v[108:111], v[92:95], a[188:191], v[108:111]
v_mfma_f32_16x16x32_bf16 v[112:115], v[96:99], a[188:191], v[112:115]
v_mfma_f32_16x16x32_bf16 v[100:103], v[68:71], a[192:195], 0
v_mfma_f32_16x16x32_bf16 v[104:107], v[72:75], a[192:195], 0
v_mfma_f32_16x16x32_bf16 v[100:103], v[76:79], a[196:199], v[100:103]
v_mfma_f32_16x16x32_bf16 v[104:107], v[80:83], a[196:199], v[104:107]
s_nop 2
v_cvt_pk_bf16_f32 v120, v108, v109
v_cvt_pk_bf16_f32 v121, v110, v111
v_cvt_pk_bf16_f32 v122, v112, v113
v_cvt_pk_bf16_f32 v123, v114, v115
s_add_u32 s52, s50, 49152
s_addc_u32 s53, s51, 0
global_store_dwordx4 v10, v[120:123], s[52:53] sc1
v_mfma_f32_16x16x32_bf16 v[100:103], v[84:87], a[200:203], v[100:103]
v_mfma_f32_16x16x32_bf16 v[104:107], v[88:91], a[200:203], v[104:107]
v_mfma_f32_16x16x32_bf16 v[100:103], v[92:95], a[204:207], v[100:103]
v_mfma_f32_16x16x32_bf16 v[104:107], v[96:99], a[204:207], v[104:107]
v_mfma_f32_16x16x32_bf16 v[108:111], v[68:71], a[208:211], 0
v_mfma_f32_16x16x32_bf16 v[112:115], v[72:75], a[208:211], 0
v_mfma_f32_16x16x32_bf16 v[108:111], v[76:79], a[212:215], v[108:111]
v_mfma_f32_16x16x32_bf16 v[112:115], v[80:83], a[212:215], v[112:115]
s_nop 2
v_cvt_pk_bf16_f32 v116, v100, v101
v_cvt_pk_bf16_f32 v117, v102, v103
v_cvt_pk_bf16_f32 v118, v104, v105
v_cvt_pk_bf16_f32 v119, v106, v107
s_add_u32 s52, s50, 393216
s_addc_u32 s53, s51, 0
global_store_dwordx4 v10, v[116:119], s[52:53] sc1
v_mfma_f32_16x16x32_bf16 v[108:111], v[84:87], a[216:219], v[108:111]
v_mfma_f32_16x16x32_bf16 v[112:115], v[88:91], a[216:219], v[112:115]
v_mfma_f32_16x16x32_bf16 v[108:111], v[92:95], a[220:223], v[108:111]
v_mfma_f32_16x16x32_bf16 v[112:115], v[96:99], a[220:223], v[112:115]
v_mfma_f32_16x16x32_bf16 v[100:103], v[68:71], a[224:227], 0
v_mfma_f32_16x16x32_bf16 v[104:107], v[72:75], a[224:227], 0
v_mfma_f32_16x16x32_bf16 v[100:103], v[76:79], a[228:231], v[100:103]
v_mfma_f32_16x16x32_bf16 v[104:107], v[80:83], a[228:231], v[104:107]
s_nop 2
v_cvt_pk_bf16_f32 v120, v108, v109
v_cvt_pk_bf16_f32 v121, v110, v111
v_cvt_pk_bf16_f32 v122, v112, v113
v_cvt_pk_bf16_f32 v123, v114, v115
s_add_u32 s52, s50, 442368
s_addc_u32 s53, s51, 0
global_store_dwordx4 v10, v[120:123], s[52:53] sc1
v_mfma_f32_16x16x32_bf16 v[100:103], v[84:87], a[232:235], v[100:103]
v_mfma_f32_16x16x32_bf16 v[104:107], v[88:91], a[232:235], v[104:107]
v_mfma_f32_16x16x32_bf16 v[100:103], v[92:95], a[236:239], v[100:103]
v_mfma_f32_16x16x32_bf16 v[104:107], v[96:99], a[236:239], v[104:107]
v_mfma_f32_16x16x32_bf16 v[108:111], v[68:71], a[240:243], 0
v_mfma_f32_16x16x32_bf16 v[112:115], v[72:75], a[240:243], 0
v_mfma_f32_16x16x32_bf16 v[108:111], v[76:79], a[244:247], v[108:111]
v_mfma_f32_16x16x32_bf16 v[112:115], v[80:83], a[244:247], v[112:115]
s_nop 2
v_cvt_pk_bf16_f32 v116, v100, v101
v_cvt_pk_bf16_f32 v117, v102, v103
v_cvt_pk_bf16_f32 v118, v104, v105
v_cvt_pk_bf16_f32 v119, v106, v107
s_add_u32 s52, s50, 1024
s_addc_u32 s53, s51, 0
global_store_dwordx4 v10, v[116:119], s[52:53] sc1
v_mfma_f32_16x16x32_bf16 v[108:111], v[84:87], a[248:251], v[108:111]
v_mfma_f32_16x16x32_bf16 v[112:115], v[88:91], a[248:251], v[112:115]
v_mfma_f32_16x16x32_bf16 v[108:111], v[92:95], a[252:255], v[108:111]
v_mfma_f32_16x16x32_bf16 v[112:115], v[96:99], a[252:255], v[112:115]
v_mfma_f32_16x16x32_bf16 v[100:103], v[68:71], v[192:195], 0
v_mfma_f32_16x16x32_bf16 v[104:107], v[72:75], v[192:195], 0
v_mfma_f32_16x16x32_bf16 v[100:103], v[76:79], v[196:199], v[100:103]
v_mfma_f32_16x16x32_bf16 v[104:107], v[80:83], v[196:199], v[104:107]
s_nop 2
v_cvt_pk_bf16_f32 v120, v108, v109
v_cvt_pk_bf16_f32 v121, v110, v111
v_cvt_pk_bf16_f32 v122, v112, v113
v_cvt_pk_bf16_f32 v123, v114, v115
s_add_u32 s52, s50, 50176
s_addc_u32 s53, s51, 0
global_store_dwordx4 v10, v[120:123], s[52:53] sc1
v_mfma_f32_16x16x32_bf16 v[100:103], v[84:87], v[200:203], v[100:103]
v_mfma_f32_16x16x32_bf16 v[104:107], v[88:91], v[200:203], v[104:107]
v_mfma_f32_16x16x32_bf16 v[100:103], v[92:95], v[204:207], v[100:103]
v_mfma_f32_16x16x32_bf16 v[104:107], v[96:99], v[204:207], v[104:107]
v_mfma_f32_16x16x32_bf16 v[108:111], v[68:71], v[208:211], 0
v_mfma_f32_16x16x32_bf16 v[112:115], v[72:75], v[208:211], 0
v_mfma_f32_16x16x32_bf16 v[108:111], v[76:79], v[212:215], v[108:111]
v_mfma_f32_16x16x32_bf16 v[112:115], v[80:83], v[212:215], v[112:115]
s_nop 2
v_cvt_pk_bf16_f32 v116, v100, v101
v_cvt_pk_bf16_f32 v117, v102, v103
v_cvt_pk_bf16_f32 v118, v104, v105
v_cvt_pk_bf16_f32 v119, v106, v107
s_add_u32 s52, s50, 394240
s_addc_u32 s53, s51, 0
global_store_dwordx4 v10, v[116:119], s[52:53] sc1
v_mfma_f32_16x16x32_bf16 v[108:111], v[84:87], v[216:219], v[108:111]
v_mfma_f32_16x16x32_bf16 v[112:115], v[88:91], v[216:219], v[112:115]
v_mfma_f32_16x16x32_bf16 v[108:111], v[92:95], v[220:223], v[108:111]
v_mfma_f32_16x16x32_bf16 v[112:115], v[96:99], v[220:223], v[112:115]
v_mfma_f32_16x16x32_bf16 v[100:103], v[68:71], v[224:227], 0
v_mfma_f32_16x16x32_bf16 v[104:107], v[72:75], v[224:227], 0
v_mfma_f32_16x16x32_bf16 v[100:103], v[76:79], v[228:231], v[100:103]
v_mfma_f32_16x16x32_bf16 v[104:107], v[80:83], v[228:231], v[104:107]
s_nop 2
v_cvt_pk_bf16_f32 v120, v108, v109
v_cvt_pk_bf16_f32 v121, v110, v111
v_cvt_pk_bf16_f32 v122, v112, v113
v_cvt_pk_bf16_f32 v123, v114, v115
s_add_u32 s52, s50, 443392
s_addc_u32 s53, s51, 0
global_store_dwordx4 v10, v[120:123], s[52:53] sc1
v_mfma_f32_16x16x32_bf16 v[100:103], v[84:87], v[232:235], v[100:103]
v_mfma_f32_16x16x32_bf16 v[104:107], v[88:91], v[232:235], v[104:107]
v_mfma_f32_16x16x32_bf16 v[100:103], v[92:95], v[236:239], v[100:103]
v_mfma_f32_16x16x32_bf16 v[104:107], v[96:99], v[236:239], v[104:107]
v_mfma_f32_16x16x32_bf16 v[108:111], v[68:71], v[240:243], 0
v_mfma_f32_16x16x32_bf16 v[112:115], v[72:75], v[240:243], 0
v_mfma_f32_16x16x32_bf16 v[108:111], v[76:79], v[244:247], v[108:111]
v_mfma_f32_16x16x32_bf16 v[112:115], v[80:83], v[244:247], v[112:115]
s_nop 2
v_cvt_pk_bf16_f32 v116, v100, v101
v_cvt_pk_bf16_f32 v117, v102, v103
v_cvt_pk_bf16_f32 v118, v104, v105
v_cvt_pk_bf16_f32 v119, v106, v107
s_add_u32 s52, s50, 2048
s_addc_u32 s53, s51, 0
global_store_dwordx4 v10, v[116:119], s[52:53] sc1
v_mfma_f32_16x16x32_bf16 v[108:111], v[84:87], v[248:251], v[108:111]
v_mfma_f32_16x16x32_bf16 v[112:115], v[88:91], v[248:251], v[112:115]
v_mfma_f32_16x16x32_bf16 v[108:111], v[92:95], v[252:255], v[108:111]
v_mfma_f32_16x16x32_bf16 v[112:115], v[96:99], v[252:255], v[112:115]
s_nop 6
v_cvt_pk_bf16_f32 v120, v108, v109
v_cvt_pk_bf16_f32 v121, v110, v111
v_cvt_pk_bf16_f32 v122, v112, v113
v_cvt_pk_bf16_f32 v123, v114, v115
s_add_u32 s52, s50, 51200
s_addc_u32 s53, s51, 0
global_store_dwordx4 v10, v[120:123], s[52:53] sc1
s_waitcnt vmcnt(0)
s_barrier
s_cmp_lg_u32 s3, 0
s_cbranch_scc1 uf_41
s_lshl_b32 s44, s30, 7
s_lshl_b32 s45, s16, 2
s_add_u32 s44, s44, s45
s_add_u32 s44, s44, 46153728
v_mov_b32 v30, s44
v_mov_b32 v31, 1
global_store_dword v30, v31, s[4:5] sc1
uf_41:
s_add_u32 s30, s30, 2
s_cmp_ge_u32 s30, 64
s_cbranch_scc1 VUe_40
s_add_u32 s32, s30, 2
s_min_u32 s32, s32, 63
ds_read_b128 v[52:55], v12 offset:0
ds_read_b128 v[56:59], v14 offset:0
ds_read_b128 v[60:63], v13 offset:0
ds_read_b128 v[64:67], v15 offset:0
s_waitcnt lgkmcnt(2)
v_mfma_f32_16x16x32_bf16 v[36:39], a[0:3], v[52:55], 0
v_mfma_f32_16x16x32_bf16 v[40:43], a[0:3], v[56:59], 0
s_mul_i32 s44, s32, 40960
s_add_u32 s46, s18, s44
v_mfma_f32_16x16x32_bf16 v[44:47], a[80:83], v[52:55], 0
v_mfma_f32_16x16x32_bf16 v[48:51], a[80:83], v[56:59], 0
s_addc_u32 s47, s19, 0
s_add_u32 s45, s21, 0
ds_read_b128 v[52:55], v12 offset:4096
ds_read_b128 v[56:59], v14 offset:4096
s_waitcnt lgkmcnt(2)
v_mfma_f32_16x16x32_bf16 v[36:39], a[4:7], v[60:63], v[36:39]
v_mfma_f32_16x16x32_bf16 v[40:43], a[4:7], v[64:67], v[40:43]
s_add_u32 m0, s45, 0
s_nop 0
global_load_lds_dwordx4 v2, s[46:47] offset:0
v_mfma_f32_16x16x32_bf16 v[44:47], a[84:87], v[60:63], v[44:47]
v_mfma_f32_16x16x32_bf16 v[48:51], a[84:87], v[64:67], v[48:51]
s_add_u32 m0, s45, 3968
s_nop 0
global_load_lds_dwordx4 v2, s[46:47] offset:128
ds_read_b128 v[60:63], v13 offset:4096
ds_read_b128 v[64:67], v15 offset:4096
s_waitcnt lgkmcnt(2)
v_mfma_f32_16x16x32_bf16 v[36:39], a[8:11], v[52:55], v[36:39]
v_mfma_f32_16x16x32_bf16 v[40:43], a[8:11], v[56:59], v[40:43]
s_add_u32 m0, s45, 7936
s_nop 0
global_load_lds_dwordx4 v2, s[46:47] offset:256
v_mfma_f32_16x16x32_bf16 v[44:47], a[88:91], v[52:55], v[44:47]
v_mfma_f32_16x16x32_bf16 v[48:51], a[88:91], v[56:59], v[48:51]
s_add_u32 m0, s45, 11904
s_nop 0
global_load_lds_dwordx4 v2, s[46:47] offset:384
ds_read_b128 v[52:55], v12 offset:8192
ds_read_b128 v[56:59], v14 offset:8192
s_waitcnt lgkmcnt(2)
v_mfma_f32_16x16x32_bf16 v[36:39], a[12:15], v[60:63], v[36:39]
v_mfma_f32_16x16x32_bf16 v[40:43], a[12:15], v[64:67], v[40:43]
s_add_u32 m0, s45, 15872
s_nop 0
global_load_lds_dwordx4 v2, s[46:47] offset:512
v_mfma_f32_16x16x32_bf16 v[44:47], a[92:95], v[60:63], v[44:47]
v_mfma_f32_16x16x32_bf16 v[48:51], a[92:95], v[64:67], v[48:51]
s_add_u32 m0, s45, 19840
s_nop 0
global_load_lds_dwordx4 v2, s[46:47] offset:640
ds_read_b128 v[60:63], v13 offset:8192
ds_read_b128 v[64:67], v15 offset:8192
s_waitcnt lgkmcnt(2)
v_mfma_f32_16x16x32_bf16 v[36:39], a[16:19], v[52:55], v[36:39]
v_mfma_f32_16x16x32_bf16 v[40:43], a[16:19], v[56:59], v[40:43]
s_add_u32 m0, s45, 23808
s_nop 0
global_load_lds_dwordx4 v2, s[46:47] offset:768
v_mfma_f32_16x16x32_bf16 v[44:47], a[96:99], v[52:55], v[44:47]
v_mfma_f32_16x16x32_bf16 v[48:51], a[96:99], v[56:59], v[48:51]
s_add_u32 m0, s45, 27776
s_nop 0
global_load_lds_dwordx4 v2, s[46:47] offset:896
ds_read_b128 v[52:55], v12 offset:12288
ds_read_b128 v[56:59], v14 offset:12288
s_waitcnt lgkmcnt(2)
v_mfma_f32_16x16x32_bf16 v[36:39], a[20:23], v[60:63], v[36:39]
v_mfma_f32_16x16x32_bf16 v[40:43], a[20:23], v[64:67], v[40:43]
s_add_u32 m0, s45, 31744
s_nop 0
global_load_lds_dwordx4 v2, s[46:47] offset:1024
v_mfma_f32_16x16x32_bf16 v[44:47], a[100:103], v[60:63], v[44:47]
v_mfma_f32_16x16x32_bf16 v[48:51], a[100:103], v[64:67], v[48:51]
s_add_u32 m0, s45, 35712
s_nop 0
global_load_lds_dwordx4 v2, s[46:47] offset:1152
ds_read_b128 v[60:63], v13 offset:12288
ds_read_b128 v[64:67], v15 offset:12288
s_waitcnt lgkmcnt(2)
v_mfma_f32_16x16x32_bf16 v[36:39], a[24:27], v[52:55], v[36:39]
v_mfma_f32_16x16x32_bf16 v[40:43], a[24:27], v[56:59], v[40:43]
v_mfma_f32_16x16x32_bf16 v[44:47], a[104:107], v[52:55], v[44:47]
v_mfma_f32_16x16x32_bf16 v[48:51], a[104:107], v[56:59], v[48:51]
ds_read_b128 v[52:55], v12 offset:16384
ds_read_b128 v[56:59], v14 offset:16384
s_waitcnt lgkmcnt(2)
v_mfma_f32_16x16x32_bf16 v[36:39], a[28:31], v[60:63], v[36:39]
v_mfma_f32_16x16x32_bf16 v[40:43], a[28:31], v[64:67], v[40:43]
v_mfma_f32_16x16x32_bf16 v[44:47], a[108:111], v[60:63], v[44:47]
v_mfma_f32_16x16x32_bf16 v[48:51], a[108:111], v[64:67], v[48:51]
ds_read_b128 v[60:63], v13 offset:16384
ds_read_b128 v[64:67], v15 offset:16384
s_waitcnt lgkmcnt(2)
v_mfma_f32_16x16x32_bf16 v[36:39], a[32:35], v[52:55], v[36:39]
v_mfma_f32_16x16x32_bf16 v[40:43], a[32:35], v[56:59], v[40:43]
v_mfma_f32_16x16x32_bf16 v[44:47], a[112:115], v[52:55], v[44:47]
v_mfma_f32_16x16x32_bf16 v[48:51], a[112:115], v[56:59], v[48:51]
ds_read_b128 v[52:55], v12 offset:20480
ds_read_b128 v[56:59], v14 offset:20480
s_waitcnt lgkmcnt(2)
v_mfma_f32_16x16x32_bf16 v[36:39], a[36:39], v[60:63], v[36:39]
v_mfma_f32_16x16x32_bf16 v[40:43], a[36:39], v[64:67], v[40:43]
v_mfma_f32_16x16x32_bf16 v[44:47], a[116:119], v[60:63], v[44:47]
v_mfma_f32_16x16x32_bf16 v[48:51], a[116:119], v[64:67], v[48:51]
ds_read_b128 v[60:63], v13 offset:20480
ds_read_b128 v[64:67], v15 offset:20480
s_waitcnt lgkmcnt(2)
v_mfma_f32_16x16x32_bf16 v[36:39], a[40:43], v[52:55], v[36:39]
v_mfma_f32_16x16x32_bf16 v[40:43], a[40:43], v[56:59], v[40:43]
v_mfma_f32_16x16x32_bf16 v[44:47], a[120:123], v[52:55], v[44:47]
v_mfma_f32_16x16x32_bf16 v[48:51], a[120:123], v[56:59], v[48:51]
ds_read_b128 v[52:55], v12 offset:24576
ds_read_b128 v[56:59], v14 offset:24576
s_waitcnt lgkmcnt(2)
v_mfma_f32_16x16x32_bf16 v[36:39], a[44:47], v[60:63], v[36:39]
v_mfma_f32_16x16x32_bf16 v[40:43], a[44:47], v[64:67], v[40:43]
v_mfma_f32_16x16x32_bf16 v[44:47], a[124:127], v[60:63], v[44:47]
v_mfma_f32_16x16x32_bf16 v[48:51], a[124:127], v[64:67], v[48:51]
ds_read_b128 v[60:63], v13 offset:24576
ds_read_b128 v[64:67], v15 offset:24576
s_waitcnt lgkmcnt(2)
v_mfma_f32_16x16x32_bf16 v[36:39], a[48:51], v[52:55], v[36:39]
v_mfma_f32_16x16x32_bf16 v[40:43], a[48:51], v[56:59], v[40:43]
v_mfma_f32_16x16x32_bf16 v[44:47], a[128:131], v[52:55], v[44:47]
v_mfma_f32_16x16x32_bf16 v[48:51], a[128:131], v[56:59], v[48:51]
ds_read_b128 v[52:55], v12 offset:28672
ds_read_b128 v[56:59], v14 offset:28672
s_waitcnt lgkmcnt(2)
v_mfma_f32_16x16x32_bf16 v[36:39], a[52:55], v[60:63], v[36:39]
v_mfma_f32_16x16x32_bf16 v[40:43], a[52:55], v[64:67], v[40:43]
v_mfma_f32_16x16x32_bf16 v[44:47], a[132:135], v[60:63], v[44:47]
v_mfma_f32_16x16x32_bf16 v[48:51], a[132:135], v[64:67], v[48:51]
ds_read_b128 v[60:63], v13 offset:28672
ds_read_b128 v[64:67], v15 offset:28672
s_waitcnt lgkmcnt(2)
v_mfma_f32_16x16x32_bf16 v[36:39], a[56:59], v[52:55], v[36:39]
v_mfma_f32_16x16x32_bf16 v[40:43], a[56:59], v[56:59], v[40:43]
v_mfma_f32_16x16x32_bf16 v[44:47], a[136:139], v[52:55], v[44:47]
v_mfma_f32_16x16x32_bf16 v[48:51], a[136:139], v[56:59], v[48:51]
ds_read_b128 v[52:55], v12 offset:32768
ds_read_b128 v[56:59], v14 offset:32768
s_waitcnt lgkmcnt(2)
v_mfma_f32_16x16x32_bf16 v[36:39], a[60:63], v[60:63], v[36:39]
v_mfma_f32_16x16x32_bf16 v[40:43], a[60:63], v[64:67], v[40:43]
v_mfma_f32_16x16x32_bf16 v[44:47], a[140:143], v[60:63], v[44:47]
v_mfma_f32_16x16x32_bf16 v[48:51], a[140:143], v[64:67], v[48:51]
ds_read_b128 v[60:63], v13 offset:32768
ds_read_b128 v[64:67], v15 offset:32768
s_waitcnt lgkmcnt(2)
v_mfma_f32_16x16x32_bf16 v[36:39], a[64:67], v[52:55], v[36:39]
v_mfma_f32_16x16x32_bf16 v[40:43], a[64:67], v[56:59], v[40:43]
v_mfma_f32_16x16x32_bf16 v[44:47], a[144:147], v[52:55], v[44:47]
v_mfma_f32_16x16x32_bf16 v[48:51], a[144:147], v[56:59], v[48:51]
ds_read_b128 v[52:55], v12 offset:36864
ds_read_b128 v[56:59], v14 offset:36864
s_waitcnt lgkmcnt(2)
v_mfma_f32_16x16x32_bf16 v[36:39], a[68:71], v[60:63], v[36:39]
v_mfma_f32_16x16x32_bf16 v[40:43], a[68:71], v[64:67], v[40:43]
v_mfma_f32_16x16x32_bf16 v[44:47], a[148:151], v[60:63], v[44:47]
v_mfma_f32_16x16x32_bf16 v[48:51], a[148:151], v[64:67], v[48:51]
ds_read_b128 v[60:63], v13 offset:36864
ds_read_b128 v[64:67], v15 offset:36864
s_waitcnt lgkmcnt(2)
v_mfma_f32_16x16x32_bf16 v[36:39], a[72:75], v[52:55], v[36:39]
v_mfma_f32_16x16x32_bf16 v[40:43], a[72:75], v[56:59], v[40:43]
v_mfma_f32_16x16x32_bf16 v[44:47], a[152:155], v[52:55], v[44:47]
v_mfma_f32_16x16x32_bf16 v[48:51], a[152:155], v[56:59], v[48:51]
s_waitcnt lgkmcnt(0)
v_mfma_f32_16x16x32_bf16 v[36:39], a[76:79], v[60:63], v[36:39]
v_mfma_f32_16x16x32_bf16 v[40:43], a[76:79], v[64:67], v[40:43]
v_mfma_f32_16x16x32_bf16 v[44:47], a[156:159], v[60:63], v[44:47]
v_mfma_f32_16x16x32_bf16 v[48:51], a[156:159], v[64:67], v[48:51]
s_nop 4
v_cvt_pk_bf16_f32 v30, v36, v37
v_cvt_pk_bf16_f32 v31, v38, v39
ds_write_b64 v8, v[30:31] offset:0
v_cvt_pk_bf16_f32 v30, v40, v41
v_cvt_pk_bf16_f32 v31, v42, v43
ds_write_b64 v8, v[30:31] offset:1024
v_cvt_pk_bf16_f32 v30, v44, v45
v_cvt_pk_bf16_f32 v31, v46, v47
ds_write_b64 v8, v[30:31] offset:512
v_cvt_pk_bf16_f32 v30, v48, v49
v_cvt_pk_bf16_f32 v31, v50, v51
ds_write_b64 v8, v[30:31] offset:1536
s_waitcnt lgkmcnt(0)
s_barrier
ds_read_b128 v[68:71], v9 offset:0
ds_read_b128 v[72:75], v9 offset:1024
ds_read_b128 v[76:79], v9 offset:2048
ds_read_b128 v[80:83], v9 offset:3072
ds_read_b128 v[84:87], v9 offset:4096
ds_read_b128 v[88:91], v9 offset:5120
ds_read_b128 v[92:95], v9 offset:6144
ds_read_b128 v[96:99], v9 offset:7168
s_mul_i32 s44, s30, 1572864
s_add_u32 s50, s4, s44
s_addc_u32 s51, s5, 0
s_add_u32 s50, s50, 75497472
s_addc_u32 s51, s51, 0
s_waitcnt lgkmcnt(0)
v_mfma_f32_16x16x32_bf16 v[100:103], v[68:71], a[160:163], 0
v_mfma_f32_16x16x32_bf16 v[104:107], v[72:75], a[160:163], 0
v_mfma_f32_16x16x32_bf16 v[100:103], v[76:79], a[164:167], v[100:103]
v_mfma_f32_16x16x32_bf16 v[104:107], v[80:83], a[164:167], v[104:107]
v_mfma_f32_16x16x32_bf16 v[100:103], v[84:87], a[168:171], v[100:103]
v_mfma_f32_16x16x32_bf16 v[104:107], v[88:91], a[168:171], v[104:107]
v_mfma_f32_16x16x32_bf16 v[100:103], v[92:95], a[172:175], v[100:103]
v_mfma_f32_16x16x32_bf16 v[104:107], v[96:99], a[172:175], v[104:107]
v_mfma_f32_16x16x32_bf16 v[108:111], v[68:71], a[176:179], 0
v_mfma_f32_16x16x32_bf16 v[112:115], v[72:75], a[176:179], 0
v_mfma_f32_16x16x32_bf16 v[108:111], v[76:79], a[180:183], v[108:111]
v_mfma_f32_16x16x32_bf16 v[112:115], v[80:83], a[180:183], v[112:115]
s_nop 2
v_cvt_pk_bf16_f32 v116, v100, v101
v_cvt_pk_bf16_f32 v117, v102, v103
v_cvt_pk_bf16_f32 v118, v104, v105
v_cvt_pk_bf16_f32 v119, v106, v107
s_add_u32 s52, s50, 0
s_addc_u32 s53, s51, 0
global_store_dwordx4 v10, v[116:119], s[52:53] sc1
v_mfma_f32_16x16x32_bf16 v[108:111], v[84:87], a[184:187], v[108:111]
v_mfma_f32_16x16x32_bf16 v[112:115], v[88:91], a[184:187], v[112:115]
v_mfma_f32_16x16x32_bf16 v[108:111], v[92:95], a[188:191], v[108:111]
v_mfma_f32_16x16x32_bf16 v[112:115], v[96:99], a[188:191], v[112:115]
v_mfma_f32_16x16x32_bf16 v[100:103], v[68:71], a[192:195], 0
v_mfma_f32_16x16x32_bf16 v[104:107], v[72:75], a[192:195], 0
v_mfma_f32_16x16x32_bf16 v[100:103], v[76:79], a[196:199], v[100:103]
v_mfma_f32_16x16x32_bf16 v[104:107], v[80:83], a[196:199], v[104:107]
s_nop 2
v_cvt_pk_bf16_f32 v120, v108, v109
v_cvt_pk_bf16_f32 v121, v110, v111
v_cvt_pk_bf16_f32 v122, v112, v113
v_cvt_pk_bf16_f32 v123, v114, v115
s_add_u32 s52, s50, 49152
s_addc_u32 s53, s51, 0
global_store_dwordx4 v10, v[120:123], s[52:53] sc1
v_mfma_f32_16x16x32_bf16 v[100:103], v[84:87], a[200:203], v[100:103]
v_mfma_f32_16x16x32_bf16 v[104:107], v[88:91], a[200:203], v[104:107]
v_mfma_f32_16x16x32_bf16 v[100:103], v[92:95], a[204:207], v[100:103]
v_mfma_f32_16x16x32_bf16 v[104:107], v[96:99], a[204:207], v[104:107]
v_mfma_f32_16x16x32_bf16 v[108:111], v[68:71], a[208:211], 0
v_mfma_f32_16x16x32_bf16 v[112:115], v[72:75], a[208:211], 0
v_mfma_f32_16x16x32_bf16 v[108:111], v[76:79], a[212:215], v[108:111]
v_mfma_f32_16x16x32_bf16 v[112:115], v[80:83], a[212:215], v[112:115]
s_nop 2
v_cvt_pk_bf16_f32 v116, v100, v101
v_cvt_pk_bf16_f32 v117, v102, v103
v_cvt_pk_bf16_f32 v118, v104, v105
v_cvt_pk_bf16_f32 v119, v106, v107
s_add_u32 s52, s50, 393216
s_addc_u32 s53, s51, 0
global_store_dwordx4 v10, v[116:119], s[52:53] sc1
v_mfma_f32_16x16x32_bf16 v[108:111], v[84:87], a[216:219], v[108:111]
v_mfma_f32_16x16x32_bf16 v[112:115], v[88:91], a[216:219], v[112:115]
v_mfma_f32_16x16x32_bf16 v[108:111], v[92:95], a[220:223], v[108:111]
v_mfma_f32_16x16x32_bf16 v[112:115], v[96:99], a[220:223], v[112:115]
v_mfma_f32_16x16x32_bf16 v[100:103], v[68:71], a[224:227], 0
v_mfma_f32_16x16x32_bf16 v[104:107], v[72:75], a[224:227], 0
v_mfma_f32_16x16x32_bf16 v[100:103], v[76:79], a[228:231], v[100:103]
v_mfma_f32_16x16x32_bf16 v[104:107], v[80:83], a[228:231], v[104:107]
s_nop 2
v_cvt_pk_bf16_f32 v120, v108, v109
v_cvt_pk_bf16_f32 v121, v110, v111
v_cvt_pk_bf16_f32 v122, v112, v113
v_cvt_pk_bf16_f32 v123, v114, v115
s_add_u32 s52, s50, 442368
s_addc_u32 s53, s51, 0
global_store_dwordx4 v10, v[120:123], s[52:53] sc1
v_mfma_f32_16x16x32_bf16 v[100:103], v[84:87], a[232:235], v[100:103]
v_mfma_f32_16x16x32_bf16 v[104:107], v[88:91], a[232:235], v[104:107]
v_mfma_f32_16x16x32_bf16 v[100:103], v[92:95], a[236:239], v[100:103]
v_mfma_f32_16x16x32_bf16 v[104:107], v[96:99], a[236:239], v[104:107]
v_mfma_f32_16x16x32_bf16 v[108:111], v[68:71], a[240:243], 0
v_mfma_f32_16x16x32_bf16 v[112:115], v[72:75], a[240:243], 0
v_mfma_f32_16x16x32_bf16 v[108:111], v[76:79], a[244:247], v[108:111]
v_mfma_f32_16x16x32_bf16 v[112:115], v[80:83], a[244:247], v[112:115]
s_nop 2
v_cvt_pk_bf16_f32 v116, v100, v101
v_cvt_pk_bf16_f32 v117, v102, v103
v_cvt_pk_bf16_f32 v118, v104, v105
v_cvt_pk_bf16_f32 v119, v106, v107
s_add_u32 s52, s50, 1024
s_addc_u32 s53, s51, 0
global_store_dwordx4 v10, v[116:119], s[52:53] sc1
v_mfma_f32_16x16x32_bf16 v[108:111], v[84:87], a[248:251], v[108:111]
v_mfma_f32_16x16x32_bf16 v[112:115], v[88:91], a[248:251], v[112:115]
v_mfma_f32_16x16x32_bf16 v[108:111], v[92:95], a[252:255], v[108:111]
v_mfma_f32_16x16x32_bf16 v[112:115], v[96:99], a[252:255], v[112:115]
v_mfma_f32_16x16x32_bf16 v[100:103], v[68:71], v[192:195], 0
v_mfma_f32_16x16x32_bf16 v[104:107], v[72:75], v[192:195], 0
v_mfma_f32_16x16x32_bf16 v[100:103], v[76:79], v[196:199], v[100:103]
v_mfma_f32_16x16x32_bf16 v[104:107], v[80:83], v[196:199], v[104:107]
s_nop 2
v_cvt_pk_bf16_f32 v120, v108, v109
v_cvt_pk_bf16_f32 v121, v110, v111
v_cvt_pk_bf16_f32 v122, v112, v113
v_cvt_pk_bf16_f32 v123, v114, v115
s_add_u32 s52, s50, 50176
s_addc_u32 s53, s51, 0
global_store_dwordx4 v10, v[120:123], s[52:53] sc1
v_mfma_f32_16x16x32_bf16 v[100:103], v[84:87], v[200:203], v[100:103]
v_mfma_f32_16x16x32_bf16 v[104:107], v[88:91], v[200:203], v[104:107]
v_mfma_f32_16x16x32_bf16 v[100:103], v[92:95], v[204:207], v[100:103]
v_mfma_f32_16x16x32_bf16 v[104:107], v[96:99], v[204:207], v[104:107]
v_mfma_f32_16x16x32_bf16 v[108:111], v[68:71], v[208:211], 0
v_mfma_f32_16x16x32_bf16 v[112:115], v[72:75], v[208:211], 0
v_mfma_f32_16x16x32_bf16 v[108:111], v[76:79], v[212:215], v[108:111]
v_mfma_f32_16x16x32_bf16 v[112:115], v[80:83], v[212:215], v[112:115]
s_nop 2
v_cvt_pk_bf16_f32 v116, v100, v101
v_cvt_pk_bf16_f32 v117, v102, v103
v_cvt_pk_bf16_f32 v118, v104, v105
v_cvt_pk_bf16_f32 v119, v106, v107
s_add_u32 s52, s50, 394240
s_addc_u32 s53, s51, 0
global_store_dwordx4 v10, v[116:119], s[52:53] sc1
v_mfma_f32_16x16x32_bf16 v[108:111], v[84:87], v[216:219], v[108:111]
v_mfma_f32_16x16x32_bf16 v[112:115], v[88:91], v[216:219], v[112:115]
v_mfma_f32_16x16x32_bf16 v[108:111], v[92:95], v[220:223], v[108:111]
v_mfma_f32_16x16x32_bf16 v[112:115], v[96:99], v[220:223], v[112:115]
v_mfma_f32_16x16x32_bf16 v[100:103], v[68:71], v[224:227], 0
v_mfma_f32_16x16x32_bf16 v[104:107], v[72:75], v[224:227], 0
v_mfma_f32_16x16x32_bf16 v[100:103], v[76:79], v[228:231], v[100:103]
v_mfma_f32_16x16x32_bf16 v[104:107], v[80:83], v[228:231], v[104:107]
s_nop 2
v_cvt_pk_bf16_f32 v120, v108, v109
v_cvt_pk_bf16_f32 v121, v110, v111
v_cvt_pk_bf16_f32 v122, v112, v113
v_cvt_pk_bf16_f32 v123, v114, v115
s_add_u32 s52, s50, 443392
s_addc_u32 s53, s51, 0
global_store_dwordx4 v10, v[120:123], s[52:53] sc1
v_mfma_f32_16x16x32_bf16 v[100:103], v[84:87], v[232:235], v[100:103]
v_mfma_f32_16x16x32_bf16 v[104:107], v[88:91], v[232:235], v[104:107]
v_mfma_f32_16x16x32_bf16 v[100:103], v[92:95], v[236:239], v[100:103]
v_mfma_f32_16x16x32_bf16 v[104:107], v[96:99], v[236:239], v[104:107]
v_mfma_f32_16x16x32_bf16 v[108:111], v[68:71], v[240:243], 0
v_mfma_f32_16x16x32_bf16 v[112:115], v[72:75], v[240:243], 0
v_mfma_f32_16x16x32_bf16 v[108:111], v[76:79], v[244:247], v[108:111]
v_mfma_f32_16x16x32_bf16 v[112:115], v[80:83], v[244:247], v[112:115]
s_nop 2
v_cvt_pk_bf16_f32 v116, v100, v101
v_cvt_pk_bf16_f32 v117, v102, v103
v_cvt_pk_bf16_f32 v118, v104, v105
v_cvt_pk_bf16_f32 v119, v106, v107
s_add_u32 s52, s50, 2048
s_addc_u32 s53, s51, 0
global_store_dwordx4 v10, v[116:119], s[52:53] sc1
v_mfma_f32_16x16x32_bf16 v[108:111], v[84:87], v[248:251], v[108:111]
v_mfma_f32_16x16x32_bf16 v[112:115], v[88:91], v[248:251], v[112:115]
v_mfma_f32_16x16x32_bf16 v[108:111], v[92:95], v[252:255], v[108:111]
v_mfma_f32_16x16x32_bf16 v[112:115], v[96:99], v[252:255], v[112:115]
s_nop 6
v_cvt_pk_bf16_f32 v120, v108, v109
v_cvt_pk_bf16_f32 v121, v110, v111
v_cvt_pk_bf16_f32 v122, v112, v113
v_cvt_pk_bf16_f32 v123, v114, v115
s_add_u32 s52, s50, 51200
s_addc_u32 s53, s51, 0
global_store_dwordx4 v10, v[120:123], s[52:53] sc1
s_waitcnt vmcnt(0)
s_barrier
s_cmp_lg_u32 s3, 0
s_cbranch_scc1 uf_42
s_lshl_b32 s44, s30, 7
s_lshl_b32 s45, s16, 2
s_add_u32 s44, s44, s45
s_add_u32 s44, s44, 46153728
v_mov_b32 v30, s44
v_mov_b32 v31, 1
global_store_dword v30, v31, s[4:5] sc1
uf_42:
s_add_u32 s30, s30, 2
s_cmp_ge_u32 s30, 64
s_cbranch_scc1 VUe_40
s_branch VUl_39
VUe_40:
s_waitcnt vmcnt(0)
s_endpgm
L_chain:
s_and_b32 s17, s17, 31
s_mov_b32 s15, s12
s_and_b32 s14, s17, 15
s_lshl_b32 s16, s15, 4
s_add_u32 s16, s16, s14
s_cmp_lg_u32 s101, 0
s_cbranch_scc1 L_chain_safe
s_cmp_ge_u32 s17, 16
s_cbranch_scc1 L_vo
s_mov_b32 s60, 0x00ff00ff
s_mov_b32 s61, 0x00ff00ff
s_mov_b32 s62, 0
s_mov_b32 s63, 0x00ff00ff
s_mov_b32 s64, -1
s_mov_b32 s65, 0
s_mov_b32 s72, 0xff00ff00
s_mov_b32 s73, 0xff00ff00
s_mov_b32 s66, 0x3e0293ee
s_mov_b32 s67, 0x3e0293ee
s_mov_b32 s70, 0xfffffffe
s_load_dwordx2 s[8:9], s[0:1], 88
s_load_dwordx2 s[10:11], s[0:1], 96
s_waitcnt lgkmcnt(0)
v_lshrrev_b32 v34, 4, v1
v_lshlrev_b32 v34, 13, v34
v_and_b32 v35, 15, v1
v_lshl_add_u32 v34, v35, 4, v34
s_cmp_lt_u32 s3, 2
s_cselect_b32 s12, s8, s10
s_cselect_b32 s13, s9, s11
s_and_b32 s40, s3, 1
s_lshl_b32 s40, s40, 18
s_lshl_b32 s41, s16, 8
s_add_u32 s40, s40, s41
s_add_u32 s12, s12, s40
s_addc_u32 s13, s13, 0
s_mov_b32 s43, 32768
v_lshrrev_b32 v30, 4, v1
v_mul_u32_u24 v10, 2176, v30
v_bfe_u32 v30, v1, 2, 2
v_lshl_add_u32 v10, v30, 8, v10
v_and_b32 v30, 3, v1
v_lshl_add_u32 v10, v30, 3, v10
s_lshl_b32 s40, s3, 6
v_add_u32 v10, s40, v10
s_add_u32 s40, s12, 0
s_addc_u32 s41, s13, 0
s_mul_i32 s44, s3, 8704
s_add_u32 s44, s44, 0
v_mov_b32 v35, v34
s_add_u32 m0, s44, 0
s_nop 0
global_load_lds_dwordx4 v35, s[40:41]
v_add_u32 v35, s43, v35
s_add_u32 m0, s44, 1088
s_nop 0
global_load_lds_dwordx4 v35, s[40:41]
v_add_u32 v35, s43, v35
s_add_u32 m0, s44, 2176
s_nop 0
global_load_lds_dwordx4 v35, s[40:41]
v_add_u32 v35, s43, v35
s_add_u32 m0, s44, 3264
s_nop 0
global_load_lds_dwordx4 v35, s[40:41]
v_add_u32 v35, s43, v35
s_add_u32 m0, s44, 4352
s_nop 0
global_load_lds_dwordx4 v35, s[40:41]
v_add_u32 v35, s43, v35
s_add_u32 m0, s44, 5440
s_nop 0
global_load_lds_dwordx4 v35, s[40:41]
v_add_u32 v35, s43, v35
s_add_u32 m0, s44, 6528
s_nop 0
global_load_lds_dwordx4 v35, s[40:41]
v_add_u32 v35, s43, v35
s_add_u32 m0, s44, 7616
s_nop 0
global_load_lds_dwordx4 v35, s[40:41]
s_add_u32 s40, s12, 524288
s_addc_u32 s41, s13, 0
s_mul_i32 s44, s3, 8704
s_add_u32 s44, s44, 34816
v_mov_b32 v35, v34
s_add_u32 m0, s44, 0
s_nop 0
global_load_lds_dwordx4 v35, s[40:41]
v_add_u32 v35, s43, v35
s_add_u32 m0, s44, 1088
s_nop 0
global_load_lds_dwordx4 v35, s[40:41]
v_add_u32 v35, s43, v35
s_add_u32 m0, s44, 2176
s_nop 0
global_load_lds_dwordx4 v35, s[40:41]
v_add_u32 v35, s43, v35
s_add_u32 m0, s44, 3264
s_nop 0
global_load_lds_dwordx4 v35, s[40:41]
v_add_u32 v35, s43, v35
s_add_u32 m0, s44, 4352
s_nop 0
global_load_lds_dwordx4 v35, s[40:41]
v_add_u32 v35, s43, v35
s_add_u32 m0, s44, 5440
s_nop 0
global_load_lds_dwordx4 v35, s[40:41]
v_add_u32 v35, s43, v35
s_add_u32 m0, s44, 6528
s_nop 0
global_load_lds_dwordx4 v35, s[40:41]
v_add_u32 v35, s43, v35
s_add_u32 m0, s44, 7616
s_nop 0
global_load_lds_dwordx4 v35, s[40:41]
s_add_u32 s40, s12, 1048576
s_addc_u32 s41, s13, 0
s_mul_i32 s44, s3, 8704
s_add_u32 s44, s44, 69632
v_mov_b32 v35, v34
s_add_u32 m0, s44, 0
s_nop 0
global_load_lds_dwordx4 v35, s[40:41]
v_add_u32 v35, s43, v35
s_add_u32 m0, s44, 1088
s_nop 0
global_load_lds_dwordx4 v35, s[40:41]
v_add_u32 v35, s43, v35
s_add_u32 m0, s44, 2176
s_nop 0
global_load_lds_dwordx4 v35, s[40:41]
v_add_u32 v35, s43, v35
s_add_u32 m0, s44, 3264
s_nop 0
global_load_lds_dwordx4 v35, s[40:41]
v_add_u32 v35, s43, v35
s_add_u32 m0, s44, 4352
s_nop 0
global_load_lds_dwordx4 v35, s[40:41]
v_add_u32 v35, s43, v35
s_add_u32 m0, s44, 5440
s_nop 0
global_load_lds_dwordx4 v35, s[40:41]
v_add_u32 v35, s43, v35
s_add_u32 m0, s44, 6528
s_nop 0
global_load_lds_dwordx4 v35, s[40:41]
v_add_u32 v35, s43, v35
s_add_u32 m0, s44, 7616
s_nop 0
global_load_lds_dwordx4 v35, s[40:41]
s_add_u32 s40, s12, 1572864
s_addc_u32 s41, s13, 0
s_mul_i32 s44, s3, 8704
s_add_u32 s44, s44, 104448
v_mov_b32 v35, v34
s_add_u32 m0, s44, 0
s_nop 0
global_load_lds_dwordx4 v35, s[40:41]
v_add_u32 v35, s43, v35
s_add_u32 m0, s44, 1088
s_nop 0
global_load_lds_dwordx4 v35, s[40:41]
v_add_u32 v35, s43, v35
s_add_u32 m0, s44, 2176
s_nop 0
global_load_lds_dwordx4 v35, s[40:41]
v_add_u32 v35, s43, v35
s_add_u32 m0, s44, 3264
s_nop 0
global_load_lds_dwordx4 v35, s[40:41]
v_add_u32 v35, s43, v35
s_add_u32 m0, s44, 4352
s_nop 0
global_load_lds_dwordx4 v35, s[40:41]
v_add_u32 v35, s43, v35
s_add_u32 m0, s44, 5440
s_nop 0
global_load_lds_dwordx4 v35, s[40:41]
v_add_u32 v35, s43, v35
s_add_u32 m0, s44, 6528
s_nop 0
global_load_lds_dwordx4 v35, s[40:41]
v_add_u32 v35, s43, v35
s_add_u32 m0, s44, 7616
s_nop 0
global_load_lds_dwordx4 v35, s[40:41]
s_cmp_lg_u32 s101, 0
s_cbranch_scc1 arr_43
s_cmp_lg_u32 s99, 0
s_cbranch_scc1 arr_43
s_waitcnt vmcnt(32)
s_barrier
s_cmp_lg_u32 s3, 0
s_cbranch_scc1 arr_43
v_mov_b32 v30, 64
v_mov_b32 v31, 1
s_mov_b64 exec, 1
global_atomic_add v30, v31, s[6:7]
s_mov_b64 exec, -1
arr_43:
s_waitcnt vmcnt(24)
s_barrier
v_add_u32 v33, 0, v10
ds_read_b64_tr_b16 a[0:1], v33 offset:0
ds_read_b64_tr_b16 a[2:3], v33 offset:1088
ds_read_b64_tr_b16 a[4:5], v33 offset:8704
ds_read_b64_tr_b16 a[6:7], v33 offset:9792
ds_read_b64_tr_b16 a[80:81], v33 offset:32
ds_read_b64_tr_b16 a[82:83], v33 offset:1120
ds_read_b64_tr_b16 a[84:85], v33 offset:8736
ds_read_b64_tr_b16 a[86:87], v33 offset:9824
ds_read_b64_tr_b16 a[160:161], v33 offset:17408
ds_read_b64_tr_b16 a[162:163], v33 offset:18496
ds_read_b64_tr_b16 a[164:165], v33 offset:26112
ds_read_b64_tr_b16 a[166:167], v33 offset:27200
ds_read_b64_tr_b16 a[240:241], v33 offset:17440
ds_read_b64_tr_b16 a[242:243], v33 offset:18528
ds_read_b64_tr_b16 a[244:245], v33 offset:26144
ds_read_b64_tr_b16 a[246:247], v33 offset:27232
s_waitcnt lgkmcnt(0)
s_barrier
s_add_u32 s40, s12, 2097152
s_addc_u32 s41, s13, 0
s_mul_i32 s44, s3, 8704
s_add_u32 s44, s44, 0
v_mov_b32 v35, v34
s_add_u32 m0, s44, 0
s_nop 0
global_load_lds_dwordx4 v35, s[40:41]
v_add_u32 v35, s43, v35
s_add_u32 m0, s44, 1088
s_nop 0
global_load_lds_dwordx4 v35, s[40:41]
v_add_u32 v35, s43, v35
s_add_u32 m0, s44, 2176
s_nop 0
global_load_lds_dwordx4 v35, s[40:41]
v_add_u32 v35, s43, v35
s_add_u32 m0, s44, 3264
s_nop 0
global_load_lds_dwordx4 v35, s[40:41]
v_add_u32 v35, s43, v35
s_add_u32 m0, s44, 4352
s_nop 0
global_load_lds_dwordx4 v35, s[40:41]
v_add_u32 v35, s43, v35
s_add_u32 m0, s44, 5440
s_nop 0
global_load_lds_dwordx4 v35, s[40:41]
v_add_u32 v35, s43, v35
s_add_u32 m0, s44, 6528
s_nop 0
global_load_lds_dwordx4 v35, s[40:41]
v_add_u32 v35, s43, v35
s_add_u32 m0, s44, 7616
s_nop 0
global_load_lds_dwordx4 v35, s[40:41]
s_waitcnt vmcnt(24)
s_barrier
v_add_u32 v33, 34816, v10
ds_read_b64_tr_b16 a[8:9], v33 offset:0
ds_read_b64_tr_b16 a[10:11], v33 offset:1088
ds_read_b64_tr_b16 a[12:13], v33 offset:8704
ds_read_b64_tr_b16 a[14:15], v33 offset:9792
ds_read_b64_tr_b16 a[88:89], v33 offset:32
ds_read_b64_tr_b16 a[90:91], v33 offset:1120
ds_read_b64_tr_b16 a[92:93], v33 offset:8736
ds_read_b64_tr_b16 a[94:95], v33 offset:9824
ds_read_b64_tr_b16 a[168:169], v33 offset:17408
ds_read_b64_tr_b16 a[170:171], v33 offset:18496
ds_read_b64_tr_b16 a[172:173], v33 offset:26112
ds_read_b64_tr_b16 a[174:175], v33 offset:27200
ds_read_b64_tr_b16 a[248:249], v33 offset:17440
ds_read_b64_tr_b16 a[250:251], v33 offset:18528
ds_read_b64_tr_b16 a[252:253], v33 offset:26144
ds_read_b64_tr_b16 a[254:255], v33 offset:27232
s_waitcnt lgkmcnt(0)
s_barrier
s_add_u32 s40, s12, 2621440
s_addc_u32 s41, s13, 0
s_mul_i32 s44, s3, 8704
s_add_u32 s44, s44, 34816
v_mov_b32 v35, v34
s_add_u32 m0, s44, 0
s_nop 0
global_load_lds_dwordx4 v35, s[40:41]
v_add_u32 v35, s43, v35
s_add_u32 m0, s44, 1088
s_nop 0
global_load_lds_dwordx4 v35, s[40:41]
v_add_u32 v35, s43, v35
s_add_u32 m0, s44, 2176
s_nop 0
global_load_lds_dwordx4 v35, s[40:41]
v_add_u32 v35, s43, v35
s_add_u32 m0, s44, 3264
s_nop 0
global_load_lds_dwordx4 v35, s[40:41]
v_add_u32 v35, s43, v35
s_add_u32 m0, s44, 4352
s_nop 0
global_load_lds_dwordx4 v35, s[40:41]
v_add_u32 v35, s43, v35
s_add_u32 m0, s44, 5440
s_nop 0
global_load_lds_dwordx4 v35, s[40:41]
v_add_u32 v35, s43, v35
s_add_u32 m0, s44, 6528
s_nop 0
global_load_lds_dwordx4 v35, s[40:41]
v_add_u32 v35, s43, v35
s_add_u32 m0, s44, 7616
s_nop 0
global_load_lds_dwordx4 v35, s[40:41]
s_waitcnt vmcnt(24)
s_barrier
v_add_u32 v33, 69632, v10
ds_read_b64_tr_b16 a[16:17], v33 offset:0
ds_read_b64_tr_b16 a[18:19], v33 offset:1088
ds_read_b64_tr_b16 a[20:21], v33 offset:8704
ds_read_b64_tr_b16 a[22:23], v33 offset:9792
ds_read_b64_tr_b16 a[96:97], v33 offset:32
ds_read_b64_tr_b16 a[98:99], v33 offset:1120
ds_read_b64_tr_b16 a[100:101], v33 offset:8736
ds_read_b64_tr_b16 a[102:103], v33 offset:9824
ds_read_b64_tr_b16 a[176:177], v33 offset:17408
ds_read_b64_tr_b16 a[178:179], v33 offset:18496
ds_read_b64_tr_b16 a[180:181], v33 offset:26112
ds_read_b64_tr_b16 a[182:183], v33 offset:27200
ds_read_b64_tr_b16 v[192:193], v33 offset:17440
ds_read_b64_tr_b16 v[194:195], v33 offset:18528
ds_read_b64_tr_b16 v[196:197], v33 offset:26144
ds_read_b64_tr_b16 v[198:199], v33 offset:27232
s_waitcnt lgkmcnt(0)
s_barrier
s_add_u32 s40, s12, 3145728
s_addc_u32 s41, s13, 0
s_mul_i32 s44, s3, 8704
s_add_u32 s44, s44, 69632
v_mov_b32 v35, v34
s_add_u32 m0, s44, 0
s_nop 0
global_load_lds_dwordx4 v35, s[40:41]
v_add_u32 v35, s43, v35
s_add_u32 m0, s44, 1088
s_nop 0
global_load_lds_dwordx4 v35, s[40:41]
v_add_u32 v35, s43, v35
s_add_u32 m0, s44, 2176
s_nop 0
global_load_lds_dwordx4 v35, s[40:41]
v_add_u32 v35, s43, v35
s_add_u32 m0, s44, 3264
s_nop 0
global_load_lds_dwordx4 v35, s[40:41]
v_add_u32 v35, s43, v35
s_add_u32 m0, s44, 4352
s_nop 0
global_load_lds_dwordx4 v35, s[40:41]
v_add_u32 v35, s43, v35
s_add_u32 m0, s44, 5440
s_nop 0
global_load_lds_dwordx4 v35, s[40:41]
v_add_u32 v35, s43, v35
s_add_u32 m0, s44, 6528
s_nop 0
global_load_lds_dwordx4 v35, s[40:41]
v_add_u32 v35, s43, v35
s_add_u32 m0, s44, 7616
s_nop 0
global_load_lds_dwordx4 v35, s[40:41]
s_waitcnt vmcnt(24)
s_barrier
v_add_u32 v33, 104448, v10
ds_read_b64_tr_b16 a[24:25], v33 offset:0
ds_read_b64_tr_b16 a[26:27], v33 offset:1088
ds_read_b64_tr_b16 a[28:29], v33 offset:8704
ds_read_b64_tr_b16 a[30:31], v33 offset:9792
ds_read_b64_tr_b16 a[104:105], v33 offset:32
ds_read_b64_tr_b16 a[106:107], v33 offset:1120
ds_read_b64_tr_b16 a[108:109], v33 offset:8736
ds_read_b64_tr_b16 a[110:111], v33 offset:9824
ds_read_b64_tr_b16 a[184:185], v33 offset:17408
ds_read_b64_tr_b16 a[186:187], v33 offset:18496
ds_read_b64_tr_b16 a[188:189], v33 offset:26112
ds_read_b64_tr_b16 a[190:191], v33 offset:27200
ds_read_b64_tr_b16 v[200:201], v33 offset:17440
ds_read_b64_tr_b16 v[202:203], v33 offset:18528
ds_read_b64_tr_b16 v[204:205], v33 offset:26144
ds_read_b64_tr_b16 v[206:207], v33 offset:27232
s_waitcnt lgkmcnt(0)
s_barrier
s_add_u32 s40, s12, 3670016
s_addc_u32 s41, s13, 0
s_mul_i32 s44, s3, 8704
s_add_u32 s44, s44, 104448
v_mov_b32 v35, v34
s_add_u32 m0, s44, 0
s_nop 0
global_load_lds_dwordx4 v35, s[40:41]
v_add_u32 v35, s43, v35
s_add_u32 m0, s44, 1088
s_nop 0
global_load_lds_dwordx4 v35, s[40:41]
v_add_u32 v35, s43, v35
s_add_u32 m0, s44, 2176
s_nop 0
global_load_lds_dwordx4 v35, s[40:41]
v_add_u32 v35, s43, v35
s_add_u32 m0, s44, 3264
s_nop 0
global_load_lds_dwordx4 v35, s[40:41]
v_add_u32 v35, s43, v35
s_add_u32 m0, s44, 4352
s_nop 0
global_load_lds_dwordx4 v35, s[40:41]
v_add_u32 v35, s43, v35
s_add_u32 m0, s44, 5440
s_nop 0
global_load_lds_dwordx4 v35, s[40:41]
v_add_u32 v35, s43, v35
s_add_u32 m0, s44, 6528
s_nop 0
global_load_lds_dwordx4 v35, s[40:41]
v_add_u32 v35, s43, v35
s_add_u32 m0, s44, 7616
s_nop 0
global_load_lds_dwordx4 v35, s[40:41]
s_waitcnt vmcnt(24)
s_barrier
v_add_u32 v33, 0, v10
ds_read_b64_tr_b16 a[32:33], v33 offset:0
ds_read_b64_tr_b16 a[34:35], v33 offset:1088
ds_read_b64_tr_b16 a[36:37], v33 offset:8704
ds_read_b64_tr_b16 a[38:39], v33 offset:9792
ds_read_b64_tr_b16 a[112:113], v33 offset:32
ds_read_b64_tr_b16 a[114:115], v33 offset:1120
ds_read_b64_tr_b16 a[116:117], v33 offset:8736
ds_read_b64_tr_b16 a[118:119], v33 offset:9824
ds_read_b64_tr_b16 a[192:193], v33 offset:17408
ds_read_b64_tr_b16 a[194:195], v33 offset:18496
ds_read_b64_tr_b16 a[196:197], v33 offset:26112
ds_read_b64_tr_b16 a[198:199], v33 offset:27200
ds_read_b64_tr_b16 v[208:209], v33 offset:17440
ds_read_b64_tr_b16 v[210:211], v33 offset:18528
ds_read_b64_tr_b16 v[212:213], v33 offset:26144
ds_read_b64_tr_b16 v[214:215], v33 offset:27232
s_waitcnt lgkmcnt(0)
s_barrier
s_add_u32 s40, s12, 4194304
s_addc_u32 s41, s13, 0
s_mul_i32 s44, s3, 8704
s_add_u32 s44, s44, 0
v_mov_b32 v35, v34
s_add_u32 m0, s44, 0
s_nop 0
global_load_lds_dwordx4 v35, s[40:41]
v_add_u32 v35, s43, v35
s_add_u32 m0, s44, 1088
s_nop 0
global_load_lds_dwordx4 v35, s[40:41]
v_add_u32 v35, s43, v35
s_add_u32 m0, s44, 2176
s_nop 0
global_load_lds_dwordx4 v35, s[40:41]
v_add_u32 v35, s43, v35
s_add_u32 m0, s44, 3264
s_nop 0
global_load_lds_dwordx4 v35, s[40:41]
v_add_u32 v35, s43, v35
s_add_u32 m0, s44, 4352
s_nop 0
global_load_lds_dwordx4 v35, s[40:41]
v_add_u32 v35, s43, v35
s_add_u32 m0, s44, 5440
s_nop 0
global_load_lds_dwordx4 v35, s[40:41]
v_add_u32 v35, s43, v35
s_add_u32 m0, s44, 6528
s_nop 0
global_load_lds_dwordx4 v35, s[40:41]
v_add_u32 v35, s43, v35
s_add_u32 m0, s44, 7616
s_nop 0
global_load_lds_dwordx4 v35, s[40:41]
s_waitcnt vmcnt(24)
s_barrier
v_add_u32 v33, 34816, v10
ds_read_b64_tr_b16 a[40:41], v33 offset:0
ds_read_b64_tr_b16 a[42:43], v33 offset:1088
ds_read_b64_tr_b16 a[44:45], v33 offset:8704
ds_read_b64_tr_b16 a[46:47], v33 offset:9792
ds_read_b64_tr_b16 a[120:121], v33 offset:32
ds_read_b64_tr_b16 a[122:123], v33 offset:1120
ds_read_b64_tr_b16 a[124:125], v33 offset:8736
ds_read_b64_tr_b16 a[126:127], v33 offset:9824
ds_read_b64_tr_b16 a[200:201], v33 offset:17408
ds_read_b64_tr_b16 a[202:203], v33 offset:18496
ds_read_b64_tr_b16 a[204:205], v33 offset:26112
ds_read_b64_tr_b16 a[206:207], v33 offset:27200
ds_read_b64_tr_b16 v[216:217], v33 offset:17440
ds_read_b64_tr_b16 v[218:219], v33 offset:18528
ds_read_b64_tr_b16 v[220:221], v33 offset:26144
ds_read_b64_tr_b16 v[222:223], v33 offset:27232
s_waitcnt lgkmcnt(0)
s_barrier
s_add_u32 s40, s12, 4718592
s_addc_u32 s41, s13, 0
s_mul_i32 s44, s3, 8704
s_add_u32 s44, s44, 34816
v_mov_b32 v35, v34
s_add_u32 m0, s44, 0
s_nop 0
global_load_lds_dwordx4 v35, s[40:41]
v_add_u32 v35, s43, v35
s_add_u32 m0, s44, 1088
s_nop 0
global_load_lds_dwordx4 v35, s[40:41]
v_add_u32 v35, s43, v35
s_add_u32 m0, s44, 2176
s_nop 0
global_load_lds_dwordx4 v35, s[40:41]
v_add_u32 v35, s43, v35
s_add_u32 m0, s44, 3264
s_nop 0
global_load_lds_dwordx4 v35, s[40:41]
v_add_u32 v35, s43, v35
s_add_u32 m0, s44, 4352
s_nop 0
global_load_lds_dwordx4 v35, s[40:41]
v_add_u32 v35, s43, v35
s_add_u32 m0, s44, 5440
s_nop 0
global_load_lds_dwordx4 v35, s[40:41]
v_add_u32 v35, s43, v35
s_add_u32 m0, s44, 6528
s_nop 0
global_load_lds_dwordx4 v35, s[40:41]
v_add_u32 v35, s43, v35
s_add_u32 m0, s44, 7616
s_nop 0
global_load_lds_dwordx4 v35, s[40:41]
s_waitcnt vmcnt(24)
s_barrier
v_add_u32 v33, 69632, v10
ds_read_b64_tr_b16 a[48:49], v33 offset:0
ds_read_b64_tr_b16 a[50:51], v33 offset:1088
ds_read_b64_tr_b16 a[52:53], v33 offset:8704
ds_read_b64_tr_b16 a[54:55], v33 offset:9792
ds_read_b64_tr_b16 a[128:129], v33 offset:32
ds_read_b64_tr_b16 a[130:131], v33 offset:1120
ds_read_b64_tr_b16 a[132:133], v33 offset:8736
ds_read_b64_tr_b16 a[134:135], v33 offset:9824
ds_read_b64_tr_b16 a[208:209], v33 offset:17408
ds_read_b64_tr_b16 a[210:211], v33 offset:18496
ds_read_b64_tr_b16 a[212:213], v33 offset:26112
ds_read_b64_tr_b16 a[214:215], v33 offset:27200
ds_read_b64_tr_b16 v[224:225], v33 offset:17440
ds_read_b64_tr_b16 v[226:227], v33 offset:18528
ds_read_b64_tr_b16 v[228:229], v33 offset:26144
ds_read_b64_tr_b16 v[230:231], v33 offset:27232
s_waitcnt lgkmcnt(0)
s_barrier
s_waitcnt vmcnt(16)
s_barrier
v_add_u32 v33, 104448, v10
ds_read_b64_tr_b16 a[56:57], v33 offset:0
ds_read_b64_tr_b16 a[58:59], v33 offset:1088
ds_read_b64_tr_b16 a[60:61], v33 offset:8704
ds_read_b64_tr_b16 a[62:63], v33 offset:9792
ds_read_b64_tr_b16 a[136:137], v33 offset:32
ds_read_b64_tr_b16 a[138:139], v33 offset:1120
ds_read_b64_tr_b16 a[140:141], v33 offset:8736
ds_read_b64_tr_b16 a[142:143], v33 offset:9824
ds_read_b64_tr_b16 a[216:217], v33 offset:17408
ds_read_b64_tr_b16 a[218:219], v33 offset:18496
ds_read_b64_tr_b16 a[220:221], v33 offset:26112
ds_read_b64_tr_b16 a[222:223], v33 offset:27200
ds_read_b64_tr_b16 v[232:233], v33 offset:17440
ds_read_b64_tr_b16 v[234:235], v33 offset:18528
ds_read_b64_tr_b16 v[236:237], v33 offset:26144
ds_read_b64_tr_b16 v[238:239], v33 offset:27232
s_waitcnt lgkmcnt(0)
s_barrier
s_waitcnt vmcnt(8)
s_barrier
v_add_u32 v33, 0, v10
ds_read_b64_tr_b16 a[64:65], v33 offset:0
ds_read_b64_tr_b16 a[66:67], v33 offset:1088
ds_read_b64_tr_b16 a[68:69], v33 offset:8704
ds_read_b64_tr_b16 a[70:71], v33 offset:9792
ds_read_b64_tr_b16 a[144:145], v33 offset:32
ds_read_b64_tr_b16 a[146:147], v33 offset:1120
ds_read_b64_tr_b16 a[148:149], v33 offset:8736
ds_read_b64_tr_b16 a[150:151], v33 offset:9824
ds_read_b64_tr_b16 a[224:225], v33 offset:17408
ds_read_b64_tr_b16 a[226:227], v33 offset:18496
ds_read_b64_tr_b16 a[228:229], v33 offset:26112
ds_read_b64_tr_b16 a[230:231], v33 offset:27200
ds_read_b64_tr_b16 v[240:241], v33 offset:17440
ds_read_b64_tr_b16 v[242:243], v33 offset:18528
ds_read_b64_tr_b16 v[244:245], v33 offset:26144
ds_read_b64_tr_b16 v[246:247], v33 offset:27232
s_waitcnt lgkmcnt(0)
s_barrier
s_waitcnt vmcnt(0)
s_barrier
v_add_u32 v33, 34816, v10
ds_read_b64_tr_b16 a[72:73], v33 offset:0
ds_read_b64_tr_b16 a[74:75], v33 offset:1088
ds_read_b64_tr_b16 a[76:77], v33 offset:8704
ds_read_b64_tr_b16 a[78:79], v33 offset:9792
ds_read_b64_tr_b16 a[152:153], v33 offset:32
ds_read_b64_tr_b16 a[154:155], v33 offset:1120
ds_read_b64_tr_b16 a[156:157], v33 offset:8736
ds_read_b64_tr_b16 a[158:159], v33 offset:9824
ds_read_b64_tr_b16 a[232:233], v33 offset:17408
ds_read_b64_tr_b16 a[234:235], v33 offset:18496
ds_read_b64_tr_b16 a[236:237], v33 offset:26112
ds_read_b64_tr_b16 a[238:239], v33 offset:27200
ds_read_b64_tr_b16 v[248:249], v33 offset:17440
ds_read_b64_tr_b16 v[250:251], v33 offset:18528
ds_read_b64_tr_b16 v[252:253], v33 offset:26144
ds_read_b64_tr_b16 v[254:255], v33 offset:27232
s_waitcnt lgkmcnt(0)
s_barrier
s_cmp_lg_u32 s3, 0
s_cbranch_scc1 cl_44
v_mov_b32 v30, 192
v_mov_b32 v31, 1
s_mov_b64 exec, 1
global_atomic_add v30, v31, s[6:7]
s_mov_b64 exec, -1
cl_44:
v_mov_b32 v30, 64
sc_45:
global_load_dword v31, v30, s[6:7] sc1
s_waitcnt vmcnt(0)
v_readfirstlane_b32 s40, v31
s_cmp_ge_u32 s40, 256
s_nop 2
s_cbranch_scc1 scg_47
s_sleep 4
s_add_u32 s100, s100, 64
s_cmp_lt_u32 s100, 0x1000000
s_cbranch_scc1 sc_45
s_endpgm
scg_47:
s_cmp_lg_u32 s101, 0
s_cbranch_scc1 sco_46
v_and_b32 v30, 7, v1
v_lshlrev_b32 v30, 2, v30
global_load_dword v31, v30, s[6:7] sc1
s_waitcnt vmcnt(0)
v_cmp_ne_u32 vcc, 32, v31
s_nop 3
s_cbranch_vccz sco_46
s_mov_b32 s101, 1
s_lshr_b32 s12, s2, 5
s_and_b32 s17, s2, 31
s_barrier
s_branch L_dispatch
sco_46:
v_and_b32 v30, 15, v1
v_lshrrev_b32 v31, 4, v1
v_lshrrev_b32 v32, 2, v30
v_lshlrev_b32 v32, 4, v32
v_lshrrev_b32 v33, 1, v31
v_lshl_add_u32 v32, v33, 3, v32
v_bfe_u32 v33, v30, 1, 1
v_lshl_add_u32 v32, v33, 2, v32
v_and_b32 v33, 1, v31
v_lshl_add_u32 v32, v33, 1, v32
v_and_b32 v33, 1, v30
v_add_u32 v32, v32, v33
v_lshlrev_b32 v32, 4, v32
s_lshl_b32 s40, s3, 10
s_add_u32 s41, s40, 4096
v_add_u32 v2, s41, v32
v_lshlrev_b32 v4, 4, v1
v_add_u32 v3, s40, v4
s_cmp_lt_u32 s3, 2
s_cselect_b32 s42, 4096, 0
v_add_u32 v184, s42, v2
s_add_u32 s42, s42, 4096
v_add_u32 v185, s42, v3
v_mov_b32 v5, 0x4444
v_mov_b32 v32, 0xeeee
v_cmp_lt_u32 vcc, 7, v30
s_nop 1
v_cndmask_b32 v5, v5, v32, vcc
v_lshrrev_b32 v32, 3, v30
v_and_b32 v33, 1, v31
v_cmp_eq_u32 s[40:41], v32, v33
v_and_b32 v32, 1, v30
v_lshlrev_b32 v32, 4, v32
v_mov_b32 v33, 0x3f80
v_lshlrev_b32 v32, v32, v33
v_cndmask_b32 v32, 0, v32, s[40:41]
v_bfe_u32 v33, v30, 1, 2
v_cmp_gt_u32 s[42:43], 2, v31
v_cmp_eq_u32 vcc, 0, v33
s_nop 1
v_cndmask_b32 v34, 0, v32, vcc
v_cndmask_b32 v6, 0, v34, s[42:43]
v_cndmask_b32 v186, v34, 0, s[42:43]
v_cmp_eq_u32 vcc, 1, v33
s_nop 1
v_cndmask_b32 v34, 0, v32, vcc
v_cndmask_b32 v7, 0, v34, s[42:43]
v_cndmask_b32 v187, v34, 0, s[42:43]
v_cmp_eq_u32 vcc, 2, v33
s_nop 1
v_cndmask_b32 v34, 0, v32, vcc
v_cndmask_b32 v8, 0, v34, s[42:43]
v_cndmask_b32 v188, v34, 0, s[42:43]
v_cmp_eq_u32 vcc, 3, v33
s_nop 1
v_cndmask_b32 v34, 0, v32, vcc
v_cndmask_b32 v9, 0, v34, s[42:43]
v_cndmask_b32 v189, v34, 0, s[42:43]
v_and_b32 v30, 15, v1
v_lshlrev_b32 v30, 2, v30
s_lshl_b32 s40, s15, 7
s_add_u32 s40, s40, 46186496
v_add_u32 v29, s40, v30
v_mov_b32 v30, 21504
v_mov_b32 v32, 0
v_mov_b32 v33, 0
ds_write_b64 v30, v[32:33]
v_mov_b32 v34, 0
v_mov_b32 v35, 0
v_lshlrev_b32 v30, 4, v1
ds_write_b128 v30, v[32:35] offset:21760
s_waitcnt lgkmcnt(0)
s_barrier
s_mul_i32 s18, s15, 10240
s_sub_u32 s19, 1, s15
s_mul_i32 s19, s19, 10240
s_add_u32 s19, s19, 20480
v_and_b32 v30, 15, v1
v_lshrrev_b32 v31, 4, v1
v_lshrrev_b32 v32, 5, v1
v_lshlrev_b32 v32, 4, v32
v_add_u32 v32, v32, v30
s_lshl_b32 s40, s3, 5
v_add_u32 v32, s40, v32
v_lshlrev_b32 v32, 5, v32
v_and_b32 v33, 1, v31
v_lshl_add_u32 v32, v33, 3, v32
v_add_u32 v10, 10240, v32
v_bfe_u32 v32, v1, 2, 2
v_lshl_add_u32 v32, v31, 3, v32
v_lshlrev_b32 v32, 5, v32
v_and_b32 v33, 3, v1
v_lshl_add_u32 v32, v33, 3, v32
v_add_u32 v11, 10240, v32
s_sub_u32 s40, s3, 1
s_and_b32 s40, s40, 1
s_lshl_b32 s40, s40, 8
s_add_u32 s40, s40, 4096
v_lshlrev_b32 v32, 9, v31
v_lshl_add_u32 v32, v30, 4, v32
v_add_u32 v12, s40, v32
v_lshlrev_b32 v32, 3, v31
v_add_u32 v32, v32, v30
v_lshlrev_b32 v32, 4, v32
s_sub_u32 s40, s3, 1
s_and_b32 s40, s40, 1
s_lshl_b32 s40, s40, 3
s_lshl_b32 s41, s14, 9
s_add_u32 s40, s40, s41
s_lshl_b32 s41, s15, 13
s_add_u32 s40, s40, s41
v_add_u32 v13, s40, v32
v_and_b32 v32, 1, v31
v_lshlrev_b32 v32, 3, v32
v_lshl_add_u32 v32, v30, 4, v32
s_lshl_b32 s41, s14, 7
s_lshl_b32 s42, s15, 11
s_add_u32 s41, s41, s42
s_add_u32 s41, s41, 16384
v_add_u32 v32, s41, v32
s_cmp_eq_u32 s3, 0
s_cselect_b64 vcc, -1, 0
v_cndmask_b32 v13, v13, v32, vcc
s_lshl_b32 s40, s14, 7
s_lshl_b32 s42, s15, 11
s_add_u32 s40, s40, s42
s_add_u32 s40, s40, 16384
v_and_b32 v33, 7, v1
v_lshlrev_b32 v33, 4, v33
v_add_u32 v180, s40, v33
s_lshl_b32 s40, s14, 9
s_lshl_b32 s42, s15, 13
s_add_u32 s40, s40, s42
v_and_b32 v33, 31, v1
v_lshlrev_b32 v33, 4, v33
v_add_u32 v181, s40, v33
v_lshlrev_b32 v32, 7, v31
v_lshl_add_u32 v32, v30, 4, v32
v_subrev_u32 v23, 128, v32
v_lshlrev_b32 v32, 4, v30
v_add_u32 v25, 21760, v32
s_lshl_b32 s40, s3, 8
v_add_u32 v24, s40, v25
v_lshlrev_b32 v14, 6, v1
s_lshl_b32 s40, s15, 8
s_lshl_b32 s41, s14, 2
s_add_u32 s40, s40, s41
s_add_u32 s40, s40, 46186752
v_mov_b32 v21, s40
v_mul_u32_u24 v32, 12288, v31
v_lshl_add_u32 v32, v30, 4, v32
s_mul_i32 s40, s15, 196608
s_mul_i32 s41, s14, 768
s_add_u32 s40, s40, s41
s_mul_i32 s41, s3, 49152
s_add_u32 s40, s40, s41
v_add_u32 v15, s40, v32
s_movk_i32 s41, 256
s_cmp_lt_u32 s3, 2
s_cselect_b32 s40, 512, s41
v_add_u32 v16, s40, v15
v_mov_b32 v132, -1
v_mov_b32 v133, -1
v_mov_b32 v134, -1
v_mov_b32 v135, -1
s_cmp_eq_u32 s3, 0
s_cselect_b32 s40, -1, 0
s_mov_b32 s41, 0
v_mov_b32 v32, 0xff800000
v_cndmask_b32 v26, 0, v32, s[40:41]
v_mov_b32 v27, v26
v_mov_b32 v112, -1
v_mov_b32 v113, -1
v_mov_b32 v114, -1
v_mov_b32 v115, -1
s_cmp_eq_u32 s3, 0
s_cselect_b32 s78, s62, s60
s_cselect_b32 s79, s63, s61
s_mov_b32 s30, 0
s_sub_u32 s46, s3, 1
s_cmp_gt_u32 s46, 1
s_cbranch_scc1 nkx_50
nkx_50:
s_add_u32 s44, s30, 4294967295
s_and_b32 s44, s44, 3
s_mul_i32 s44, s44, 40960
s_add_u32 s44, s44, 44040192
s_add_u32 s45, s44, s18
s_add_u32 s36, s4, s45
s_addc_u32 s37, s5, 0
s_add_u32 s45, s44, s19
s_add_u32 s38, s4, s45
s_addc_u32 s39, s5, 0
s_and_b32 s44, s30, 3
s_mul_i32 s44, s44, 20480
s_add_u32 s44, s44, 44236800
s_add_u32 s52, s4, s44
s_addc_u32 s53, s5, 0
v_mov_b32 v96, 0
v_mov_b32 v97, 0
v_mov_b32 v98, 0
v_mov_b32 v99, 0
v_mov_b32 v100, 0
v_mov_b32 v101, 0
v_mov_b32 v102, 0
v_mov_b32 v103, 0
v_mov_b32 v104, 0
v_mov_b32 v105, 0
v_mov_b32 v106, 0
v_mov_b32 v107, 0
v_mov_b32 v108, 0
v_mov_b32 v109, 0
v_mov_b32 v110, 0
v_mov_b32 v111, 0
s_add_u32 s40, s30, 1
v_mov_b32 v22, s40
v_mov_b32 v161, s40
v_mov_b32 v163, s40
s_add_u32 s40, s30, 1
s_cmp_lg_u32 s3, 0
s_cbranch_scc1 Fo_54
s_mov_b64 exec, 0xffff
global_load_dword v31, v29, s[4:5] sc1
s_nop 15
global_load_dword v33, v29, s[4:5] sc1
s_nop 15
global_load_dword v34, v29, s[4:5] sc1
Fq_52:
s_waitcnt vmcnt(2)
v_cmp_gt_u32 vcc, s40, v31
s_nop 3
s_cbranch_vccz Fk_55
global_load_dword v31, v29, s[4:5] sc1
s_waitcnt vmcnt(2)
v_cmp_gt_u32 vcc, s40, v33
s_nop 3
s_cbranch_vccz Fk_55
global_load_dword v33, v29, s[4:5] sc1
s_waitcnt vmcnt(2)
v_cmp_gt_u32 vcc, s40, v34
s_nop 3
s_cbranch_vccz Fk_55
global_load_dword v34, v29, s[4:5] sc1
s_add_u32 s100, s100, 1
s_cmp_lt_u32 s100, 0x1000000
s_cbranch_scc1 Fq_52
s_endpgm
Fk_55:
s_mov_b64 exec, -1
Fo_54:
s_barrier
s_sleep 1
s_sleep 1
nd_56:
global_load_dwordx4 v[36:39], v2, s[36:37] offset:-4096 sc1
global_load_dwordx4 v[40:43], v2, s[36:37] offset:0 sc1
global_load_dwordx4 v[44:47], v184, s[36:37] sc1
s_sleep 1
s_sleep 1
global_load_dwordx4 v[144:147], v2, s[38:39] offset:-4096 sc1
global_load_dwordx4 v[148:151], v2, s[38:39] offset:0 sc1
global_load_dwordx4 v[152:155], v184, s[38:39] sc1
s_waitcnt vmcnt(3)
Gl_57:
v_max3_u32 v30, v36, v38, v40
v_max3_u32 v30, v30, v42, v44
v_max_u32 v30, v30, v46
v_cmp_eq_u32 vcc, -1, v30
s_nop 3
s_cbranch_vccz Glo_58
global_load_dwordx4 v[36:39], v2, s[36:37] offset:-4096 sc1
global_load_dwordx4 v[40:43], v2, s[36:37] offset:0 sc1
global_load_dwordx4 v[44:47], v184, s[36:37] sc1
s_waitcnt vmcnt(0)
s_add_u32 s100, s100, 1
s_cmp_lt_u32 s100, 0x1000000
s_cbranch_scc1 Gl_57
s_endpgm
Glo_58:
v_mfma_f32_16x16x32_bf16 v[56:59], v[36:39], v[6:9], 0
v_mfma_f32_16x16x32_bf16 v[60:63], v[36:39], v[186:189], 0
v_mfma_f32_16x16x32_bf16 v[64:67], v[40:43], v[6:9], 0
v_mfma_f32_16x16x32_bf16 v[68:71], v[40:43], v[186:189], 0
v_mfma_f32_16x16x32_bf16 v[72:75], v[44:47], v[6:9], 0
v_mfma_f32_16x16x32_bf16 v[76:79], v[44:47], v[186:189], 0
s_waitcnt vmcnt(0)
Gr_59:
v_max3_u32 v30, v144, v146, v148
v_max3_u32 v30, v30, v150, v152
v_max_u32 v30, v30, v154
v_cmp_eq_u32 vcc, -1, v30
s_nop 3
s_cbranch_vccz Gro_60
global_load_dwordx4 v[144:147], v2, s[38:39] offset:-4096 sc1
global_load_dwordx4 v[148:151], v2, s[38:39] offset:0 sc1
global_load_dwordx4 v[152:155], v184, s[38:39] sc1
s_waitcnt vmcnt(0)
s_add_u32 s100, s100, 1
s_cmp_lt_u32 s100, 0x1000000
s_cbranch_scc1 Gr_59
s_endpgm
Gro_60:
v_mfma_f32_16x16x32_bf16 v[56:59], v[144:147], v[6:9], v[56:59]
v_mfma_f32_16x16x32_bf16 v[60:63], v[144:147], v[186:189], v[60:63]
v_mfma_f32_16x16x32_bf16 v[64:67], v[148:151], v[6:9], v[64:67]
v_mfma_f32_16x16x32_bf16 v[68:71], v[148:151], v[186:189], v[68:71]
v_mfma_f32_16x16x32_bf16 v[72:75], v[152:155], v[6:9], v[72:75]
v_mfma_f32_16x16x32_bf16 v[76:79], v[152:155], v[186:189], v[76:79]
s_nop 2
v_cvt_pk_bf16_f32 v36, v56, v57
v_cvt_pk_bf16_f32 v37, v58, v59
v_cvt_pk_bf16_f32 v38, v60, v61
v_cvt_pk_bf16_f32 v39, v62, v63
ds_write_b128 v3, v[36:39] offset:0
v_cvt_pk_bf16_f32 v40, v64, v65
v_cvt_pk_bf16_f32 v41, v66, v67
v_cvt_pk_bf16_f32 v42, v68, v69
v_cvt_pk_bf16_f32 v43, v70, v71
ds_write_b128 v3, v[40:43] offset:4096
v_cvt_pk_bf16_f32 v44, v72, v73
v_cvt_pk_bf16_f32 v45, v74, v75
v_cvt_pk_bf16_f32 v46, v76, v77
v_cvt_pk_bf16_f32 v47, v78, v79
ds_write_b128 v185, v[44:47]
s_waitcnt lgkmcnt(0)
Gs_51:
s_barrier
ds_read_b128 v[56:59], v4 offset:0
ds_read_b128 v[60:63], v4 offset:1024
ds_read_b128 v[64:67], v4 offset:2048
ds_read_b128 v[68:71], v4 offset:3072
ds_read_b128 v[72:75], v4 offset:4096
ds_read_b128 v[76:79], v4 offset:5120
ds_read_b128 v[80:83], v4 offset:6144
ds_read_b128 v[84:87], v4 offset:7168
ds_read_b128 v[88:91], v4 offset:8192
ds_read_b128 v[92:95], v4 offset:9216
s_waitcnt lgkmcnt(9)
v_smfmac_f32_16x16x64_bf16 v[96:99], v[56:59], a[0:7], v5
v_smfmac_f32_16x16x64_bf16 v[100:103], v[56:59], a[80:87], v5
v_smfmac_f32_16x16x64_bf16 v[104:107], v[56:59], a[160:167], v5
v_smfmac_f32_16x16x64_bf16 v[108:111], v[56:59], a[240:247], v5
s_waitcnt lgkmcnt(8)
v_smfmac_f32_16x16x64_bf16 v[96:99], v[60:63], a[8:15], v5
v_smfmac_f32_16x16x64_bf16 v[100:103], v[60:63], a[88:95], v5
v_smfmac_f32_16x16x64_bf16 v[104:107], v[60:63], a[168:175], v5
v_smfmac_f32_16x16x64_bf16 v[108:111], v[60:63], a[248:255], v5
s_waitcnt lgkmcnt(7)
v_smfmac_f32_16x16x64_bf16 v[96:99], v[64:67], a[16:23], v5
v_smfmac_f32_16x16x64_bf16 v[100:103], v[64:67], a[96:103], v5
v_smfmac_f32_16x16x64_bf16 v[104:107], v[64:67], a[176:183], v5
v_smfmac_f32_16x16x64_bf16 v[108:111], v[64:67], v[192:199], v5
s_waitcnt lgkmcnt(6)
v_smfmac_f32_16x16x64_bf16 v[96:99], v[68:71], a[24:31], v5
v_smfmac_f32_16x16x64_bf16 v[100:103], v[68:71], a[104:111], v5
v_smfmac_f32_16x16x64_bf16 v[104:107], v[68:71], a[184:191], v5
v_smfmac_f32_16x16x64_bf16 v[108:111], v[68:71], v[200:207], v5
s_waitcnt lgkmcnt(5)
v_smfmac_f32_16x16x64_bf16 v[96:99], v[72:75], a[32:39], v5
v_smfmac_f32_16x16x64_bf16 v[100:103], v[72:75], a[112:119], v5
v_smfmac_f32_16x16x64_bf16 v[104:107], v[72:75], a[192:199], v5
v_smfmac_f32_16x16x64_bf16 v[108:111], v[72:75], v[208:215], v5
s_waitcnt lgkmcnt(0)
v_smfmac_f32_16x16x64_bf16 v[96:99], v[76:79], a[40:47], v5
v_smfmac_f32_16x16x64_bf16 v[100:103], v[76:79], a[120:127], v5
v_smfmac_f32_16x16x64_bf16 v[96:99], v[80:83], a[48:55], v5
v_smfmac_f32_16x16x64_bf16 v[100:103], v[80:83], a[128:135], v5
v_smfmac_f32_16x16x64_bf16 v[96:99], v[84:87], a[56:63], v5
v_smfmac_f32_16x16x64_bf16 v[100:103], v[84:87], a[136:143], v5
v_smfmac_f32_16x16x64_bf16 v[96:99], v[88:91], a[64:71], v5
v_smfmac_f32_16x16x64_bf16 v[100:103], v[88:91], a[144:151], v5
v_smfmac_f32_16x16x64_bf16 v[96:99], v[92:95], a[72:79], v5
v_smfmac_f32_16x16x64_bf16 v[100:103], v[92:95], a[152:159], v5
v_smfmac_f32_16x16x64_bf16 v[104:107], v[76:79], a[200:207], v5
v_smfmac_f32_16x16x64_bf16 v[108:111], v[76:79], v[216:223], v5
v_smfmac_f32_16x16x64_bf16 v[104:107], v[80:83], a[208:215], v5
v_smfmac_f32_16x16x64_bf16 v[108:111], v[80:83], v[224:231], v5
s_nop 3
v_permlane32_swap_b32 v96, v100
v_smfmac_f32_16x16x64_bf16 v[104:107], v[84:87], a[216:223], v5
v_permlane32_swap_b32 v97, v101
v_smfmac_f32_16x16x64_bf16 v[108:111], v[84:87], v[232:239], v5
v_permlane32_swap_b32 v98, v102
v_permlane32_swap_b32 v99, v103
v_smfmac_f32_16x16x64_bf16 v[104:107], v[88:91], a[224:231], v5
v_pk_add_f32 v[96:97], v[96:97], v[100:101]
v_pk_add_f32 v[98:99], v[98:99], v[102:103]
v_smfmac_f32_16x16x64_bf16 v[108:111], v[88:91], v[240:247], v5
v_cvt_pk_bf16_f32 v36, v96, v97
v_cvt_pk_bf16_f32 v37, v98, v99
v_smfmac_f32_16x16x64_bf16 v[104:107], v[92:95], a[232:239], v5
ds_write_b64 v10, v[36:37]
v_smfmac_f32_16x16x64_bf16 v[108:111], v[92:95], v[248:255], v5
s_nop 7
v_permlane32_swap_b32 v104, v108
v_permlane32_swap_b32 v105, v109
v_permlane32_swap_b32 v106, v110
v_permlane32_swap_b32 v107, v111
v_pk_add_f32 v[104:105], v[104:105], v[108:109]
v_pk_add_f32 v[106:107], v[106:107], v[110:111]
v_cvt_pk_bf16_f32 v38, v104, v105
v_cvt_pk_bf16_f32 v39, v106, v107
ds_write_b64 v10, v[38:39] offset:16
s_waitcnt lgkmcnt(0)
s_barrier
s_cmp_eq_u32 s3, 3
s_cbranch_scc1 w3_61
ds_read_b64_tr_b16 v[56:57], v11 offset:0
ds_read_b64_tr_b16 v[58:59], v11 offset:128
ds_read_b64_tr_b16 v[60:61], v11 offset:1024
ds_read_b64_tr_b16 v[62:63], v11 offset:1152
ds_read_b64_tr_b16 v[64:65], v11 offset:2048
ds_read_b64_tr_b16 v[66:67], v11 offset:2176
ds_read_b64_tr_b16 v[68:69], v11 offset:3072
ds_read_b64_tr_b16 v[70:71], v11 offset:3200
s_cmp_lg_u32 s3, 0
s_cbranch_scc1 xs_63
s_waitcnt lgkmcnt(6)
v_mfma_f32_16x16x32_bf16 v[36:39], v[56:59], v[56:59], 0
s_waitcnt lgkmcnt(4)
v_mfma_f32_16x16x32_bf16 v[36:39], v[60:63], v[60:63], v[36:39]
s_waitcnt lgkmcnt(2)
v_mfma_f32_16x16x32_bf16 v[36:39], v[64:67], v[64:67], v[36:39]
s_waitcnt lgkmcnt(0)
v_mfma_f32_16x16x32_bf16 v[36:39], v[68:71], v[68:71], v[36:39]
s_branch sm_64
xs_63:
s_add_u32 s45, s30, 0
s_min_u32 s45, s45, 63
s_lshl_b32 s46, s45, 8
s_lshr_b32 s47, s16, 1
s_add_u32 s47, s47, 16
s_lshl_b32 s47, s47, 2
s_add_u32 s46, s46, s47
s_add_u32 s46, s46, 46137344
v_mov_b32 v32, s46
vf_65:
global_load_dword v33, v32, s[4:5] sc1
s_waitcnt vmcnt(0)
v_cmp_eq_u32 vcc, 0, v33
s_nop 3
s_cbranch_vccz ok_66
s_add_u32 s100, s100, 1
s_cmp_lt_u32 s100, 0x1000000
s_cbranch_scc1 vf_65
s_endpgm
ok_66:
s_lshl_b32 s46, s30, 5
s_add_u32 s46, s46, s16
s_lshl_b32 s46, s46, 13
s_add_u32 s46, s46, 16777216
s_add_u32 s48, s4, s46
s_addc_u32 s49, s5, 0
global_load_dwordx4 v[112:115], v12, s[48:49] offset:-4096 sc1
global_load_dwordx4 v[116:119], v12, s[48:49] offset:-2048 sc1
global_load_dwordx4 v[120:123], v12, s[48:49] offset:0 sc1
global_load_dwordx4 v[124:127], v12, s[48:49] offset:2048 sc1
s_waitcnt vmcnt(0)
s_waitcnt lgkmcnt(6)
v_mfma_f32_16x16x32_bf16 v[36:39], v[112:115], v[56:59], 0
s_waitcnt lgkmcnt(4)
v_mfma_f32_16x16x32_bf16 v[36:39], v[116:119], v[60:63], v[36:39]
s_waitcnt lgkmcnt(2)
v_mfma_f32_16x16x32_bf16 v[36:39], v[120:123], v[64:67], v[36:39]
s_waitcnt lgkmcnt(0)
v_mfma_f32_16x16x32_bf16 v[36:39], v[124:127], v[68:71], v[36:39]
sm_64:
s_nop 7
v_pk_add_f32 v[36:37], v[36:37], v[26:27]
v_pk_add_f32 v[38:39], v[38:39], v[26:27]
v_max3_f32 v160, v36, v37, v38
v_max_f32 v160, v160, v39
v_mov_b32 v34, v160
s_nop 1
v_permlane16_swap_b32 v160, v34
v_max_f32 v160, v160, v34
v_mov_b32 v34, v160
s_nop 1
v_permlane32_swap_b32 v160, v34
v_max_f32 v160, v160, v34
v_pk_mul_f32 v[32:33], v[160:161], s[66:67] op_sel_hi:[0,1]
s_nop 0
v_pk_fma_f32 v[40:41], v[36:37], s[66:67], v[32:33] neg_lo:[0,0,1] neg_hi:[0,0,1]
v_pk_fma_f32 v[42:43], v[38:39], s[66:67], v[32:33] neg_lo:[0,0,1] neg_hi:[0,0,1]
v_exp_f32 v40, v40
v_exp_f32 v41, v41
v_exp_f32 v42, v42
v_exp_f32 v43, v43
s_nop 0
v_pk_add_f32 v[32:33], v[40:41], v[42:43]
v_add_f32 v162, v32, v33
v_mov_b32 v34, v162
s_nop 1
v_permlane16_swap_b32 v162, v34
v_add_f32 v162, v162, v34
v_mov_b32 v34, v162
s_nop 1
v_permlane32_swap_b32 v162, v34
v_add_f32 v162, v162, v34
ds_write_b128 v24, v[160:163]
s_waitcnt lgkmcnt(0)
s_barrier
ds_read_b128 v[44:47], v25 offset:0
ds_read_b128 v[48:51], v25 offset:256
ds_read_b128 v[52:55], v25 offset:512
s_waitcnt lgkmcnt(0)
v_max3_f32 v30, v44, v48, v52
v_mul_f32 v31, s66, v30
v_fma_f32 v44, v44, s66, -v31
v_fma_f32 v48, v48, s66, -v31
v_fma_f32 v52, v52, s66, -v31
v_fma_f32 v32, v160, s66, -v31
v_exp_f32 v44, v44
v_exp_f32 v48, v48
v_exp_f32 v52, v52
v_exp_f32 v32, v32
v_mul_f32 v34, v44, v46
v_fmac_f32 v34, v48, v50
v_fmac_f32 v34, v52, v54
v_rcp_f32 v34, v34
s_nop 0
v_mul_f32 v32, v32, v34
v_pk_mul_f32 v[40:41], v[40:41], v[32:33] op_sel_hi:[1,0]
v_pk_mul_f32 v[42:43], v[42:43], v[32:33] op_sel_hi:[1,0]
v_cvt_pk_bf16_f32 v30, v40, v41
v_cvt_pk_bf16_f32 v31, v42, v43
v_min_u32 v30, s70, v30
s_mov_b64 exec, s[78:79]
global_store_dwordx2 v13, v[30:31], s[52:53]
s_mov_b64 exec, -1
s_branch sh_67
w3_61:
s_cmp_eq_u32 s30, 0
s_cbranch_scc1 nz_69
s_waitcnt vmcnt(0)
s_add_u32 s46, s30, 4294967295
s_lshl_b32 s46, s46, 5
s_add_u32 s46, s46, s16
s_lshl_b32 s46, s46, 2
s_add_u32 s46, s46, 46170112
v_mov_b32 v30, s46
v_mov_b32 v31, 1
global_store_dword v30, v31, s[4:5] sc1
nz_69:
s_sleep 1
s_sleep 1
s_sleep 1
s_sleep 1
s_sleep 1
s_sleep 1
s_mov_b64 exec, 1
global_store_dword v21, v22, s[4:5]
s_mov_b64 exec, -1
s_barrier
s_sleep 1
s_sleep 1
s_sleep 1
s_sleep 1
s_sleep 1
s_sleep 1
ds_read_b64_tr_b16 v[56:57], v11 offset:0
ds_read_b64_tr_b16 v[58:59], v11 offset:128
ds_read_b64_tr_b16 v[60:61], v11 offset:1024
ds_read_b64_tr_b16 v[62:63], v11 offset:1152
ds_read_b64_tr_b16 v[64:65], v11 offset:2048
ds_read_b64_tr_b16 v[66:67], v11 offset:2176
ds_read_b64_tr_b16 v[68:69], v11 offset:3072
ds_read_b64_tr_b16 v[70:71], v11 offset:3200
s_lshl_b32 s46, s30, 5
s_add_u32 s46, s46, s16
s_lshl_b32 s46, s46, 11
s_add_u32 s46, s46, 33554432
s_add_u32 s56, s4, s46
s_addc_u32 s57, s5, 0
s_waitcnt lgkmcnt(0)
s_mov_b64 exec, s[72:73]
global_store_dwordx4 v23, v[56:59], s[56:57] offset:0 sc1
global_store_dwordx4 v23, v[60:63], s[56:57] offset:512 sc1
global_store_dwordx4 v23, v[64:67], s[56:57] offset:1024 sc1
global_store_dwordx4 v23, v[68:71], s[56:57] offset:1536 sc1
s_mov_b64 exec, -1
s_add_u32 s44, s30, 4294967295
s_and_b32 s44, s44, 3
s_mul_i32 s44, s44, 20480
s_add_u32 s44, s44, 44236800
s_add_u32 s58, s4, s44
s_addc_u32 s59, s5, 0
global_store_dwordx4 v180, v[112:115], s[58:59]
global_store_dwordx4 v181, v[112:115], s[58:59]
s_add_u32 s45, s30, 2
s_min_u32 s45, s45, 63
s_lshl_b32 s46, s45, 8
s_lshr_b32 s47, s16, 1
s_add_u32 s47, s47, 16
s_lshl_b32 s47, s47, 2
s_add_u32 s46, s46, s47
s_add_u32 s46, s46, 46137344
v_mov_b32 v32, s46
vf_70:
global_load_dword v33, v32, s[4:5] sc1
s_waitcnt vmcnt(0)
v_cmp_eq_u32 vcc, 0, v33
s_nop 3
s_cbranch_vccz ok_71
s_add_u32 s100, s100, 1
s_cmp_lt_u32 s100, 0x1000000
s_cbranch_scc1 vf_70
s_endpgm
ok_71:
s_add_u32 s46, s30, 0
s_lshl_b32 s46, s46, 5
s_add_u32 s46, s46, s16
s_lshl_b32 s46, s46, 2
s_add_u32 s46, s46, 46161920
v_mov_b32 v30, s46
v_mov_b32 v31, 1
global_store_dword v30, v31, s[4:5] sc1
sh_67:
s_and_b32 s44, s30, 3
s_mul_i32 s44, s44, 393216
s_add_u32 s44, s44, 44367872
s_add_u32 s54, s4, s44
s_addc_u32 s55, s5, 0
s_mul_i32 s44, s30, 393216
s_add_u32 s56, s4, s44
s_addc_u32 s57, s5, 0
s_add_u32 s56, s56, 50331648
s_addc_u32 s57, s57, 0
zc_72:
global_load_dwordx4 v[164:167], v15, s[54:55] sc1
global_load_dwordx4 v[168:171], v15, s[54:55] offset:256 sc1
global_load_dwordx4 v[172:175], v16, s[54:55] sc1
s_waitcnt vmcnt(0)
v_max3_u32 v30, v164, v166, v168
v_max3_u32 v30, v30, v170, v172
v_max_u32 v30, v30, v174
v_cmp_eq_u32 vcc, -1, v30
s_nop 3
s_cbranch_vccz ok_73
s_add_u32 s100, s100, 1
s_cmp_lt_u32 s100, 0x1000000
s_cbranch_scc1 zc_72
s_endpgm
ok_73:
global_store_dwordx4 v15, v[164:167], s[56:57] sc1
global_store_dwordx4 v15, v[168:171], s[56:57] offset:256 sc1
global_store_dwordx4 v16, v[172:175], s[56:57] sc1
s_add_u32 s44, s30, 4294967295
s_and_b32 s44, s44, 3
s_mul_i32 s44, s44, 393216
s_add_u32 s44, s44, 44367872
s_add_u32 s54, s4, s44
s_addc_u32 s55, s5, 0
global_store_dwordx4 v15, v[132:135], s[54:55]
global_store_dwordx4 v15, v[132:135], s[54:55] offset:256
global_store_dwordx4 v16, v[132:135], s[54:55]
s_add_u32 s30, s30, 1
.p2align 6
QKstep_48:
s_sub_u32 s46, s3, 1
s_cmp_gt_u32 s46, 1
s_cbranch_scc1 nkx_74
s_cmp_lg_u32 s30, 1
s_cbranch_scc1 k1_75
s_add_u32 s45, s30, 0
s_min_u32 s45, s45, 63
s_lshl_b32 s46, s45, 8
s_lshr_b32 s47, s16, 1
s_add_u32 s47, s47, 16
s_lshl_b32 s47, s47, 2
s_add_u32 s46, s46, s47
s_add_u32 s46, s46, 46137344
v_mov_b32 v32, s46
vf_76:
global_load_dword v33, v32, s[4:5] sc1
s_waitcnt vmcnt(0)
v_cmp_eq_u32 vcc, 0, v33
s_nop 3
s_cbranch_vccz ok_77
s_add_u32 s100, s100, 1
s_cmp_lt_u32 s100, 0x1000000
s_cbranch_scc1 vf_76
s_endpgm
ok_77:
k1_75:
s_lshl_b32 s46, s30, 5
s_add_u32 s46, s46, s16
s_lshl_b32 s46, s46, 13
s_add_u32 s46, s46, 16777216
s_add_u32 s48, s4, s46
s_addc_u32 s49, s5, 0
global_load_dwordx4 v[112:115], v12, s[48:49] offset:-4096 sc1
global_load_dwordx4 v[116:119], v12, s[48:49] offset:-2048 sc1
global_load_dwordx4 v[120:123], v12, s[48:49] offset:0 sc1
global_load_dwordx4 v[124:127], v12, s[48:49] offset:2048 sc1
nkx_74:
s_add_u32 s44, s30, 4294967295
s_and_b32 s44, s44, 3
s_mul_i32 s44, s44, 40960
s_add_u32 s44, s44, 44040192
s_add_u32 s45, s44, s18
s_add_u32 s36, s4, s45
s_addc_u32 s37, s5, 0
s_add_u32 s45, s44, s19
s_add_u32 s38, s4, s45
s_addc_u32 s39, s5, 0
s_and_b32 s44, s30, 3
s_mul_i32 s44, s44, 20480
s_add_u32 s44, s44, 44236800
s_add_u32 s52, s4, s44
s_addc_u32 s53, s5, 0
v_mov_b32 v96, 0
v_mov_b32 v97, 0
v_mov_b32 v98, 0
v_mov_b32 v99, 0
v_mov_b32 v100, 0
v_mov_b32 v101, 0
v_mov_b32 v102, 0
v_mov_b32 v103, 0
v_mov_b32 v104, 0
v_mov_b32 v105, 0
v_mov_b32 v106, 0
v_mov_b32 v107, 0
v_mov_b32 v108, 0
v_mov_b32 v109, 0
v_mov_b32 v110, 0
v_mov_b32 v111, 0
s_add_u32 s40, s30, 1
v_mov_b32 v22, s40
v_mov_b32 v161, s40
v_mov_b32 v163, s40
s_add_u32 s40, s30, 1
s_cmp_lg_u32 s3, 0
s_cbranch_scc1 Fo_81
s_mov_b64 exec, 0xffff
global_load_dword v31, v29, s[4:5] sc1
s_nop 15
global_load_dword v33, v29, s[4:5] sc1
s_nop 15
global_load_dword v34, v29, s[4:5] sc1
Fq_79:
s_waitcnt vmcnt(2)
v_cmp_gt_u32 vcc, s40, v31
s_nop 3
s_cbranch_vccz Fk_82
global_load_dword v31, v29, s[4:5] sc1
s_waitcnt vmcnt(2)
v_cmp_gt_u32 vcc, s40, v33
s_nop 3
s_cbranch_vccz Fk_82
global_load_dword v33, v29, s[4:5] sc1
s_waitcnt vmcnt(2)
v_cmp_gt_u32 vcc, s40, v34
s_nop 3
s_cbranch_vccz Fk_82
global_load_dword v34, v29, s[4:5] sc1
s_add_u32 s100, s100, 1
s_cmp_lt_u32 s100, 0x1000000
s_cbranch_scc1 Fq_79
s_endpgm
Fk_82:
s_mov_b64 exec, -1
Fo_81:
s_barrier
s_sleep 1
s_sleep 1
nd_83:
global_load_dwordx4 v[36:39], v2, s[36:37] offset:-4096 sc1
global_load_dwordx4 v[40:43], v2, s[36:37] offset:0 sc1
global_load_dwordx4 v[44:47], v184, s[36:37] sc1
s_sleep 1
s_sleep 1
global_load_dwordx4 v[144:147], v2, s[38:39] offset:-4096 sc1
global_load_dwordx4 v[148:151], v2, s[38:39] offset:0 sc1
global_load_dwordx4 v[152:155], v184, s[38:39] sc1
s_waitcnt vmcnt(3)
Gl_84:
v_max3_u32 v30, v36, v38, v40
v_max3_u32 v30, v30, v42, v44
v_max_u32 v30, v30, v46
v_cmp_eq_u32 vcc, -1, v30
s_nop 3
s_cbranch_vccz Glo_85
global_load_dwordx4 v[36:39], v2, s[36:37] offset:-4096 sc1
global_load_dwordx4 v[40:43], v2, s[36:37] offset:0 sc1
global_load_dwordx4 v[44:47], v184, s[36:37] sc1
s_waitcnt vmcnt(0)
s_add_u32 s100, s100, 1
s_cmp_lt_u32 s100, 0x1000000
s_cbranch_scc1 Gl_84
s_endpgm
Glo_85:
v_mfma_f32_16x16x32_bf16 v[56:59], v[36:39], v[6:9], 0
v_mfma_f32_16x16x32_bf16 v[60:63], v[36:39], v[186:189], 0
v_mfma_f32_16x16x32_bf16 v[64:67], v[40:43], v[6:9], 0
v_mfma_f32_16x16x32_bf16 v[68:71], v[40:43], v[186:189], 0
v_mfma_f32_16x16x32_bf16 v[72:75], v[44:47], v[6:9], 0
v_mfma_f32_16x16x32_bf16 v[76:79], v[44:47], v[186:189], 0
s_waitcnt vmcnt(0)
Gr_86:
v_max3_u32 v30, v144, v146, v148
v_max3_u32 v30, v30, v150, v152
v_max_u32 v30, v30, v154
v_cmp_eq_u32 vcc, -1, v30
s_nop 3
s_cbranch_vccz Gro_87
global_load_dwordx4 v[144:147], v2, s[38:39] offset:-4096 sc1
global_load_dwordx4 v[148:151], v2, s[38:39] offset:0 sc1
global_load_dwordx4 v[152:155], v184, s[38:39] sc1
s_waitcnt vmcnt(0)
s_add_u32 s100, s100, 1
s_cmp_lt_u32 s100, 0x1000000
s_cbranch_scc1 Gr_86
s_endpgm
Gro_87:
v_mfma_f32_16x16x32_bf16 v[56:59], v[144:147], v[6:9], v[56:59]
v_mfma_f32_16x16x32_bf16 v[60:63], v[144:147], v[186:189], v[60:63]
v_mfma_f32_16x16x32_bf16 v[64:67], v[148:151], v[6:9], v[64:67]
v_mfma_f32_16x16x32_bf16 v[68:71], v[148:151], v[186:189], v[68:71]
v_mfma_f32_16x16x32_bf16 v[72:75], v[152:155], v[6:9], v[72:75]
v_mfma_f32_16x16x32_bf16 v[76:79], v[152:155], v[186:189], v[76:79]
s_nop 2
v_cvt_pk_bf16_f32 v36, v56, v57
v_cvt_pk_bf16_f32 v37, v58, v59
v_cvt_pk_bf16_f32 v38, v60, v61
v_cvt_pk_bf16_f32 v39, v62, v63
ds_write_b128 v3, v[36:39] offset:0
v_cvt_pk_bf16_f32 v40, v64, v65
v_cvt_pk_bf16_f32 v41, v66, v67
v_cvt_pk_bf16_f32 v42, v68, v69
v_cvt_pk_bf16_f32 v43, v70, v71
ds_write_b128 v3, v[40:43] offset:4096
v_cvt_pk_bf16_f32 v44, v72, v73
v_cvt_pk_bf16_f32 v45, v74, v75
v_cvt_pk_bf16_f32 v46, v76, v77
v_cvt_pk_bf16_f32 v47, v78, v79
ds_write_b128 v185, v[44:47]
s_waitcnt lgkmcnt(0)
Gs_78:
s_barrier
ds_read_b128 v[56:59], v4 offset:0
ds_read_b128 v[60:63], v4 offset:1024
ds_read_b128 v[64:67], v4 offset:2048
ds_read_b128 v[68:71], v4 offset:3072
ds_read_b128 v[72:75], v4 offset:4096
ds_read_b128 v[76:79], v4 offset:5120
ds_read_b128 v[80:83], v4 offset:6144
ds_read_b128 v[84:87], v4 offset:7168
ds_read_b128 v[88:91], v4 offset:8192
ds_read_b128 v[92:95], v4 offset:9216
s_waitcnt lgkmcnt(9)
v_smfmac_f32_16x16x64_bf16 v[96:99], v[56:59], a[0:7], v5
v_smfmac_f32_16x16x64_bf16 v[100:103], v[56:59], a[80:87], v5
v_smfmac_f32_16x16x64_bf16 v[104:107], v[56:59], a[160:167], v5
v_smfmac_f32_16x16x64_bf16 v[108:111], v[56:59], a[240:247], v5
s_waitcnt lgkmcnt(8)
v_smfmac_f32_16x16x64_bf16 v[96:99], v[60:63], a[8:15], v5
v_smfmac_f32_16x16x64_bf16 v[100:103], v[60:63], a[88:95], v5
v_smfmac_f32_16x16x64_bf16 v[104:107], v[60:63], a[168:175], v5
v_smfmac_f32_16x16x64_bf16 v[108:111], v[60:63], a[248:255], v5
s_waitcnt lgkmcnt(7)
v_smfmac_f32_16x16x64_bf16 v[96:99], v[64:67], a[16:23], v5
v_smfmac_f32_16x16x64_bf16 v[100:103], v[64:67], a[96:103], v5
v_smfmac_f32_16x16x64_bf16 v[104:107], v[64:67], a[176:183], v5
v_smfmac_f32_16x16x64_bf16 v[108:111], v[64:67], v[192:199], v5
s_waitcnt lgkmcnt(6)
v_smfmac_f32_16x16x64_bf16 v[96:99], v[68:71], a[24:31], v5
v_smfmac_f32_16x16x64_bf16 v[100:103], v[68:71], a[104:111], v5
v_smfmac_f32_16x16x64_bf16 v[104:107], v[68:71], a[184:191], v5
v_smfmac_f32_16x16x64_bf16 v[108:111], v[68:71], v[200:207], v5
s_waitcnt lgkmcnt(5)
v_smfmac_f32_16x16x64_bf16 v[96:99], v[72:75], a[32:39], v5
v_smfmac_f32_16x16x64_bf16 v[100:103], v[72:75], a[112:119], v5
v_smfmac_f32_16x16x64_bf16 v[104:107], v[72:75], a[192:199], v5
v_smfmac_f32_16x16x64_bf16 v[108:111], v[72:75], v[208:215], v5
s_waitcnt lgkmcnt(0)
v_smfmac_f32_16x16x64_bf16 v[96:99], v[76:79], a[40:47], v5
v_smfmac_f32_16x16x64_bf16 v[100:103], v[76:79], a[120:127], v5
v_smfmac_f32_16x16x64_bf16 v[96:99], v[80:83], a[48:55], v5
v_smfmac_f32_16x16x64_bf16 v[100:103], v[80:83], a[128:135], v5
v_smfmac_f32_16x16x64_bf16 v[96:99], v[84:87], a[56:63], v5
v_smfmac_f32_16x16x64_bf16 v[100:103], v[84:87], a[136:143], v5
v_smfmac_f32_16x16x64_bf16 v[96:99], v[88:91], a[64:71], v5
v_smfmac_f32_16x16x64_bf16 v[100:103], v[88:91], a[144:151], v5
v_smfmac_f32_16x16x64_bf16 v[96:99], v[92:95], a[72:79], v5
v_smfmac_f32_16x16x64_bf16 v[100:103], v[92:95], a[152:159], v5
v_smfmac_f32_16x16x64_bf16 v[104:107], v[76:79], a[200:207], v5
v_smfmac_f32_16x16x64_bf16 v[108:111], v[76:79], v[216:223], v5
v_smfmac_f32_16x16x64_bf16 v[104:107], v[80:83], a[208:215], v5
v_smfmac_f32_16x16x64_bf16 v[108:111], v[80:83], v[224:231], v5
s_nop 3
v_permlane32_swap_b32 v96, v100
v_smfmac_f32_16x16x64_bf16 v[104:107], v[84:87], a[216:223], v5
v_permlane32_swap_b32 v97, v101
v_smfmac_f32_16x16x64_bf16 v[108:111], v[84:87], v[232:239], v5
v_permlane32_swap_b32 v98, v102
v_permlane32_swap_b32 v99, v103
v_smfmac_f32_16x16x64_bf16 v[104:107], v[88:91], a[224:231], v5
v_pk_add_f32 v[96:97], v[96:97], v[100:101]
v_pk_add_f32 v[98:99], v[98:99], v[102:103]
v_smfmac_f32_16x16x64_bf16 v[108:111], v[88:91], v[240:247], v5
v_cvt_pk_bf16_f32 v36, v96, v97
v_cvt_pk_bf16_f32 v37, v98, v99
v_smfmac_f32_16x16x64_bf16 v[104:107], v[92:95], a[232:239], v5
ds_write_b64 v10, v[36:37]
v_smfmac_f32_16x16x64_bf16 v[108:111], v[92:95], v[248:255], v5
s_nop 7
v_permlane32_swap_b32 v104, v108
v_permlane32_swap_b32 v105, v109
v_permlane32_swap_b32 v106, v110
v_permlane32_swap_b32 v107, v111
v_pk_add_f32 v[104:105], v[104:105], v[108:109]
v_pk_add_f32 v[106:107], v[106:107], v[110:111]
v_cvt_pk_bf16_f32 v38, v104, v105
v_cvt_pk_bf16_f32 v39, v106, v107
ds_write_b64 v10, v[38:39] offset:16
s_waitcnt lgkmcnt(0)
s_barrier
s_cmp_eq_u32 s30, 63
s_cbranch_scc1 QKlast_49
s_cmp_eq_u32 s3, 3
s_cbranch_scc1 w3_88
ds_read_b64_tr_b16 v[56:57], v11 offset:0
ds_read_b64_tr_b16 v[58:59], v11 offset:128
ds_read_b64_tr_b16 v[60:61], v11 offset:1024
ds_read_b64_tr_b16 v[62:63], v11 offset:1152
ds_read_b64_tr_b16 v[64:65], v11 offset:2048
ds_read_b64_tr_b16 v[66:67], v11 offset:2176
ds_read_b64_tr_b16 v[68:69], v11 offset:3072
ds_read_b64_tr_b16 v[70:71], v11 offset:3200
s_cmp_lg_u32 s3, 0
s_cbranch_scc1 xs_90
s_waitcnt lgkmcnt(6)
v_mfma_f32_16x16x32_bf16 v[36:39], v[56:59], v[56:59], 0
s_waitcnt lgkmcnt(4)
v_mfma_f32_16x16x32_bf16 v[36:39], v[60:63], v[60:63], v[36:39]
s_waitcnt lgkmcnt(2)
v_mfma_f32_16x16x32_bf16 v[36:39], v[64:67], v[64:67], v[36:39]
s_waitcnt lgkmcnt(0)
v_mfma_f32_16x16x32_bf16 v[36:39], v[68:71], v[68:71], v[36:39]
s_branch sm_91
xs_90:
s_waitcnt lgkmcnt(6)
s_nop 3
v_mfma_f32_16x16x32_bf16 v[36:39], v[112:115], v[56:59], 0
s_waitcnt lgkmcnt(4)
v_mfma_f32_16x16x32_bf16 v[36:39], v[116:119], v[60:63], v[36:39]
s_waitcnt lgkmcnt(2)
v_mfma_f32_16x16x32_bf16 v[36:39], v[120:123], v[64:67], v[36:39]
s_waitcnt lgkmcnt(0)
v_mfma_f32_16x16x32_bf16 v[36:39], v[124:127], v[68:71], v[36:39]
sm_91:
s_nop 7
v_pk_add_f32 v[36:37], v[36:37], v[26:27]
v_pk_add_f32 v[38:39], v[38:39], v[26:27]
v_max3_f32 v160, v36, v37, v38
v_max_f32 v160, v160, v39
v_mov_b32 v34, v160
s_nop 1
v_permlane16_swap_b32 v160, v34
v_max_f32 v160, v160, v34
v_mov_b32 v34, v160
s_nop 1
v_permlane32_swap_b32 v160, v34
v_max_f32 v160, v160, v34
v_pk_mul_f32 v[32:33], v[160:161], s[66:67] op_sel_hi:[0,1]
s_nop 0
v_pk_fma_f32 v[40:41], v[36:37], s[66:67], v[32:33] neg_lo:[0,0,1] neg_hi:[0,0,1]
v_pk_fma_f32 v[42:43], v[38:39], s[66:67], v[32:33] neg_lo:[0,0,1] neg_hi:[0,0,1]
v_exp_f32 v40, v40
v_exp_f32 v41, v41
v_exp_f32 v42, v42
v_exp_f32 v43, v43
s_nop 0
v_pk_add_f32 v[32:33], v[40:41], v[42:43]
v_add_f32 v162, v32, v33
v_mov_b32 v34, v162
s_nop 1
v_permlane16_swap_b32 v162, v34
v_add_f32 v162, v162, v34
v_mov_b32 v34, v162
s_nop 1
v_permlane32_swap_b32 v162, v34
v_add_f32 v162, v162, v34
ds_write_b128 v24, v[160:163]
s_waitcnt lgkmcnt(0)
s_barrier
ds_read_b128 v[44:47], v25 offset:0
ds_read_b128 v[48:51], v25 offset:256
ds_read_b128 v[52:55], v25 offset:512
s_waitcnt lgkmcnt(0)
v_max3_f32 v30, v44, v48, v52
v_mul_f32 v31, s66, v30
v_fma_f32 v44, v44, s66, -v31
v_fma_f32 v48, v48, s66, -v31
v_fma_f32 v52, v52, s66, -v31
v_fma_f32 v32, v160, s66, -v31
v_exp_f32 v44, v44
v_exp_f32 v48, v48
v_exp_f32 v52, v52
v_exp_f32 v32, v32
v_mul_f32 v34, v44, v46
v_fmac_f32 v34, v48, v50
v_fmac_f32 v34, v52, v54
v_rcp_f32 v34, v34
s_nop 0
v_mul_f32 v32, v32, v34
v_pk_mul_f32 v[40:41], v[40:41], v[32:33] op_sel_hi:[1,0]
v_pk_mul_f32 v[42:43], v[42:43], v[32:33] op_sel_hi:[1,0]
v_cvt_pk_bf16_f32 v30, v40, v41
v_cvt_pk_bf16_f32 v31, v42, v43
v_min_u32 v30, s70, v30
s_mov_b64 exec, s[78:79]
global_store_dwordx2 v13, v[30:31], s[52:53]
s_mov_b64 exec, -1
s_branch sh_92
w3_88:
s_cmp_eq_u32 s30, 0
s_cbranch_scc1 nz_94
s_waitcnt vmcnt(0)
s_add_u32 s46, s30, 4294967295
s_lshl_b32 s46, s46, 5
s_add_u32 s46, s46, s16
s_lshl_b32 s46, s46, 2
s_add_u32 s46, s46, 46170112
v_mov_b32 v30, s46
v_mov_b32 v31, 1
global_store_dword v30, v31, s[4:5] sc1
nz_94:
s_sleep 1
s_sleep 1
s_sleep 1
s_sleep 1
s_sleep 1
s_sleep 1
s_mov_b64 exec, 1
global_store_dword v21, v22, s[4:5]
s_mov_b64 exec, -1
s_barrier
s_sleep 1
s_sleep 1
s_sleep 1
s_sleep 1
s_sleep 1
s_sleep 1
ds_read_b64_tr_b16 v[56:57], v11 offset:0
ds_read_b64_tr_b16 v[58:59], v11 offset:128
ds_read_b64_tr_b16 v[60:61], v11 offset:1024
ds_read_b64_tr_b16 v[62:63], v11 offset:1152
ds_read_b64_tr_b16 v[64:65], v11 offset:2048
ds_read_b64_tr_b16 v[66:67], v11 offset:2176
ds_read_b64_tr_b16 v[68:69], v11 offset:3072
ds_read_b64_tr_b16 v[70:71], v11 offset:3200
s_lshl_b32 s46, s30, 5
s_add_u32 s46, s46, s16
s_lshl_b32 s46, s46, 11
s_add_u32 s46, s46, 33554432
s_add_u32 s56, s4, s46
s_addc_u32 s57, s5, 0
s_waitcnt lgkmcnt(0)
s_mov_b64 exec, s[72:73]
global_store_dwordx4 v23, v[56:59], s[56:57] offset:0 sc1
global_store_dwordx4 v23, v[60:63], s[56:57] offset:512 sc1
global_store_dwordx4 v23, v[64:67], s[56:57] offset:1024 sc1
global_store_dwordx4 v23, v[68:71], s[56:57] offset:1536 sc1
s_mov_b64 exec, -1
s_add_u32 s44, s30, 4294967295
s_and_b32 s44, s44, 3
s_mul_i32 s44, s44, 20480
s_add_u32 s44, s44, 44236800
s_add_u32 s58, s4, s44
s_addc_u32 s59, s5, 0
global_store_dwordx4 v180, v[112:115], s[58:59]
global_store_dwordx4 v181, v[112:115], s[58:59]
s_add_u32 s45, s30, 2
s_min_u32 s45, s45, 63
s_lshl_b32 s46, s45, 8
s_lshr_b32 s47, s16, 1
s_add_u32 s47, s47, 16
s_lshl_b32 s47, s47, 2
s_add_u32 s46, s46, s47
s_add_u32 s46, s46, 46137344
v_mov_b32 v32, s46
vf_95:
global_load_dword v33, v32, s[4:5] sc1
s_waitcnt vmcnt(0)
v_cmp_eq_u32 vcc, 0, v33
s_nop 3
s_cbranch_vccz ok_96
s_add_u32 s100, s100, 1
s_cmp_lt_u32 s100, 0x1000000
s_cbranch_scc1 vf_95
s_endpgm
ok_96:
s_add_u32 s46, s30, 0
s_lshl_b32 s46, s46, 5
s_add_u32 s46, s46, s16
s_lshl_b32 s46, s46, 2
s_add_u32 s46, s46, 46161920
v_mov_b32 v30, s46
v_mov_b32 v31, 1
global_store_dword v30, v31, s[4:5] sc1
sh_92:
s_and_b32 s44, s30, 3
s_mul_i32 s44, s44, 393216
s_add_u32 s44, s44, 44367872
s_add_u32 s54, s4, s44
s_addc_u32 s55, s5, 0
s_mul_i32 s44, s30, 393216
s_add_u32 s56, s4, s44
s_addc_u32 s57, s5, 0
s_add_u32 s56, s56, 50331648
s_addc_u32 s57, s57, 0
zc_97:
global_load_dwordx4 v[164:167], v15, s[54:55] sc1
global_load_dwordx4 v[168:171], v15, s[54:55] offset:256 sc1
global_load_dwordx4 v[172:175], v16, s[54:55] sc1
s_waitcnt vmcnt(0)
v_max3_u32 v30, v164, v166, v168
v_max3_u32 v30, v30, v170, v172
v_max_u32 v30, v30, v174
v_cmp_eq_u32 vcc, -1, v30
s_nop 3
s_cbranch_vccz ok_98
s_add_u32 s100, s100, 1
s_cmp_lt_u32 s100, 0x1000000
s_cbranch_scc1 zc_97
s_endpgm
ok_98:
global_store_dwordx4 v15, v[164:167], s[56:57] sc1
global_store_dwordx4 v15, v[168:171], s[56:57] offset:256 sc1
global_store_dwordx4 v16, v[172:175], s[56:57] sc1
s_add_u32 s44, s30, 4294967295
s_and_b32 s44, s44, 3
s_mul_i32 s44, s44, 393216
s_add_u32 s44, s44, 44367872
s_add_u32 s54, s4, s44
s_addc_u32 s55, s5, 0
global_store_dwordx4 v15, v[132:135], s[54:55]
global_store_dwordx4 v15, v[132:135], s[54:55] offset:256
global_store_dwordx4 v16, v[132:135], s[54:55]
s_add_u32 s30, s30, 1
s_branch QKstep_48
QKlast_49:
s_cmp_lg_u32 s3, 3
s_cbranch_scc1 d_99
s_waitcnt vmcnt(0)
s_add_u32 s46, s30, 4294967295
s_lshl_b32 s46, s46, 5
s_add_u32 s46, s46, s16
s_lshl_b32 s46, s46, 2
s_add_u32 s46, s46, 46170112
v_mov_b32 v30, s46
v_mov_b32 v31, 1
global_store_dword v30, v31, s[4:5] sc1
ds_read_b64_tr_b16 v[56:57], v11 offset:0
ds_read_b64_tr_b16 v[58:59], v11 offset:128
ds_read_b64_tr_b16 v[60:61], v11 offset:1024
ds_read_b64_tr_b16 v[62:63], v11 offset:1152
ds_read_b64_tr_b16 v[64:65], v11 offset:2048
ds_read_b64_tr_b16 v[66:67], v11 offset:2176
ds_read_b64_tr_b16 v[68:69], v11 offset:3072
ds_read_b64_tr_b16 v[70:71], v11 offset:3200
s_lshl_b32 s46, s30, 5
s_add_u32 s46, s46, s16
s_lshl_b32 s46, s46, 11
s_add_u32 s46, s46, 33554432
s_add_u32 s56, s4, s46
s_addc_u32 s57, s5, 0
s_waitcnt lgkmcnt(0)
s_mov_b64 exec, s[72:73]
global_store_dwordx4 v23, v[56:59], s[56:57] offset:0 sc1
global_store_dwordx4 v23, v[60:63], s[56:57] offset:512 sc1
global_store_dwordx4 v23, v[64:67], s[56:57] offset:1024 sc1
global_store_dwordx4 v23, v[68:71], s[56:57] offset:1536 sc1
s_mov_b64 exec, -1
s_waitcnt vmcnt(0)
s_add_u32 s46, s30, 0
s_lshl_b32 s46, s46, 5
s_add_u32 s46, s46, s16
s_lshl_b32 s46, s46, 2
s_add_u32 s46, s46, 46161920
v_mov_b32 v30, s46
v_mov_b32 v31, 1
global_store_dword v30, v31, s[4:5] sc1
d_99:
s_and_b32 s44, s30, 3
s_mul_i32 s44, s44, 393216
s_add_u32 s44, s44, 44367872
s_add_u32 s54, s4, s44
s_addc_u32 s55, s5, 0
s_mul_i32 s44, s30, 393216
s_add_u32 s56, s4, s44
s_addc_u32 s57, s5, 0
s_add_u32 s56, s56, 50331648
s_addc_u32 s57, s57, 0
zc_101:
global_load_dwordx4 v[164:167], v15, s[54:55] sc1
global_load_dwordx4 v[168:171], v15, s[54:55] offset:256 sc1
global_load_dwordx4 v[172:175], v16, s[54:55] sc1
s_waitcnt vmcnt(0)
v_max3_u32 v30, v164, v166, v168
v_max3_u32 v30, v30, v170, v172
v_max_u32 v30, v30, v174
v_cmp_eq_u32 vcc, -1, v30
s_nop 3
s_cbranch_vccz ok_102
s_add_u32 s100, s100, 1
s_cmp_lt_u32 s100, 0x1000000
s_cbranch_scc1 zc_101
s_endpgm
ok_102:
global_store_dwordx4 v15, v[164:167], s[56:57] sc1
global_store_dwordx4 v15, v[168:171], s[56:57] offset:256 sc1
global_store_dwordx4 v16, v[172:175], s[56:57] sc1
s_waitcnt vmcnt(0)
s_barrier
s_cmp_lg_u32 s3, 3
s_cbranch_scc1 d2_100
s_add_u32 s46, s30, 0
s_lshl_b32 s46, s46, 5
s_add_u32 s46, s46, s16
s_lshl_b32 s46, s46, 2
s_add_u32 s46, s46, 46170112
v_mov_b32 v30, s46
v_mov_b32 v31, 1
global_store_dword v30, v31, s[4:5] sc1
d2_100:
s_waitcnt vmcnt(0)
s_endpgm
L_vo:
s_mov_b32 s60, 0x00ff00ff
s_mov_b32 s61, 0x00ff00ff
s_mov_b32 s62, 0
s_mov_b32 s63, 0x00ff00ff
s_mov_b32 s64, -1
s_mov_b32 s65, 0
s_mov_b32 s72, 0xff00ff00
s_mov_b32 s73, 0xff00ff00
s_mov_b32 s66, 0x3e0293ee
s_mov_b32 s67, 0x3e0293ee
s_mov_b32 s70, 0xfffffffe
s_load_dwordx2 s[8:9], s[0:1], 104
s_load_dwordx2 s[10:11], s[0:1], 112
s_waitcnt lgkmcnt(0)
s_lshl_b32 s40, s3, 18
s_lshl_b32 s41, s16, 8
s_add_u32 s40, s40, s41
s_add_u32 s8, s8, s40
s_addc_u32 s9, s9, 0
s_mul_i32 s40, s16, 163840
s_mul_i32 s41, s3, 40960
s_add_u32 s40, s40, s41
s_add_u32 s10, s10, s40
s_addc_u32 s11, s11, 0
v_lshrrev_b32 v30, 4, v1
v_mul_u32_u24 v10, 2176, v30
v_bfe_u32 v30, v1, 2, 2
v_lshl_add_u32 v10, v30, 8, v10
v_and_b32 v30, 3, v1
v_lshl_add_u32 v10, v30, 3, v10
s_lshl_b32 s40, s3, 6
v_add_u32 v10, s40, v10
s_add_u32 s40, s8, 0
s_addc_u32 s41, s9, 0
s_mov_b32 s43, 32768
v_lshrrev_b32 v34, 4, v1
v_lshlrev_b32 v34, 13, v34
v_and_b32 v35, 15, v1
v_lshl_add_u32 v34, v35, 4, v34
s_mul_i32 s44, s3, 8704
s_add_u32 s44, s44, 0
v_mov_b32 v35, v34
s_add_u32 m0, s44, 0
s_nop 0
global_load_lds_dwordx4 v35, s[40:41]
v_add_u32 v35, s43, v35
s_add_u32 m0, s44, 1088
s_nop 0
global_load_lds_dwordx4 v35, s[40:41]
v_add_u32 v35, s43, v35
s_add_u32 m0, s44, 2176
s_nop 0
global_load_lds_dwordx4 v35, s[40:41]
v_add_u32 v35, s43, v35
s_add_u32 m0, s44, 3264
s_nop 0
global_load_lds_dwordx4 v35, s[40:41]
v_add_u32 v35, s43, v35
s_add_u32 m0, s44, 4352
s_nop 0
global_load_lds_dwordx4 v35, s[40:41]
v_add_u32 v35, s43, v35
s_add_u32 m0, s44, 5440
s_nop 0
global_load_lds_dwordx4 v35, s[40:41]
v_add_u32 v35, s43, v35
s_add_u32 m0, s44, 6528
s_nop 0
global_load_lds_dwordx4 v35, s[40:41]
v_add_u32 v35, s43, v35
s_add_u32 m0, s44, 7616
s_nop 0
global_load_lds_dwordx4 v35, s[40:41]
s_add_u32 s40, s8, 1048576
s_addc_u32 s41, s9, 0
s_mov_b32 s43, 32768
v_lshrrev_b32 v34, 4, v1
v_lshlrev_b32 v34, 13, v34
v_and_b32 v35, 15, v1
v_lshl_add_u32 v34, v35, 4, v34
s_mul_i32 s44, s3, 8704
s_add_u32 s44, s44, 34816
v_mov_b32 v35, v34
s_add_u32 m0, s44, 0
s_nop 0
global_load_lds_dwordx4 v35, s[40:41]
v_add_u32 v35, s43, v35
s_add_u32 m0, s44, 1088
s_nop 0
global_load_lds_dwordx4 v35, s[40:41]
v_add_u32 v35, s43, v35
s_add_u32 m0, s44, 2176
s_nop 0
global_load_lds_dwordx4 v35, s[40:41]
v_add_u32 v35, s43, v35
s_add_u32 m0, s44, 3264
s_nop 0
global_load_lds_dwordx4 v35, s[40:41]
v_add_u32 v35, s43, v35
s_add_u32 m0, s44, 4352
s_nop 0
global_load_lds_dwordx4 v35, s[40:41]
v_add_u32 v35, s43, v35
s_add_u32 m0, s44, 5440
s_nop 0
global_load_lds_dwordx4 v35, s[40:41]
v_add_u32 v35, s43, v35
s_add_u32 m0, s44, 6528
s_nop 0
global_load_lds_dwordx4 v35, s[40:41]
v_add_u32 v35, s43, v35
s_add_u32 m0, s44, 7616
s_nop 0
global_load_lds_dwordx4 v35, s[40:41]
s_add_u32 s40, s8, 2097152
s_addc_u32 s41, s9, 0
s_mov_b32 s43, 32768
v_lshrrev_b32 v34, 4, v1
v_lshlrev_b32 v34, 13, v34
v_and_b32 v35, 15, v1
v_lshl_add_u32 v34, v35, 4, v34
s_mul_i32 s44, s3, 8704
s_add_u32 s44, s44, 69632
v_mov_b32 v35, v34
s_add_u32 m0, s44, 0
s_nop 0
global_load_lds_dwordx4 v35, s[40:41]
v_add_u32 v35, s43, v35
s_add_u32 m0, s44, 1088
s_nop 0
global_load_lds_dwordx4 v35, s[40:41]
v_add_u32 v35, s43, v35
s_add_u32 m0, s44, 2176
s_nop 0
global_load_lds_dwordx4 v35, s[40:41]
v_add_u32 v35, s43, v35
s_add_u32 m0, s44, 3264
s_nop 0
global_load_lds_dwordx4 v35, s[40:41]
v_add_u32 v35, s43, v35
s_add_u32 m0, s44, 4352
s_nop 0
global_load_lds_dwordx4 v35, s[40:41]
v_add_u32 v35, s43, v35
s_add_u32 m0, s44, 5440
s_nop 0
global_load_lds_dwordx4 v35, s[40:41]
v_add_u32 v35, s43, v35
s_add_u32 m0, s44, 6528
s_nop 0
global_load_lds_dwordx4 v35, s[40:41]
v_add_u32 v35, s43, v35
s_add_u32 m0, s44, 7616
s_nop 0
global_load_lds_dwordx4 v35, s[40:41]
s_add_u32 s40, s8, 3145728
s_addc_u32 s41, s9, 0
s_mov_b32 s43, 32768
v_lshrrev_b32 v34, 4, v1
v_lshlrev_b32 v34, 13, v34
v_and_b32 v35, 15, v1
v_lshl_add_u32 v34, v35, 4, v34
s_mul_i32 s44, s3, 8704
s_add_u32 s44, s44, 104448
v_mov_b32 v35, v34
s_add_u32 m0, s44, 0
s_nop 0
global_load_lds_dwordx4 v35, s[40:41]
v_add_u32 v35, s43, v35
s_add_u32 m0, s44, 1088
s_nop 0
global_load_lds_dwordx4 v35, s[40:41]
v_add_u32 v35, s43, v35
s_add_u32 m0, s44, 2176
s_nop 0
global_load_lds_dwordx4 v35, s[40:41]
v_add_u32 v35, s43, v35
s_add_u32 m0, s44, 3264
s_nop 0
global_load_lds_dwordx4 v35, s[40:41]
v_add_u32 v35, s43, v35
s_add_u32 m0, s44, 4352
s_nop 0
global_load_lds_dwordx4 v35, s[40:41]
v_add_u32 v35, s43, v35
s_add_u32 m0, s44, 5440
s_nop 0
global_load_lds_dwordx4 v35, s[40:41]
v_add_u32 v35, s43, v35
s_add_u32 m0, s44, 6528
s_nop 0
global_load_lds_dwordx4 v35, s[40:41]
v_add_u32 v35, s43, v35
s_add_u32 m0, s44, 7616
s_nop 0
global_load_lds_dwordx4 v35, s[40:41]
s_cmp_lg_u32 s101, 0
s_cbranch_scc1 arr_103
s_cmp_lg_u32 s99, 0
s_cbranch_scc1 arr_103
s_waitcnt vmcnt(32)
s_barrier
s_cmp_lg_u32 s3, 0
s_cbranch_scc1 arr_103
v_mov_b32 v30, 64
v_mov_b32 v31, 1
s_mov_b64 exec, 1
global_atomic_add v30, v31, s[6:7]
s_mov_b64 exec, -1
arr_103:
s_waitcnt vmcnt(24)
s_barrier
v_add_u32 v33, 0, v10
ds_read_b64_tr_b16 a[0:1], v33 offset:0
ds_read_b64_tr_b16 a[2:3], v33 offset:1088
ds_read_b64_tr_b16 a[4:5], v33 offset:8704
ds_read_b64_tr_b16 a[6:7], v33 offset:9792
ds_read_b64_tr_b16 a[80:81], v33 offset:32
ds_read_b64_tr_b16 a[82:83], v33 offset:1120
ds_read_b64_tr_b16 a[84:85], v33 offset:8736
ds_read_b64_tr_b16 a[86:87], v33 offset:9824
ds_read_b64_tr_b16 a[8:9], v33 offset:17408
ds_read_b64_tr_b16 a[10:11], v33 offset:18496
ds_read_b64_tr_b16 a[12:13], v33 offset:26112
ds_read_b64_tr_b16 a[14:15], v33 offset:27200
ds_read_b64_tr_b16 a[88:89], v33 offset:17440
ds_read_b64_tr_b16 a[90:91], v33 offset:18528
ds_read_b64_tr_b16 a[92:93], v33 offset:26144
ds_read_b64_tr_b16 a[94:95], v33 offset:27232
s_waitcnt lgkmcnt(0)
s_barrier
s_add_u32 s40, s8, 4194304
s_addc_u32 s41, s9, 0
s_mov_b32 s43, 32768
v_lshrrev_b32 v34, 4, v1
v_lshlrev_b32 v34, 13, v34
v_and_b32 v35, 15, v1
v_lshl_add_u32 v34, v35, 4, v34
s_mul_i32 s44, s3, 8704
s_add_u32 s44, s44, 0
v_mov_b32 v35, v34
s_add_u32 m0, s44, 0
s_nop 0
global_load_lds_dwordx4 v35, s[40:41]
v_add_u32 v35, s43, v35
s_add_u32 m0, s44, 1088
s_nop 0
global_load_lds_dwordx4 v35, s[40:41]
v_add_u32 v35, s43, v35
s_add_u32 m0, s44, 2176
s_nop 0
global_load_lds_dwordx4 v35, s[40:41]
v_add_u32 v35, s43, v35
s_add_u32 m0, s44, 3264
s_nop 0
global_load_lds_dwordx4 v35, s[40:41]
v_add_u32 v35, s43, v35
s_add_u32 m0, s44, 4352
s_nop 0
global_load_lds_dwordx4 v35, s[40:41]
v_add_u32 v35, s43, v35
s_add_u32 m0, s44, 5440
s_nop 0
global_load_lds_dwordx4 v35, s[40:41]
v_add_u32 v35, s43, v35
s_add_u32 m0, s44, 6528
s_nop 0
global_load_lds_dwordx4 v35, s[40:41]
v_add_u32 v35, s43, v35
s_add_u32 m0, s44, 7616
s_nop 0
global_load_lds_dwordx4 v35, s[40:41]
s_waitcnt vmcnt(24)
s_barrier
v_add_u32 v33, 34816, v10
ds_read_b64_tr_b16 a[16:17], v33 offset:0
ds_read_b64_tr_b16 a[18:19], v33 offset:1088
ds_read_b64_tr_b16 a[20:21], v33 offset:8704
ds_read_b64_tr_b16 a[22:23], v33 offset:9792
ds_read_b64_tr_b16 a[96:97], v33 offset:32
ds_read_b64_tr_b16 a[98:99], v33 offset:1120
ds_read_b64_tr_b16 a[100:101], v33 offset:8736
ds_read_b64_tr_b16 a[102:103], v33 offset:9824
ds_read_b64_tr_b16 a[24:25], v33 offset:17408
ds_read_b64_tr_b16 a[26:27], v33 offset:18496
ds_read_b64_tr_b16 a[28:29], v33 offset:26112
ds_read_b64_tr_b16 a[30:31], v33 offset:27200
ds_read_b64_tr_b16 a[104:105], v33 offset:17440
ds_read_b64_tr_b16 a[106:107], v33 offset:18528
ds_read_b64_tr_b16 a[108:109], v33 offset:26144
ds_read_b64_tr_b16 a[110:111], v33 offset:27232
s_waitcnt lgkmcnt(0)
s_barrier
s_add_u32 s40, s10, 0
s_addc_u32 s41, s11, 0
s_mov_b32 s43, 5120
v_lshrrev_b32 v34, 4, v1
v_mul_u32_u24 v34, 1280, v34
v_and_b32 v35, 15, v1
v_lshl_add_u32 v34, v35, 4, v34
s_mul_i32 s44, s3, 8704
s_add_u32 s44, s44, 34816
v_mov_b32 v35, v34
s_add_u32 m0, s44, 0
s_nop 0
global_load_lds_dwordx4 v35, s[40:41]
v_add_u32 v35, s43, v35
s_add_u32 m0, s44, 1088
s_nop 0
global_load_lds_dwordx4 v35, s[40:41]
v_add_u32 v35, s43, v35
s_add_u32 m0, s44, 2176
s_nop 0
global_load_lds_dwordx4 v35, s[40:41]
v_add_u32 v35, s43, v35
s_add_u32 m0, s44, 3264
s_nop 0
global_load_lds_dwordx4 v35, s[40:41]
v_add_u32 v35, s43, v35
s_add_u32 m0, s44, 4352
s_nop 0
global_load_lds_dwordx4 v35, s[40:41]
v_add_u32 v35, s43, v35
s_add_u32 m0, s44, 5440
s_nop 0
global_load_lds_dwordx4 v35, s[40:41]
v_add_u32 v35, s43, v35
s_add_u32 m0, s44, 6528
s_nop 0
global_load_lds_dwordx4 v35, s[40:41]
v_add_u32 v35, s43, v35
s_add_u32 m0, s44, 7616
s_nop 0
global_load_lds_dwordx4 v35, s[40:41]
s_waitcnt vmcnt(24)
s_barrier
v_add_u32 v33, 69632, v10
ds_read_b64_tr_b16 a[32:33], v33 offset:0
ds_read_b64_tr_b16 a[34:35], v33 offset:1088
ds_read_b64_tr_b16 a[36:37], v33 offset:8704
ds_read_b64_tr_b16 a[38:39], v33 offset:9792
ds_read_b64_tr_b16 a[112:113], v33 offset:32
ds_read_b64_tr_b16 a[114:115], v33 offset:1120
ds_read_b64_tr_b16 a[116:117], v33 offset:8736
ds_read_b64_tr_b16 a[118:119], v33 offset:9824
ds_read_b64_tr_b16 a[40:41], v33 offset:17408
ds_read_b64_tr_b16 a[42:43], v33 offset:18496
ds_read_b64_tr_b16 a[44:45], v33 offset:26112
ds_read_b64_tr_b16 a[46:47], v33 offset:27200
ds_read_b64_tr_b16 a[120:121], v33 offset:17440
ds_read_b64_tr_b16 a[122:123], v33 offset:18528
ds_read_b64_tr_b16 a[124:125], v33 offset:26144
ds_read_b64_tr_b16 a[126:127], v33 offset:27232
s_waitcnt lgkmcnt(0)
s_barrier
s_add_u32 s40, s10, 256
s_addc_u32 s41, s11, 0
s_mov_b32 s43, 5120
v_lshrrev_b32 v34, 4, v1
v_mul_u32_u24 v34, 1280, v34
v_and_b32 v35, 15, v1
v_lshl_add_u32 v34, v35, 4, v34
s_mul_i32 s44, s3, 8704
s_add_u32 s44, s44, 69632
v_mov_b32 v35, v34
s_add_u32 m0, s44, 0
s_nop 0
global_load_lds_dwordx4 v35, s[40:41]
v_add_u32 v35, s43, v35
s_add_u32 m0, s44, 1088
s_nop 0
global_load_lds_dwordx4 v35, s[40:41]
v_add_u32 v35, s43, v35
s_add_u32 m0, s44, 2176
s_nop 0
global_load_lds_dwordx4 v35, s[40:41]
v_add_u32 v35, s43, v35
s_add_u32 m0, s44, 3264
s_nop 0
global_load_lds_dwordx4 v35, s[40:41]
v_add_u32 v35, s43, v35
s_add_u32 m0, s44, 4352
s_nop 0
global_load_lds_dwordx4 v35, s[40:41]
v_add_u32 v35, s43, v35
s_add_u32 m0, s44, 5440
s_nop 0
global_load_lds_dwordx4 v35, s[40:41]
v_add_u32 v35, s43, v35
s_add_u32 m0, s44, 6528
s_nop 0
global_load_lds_dwordx4 v35, s[40:41]
v_add_u32 v35, s43, v35
s_add_u32 m0, s44, 7616
s_nop 0
global_load_lds_dwordx4 v35, s[40:41]
s_waitcnt vmcnt(24)
s_barrier
v_add_u32 v33, 104448, v10
ds_read_b64_tr_b16 a[48:49], v33 offset:0
ds_read_b64_tr_b16 a[50:51], v33 offset:1088
ds_read_b64_tr_b16 a[52:53], v33 offset:8704
ds_read_b64_tr_b16 a[54:55], v33 offset:9792
ds_read_b64_tr_b16 a[128:129], v33 offset:32
ds_read_b64_tr_b16 a[130:131], v33 offset:1120
ds_read_b64_tr_b16 a[132:133], v33 offset:8736
ds_read_b64_tr_b16 a[134:135], v33 offset:9824
ds_read_b64_tr_b16 a[56:57], v33 offset:17408
ds_read_b64_tr_b16 a[58:59], v33 offset:18496
ds_read_b64_tr_b16 a[60:61], v33 offset:26112
ds_read_b64_tr_b16 a[62:63], v33 offset:27200
ds_read_b64_tr_b16 a[136:137], v33 offset:17440
ds_read_b64_tr_b16 a[138:139], v33 offset:18528
ds_read_b64_tr_b16 a[140:141], v33 offset:26144
ds_read_b64_tr_b16 a[142:143], v33 offset:27232
s_waitcnt lgkmcnt(0)
s_barrier
s_add_u32 s40, s10, 512
s_addc_u32 s41, s11, 0
s_mov_b32 s43, 5120
v_lshrrev_b32 v34, 4, v1
v_mul_u32_u24 v34, 1280, v34
v_and_b32 v35, 15, v1
v_lshl_add_u32 v34, v35, 4, v34
s_mul_i32 s44, s3, 8704
s_add_u32 s44, s44, 104448
v_mov_b32 v35, v34
s_add_u32 m0, s44, 0
s_nop 0
global_load_lds_dwordx4 v35, s[40:41]
v_add_u32 v35, s43, v35
s_add_u32 m0, s44, 1088
s_nop 0
global_load_lds_dwordx4 v35, s[40:41]
v_add_u32 v35, s43, v35
s_add_u32 m0, s44, 2176
s_nop 0
global_load_lds_dwordx4 v35, s[40:41]
v_add_u32 v35, s43, v35
s_add_u32 m0, s44, 3264
s_nop 0
global_load_lds_dwordx4 v35, s[40:41]
v_add_u32 v35, s43, v35
s_add_u32 m0, s44, 4352
s_nop 0
global_load_lds_dwordx4 v35, s[40:41]
v_add_u32 v35, s43, v35
s_add_u32 m0, s44, 5440
s_nop 0
global_load_lds_dwordx4 v35, s[40:41]
v_add_u32 v35, s43, v35
s_add_u32 m0, s44, 6528
s_nop 0
global_load_lds_dwordx4 v35, s[40:41]
v_add_u32 v35, s43, v35
s_add_u32 m0, s44, 7616
s_nop 0
global_load_lds_dwordx4 v35, s[40:41]
s_waitcnt vmcnt(24)
s_barrier
v_add_u32 v33, 0, v10
ds_read_b64_tr_b16 a[64:65], v33 offset:0
ds_read_b64_tr_b16 a[66:67], v33 offset:1088
ds_read_b64_tr_b16 a[68:69], v33 offset:8704
ds_read_b64_tr_b16 a[70:71], v33 offset:9792
ds_read_b64_tr_b16 a[144:145], v33 offset:32
ds_read_b64_tr_b16 a[146:147], v33 offset:1120
ds_read_b64_tr_b16 a[148:149], v33 offset:8736
ds_read_b64_tr_b16 a[150:151], v33 offset:9824
ds_read_b64_tr_b16 a[72:73], v33 offset:17408
ds_read_b64_tr_b16 a[74:75], v33 offset:18496
ds_read_b64_tr_b16 a[76:77], v33 offset:26112
ds_read_b64_tr_b16 a[78:79], v33 offset:27200
ds_read_b64_tr_b16 a[152:153], v33 offset:17440
ds_read_b64_tr_b16 a[154:155], v33 offset:18528
ds_read_b64_tr_b16 a[156:157], v33 offset:26144
ds_read_b64_tr_b16 a[158:159], v33 offset:27232
s_waitcnt lgkmcnt(0)
s_barrier
s_add_u32 s40, s10, 768
s_addc_u32 s41, s11, 0
s_mov_b32 s43, 5120
v_lshrrev_b32 v34, 4, v1
v_mul_u32_u24 v34, 1280, v34
v_and_b32 v35, 15, v1
v_lshl_add_u32 v34, v35, 4, v34
s_mul_i32 s44, s3, 8704
s_add_u32 s44, s44, 0
v_mov_b32 v35, v34
s_add_u32 m0, s44, 0
s_nop 0
global_load_lds_dwordx4 v35, s[40:41]
v_add_u32 v35, s43, v35
s_add_u32 m0, s44, 1088
s_nop 0
global_load_lds_dwordx4 v35, s[40:41]
v_add_u32 v35, s43, v35
s_add_u32 m0, s44, 2176
s_nop 0
global_load_lds_dwordx4 v35, s[40:41]
v_add_u32 v35, s43, v35
s_add_u32 m0, s44, 3264
s_nop 0
global_load_lds_dwordx4 v35, s[40:41]
v_add_u32 v35, s43, v35
s_add_u32 m0, s44, 4352
s_nop 0
global_load_lds_dwordx4 v35, s[40:41]
v_add_u32 v35, s43, v35
s_add_u32 m0, s44, 5440
s_nop 0
global_load_lds_dwordx4 v35, s[40:41]
v_add_u32 v35, s43, v35
s_add_u32 m0, s44, 6528
s_nop 0
global_load_lds_dwordx4 v35, s[40:41]
v_add_u32 v35, s43, v35
s_add_u32 m0, s44, 7616
s_nop 0
global_load_lds_dwordx4 v35, s[40:41]
s_waitcnt vmcnt(24)
s_barrier
v_add_u32 v33, 34816, v10
ds_read_b64_tr_b16 a[160:161], v33 offset:0
ds_read_b64_tr_b16 a[162:163], v33 offset:1088
ds_read_b64_tr_b16 a[164:165], v33 offset:8704
ds_read_b64_tr_b16 a[166:167], v33 offset:9792
ds_read_b64_tr_b16 a[176:177], v33 offset:32
ds_read_b64_tr_b16 a[178:179], v33 offset:1120
ds_read_b64_tr_b16 a[180:181], v33 offset:8736
ds_read_b64_tr_b16 a[182:183], v33 offset:9824
ds_read_b64_tr_b16 a[168:169], v33 offset:17408
ds_read_b64_tr_b16 a[170:171], v33 offset:18496
ds_read_b64_tr_b16 a[172:173], v33 offset:26112
ds_read_b64_tr_b16 a[174:175], v33 offset:27200
ds_read_b64_tr_b16 a[184:185], v33 offset:17440
ds_read_b64_tr_b16 a[186:187], v33 offset:18528
ds_read_b64_tr_b16 a[188:189], v33 offset:26144
ds_read_b64_tr_b16 a[190:191], v33 offset:27232
s_waitcnt lgkmcnt(0)
s_barrier
s_add_u32 s40, s10, 1024
s_addc_u32 s41, s11, 0
s_mov_b32 s43, 5120
v_lshrrev_b32 v34, 4, v1
v_mul_u32_u24 v34, 1280, v34
v_and_b32 v35, 15, v1
v_lshl_add_u32 v34, v35, 4, v34
s_mul_i32 s44, s3, 8704
s_add_u32 s44, s44, 34816
v_mov_b32 v35, v34
s_add_u32 m0, s44, 0
s_nop 0
global_load_lds_dwordx4 v35, s[40:41]
v_add_u32 v35, s43, v35
s_add_u32 m0, s44, 1088
s_nop 0
global_load_lds_dwordx4 v35, s[40:41]
v_add_u32 v35, s43, v35
s_add_u32 m0, s44, 2176
s_nop 0
global_load_lds_dwordx4 v35, s[40:41]
v_add_u32 v35, s43, v35
s_add_u32 m0, s44, 3264
s_nop 0
global_load_lds_dwordx4 v35, s[40:41]
v_add_u32 v35, s43, v35
s_add_u32 m0, s44, 4352
s_nop 0
global_load_lds_dwordx4 v35, s[40:41]
v_add_u32 v35, s43, v35
s_add_u32 m0, s44, 5440
s_nop 0
global_load_lds_dwordx4 v35, s[40:41]
v_add_u32 v35, s43, v35
s_add_u32 m0, s44, 6528
s_nop 0
global_load_lds_dwordx4 v35, s[40:41]
v_add_u32 v35, s43, v35
s_add_u32 m0, s44, 7616
s_nop 0
global_load_lds_dwordx4 v35, s[40:41]
s_waitcnt vmcnt(24)
s_barrier
v_add_u32 v33, 69632, v10
ds_read_b64_tr_b16 a[192:193], v33 offset:0
ds_read_b64_tr_b16 a[194:195], v33 offset:1088
ds_read_b64_tr_b16 a[196:197], v33 offset:8704
ds_read_b64_tr_b16 a[198:199], v33 offset:9792
ds_read_b64_tr_b16 a[208:209], v33 offset:32
ds_read_b64_tr_b16 a[210:211], v33 offset:1120
ds_read_b64_tr_b16 a[212:213], v33 offset:8736
ds_read_b64_tr_b16 a[214:215], v33 offset:9824
ds_read_b64_tr_b16 a[200:201], v33 offset:17408
ds_read_b64_tr_b16 a[202:203], v33 offset:18496
ds_read_b64_tr_b16 a[204:205], v33 offset:26112
ds_read_b64_tr_b16 a[206:207], v33 offset:27200
ds_read_b64_tr_b16 a[216:217], v33 offset:17440
ds_read_b64_tr_b16 a[218:219], v33 offset:18528
ds_read_b64_tr_b16 a[220:221], v33 offset:26144
ds_read_b64_tr_b16 a[222:223], v33 offset:27232
s_waitcnt lgkmcnt(0)
s_barrier
s_waitcnt vmcnt(16)
s_barrier
v_add_u32 v33, 104448, v10
ds_read_b64_tr_b16 a[224:225], v33 offset:0
ds_read_b64_tr_b16 a[226:227], v33 offset:1088
ds_read_b64_tr_b16 a[228:229], v33 offset:8704
ds_read_b64_tr_b16 a[230:231], v33 offset:9792
ds_read_b64_tr_b16 a[240:241], v33 offset:32
ds_read_b64_tr_b16 a[242:243], v33 offset:1120
ds_read_b64_tr_b16 a[244:245], v33 offset:8736
ds_read_b64_tr_b16 a[246:247], v33 offset:9824
ds_read_b64_tr_b16 a[232:233], v33 offset:17408
ds_read_b64_tr_b16 a[234:235], v33 offset:18496
ds_read_b64_tr_b16 a[236:237], v33 offset:26112
ds_read_b64_tr_b16 a[238:239], v33 offset:27200
ds_read_b64_tr_b16 a[248:249], v33 offset:17440
ds_read_b64_tr_b16 a[250:251], v33 offset:18528
ds_read_b64_tr_b16 a[252:253], v33 offset:26144
ds_read_b64_tr_b16 a[254:255], v33 offset:27232
s_waitcnt lgkmcnt(0)
s_barrier
s_waitcnt vmcnt(8)
s_barrier
v_add_u32 v33, 0, v10
ds_read_b64_tr_b16 v[192:193], v33 offset:0
ds_read_b64_tr_b16 v[194:195], v33 offset:1088
ds_read_b64_tr_b16 v[196:197], v33 offset:8704
ds_read_b64_tr_b16 v[198:199], v33 offset:9792
ds_read_b64_tr_b16 v[208:209], v33 offset:32
ds_read_b64_tr_b16 v[210:211], v33 offset:1120
ds_read_b64_tr_b16 v[212:213], v33 offset:8736
ds_read_b64_tr_b16 v[214:215], v33 offset:9824
ds_read_b64_tr_b16 v[200:201], v33 offset:17408
ds_read_b64_tr_b16 v[202:203], v33 offset:18496
ds_read_b64_tr_b16 v[204:205], v33 offset:26112
ds_read_b64_tr_b16 v[206:207], v33 offset:27200
ds_read_b64_tr_b16 v[216:217], v33 offset:17440
ds_read_b64_tr_b16 v[218:219], v33 offset:18528
ds_read_b64_tr_b16 v[220:221], v33 offset:26144
ds_read_b64_tr_b16 v[222:223], v33 offset:27232
s_waitcnt lgkmcnt(0)
s_barrier
s_waitcnt vmcnt(0)
s_barrier
v_add_u32 v33, 34816, v10
ds_read_b64_tr_b16 v[224:225], v33 offset:0
ds_read_b64_tr_b16 v[226:227], v33 offset:1088
ds_read_b64_tr_b16 v[228:229], v33 offset:8704
ds_read_b64_tr_b16 v[230:231], v33 offset:9792
ds_read_b64_tr_b16 v[240:241], v33 offset:32
ds_read_b64_tr_b16 v[242:243], v33 offset:1120
ds_read_b64_tr_b16 v[244:245], v33 offset:8736
ds_read_b64_tr_b16 v[246:247], v33 offset:9824
ds_read_b64_tr_b16 v[232:233], v33 offset:17408
ds_read_b64_tr_b16 v[234:235], v33 offset:18496
ds_read_b64_tr_b16 v[236:237], v33 offset:26112
ds_read_b64_tr_b16 v[238:239], v33 offset:27200
ds_read_b64_tr_b16 v[248:249], v33 offset:17440
ds_read_b64_tr_b16 v[250:251], v33 offset:18528
ds_read_b64_tr_b16 v[252:253], v33 offset:26144
ds_read_b64_tr_b16 v[254:255], v33 offset:27232
s_waitcnt lgkmcnt(0)
s_barrier
s_cmp_lg_u32 s3, 0
s_cbranch_scc1 cl_104
v_mov_b32 v30, 192
v_mov_b32 v31, 1
s_mov_b64 exec, 1
global_atomic_add v30, v31, s[6:7]
s_mov_b64 exec, -1
cl_104:
v_mov_b32 v30, 64
sc_105:
global_load_dword v31, v30, s[6:7] sc1
s_waitcnt vmcnt(0)
v_readfirstlane_b32 s40, v31
s_cmp_ge_u32 s40, 256
s_nop 2
s_cbranch_scc1 scg_107
s_sleep 4
s_add_u32 s100, s100, 64
s_cmp_lt_u32 s100, 0x1000000
s_cbranch_scc1 sc_105
s_endpgm
scg_107:
s_cmp_lg_u32 s101, 0
s_cbranch_scc1 sco_106
v_and_b32 v30, 7, v1
v_lshlrev_b32 v30, 2, v30
global_load_dword v31, v30, s[6:7] sc1
s_waitcnt vmcnt(0)
v_cmp_ne_u32 vcc, 32, v31
s_nop 3
s_cbranch_vccz sco_106
s_mov_b32 s101, 1
s_lshr_b32 s12, s2, 5
s_and_b32 s17, s2, 31
s_barrier
s_branch L_dispatch
sco_106:
v_and_b32 v30, 15, v1
v_lshrrev_b32 v31, 4, v1
v_lshrrev_b32 v32, 2, v30
v_lshlrev_b32 v32, 4, v32
v_lshrrev_b32 v33, 1, v31
v_lshl_add_u32 v32, v33, 3, v32
v_bfe_u32 v33, v30, 1, 1
v_lshl_add_u32 v32, v33, 2, v32
v_and_b32 v33, 1, v31
v_lshl_add_u32 v32, v33, 1, v32
v_and_b32 v33, 1, v30
v_add_u32 v32, v32, v33
v_lshlrev_b32 v32, 4, v32
s_lshl_b32 s40, s3, 10
s_add_u32 s41, s40, 4096
v_add_u32 v2, s41, v32
v_lshlrev_b32 v4, 4, v1
v_add_u32 v3, s40, v4
s_cmp_lt_u32 s3, 2
s_cselect_b32 s42, 4096, 0
v_add_u32 v184, s42, v2
s_add_u32 s42, s42, 4096
v_add_u32 v185, s42, v3
v_mov_b32 v5, 0x4444
v_mov_b32 v32, 0xeeee
v_cmp_lt_u32 vcc, 7, v30
s_nop 1
v_cndmask_b32 v5, v5, v32, vcc
v_lshrrev_b32 v32, 3, v30
v_and_b32 v33, 1, v31
v_cmp_eq_u32 s[40:41], v32, v33
v_and_b32 v32, 1, v30
v_lshlrev_b32 v32, 4, v32
v_mov_b32 v33, 0x3f80
v_lshlrev_b32 v32, v32, v33
v_cndmask_b32 v32, 0, v32, s[40:41]
v_bfe_u32 v33, v30, 1, 2
v_cmp_gt_u32 s[42:43], 2, v31
v_cmp_eq_u32 vcc, 0, v33
s_nop 1
v_cndmask_b32 v34, 0, v32, vcc
v_cndmask_b32 v6, 0, v34, s[42:43]
v_cndmask_b32 v186, v34, 0, s[42:43]
v_cmp_eq_u32 vcc, 1, v33
s_nop 1
v_cndmask_b32 v34, 0, v32, vcc
v_cndmask_b32 v7, 0, v34, s[42:43]
v_cndmask_b32 v187, v34, 0, s[42:43]
v_cmp_eq_u32 vcc, 2, v33
s_nop 1
v_cndmask_b32 v34, 0, v32, vcc
v_cndmask_b32 v8, 0, v34, s[42:43]
v_cndmask_b32 v188, v34, 0, s[42:43]
v_cmp_eq_u32 vcc, 3, v33
s_nop 1
v_cndmask_b32 v34, 0, v32, vcc
v_cndmask_b32 v9, 0, v34, s[42:43]
v_cndmask_b32 v189, v34, 0, s[42:43]
v_and_b32 v30, 15, v1
v_lshlrev_b32 v30, 2, v30
s_lshl_b32 s40, s15, 7
s_add_u32 s40, s40, 46186496
v_add_u32 v29, s40, v30
v_mov_b32 v30, 21504
v_mov_b32 v32, 0
v_mov_b32 v33, 0
ds_write_b64 v30, v[32:33]
v_mov_b32 v34, 0
v_mov_b32 v35, 0
v_lshlrev_b32 v30, 4, v1
ds_write_b128 v30, v[32:35] offset:21760
s_waitcnt lgkmcnt(0)
s_barrier
s_mul_i32 s18, s15, 10240
s_sub_u32 s19, 1, s15
s_mul_i32 s19, s19, 10240
s_add_u32 s19, s19, 20480
v_and_b32 v30, 15, v1
v_lshrrev_b32 v31, 4, v1
s_lshr_b32 s40, s3, 1
s_lshl_b32 s40, s40, 5
s_and_b32 s41, s3, 1
s_lshl_b32 s41, s41, 4
s_add_u32 s40, s40, s41
v_lshrrev_b32 v32, 5, v1
v_lshlrev_b32 v32, 3, v32
v_add_u32 v32, s40, v32
v_lshrrev_b32 v33, 2, v30
v_lshl_add_u32 v32, v33, 1, v32
v_and_b32 v33, 1, v30
v_add_u32 v32, v32, v33
v_lshlrev_b32 v32, 5, v32
v_bfe_u32 v33, v30, 1, 1
v_lshl_add_u32 v32, v33, 4, v32
v_and_b32 v33, 1, v31
v_lshl_add_u32 v32, v33, 3, v32
v_add_u32 v10, 10240, v32
v_bfe_u32 v32, v1, 2, 2
v_lshl_add_u32 v32, v31, 3, v32
v_lshlrev_b32 v32, 5, v32
v_and_b32 v33, 3, v1
v_lshl_add_u32 v32, v33, 3, v32
v_add_u32 v11, 10240, v32
v_lshrrev_b32 v32, 5, v1
s_lshl_b32 s40, s3, 1
v_add_u32 v32, s40, v32
v_mul_u32_u24 v32, 12288, v32
s_mul_i32 s40, s15, 196608
s_mul_i32 s41, s14, 768
s_add_u32 s40, s40, s41
v_add_u32 v32, s40, v32
v_lshl_add_u32 v32, v30, 4, v32
v_and_b32 v33, 1, v31
v_lshl_add_u32 v13, v33, 3, v32
v_add_u32 v14, 98304, v13
v_and_b32 v32, 15, v1
v_lshlrev_b32 v32, 2, v32
s_lshl_b32 s40, s15, 8
s_add_u32 s40, s40, 46186752
v_add_u32 v12, s40, v32
v_lshlrev_b32 v15, 4, v1
s_lshl_b32 s40, s15, 13
s_lshl_b32 s41, s3, 11
s_add_u32 s40, s40, s41
v_add_u32 v21, s40, v15
s_lshl_b32 s40, s15, 11
s_lshl_b32 s41, s3, 9
s_add_u32 s40, s40, s41
s_add_u32 s40, s40, 16384
v_lshlrev_b32 v32, 7, v31
v_lshl_add_u32 v32, v30, 4, v32
v_add_u32 v16, s40, v32
s_mul_i32 s40, s15, 196608
s_mul_i32 s41, s14, 12288
s_add_u32 s40, s40, s41
s_mul_i32 s41, s3, 3072
s_add_u32 s40, s40, s41
v_mul_u32_u24 v32, 768, v31
v_lshl_add_u32 v32, v30, 4, v32
v_add_u32 v17, s40, v32
s_movk_i32 s41, 256
s_cmp_lt_u32 s14, 8
s_cselect_b32 s40, 512, s41
v_add_u32 v18, s40, v17
s_mul_i32 s41, s3, 12288
s_add_u32 s41, s41, 40960
v_add_u32 v19, s41, v15
v_add_u32 v20, 49152, v19
s_mul_i32 s40, s3, 1536
s_add_u32 s40, s40, 14848
v_add_u32 v22, s40, v15
s_cmp_lt_u32 s14, 8
s_cselect_b32 s40, 3, 2
s_mov_b32 s77, s40
v_cmp_gt_u32 vcc, s40, v31
s_nop 1
v_cndmask_b32 v33, 0, v31, vcc
v_lshlrev_b32 v33, 4, v33
v_add_u32 v33, s14, v33
v_lshlrev_b32 v33, 4, v33
v_add_u32 v33, v33, v30
v_lshlrev_b32 v33, 4, v33
v_add_u32 v26, s18, v33
v_add_u32 v27, 20480, v26
s_lshl_b32 s40, s15, 7
s_lshl_b32 s41, s14, 2
s_add_u32 s40, s40, s41
s_add_u32 s40, s40, 46186496
v_mov_b32 v190, s40
v_and_b32 v32, 15, v1
v_lshlrev_b32 v32, 2, v32
s_lshl_b32 s40, s15, 6
s_add_u32 s40, s40, 46153728
v_add_u32 v28, s40, v32
v_lshrrev_b32 v30, 5, v0
v_bfe_u32 v31, v0, 1, 4
v_and_b32 v32, 1, v0
v_lshlrev_b32 v33, 5, v30
v_lshl_add_u32 v33, v32, 4, v33
v_add_u32 v33, v33, v31
v_lshlrev_b32 v33, 4, v33
v_add_u32 v23, 14848, v33
v_lshlrev_b32 v33, 4, v30
v_add_u32 v33, s14, v33
v_lshlrev_b32 v33, 4, v33
v_add_u32 v33, v33, v31
v_lshlrev_b32 v33, 4, v33
v_lshl_add_u32 v33, v32, 3, v33
v_add_u32 v24, s18, v33
v_add_u32 v25, 20480, v24
v_mov_b32 v176, 0
v_mov_b32 v177, 0
v_mov_b32 v178, 0
v_mov_b32 v179, 0
v_mov_b32 v180, -1
v_mov_b32 v181, -1
v_mov_b32 v182, -1
v_mov_b32 v183, -1
s_cmp_eq_u32 s3, 0
s_cselect_b32 s74, -1, 0
s_cselect_b32 s75, -1, 0
s_cmp_eq_u32 s3, 1
s_cselect_b32 s40, 1, 0
s_cmp_lt_u32 s14, 8
s_cselect_b32 s41, 1, 0
s_and_b32 s40, s40, s41
s_cmp_eq_u32 s40, 1
s_cselect_b32 s74, -1, s74
s_or_b32 s76, s74, s75
s_mul_i32 s33, s15, 786432
s_mul_i32 s40, s14, 49152
s_add_u32 s33, s33, s40
s_mul_i32 s40, s3, 12288
s_add_u32 s33, s33, s40
s_add_u32 s71, s40, 40960
s_load_dwordx2 s[8:9], s[0:1], 80
s_add_u32 s34, s4, 44163072
s_addc_u32 s35, s5, 0
s_waitcnt lgkmcnt(0)
s_cmp_eq_u32 s76, 0
s_cbranch_scc1 Pinit_108
s_mov_b64 exec, s[74:75]
v_subrev_u32 v30, s18, v24
v_lshrrev_b32 v30, 4, v30
v_lshlrev_b32 v30, 1, v30
v_and_b32 v31, 1, v0
v_mul_u32_u24 v31, 5120, v31
v_add_u32 v30, v30, v31
v_mov_b32 v32, 0
v_mov_b32 v33, 0
s_cmp_lg_u32 s15, 0
s_cbranch_scc1 Pz_109
global_load_ushort v32, v30, s[8:9]
global_load_ushort v34, v30, s[8:9] offset:1280
global_load_ushort v33, v30, s[8:9] offset:2560
global_load_ushort v35, v30, s[8:9] offset:3840
s_waitcnt vmcnt(0)
v_lshl_or_b32 v32, v34, 16, v32
v_lshl_or_b32 v33, v35, 16, v33
v_min_u32 v32, s70, v32
Pz_109:
global_store_dwordx2 v24, v[32:33], s[34:35]
global_store_dwordx2 v25, v[32:33], s[34:35] sc1
v_mov_b32 v34, 1
global_store_dword v190, v34, s[4:5]
s_mov_b64 exec, -1
Pinit_108:
s_mov_b32 s30, 0
s_add_u32 s44, s30, 4294967295
s_and_b32 s44, s44, 3
s_mul_i32 s44, s44, 40960
s_add_u32 s44, s44, 44040192
s_add_u32 s45, s44, s18
s_add_u32 s36, s4, s45
s_addc_u32 s37, s5, 0
s_add_u32 s45, s44, s19
s_add_u32 s38, s4, s45
s_addc_u32 s39, s5, 0
v_mov_b32 v96, 0
v_mov_b32 v97, 0
v_mov_b32 v98, 0
v_mov_b32 v99, 0
v_mov_b32 v100, 0
v_mov_b32 v101, 0
v_mov_b32 v102, 0
v_mov_b32 v103, 0
s_and_b32 s44, s30, 3
s_mul_i32 s44, s44, 393216
s_add_u32 s44, s44, 44367872
s_add_u32 s54, s4, s44
s_addc_u32 s55, s5, 0
s_and_b32 s44, s30, 3
s_mul_i32 s44, s44, 20480
s_add_u32 s44, s44, 44236800
s_add_u32 s52, s4, s44
s_addc_u32 s53, s5, 0
s_and_b32 s44, s30, 3
s_mul_i32 s44, s44, 40960
s_add_u32 s44, s44, 44040192
s_add_u32 s34, s4, s44
s_addc_u32 s35, s5, 0
s_add_u32 s44, s30, 4294967294
s_and_b32 s44, s44, 3
s_mul_i32 s44, s44, 40960
s_add_u32 s44, s44, 44040192
s_add_u32 s26, s4, s44
s_addc_u32 s27, s5, 0
s_add_u32 s40, s30, 2
v_mov_b32 v191, s40
s_add_u32 s45, s30, 1
s_min_u32 s45, s45, 63
s_mul_i32 s44, s45, 1572864
s_add_u32 s44, s44, s33
s_add_u32 s28, s4, s44
s_addc_u32 s29, s5, 0
s_add_u32 s28, s28, 75497472
s_addc_u32 s29, s29, 0
s_and_b32 s46, s45, 1
s_mul_i32 s46, s46, 49152
s_add_u32 s32, s46, s71
s_cmp_eq_u32 s3, 3
s_cbranch_scc1 nd_113
s_sleep 1
s_sleep 1
s_sleep 1
nd_113:
global_load_dwordx4 v[36:39], v2, s[36:37] offset:-4096 sc1
global_load_dwordx4 v[40:43], v2, s[36:37] offset:0 sc1
global_load_dwordx4 v[44:47], v184, s[36:37] sc1
s_sleep 1
s_sleep 1
s_sleep 1
s_sleep 1
s_sleep 1
global_load_dwordx4 v[80:83], v2, s[38:39] offset:-4096 sc1
global_load_dwordx4 v[84:87], v2, s[38:39] offset:0 sc1
global_load_dwordx4 v[88:91], v184, s[38:39] sc1
s_waitcnt vmcnt(3)
Gl_114:
v_max3_u32 v30, v36, v38, v40
v_max3_u32 v30, v30, v42, v44
v_max_u32 v30, v30, v46
v_cmp_eq_u32 vcc, -1, v30
s_nop 3
s_cbranch_vccz Glo_115
global_load_dwordx4 v[36:39], v2, s[36:37] offset:-4096 sc1
global_load_dwordx4 v[40:43], v2, s[36:37] offset:0 sc1
global_load_dwordx4 v[44:47], v184, s[36:37] sc1
s_waitcnt vmcnt(0)
s_add_u32 s100, s100, 1
s_cmp_lt_u32 s100, 0x1000000
s_cbranch_scc1 Gl_114
s_endpgm
Glo_115:
v_mfma_f32_16x16x32_bf16 v[56:59], v[36:39], v[6:9], 0
v_mfma_f32_16x16x32_bf16 v[60:63], v[36:39], v[186:189], 0
v_mfma_f32_16x16x32_bf16 v[64:67], v[40:43], v[6:9], 0
v_mfma_f32_16x16x32_bf16 v[68:71], v[40:43], v[186:189], 0
v_mfma_f32_16x16x32_bf16 v[72:75], v[44:47], v[6:9], 0
v_mfma_f32_16x16x32_bf16 v[76:79], v[44:47], v[186:189], 0
s_waitcnt vmcnt(0)
Gr_116:
v_max3_u32 v30, v80, v82, v84
v_max3_u32 v30, v30, v86, v88
v_max_u32 v30, v30, v90
v_cmp_eq_u32 vcc, -1, v30
s_nop 3
s_cbranch_vccz Gro_117
global_load_dwordx4 v[80:83], v2, s[38:39] offset:-4096 sc1
global_load_dwordx4 v[84:87], v2, s[38:39] offset:0 sc1
global_load_dwordx4 v[88:91], v184, s[38:39] sc1
s_waitcnt vmcnt(0)
s_add_u32 s100, s100, 1
s_cmp_lt_u32 s100, 0x1000000
s_cbranch_scc1 Gr_116
s_endpgm
Gro_117:
v_mfma_f32_16x16x32_bf16 v[56:59], v[80:83], v[6:9], v[56:59]
v_mfma_f32_16x16x32_bf16 v[60:63], v[80:83], v[186:189], v[60:63]
v_mfma_f32_16x16x32_bf16 v[64:67], v[84:87], v[6:9], v[64:67]
v_mfma_f32_16x16x32_bf16 v[68:71], v[84:87], v[186:189], v[68:71]
v_mfma_f32_16x16x32_bf16 v[72:75], v[88:91], v[6:9], v[72:75]
v_mfma_f32_16x16x32_bf16 v[76:79], v[88:91], v[186:189], v[76:79]
s_nop 2
v_cvt_pk_bf16_f32 v36, v56, v57
v_cvt_pk_bf16_f32 v37, v58, v59
v_cvt_pk_bf16_f32 v38, v60, v61
v_cvt_pk_bf16_f32 v39, v62, v63
ds_write_b128 v3, v[36:39] offset:0
v_cvt_pk_bf16_f32 v40, v64, v65
v_cvt_pk_bf16_f32 v41, v66, v67
v_cvt_pk_bf16_f32 v42, v68, v69
v_cvt_pk_bf16_f32 v43, v70, v71
ds_write_b128 v3, v[40:43] offset:4096
v_cvt_pk_bf16_f32 v44, v72, v73
v_cvt_pk_bf16_f32 v45, v74, v75
v_cvt_pk_bf16_f32 v46, v76, v77
v_cvt_pk_bf16_f32 v47, v78, v79
ds_write_b128 v185, v[44:47]
s_waitcnt lgkmcnt(0)
Gs_112:
s_barrier
ds_read_b128 v[56:59], v4 offset:0
ds_read_b128 v[60:63], v4 offset:1024
ds_read_b128 v[64:67], v4 offset:2048
ds_read_b128 v[68:71], v4 offset:3072
ds_read_b128 v[72:75], v4 offset:4096
ds_read_b128 v[76:79], v4 offset:5120
ds_read_b128 v[80:83], v4 offset:6144
ds_read_b128 v[84:87], v4 offset:7168
ds_read_b128 v[88:91], v4 offset:8192
ds_read_b128 v[92:95], v4 offset:9216
s_waitcnt lgkmcnt(9)
v_smfmac_f32_16x16x64_bf16 v[96:99], v[56:59], a[0:7], v5
v_smfmac_f32_16x16x64_bf16 v[100:103], v[56:59], a[80:87], v5
v_mov_b32 v56, 0
v_mov_b32 v57, 0
v_mov_b32 v58, 0
v_mov_b32 v59, 0
s_waitcnt lgkmcnt(8)
v_smfmac_f32_16x16x64_bf16 v[96:99], v[60:63], a[8:15], v5
v_smfmac_f32_16x16x64_bf16 v[100:103], v[60:63], a[88:95], v5
v_mov_b32 v60, 0
v_mov_b32 v61, 0
v_mov_b32 v62, 0
v_mov_b32 v63, 0
s_waitcnt lgkmcnt(7)
v_smfmac_f32_16x16x64_bf16 v[96:99], v[64:67], a[16:23], v5
v_smfmac_f32_16x16x64_bf16 v[100:103], v[64:67], a[96:103], v5
v_mov_b32 v64, 0
v_mov_b32 v65, 0
v_mov_b32 v66, 0
v_mov_b32 v67, 0
s_waitcnt lgkmcnt(6)
v_smfmac_f32_16x16x64_bf16 v[96:99], v[68:71], a[24:31], v5
v_smfmac_f32_16x16x64_bf16 v[100:103], v[68:71], a[104:111], v5
v_mov_b32 v68, 0
v_mov_b32 v69, 0
v_mov_b32 v70, 0
v_mov_b32 v71, 0
s_waitcnt lgkmcnt(5)
v_smfmac_f32_16x16x64_bf16 v[96:99], v[72:75], a[32:39], v5
v_smfmac_f32_16x16x64_bf16 v[100:103], v[72:75], a[112:119], v5
v_mov_b32 v72, 0
v_mov_b32 v73, 0
v_mov_b32 v74, 0
v_mov_b32 v75, 0
s_waitcnt lgkmcnt(4)
v_smfmac_f32_16x16x64_bf16 v[96:99], v[76:79], a[40:47], v5
v_smfmac_f32_16x16x64_bf16 v[100:103], v[76:79], a[120:127], v5
v_mov_b32 v76, 0
v_mov_b32 v77, 0
v_mov_b32 v78, 0
v_mov_b32 v79, 0
s_waitcnt lgkmcnt(3)
v_smfmac_f32_16x16x64_bf16 v[96:99], v[80:83], a[48:55], v5
v_smfmac_f32_16x16x64_bf16 v[100:103], v[80:83], a[128:135], v5
v_mov_b32 v80, 0
v_mov_b32 v81, 0
v_mov_b32 v82, 0
v_mov_b32 v83, 0
s_waitcnt lgkmcnt(2)
v_smfmac_f32_16x16x64_bf16 v[96:99], v[84:87], a[56:63], v5
v_smfmac_f32_16x16x64_bf16 v[100:103], v[84:87], a[136:143], v5
v_mov_b32 v84, 0
v_mov_b32 v85, 0
v_mov_b32 v86, 0
v_mov_b32 v87, 0
s_waitcnt lgkmcnt(1)
v_smfmac_f32_16x16x64_bf16 v[96:99], v[88:91], a[64:71], v5
v_smfmac_f32_16x16x64_bf16 v[100:103], v[88:91], a[144:151], v5
v_mov_b32 v88, 0
v_mov_b32 v89, 0
v_mov_b32 v90, 0
v_mov_b32 v91, 0
s_waitcnt lgkmcnt(0)
v_smfmac_f32_16x16x64_bf16 v[96:99], v[92:95], a[72:79], v5
v_smfmac_f32_16x16x64_bf16 v[100:103], v[92:95], a[152:159], v5
v_mov_b32 v92, 0
v_mov_b32 v93, 0
v_mov_b32 v94, 0
v_mov_b32 v95, 0
s_nop 3
v_permlane32_swap_b32 v96, v100
v_permlane32_swap_b32 v97, v101
v_permlane32_swap_b32 v98, v102
v_permlane32_swap_b32 v99, v103
v_pk_add_f32 v[96:97], v[96:97], v[100:101]
v_pk_add_f32 v[98:99], v[98:99], v[102:103]
v_cvt_pk_bf16_f32 v44, v96, v97
v_cvt_pk_bf16_f32 v45, v98, v99
ds_write_b64 v10, v[44:45]
s_waitcnt lgkmcnt(0)
s_barrier
ds_read_b64_tr_b16 v[36:37], v11 offset:0
ds_read_b64_tr_b16 v[38:39], v11 offset:128
ds_read_b64_tr_b16 v[40:41], v11 offset:1024
ds_read_b64_tr_b16 v[42:43], v11 offset:1152
s_waitcnt lgkmcnt(0)
v_smfmac_f32_16x16x64_bf16 v[56:59], v[36:39], a[160:167], v5
v_smfmac_f32_16x16x64_bf16 v[60:63], v[36:39], a[176:183], v5
v_smfmac_f32_16x16x64_bf16 v[56:59], v[40:43], a[168:175], v5
v_smfmac_f32_16x16x64_bf16 v[60:63], v[40:43], a[184:191], v5
v_smfmac_f32_16x16x64_bf16 v[64:67], v[36:39], a[192:199], v5
v_smfmac_f32_16x16x64_bf16 v[68:71], v[36:39], a[208:215], v5
s_nop 5
v_permlane32_swap_b32 v56, v60
v_permlane32_swap_b32 v57, v61
v_permlane32_swap_b32 v58, v62
v_smfmac_f32_16x16x64_bf16 v[64:67], v[40:43], a[200:207], v5
v_permlane32_swap_b32 v59, v63
v_pk_add_f32 v[56:57], v[56:57], v[60:61]
v_pk_add_f32 v[58:59], v[58:59], v[62:63]
v_smfmac_f32_16x16x64_bf16 v[68:71], v[40:43], a[216:223], v5
v_cvt_pk_bf16_f32 v46, v56, v57
v_cvt_pk_bf16_f32 v47, v58, v59
v_min_u32 v46, s70, v46
global_store_dwordx2 v13, v[46:47], s[54:55] offset:0
v_smfmac_f32_16x16x64_bf16 v[72:75], v[36:39], a[224:231], v5
v_smfmac_f32_16x16x64_bf16 v[76:79], v[36:39], a[240:247], v5
s_nop 1
v_permlane32_swap_b32 v64, v68
v_permlane32_swap_b32 v65, v69
v_permlane32_swap_b32 v66, v70
v_smfmac_f32_16x16x64_bf16 v[72:75], v[40:43], a[232:239], v5
v_permlane32_swap_b32 v67, v71
v_pk_add_f32 v[64:65], v[64:65], v[68:69]
v_pk_add_f32 v[66:67], v[66:67], v[70:71]
v_smfmac_f32_16x16x64_bf16 v[76:79], v[40:43], a[248:255], v5
v_cvt_pk_bf16_f32 v48, v64, v65
v_cvt_pk_bf16_f32 v49, v66, v67
v_min_u32 v48, s70, v48
global_store_dwordx2 v14, v[48:49], s[54:55] offset:0
v_smfmac_f32_16x16x64_bf16 v[80:83], v[36:39], v[192:199], v5
v_smfmac_f32_16x16x64_bf16 v[84:87], v[36:39], v[208:215], v5
s_nop 1
v_permlane32_swap_b32 v72, v76
v_permlane32_swap_b32 v73, v77
v_permlane32_swap_b32 v74, v78
v_smfmac_f32_16x16x64_bf16 v[80:83], v[40:43], v[200:207], v5
v_permlane32_swap_b32 v75, v79
v_pk_add_f32 v[72:73], v[72:73], v[76:77]
v_pk_add_f32 v[74:75], v[74:75], v[78:79]
v_smfmac_f32_16x16x64_bf16 v[84:87], v[40:43], v[216:223], v5
v_cvt_pk_bf16_f32 v50, v72, v73
v_cvt_pk_bf16_f32 v51, v74, v75
v_min_u32 v50, s70, v50
global_store_dwordx2 v13, v[50:51], s[54:55] offset:256
v_smfmac_f32_16x16x64_bf16 v[88:91], v[36:39], v[224:231], v5
v_smfmac_f32_16x16x64_bf16 v[92:95], v[36:39], v[240:247], v5
s_nop 1
v_permlane32_swap_b32 v80, v84
v_permlane32_swap_b32 v81, v85
v_permlane32_swap_b32 v82, v86
v_smfmac_f32_16x16x64_bf16 v[88:91], v[40:43], v[232:239], v5
v_permlane32_swap_b32 v83, v87
v_pk_add_f32 v[80:81], v[80:81], v[84:85]
v_pk_add_f32 v[82:83], v[82:83], v[86:87]
v_smfmac_f32_16x16x64_bf16 v[92:95], v[40:43], v[248:255], v5
v_cvt_pk_bf16_f32 v52, v80, v81
v_cvt_pk_bf16_f32 v53, v82, v83
v_min_u32 v52, s70, v52
global_store_dwordx2 v14, v[52:53], s[54:55] offset:256
s_nop 3
v_permlane32_swap_b32 v88, v92
v_permlane32_swap_b32 v89, v93
v_permlane32_swap_b32 v90, v94
v_permlane32_swap_b32 v91, v95
v_pk_add_f32 v[88:89], v[88:89], v[92:93]
v_pk_add_f32 v[90:91], v[90:91], v[94:95]
v_cvt_pk_bf16_f32 v54, v88, v89
v_cvt_pk_bf16_f32 v55, v90, v91
v_min_u32 v54, s70, v54
global_store_dwordx2 v13, v[54:55], s[54:55] offset:512
s_add_u32 s45, s30, 0
s_min_u32 s45, s45, 63
s_lshl_b32 s46, s45, 7
v_add_u32 v30, s46, v28
uf_118:
global_load_dword v31, v30, s[4:5] sc1
s_waitcnt vmcnt(0)
v_cmp_eq_u32 vcc, 0, v31
s_nop 3
s_cbranch_vccz ok_119
s_add_u32 s100, s100, 1
s_cmp_lt_u32 s100, 0x1000000
s_cbranch_scc1 uf_118
s_endpgm
ok_119:
s_add_u32 s45, s30, 0
s_min_u32 s45, s45, 63
s_mul_i32 s44, s45, 1572864
s_add_u32 s44, s44, s33
s_add_u32 s28, s4, s44
s_addc_u32 s29, s5, 0
s_add_u32 s28, s28, 75497472
s_addc_u32 s29, s29, 0
s_and_b32 s46, s45, 1
s_mul_i32 s46, s46, 49152
s_add_u32 s32, s46, s71
s_mov_b32 m0, s32
s_nop 0
global_load_lds_dwordx4 v15, s[28:29] sc1
global_load_lds_dwordx4 v15, s[28:29] offset:1024 sc1
s_cmp_lt_u32 s77, 3
s_cbranch_scc1 dg_121
global_load_lds_dwordx4 v15, s[28:29] offset:2048 sc1
dg_121:
s_add_u32 s28, s28, 3072
s_addc_u32 s29, s29, 0
s_add_u32 s32, s32, 3072
s_mov_b32 m0, s32
s_nop 0
global_load_lds_dwordx4 v15, s[28:29] sc1
global_load_lds_dwordx4 v15, s[28:29] offset:1024 sc1
s_cmp_lt_u32 s77, 3
s_cbranch_scc1 dg_123
global_load_lds_dwordx4 v15, s[28:29] offset:2048 sc1
dg_123:
s_add_u32 s28, s28, 3072
s_addc_u32 s29, s29, 0
s_add_u32 s32, s32, 3072
s_mov_b32 m0, s32
s_nop 0
global_load_lds_dwordx4 v15, s[28:29] sc1
global_load_lds_dwordx4 v15, s[28:29] offset:1024 sc1
s_cmp_lt_u32 s77, 3
s_cbranch_scc1 dg_125
global_load_lds_dwordx4 v15, s[28:29] offset:2048 sc1
dg_125:
s_add_u32 s28, s28, 3072
s_addc_u32 s29, s29, 0
s_add_u32 s32, s32, 3072
s_mov_b32 m0, s32
s_nop 0
global_load_lds_dwordx4 v15, s[28:29] sc1
global_load_lds_dwordx4 v15, s[28:29] offset:1024 sc1
s_cmp_lt_u32 s77, 3
s_cbranch_scc1 dg_127
global_load_lds_dwordx4 v15, s[28:29] offset:2048 sc1
dg_127:
s_add_u32 s28, s28, 3072
s_addc_u32 s29, s29, 0
s_add_u32 s32, s32, 3072
s_waitcnt vmcnt(0)
s_barrier
s_bitcmp1_b32 s30, 0
s_cbranch_scc1 ub1_128
ds_read_b128 v[124:127], v19 offset:0
ds_read_b128 v[140:143], v19 offset:1024
ds_read_b128 v[156:159], v19 offset:2048
ds_read_b128 v[128:131], v19 offset:3072
ds_read_b128 v[144:147], v19 offset:4096
ds_read_b128 v[160:163], v19 offset:5120
ds_read_b128 v[132:135], v19 offset:6144
ds_read_b128 v[148:151], v19 offset:7168
ds_read_b128 v[164:167], v19 offset:8192
ds_read_b128 v[136:139], v19 offset:9216
ds_read_b128 v[152:155], v19 offset:10240
ds_read_b128 v[168:171], v19 offset:11264
s_branch ub2_129
ub1_128:
ds_read_b128 v[124:127], v20 offset:0
ds_read_b128 v[140:143], v20 offset:1024
ds_read_b128 v[156:159], v20 offset:2048
ds_read_b128 v[128:131], v20 offset:3072
ds_read_b128 v[144:147], v20 offset:4096
ds_read_b128 v[160:163], v20 offset:5120
ds_read_b128 v[132:135], v20 offset:6144
ds_read_b128 v[148:151], v20 offset:7168
ds_read_b128 v[164:167], v20 offset:8192
ds_read_b128 v[136:139], v20 offset:9216
ds_read_b128 v[152:155], v20 offset:10240
ds_read_b128 v[168:171], v20 offset:11264
ub2_129:
v_mov_b32 v96, 0
v_mov_b32 v97, 0
v_mov_b32 v98, 0
v_mov_b32 v99, 0
v_mov_b32 v100, 0
v_mov_b32 v101, 0
v_mov_b32 v102, 0
v_mov_b32 v103, 0
v_mov_b32 v104, 0
v_mov_b32 v105, 0
v_mov_b32 v106, 0
v_mov_b32 v107, 0
s_add_u32 s40, s30, 1
s_cmp_lg_u32 s3, 0
s_cbranch_scc1 Fo_132
s_mov_b64 exec, 0xffff
global_load_dword v31, v12, s[4:5] sc1
s_nop 15
global_load_dword v33, v12, s[4:5] sc1
s_nop 15
global_load_dword v34, v12, s[4:5] sc1
Fq_130:
s_waitcnt vmcnt(2)
v_cmp_gt_u32 vcc, s40, v31
s_nop 3
s_cbranch_vccz Fk_133
global_load_dword v31, v12, s[4:5] sc1
s_waitcnt vmcnt(2)
v_cmp_gt_u32 vcc, s40, v33
s_nop 3
s_cbranch_vccz Fk_133
global_load_dword v33, v12, s[4:5] sc1
s_waitcnt vmcnt(2)
v_cmp_gt_u32 vcc, s40, v34
s_nop 3
s_cbranch_vccz Fk_133
global_load_dword v34, v12, s[4:5] sc1
s_add_u32 s100, s100, 1
s_cmp_lt_u32 s100, 0x1000000
s_cbranch_scc1 Fq_130
s_endpgm
Fk_133:
s_mov_b64 exec, -1
Fo_132:
s_barrier
global_load_dwordx4 v[72:75], v21, s[52:53] sc1
global_load_dwordx4 v[76:79], v21, s[52:53] offset:1024 sc1
s_mov_b64 exec, s[60:61]
global_load_dwordx4 v[176:179], v16, s[52:53] sc1
s_mov_b64 exec, -1
global_load_dwordx4 v[80:83], v17, s[54:55] sc1
global_load_dwordx4 v[84:87], v17, s[54:55] offset:256 sc1
global_load_dwordx4 v[88:91], v18, s[54:55] sc1
s_waitcnt vmcnt(3) lgkmcnt(0)
s_branch Sp1_135
Sp_134:
global_load_dwordx4 v[72:75], v21, s[52:53] sc1
global_load_dwordx4 v[76:79], v21, s[52:53] offset:1024 sc1
s_mov_b64 exec, s[60:61]
global_load_dwordx4 v[176:179], v16, s[52:53] sc1
s_mov_b64 exec, -1
s_waitcnt vmcnt(0)
Sp1_135:
v_max3_u32 v30, v72, v74, v76
v_max3_u32 v30, v30, v78, v176
v_max_u32 v30, v30, v178
v_cmp_eq_u32 vcc, -1, v30
s_nop 3
s_cbranch_vccz ok_136
s_add_u32 s100, s100, 1
s_cmp_lt_u32 s100, 0x1000000
s_cbranch_scc1 Sp_134
s_endpgm
ok_136:
v_smfmac_f32_16x16x64_bf16 v[96:99], v[72:75], v[124:131], v5
v_smfmac_f32_16x16x64_bf16 v[100:103], v[72:75], v[140:147], v5
v_smfmac_f32_16x16x64_bf16 v[104:107], v[72:75], v[156:163], v5
v_smfmac_f32_16x16x64_bf16 v[96:99], v[76:79], v[132:139], v5
v_smfmac_f32_16x16x64_bf16 v[100:103], v[76:79], v[148:155], v5
v_smfmac_f32_16x16x64_bf16 v[104:107], v[76:79], v[164:171], v5
s_waitcnt vmcnt(0)
Zp_137:
v_max3_u32 v30, v80, v82, v84
v_max3_u32 v30, v30, v86, v88
v_max_u32 v30, v30, v90
v_cmp_eq_u32 vcc, -1, v30
s_nop 3
s_cbranch_vccz Zo_138
global_load_dwordx4 v[80:83], v17, s[54:55] sc1
global_load_dwordx4 v[84:87], v17, s[54:55] offset:256 sc1
global_load_dwordx4 v[88:91], v18, s[54:55] sc1
s_waitcnt vmcnt(0)
s_add_u32 s100, s100, 1
s_cmp_lt_u32 s100, 0x1000000
s_cbranch_scc1 Zp_137
s_endpgm
Zo_138:
v_mfma_f32_16x16x32_bf16 v[96:99], v[176:179], v[80:83], v[96:99]
v_mfma_f32_16x16x32_bf16 v[100:103], v[176:179], v[84:87], v[100:103]
v_mfma_f32_16x16x32_bf16 v[104:107], v[176:179], v[88:91], v[104:107]
s_nop 6
v_permlane32_swap_b32 v96, v100
v_permlane32_swap_b32 v97, v101
v_permlane32_swap_b32 v98, v102
v_permlane32_swap_b32 v99, v103
v_pk_add_f32 v[96:97], v[96:97], v[100:101]
v_pk_add_f32 v[98:99], v[98:99], v[102:103]
ds_write_b128 v22, v[96:99]
v_mov_b32 v100, v104
v_mov_b32 v101, v105
v_mov_b32 v102, v106
v_mov_b32 v103, v107
v_permlane32_swap_b32 v104, v100
v_permlane32_swap_b32 v105, v101
v_permlane32_swap_b32 v106, v102
v_permlane32_swap_b32 v107, v103
v_pk_add_f32 v[104:105], v[104:105], v[100:101]
v_pk_add_f32 v[106:107], v[106:107], v[102:103]
s_mov_b64 exec, s[64:65]
ds_write_b128 v22, v[104:107] offset:1024
s_mov_b64 exec, -1
s_cmp_lg_u32 s3, 2
s_cbranch_scc1 ew_139
s_mov_b64 exec, 1
global_store_dword v190, v191, s[4:5]
s_mov_b64 exec, -1
ew_139:
s_waitcnt lgkmcnt(0)
s_barrier
s_cmp_eq_u32 s76, 0
s_cbranch_scc1 nfin_140
s_mov_b64 exec, s[74:75]
ds_read_b128 v[36:39], v23 offset:0
ds_read_b128 v[40:43], v23 offset:1536
ds_read_b128 v[44:47], v23 offset:3072
ds_read_b128 v[48:51], v23 offset:4608
s_waitcnt lgkmcnt(2)
v_pk_add_f32 v[36:37], v[36:37], v[40:41]
v_pk_add_f32 v[38:39], v[38:39], v[42:43]
s_waitcnt lgkmcnt(0)
v_pk_add_f32 v[44:45], v[44:45], v[48:49]
v_pk_add_f32 v[46:47], v[46:47], v[50:51]
v_pk_add_f32 v[36:37], v[36:37], v[44:45]
v_pk_add_f32 v[38:39], v[38:39], v[46:47]
v_cvt_pk_bf16_f32 v30, v36, v37
v_cvt_pk_bf16_f32 v31, v38, v39
v_min_u32 v30, s70, v30
global_store_dwordx2 v24, v[30:31], s[34:35]
global_store_dwordx2 v25, v[30:31], s[34:35] sc1
s_mov_b64 exec, -1
s_branch nx_141
nfin_140:
s_cmp_lg_u32 s3, 3
s_cbranch_scc1 nx_141
global_store_dwordx4 v27, v[180:183], s[26:27] sc1
global_store_dwordx4 v26, v[180:183], s[26:27]
s_add_u32 s45, s30, 2
s_min_u32 s45, s45, 63
s_lshl_b32 s46, s45, 7
v_add_u32 v30, s46, v28
uf_142:
global_load_dword v31, v30, s[4:5] sc1
s_waitcnt vmcnt(0)
v_cmp_eq_u32 vcc, 0, v31
s_nop 3
s_cbranch_vccz ok_143
s_add_u32 s100, s100, 1
s_cmp_lt_u32 s100, 0x1000000
s_cbranch_scc1 uf_142
s_endpgm
ok_143:
nx_141:
s_add_u32 s45, s30, 1
s_min_u32 s45, s45, 63
s_lshl_b32 s46, s45, 7
v_add_u32 v30, s46, v28
uf_144:
global_load_dword v31, v30, s[4:5] sc1
s_waitcnt vmcnt(0)
v_cmp_eq_u32 vcc, 0, v31
s_nop 3
s_cbranch_vccz ok_145
s_add_u32 s100, s100, 1
s_cmp_lt_u32 s100, 0x1000000
s_cbranch_scc1 uf_144
s_endpgm
ok_145:
s_add_u32 s45, s30, 1
s_min_u32 s45, s45, 63
s_mul_i32 s44, s45, 1572864
s_add_u32 s44, s44, s33
s_add_u32 s28, s4, s44
s_addc_u32 s29, s5, 0
s_add_u32 s28, s28, 75497472
s_addc_u32 s29, s29, 0
s_and_b32 s46, s45, 1
s_mul_i32 s46, s46, 49152
s_add_u32 s32, s46, s71
s_mov_b32 m0, s32
s_nop 0
global_load_lds_dwordx4 v15, s[28:29] sc1
global_load_lds_dwordx4 v15, s[28:29] offset:1024 sc1
s_cmp_lt_u32 s77, 3
s_cbranch_scc1 dg_147
global_load_lds_dwordx4 v15, s[28:29] offset:2048 sc1
dg_147:
s_add_u32 s28, s28, 3072
s_addc_u32 s29, s29, 0
s_add_u32 s32, s32, 3072
s_mov_b32 m0, s32
s_nop 0
global_load_lds_dwordx4 v15, s[28:29] sc1
global_load_lds_dwordx4 v15, s[28:29] offset:1024 sc1
s_cmp_lt_u32 s77, 3
s_cbranch_scc1 dg_149
global_load_lds_dwordx4 v15, s[28:29] offset:2048 sc1
dg_149:
s_add_u32 s28, s28, 3072
s_addc_u32 s29, s29, 0
s_add_u32 s32, s32, 3072
s_mov_b32 m0, s32
s_nop 0
global_load_lds_dwordx4 v15, s[28:29] sc1
global_load_lds_dwordx4 v15, s[28:29] offset:1024 sc1
s_cmp_lt_u32 s77, 3
s_cbranch_scc1 dg_151
global_load_lds_dwordx4 v15, s[28:29] offset:2048 sc1
dg_151:
s_add_u32 s28, s28, 3072
s_addc_u32 s29, s29, 0
s_add_u32 s32, s32, 3072
s_mov_b32 m0, s32
s_nop 0
global_load_lds_dwordx4 v15, s[28:29] sc1
global_load_lds_dwordx4 v15, s[28:29] offset:1024 sc1
s_cmp_lt_u32 s77, 3
s_cbranch_scc1 dg_153
global_load_lds_dwordx4 v15, s[28:29] offset:2048 sc1
dg_153:
s_add_u32 s28, s28, 3072
s_addc_u32 s29, s29, 0
s_add_u32 s32, s32, 3072
s_add_u32 s30, s30, 1
.p2align 6
VOstep_110:
s_add_u32 s44, s30, 4294967295
s_and_b32 s44, s44, 3
s_mul_i32 s44, s44, 40960
s_add_u32 s44, s44, 44040192
s_add_u32 s45, s44, s18
s_add_u32 s36, s4, s45
s_addc_u32 s37, s5, 0
s_add_u32 s45, s44, s19
s_add_u32 s38, s4, s45
s_addc_u32 s39, s5, 0
v_mov_b32 v96, 0
v_mov_b32 v97, 0
v_mov_b32 v98, 0
v_mov_b32 v99, 0
v_mov_b32 v100, 0
v_mov_b32 v101, 0
v_mov_b32 v102, 0
v_mov_b32 v103, 0
s_and_b32 s44, s30, 3
s_mul_i32 s44, s44, 393216
s_add_u32 s44, s44, 44367872
s_add_u32 s54, s4, s44
s_addc_u32 s55, s5, 0
s_and_b32 s44, s30, 3
s_mul_i32 s44, s44, 20480
s_add_u32 s44, s44, 44236800
s_add_u32 s52, s4, s44
s_addc_u32 s53, s5, 0
s_and_b32 s44, s30, 3
s_mul_i32 s44, s44, 40960
s_add_u32 s44, s44, 44040192
s_add_u32 s34, s4, s44
s_addc_u32 s35, s5, 0
s_add_u32 s44, s30, 4294967294
s_and_b32 s44, s44, 3
s_mul_i32 s44, s44, 40960
s_add_u32 s44, s44, 44040192
s_add_u32 s26, s4, s44
s_addc_u32 s27, s5, 0
s_add_u32 s40, s30, 2
v_mov_b32 v191, s40
s_add_u32 s45, s30, 1
s_min_u32 s45, s45, 63
s_mul_i32 s44, s45, 1572864
s_add_u32 s44, s44, s33
s_add_u32 s28, s4, s44
s_addc_u32 s29, s5, 0
s_add_u32 s28, s28, 75497472
s_addc_u32 s29, s29, 0
s_and_b32 s46, s45, 1
s_mul_i32 s46, s46, 49152
s_add_u32 s32, s46, s71
s_cmp_eq_u32 s3, 3
s_cbranch_scc1 nd_155
s_sleep 1
s_sleep 1
s_sleep 1
nd_155:
global_load_dwordx4 v[36:39], v2, s[36:37] offset:-4096 sc1
global_load_dwordx4 v[40:43], v2, s[36:37] offset:0 sc1
global_load_dwordx4 v[44:47], v184, s[36:37] sc1
s_sleep 1
s_sleep 1
s_sleep 1
s_sleep 1
s_sleep 1
global_load_dwordx4 v[80:83], v2, s[38:39] offset:-4096 sc1
global_load_dwordx4 v[84:87], v2, s[38:39] offset:0 sc1
global_load_dwordx4 v[88:91], v184, s[38:39] sc1
s_waitcnt vmcnt(3)
Gl_156:
v_max3_u32 v30, v36, v38, v40
v_max3_u32 v30, v30, v42, v44
v_max_u32 v30, v30, v46
v_cmp_eq_u32 vcc, -1, v30
s_nop 3
s_cbranch_vccz Glo_157
global_load_dwordx4 v[36:39], v2, s[36:37] offset:-4096 sc1
global_load_dwordx4 v[40:43], v2, s[36:37] offset:0 sc1
global_load_dwordx4 v[44:47], v184, s[36:37] sc1
s_waitcnt vmcnt(0)
s_add_u32 s100, s100, 1
s_cmp_lt_u32 s100, 0x1000000
s_cbranch_scc1 Gl_156
s_endpgm
Glo_157:
v_mfma_f32_16x16x32_bf16 v[56:59], v[36:39], v[6:9], 0
v_mfma_f32_16x16x32_bf16 v[60:63], v[36:39], v[186:189], 0
v_mfma_f32_16x16x32_bf16 v[64:67], v[40:43], v[6:9], 0
v_mfma_f32_16x16x32_bf16 v[68:71], v[40:43], v[186:189], 0
v_mfma_f32_16x16x32_bf16 v[72:75], v[44:47], v[6:9], 0
v_mfma_f32_16x16x32_bf16 v[76:79], v[44:47], v[186:189], 0
s_waitcnt vmcnt(0)
Gr_158:
v_max3_u32 v30, v80, v82, v84
v_max3_u32 v30, v30, v86, v88
v_max_u32 v30, v30, v90
v_cmp_eq_u32 vcc, -1, v30
s_nop 3
s_cbranch_vccz Gro_159
global_load_dwordx4 v[80:83], v2, s[38:39] offset:-4096 sc1
global_load_dwordx4 v[84:87], v2, s[38:39] offset:0 sc1
global_load_dwordx4 v[88:91], v184, s[38:39] sc1
s_waitcnt vmcnt(0)
s_add_u32 s100, s100, 1
s_cmp_lt_u32 s100, 0x1000000
s_cbranch_scc1 Gr_158
s_endpgm
Gro_159:
v_mfma_f32_16x16x32_bf16 v[56:59], v[80:83], v[6:9], v[56:59]
v_mfma_f32_16x16x32_bf16 v[60:63], v[80:83], v[186:189], v[60:63]
v_mfma_f32_16x16x32_bf16 v[64:67], v[84:87], v[6:9], v[64:67]
v_mfma_f32_16x16x32_bf16 v[68:71], v[84:87], v[186:189], v[68:71]
v_mfma_f32_16x16x32_bf16 v[72:75], v[88:91], v[6:9], v[72:75]
v_mfma_f32_16x16x32_bf16 v[76:79], v[88:91], v[186:189], v[76:79]
s_nop 2
v_cvt_pk_bf16_f32 v36, v56, v57
v_cvt_pk_bf16_f32 v37, v58, v59
v_cvt_pk_bf16_f32 v38, v60, v61
v_cvt_pk_bf16_f32 v39, v62, v63
ds_write_b128 v3, v[36:39] offset:0
v_cvt_pk_bf16_f32 v40, v64, v65
v_cvt_pk_bf16_f32 v41, v66, v67
v_cvt_pk_bf16_f32 v42, v68, v69
v_cvt_pk_bf16_f32 v43, v70, v71
ds_write_b128 v3, v[40:43] offset:4096
v_cvt_pk_bf16_f32 v44, v72, v73
v_cvt_pk_bf16_f32 v45, v74, v75
v_cvt_pk_bf16_f32 v46, v76, v77
v_cvt_pk_bf16_f32 v47, v78, v79
ds_write_b128 v185, v[44:47]
s_waitcnt lgkmcnt(0)
Gs_154:
s_barrier
ds_read_b128 v[56:59], v4 offset:0
ds_read_b128 v[60:63], v4 offset:1024
ds_read_b128 v[64:67], v4 offset:2048
ds_read_b128 v[68:71], v4 offset:3072
ds_read_b128 v[72:75], v4 offset:4096
ds_read_b128 v[76:79], v4 offset:5120
ds_read_b128 v[80:83], v4 offset:6144
ds_read_b128 v[84:87], v4 offset:7168
ds_read_b128 v[88:91], v4 offset:8192
ds_read_b128 v[92:95], v4 offset:9216
s_waitcnt lgkmcnt(9)
v_smfmac_f32_16x16x64_bf16 v[96:99], v[56:59], a[0:7], v5
v_smfmac_f32_16x16x64_bf16 v[100:103], v[56:59], a[80:87], v5
v_mov_b32 v56, 0
v_mov_b32 v57, 0
v_mov_b32 v58, 0
v_mov_b32 v59, 0
s_waitcnt lgkmcnt(8)
v_smfmac_f32_16x16x64_bf16 v[96:99], v[60:63], a[8:15], v5
v_smfmac_f32_16x16x64_bf16 v[100:103], v[60:63], a[88:95], v5
v_mov_b32 v60, 0
v_mov_b32 v61, 0
v_mov_b32 v62, 0
v_mov_b32 v63, 0
s_mov_b32 m0, s32
s_nop 0
global_load_lds_dwordx4 v15, s[28:29] sc1
global_load_lds_dwordx4 v15, s[28:29] offset:1024 sc1
s_cmp_lt_u32 s77, 3
s_cbranch_scc1 dg_161
global_load_lds_dwordx4 v15, s[28:29] offset:2048 sc1
dg_161:
s_add_u32 s28, s28, 3072
s_addc_u32 s29, s29, 0
s_add_u32 s32, s32, 3072
s_waitcnt lgkmcnt(7)
v_smfmac_f32_16x16x64_bf16 v[96:99], v[64:67], a[16:23], v5
v_smfmac_f32_16x16x64_bf16 v[100:103], v[64:67], a[96:103], v5
v_mov_b32 v64, 0
v_mov_b32 v65, 0
v_mov_b32 v66, 0
v_mov_b32 v67, 0
s_waitcnt lgkmcnt(6)
v_smfmac_f32_16x16x64_bf16 v[96:99], v[68:71], a[24:31], v5
v_smfmac_f32_16x16x64_bf16 v[100:103], v[68:71], a[104:111], v5
v_mov_b32 v68, 0
v_mov_b32 v69, 0
v_mov_b32 v70, 0
v_mov_b32 v71, 0
s_waitcnt lgkmcnt(5)
v_smfmac_f32_16x16x64_bf16 v[96:99], v[72:75], a[32:39], v5
v_smfmac_f32_16x16x64_bf16 v[100:103], v[72:75], a[112:119], v5
v_mov_b32 v72, 0
v_mov_b32 v73, 0
v_mov_b32 v74, 0
v_mov_b32 v75, 0
s_mov_b32 m0, s32
s_nop 0
global_load_lds_dwordx4 v15, s[28:29] sc1
global_load_lds_dwordx4 v15, s[28:29] offset:1024 sc1
s_cmp_lt_u32 s77, 3
s_cbranch_scc1 dg_163
global_load_lds_dwordx4 v15, s[28:29] offset:2048 sc1
dg_163:
s_add_u32 s28, s28, 3072
s_addc_u32 s29, s29, 0
s_add_u32 s32, s32, 3072
s_waitcnt lgkmcnt(4)
v_smfmac_f32_16x16x64_bf16 v[96:99], v[76:79], a[40:47], v5
v_smfmac_f32_16x16x64_bf16 v[100:103], v[76:79], a[120:127], v5
v_mov_b32 v76, 0
v_mov_b32 v77, 0
v_mov_b32 v78, 0
v_mov_b32 v79, 0
s_waitcnt lgkmcnt(3)
v_smfmac_f32_16x16x64_bf16 v[96:99], v[80:83], a[48:55], v5
v_smfmac_f32_16x16x64_bf16 v[100:103], v[80:83], a[128:135], v5
v_mov_b32 v80, 0
v_mov_b32 v81, 0
v_mov_b32 v82, 0
v_mov_b32 v83, 0
s_waitcnt lgkmcnt(2)
v_smfmac_f32_16x16x64_bf16 v[96:99], v[84:87], a[56:63], v5
v_smfmac_f32_16x16x64_bf16 v[100:103], v[84:87], a[136:143], v5
v_mov_b32 v84, 0
v_mov_b32 v85, 0
v_mov_b32 v86, 0
v_mov_b32 v87, 0
s_mov_b32 m0, s32
s_nop 0
global_load_lds_dwordx4 v15, s[28:29] sc1
global_load_lds_dwordx4 v15, s[28:29] offset:1024 sc1
s_cmp_lt_u32 s77, 3
s_cbranch_scc1 dg_165
global_load_lds_dwordx4 v15, s[28:29] offset:2048 sc1
dg_165:
s_add_u32 s28, s28, 3072
s_addc_u32 s29, s29, 0
s_add_u32 s32, s32, 3072
s_waitcnt lgkmcnt(1)
v_smfmac_f32_16x16x64_bf16 v[96:99], v[88:91], a[64:71], v5
v_smfmac_f32_16x16x64_bf16 v[100:103], v[88:91], a[144:151], v5
v_mov_b32 v88, 0
v_mov_b32 v89, 0
v_mov_b32 v90, 0
v_mov_b32 v91, 0
s_waitcnt lgkmcnt(0)
v_smfmac_f32_16x16x64_bf16 v[96:99], v[92:95], a[72:79], v5
v_smfmac_f32_16x16x64_bf16 v[100:103], v[92:95], a[152:159], v5
v_mov_b32 v92, 0
v_mov_b32 v93, 0
v_mov_b32 v94, 0
v_mov_b32 v95, 0
s_nop 3
v_permlane32_swap_b32 v96, v100
v_permlane32_swap_b32 v97, v101
v_permlane32_swap_b32 v98, v102
v_permlane32_swap_b32 v99, v103
v_pk_add_f32 v[96:97], v[96:97], v[100:101]
v_pk_add_f32 v[98:99], v[98:99], v[102:103]
v_cvt_pk_bf16_f32 v44, v96, v97
v_cvt_pk_bf16_f32 v45, v98, v99
ds_write_b64 v10, v[44:45]
s_waitcnt lgkmcnt(0)
s_barrier
ds_read_b64_tr_b16 v[36:37], v11 offset:0
ds_read_b64_tr_b16 v[38:39], v11 offset:128
ds_read_b64_tr_b16 v[40:41], v11 offset:1024
ds_read_b64_tr_b16 v[42:43], v11 offset:1152
s_waitcnt lgkmcnt(0)
v_smfmac_f32_16x16x64_bf16 v[56:59], v[36:39], a[160:167], v5
v_smfmac_f32_16x16x64_bf16 v[60:63], v[36:39], a[176:183], v5
v_smfmac_f32_16x16x64_bf16 v[56:59], v[40:43], a[168:175], v5
v_smfmac_f32_16x16x64_bf16 v[60:63], v[40:43], a[184:191], v5
s_mov_b32 m0, s32
s_nop 0
global_load_lds_dwordx4 v15, s[28:29] sc1
global_load_lds_dwordx4 v15, s[28:29] offset:1024 sc1
s_cmp_lt_u32 s77, 3
s_cbranch_scc1 dg_167
global_load_lds_dwordx4 v15, s[28:29] offset:2048 sc1
dg_167:
s_add_u32 s28, s28, 3072
s_addc_u32 s29, s29, 0
s_add_u32 s32, s32, 3072
v_smfmac_f32_16x16x64_bf16 v[64:67], v[36:39], a[192:199], v5
v_smfmac_f32_16x16x64_bf16 v[68:71], v[36:39], a[208:215], v5
v_permlane32_swap_b32 v56, v60
v_permlane32_swap_b32 v57, v61
v_permlane32_swap_b32 v58, v62
v_smfmac_f32_16x16x64_bf16 v[64:67], v[40:43], a[200:207], v5
v_permlane32_swap_b32 v59, v63
v_pk_add_f32 v[56:57], v[56:57], v[60:61]
v_pk_add_f32 v[58:59], v[58:59], v[62:63]
v_smfmac_f32_16x16x64_bf16 v[68:71], v[40:43], a[216:223], v5
v_cvt_pk_bf16_f32 v46, v56, v57
v_cvt_pk_bf16_f32 v47, v58, v59
v_min_u32 v46, s70, v46
global_store_dwordx2 v13, v[46:47], s[54:55] offset:0
v_smfmac_f32_16x16x64_bf16 v[72:75], v[36:39], a[224:231], v5
v_smfmac_f32_16x16x64_bf16 v[76:79], v[36:39], a[240:247], v5
s_nop 1
v_permlane32_swap_b32 v64, v68
v_permlane32_swap_b32 v65, v69
v_permlane32_swap_b32 v66, v70
v_smfmac_f32_16x16x64_bf16 v[72:75], v[40:43], a[232:239], v5
v_permlane32_swap_b32 v67, v71
v_pk_add_f32 v[64:65], v[64:65], v[68:69]
v_pk_add_f32 v[66:67], v[66:67], v[70:71]
v_smfmac_f32_16x16x64_bf16 v[76:79], v[40:43], a[248:255], v5
v_cvt_pk_bf16_f32 v48, v64, v65
v_cvt_pk_bf16_f32 v49, v66, v67
v_min_u32 v48, s70, v48
global_store_dwordx2 v14, v[48:49], s[54:55] offset:0
v_smfmac_f32_16x16x64_bf16 v[80:83], v[36:39], v[192:199], v5
v_smfmac_f32_16x16x64_bf16 v[84:87], v[36:39], v[208:215], v5
s_nop 1
v_permlane32_swap_b32 v72, v76
v_permlane32_swap_b32 v73, v77
v_permlane32_swap_b32 v74, v78
v_smfmac_f32_16x16x64_bf16 v[80:83], v[40:43], v[200:207], v5
v_permlane32_swap_b32 v75, v79
v_pk_add_f32 v[72:73], v[72:73], v[76:77]
v_pk_add_f32 v[74:75], v[74:75], v[78:79]
v_smfmac_f32_16x16x64_bf16 v[84:87], v[40:43], v[216:223], v5
v_cvt_pk_bf16_f32 v50, v72, v73
v_cvt_pk_bf16_f32 v51, v74, v75
v_min_u32 v50, s70, v50
global_store_dwordx2 v13, v[50:51], s[54:55] offset:256
v_smfmac_f32_16x16x64_bf16 v[88:91], v[36:39], v[224:231], v5
v_smfmac_f32_16x16x64_bf16 v[92:95], v[36:39], v[240:247], v5
s_nop 1
v_permlane32_swap_b32 v80, v84
v_permlane32_swap_b32 v81, v85
v_permlane32_swap_b32 v82, v86
v_smfmac_f32_16x16x64_bf16 v[88:91], v[40:43], v[232:239], v5
v_permlane32_swap_b32 v83, v87
v_pk_add_f32 v[80:81], v[80:81], v[84:85]
v_pk_add_f32 v[82:83], v[82:83], v[86:87]
v_smfmac_f32_16x16x64_bf16 v[92:95], v[40:43], v[248:255], v5
v_cvt_pk_bf16_f32 v52, v80, v81
v_cvt_pk_bf16_f32 v53, v82, v83
v_min_u32 v52, s70, v52
global_store_dwordx2 v14, v[52:53], s[54:55] offset:256
s_nop 3
v_permlane32_swap_b32 v88, v92
v_permlane32_swap_b32 v89, v93
v_permlane32_swap_b32 v90, v94
v_permlane32_swap_b32 v91, v95
v_pk_add_f32 v[88:89], v[88:89], v[92:93]
v_pk_add_f32 v[90:91], v[90:91], v[94:95]
v_cvt_pk_bf16_f32 v54, v88, v89
v_cvt_pk_bf16_f32 v55, v90, v91
v_min_u32 v54, s70, v54
global_store_dwordx2 v13, v[54:55], s[54:55] offset:512
s_cmp_eq_u32 s30, 63
s_cbranch_scc1 VOlast_111
s_bitcmp1_b32 s30, 0
s_cbranch_scc1 ub1_168
ds_read_b128 v[124:127], v19 offset:0
ds_read_b128 v[140:143], v19 offset:1024
ds_read_b128 v[156:159], v19 offset:2048
ds_read_b128 v[128:131], v19 offset:3072
ds_read_b128 v[144:147], v19 offset:4096
ds_read_b128 v[160:163], v19 offset:5120
ds_read_b128 v[132:135], v19 offset:6144
ds_read_b128 v[148:151], v19 offset:7168
ds_read_b128 v[164:167], v19 offset:8192
ds_read_b128 v[136:139], v19 offset:9216
ds_read_b128 v[152:155], v19 offset:10240
ds_read_b128 v[168:171], v19 offset:11264
s_branch ub2_169
ub1_168:
ds_read_b128 v[124:127], v20 offset:0
ds_read_b128 v[140:143], v20 offset:1024
ds_read_b128 v[156:159], v20 offset:2048
ds_read_b128 v[128:131], v20 offset:3072
ds_read_b128 v[144:147], v20 offset:4096
ds_read_b128 v[160:163], v20 offset:5120
ds_read_b128 v[132:135], v20 offset:6144
ds_read_b128 v[148:151], v20 offset:7168
ds_read_b128 v[164:167], v20 offset:8192
ds_read_b128 v[136:139], v20 offset:9216
ds_read_b128 v[152:155], v20 offset:10240
ds_read_b128 v[168:171], v20 offset:11264
ub2_169:
v_mov_b32 v96, 0
v_mov_b32 v97, 0
v_mov_b32 v98, 0
v_mov_b32 v99, 0
v_mov_b32 v100, 0
v_mov_b32 v101, 0
v_mov_b32 v102, 0
v_mov_b32 v103, 0
v_mov_b32 v104, 0
v_mov_b32 v105, 0
v_mov_b32 v106, 0
v_mov_b32 v107, 0
s_add_u32 s40, s30, 1
s_cmp_lg_u32 s3, 0
s_cbranch_scc1 Fo_172
s_mov_b64 exec, 0xffff
global_load_dword v31, v12, s[4:5] sc1
s_nop 15
global_load_dword v33, v12, s[4:5] sc1
s_nop 15
global_load_dword v34, v12, s[4:5] sc1
Fq_170:
s_waitcnt vmcnt(2)
v_cmp_gt_u32 vcc, s40, v31
s_nop 3
s_cbranch_vccz Fk_173
global_load_dword v31, v12, s[4:5] sc1
s_waitcnt vmcnt(2)
v_cmp_gt_u32 vcc, s40, v33
s_nop 3
s_cbranch_vccz Fk_173
global_load_dword v33, v12, s[4:5] sc1
s_waitcnt vmcnt(2)
v_cmp_gt_u32 vcc, s40, v34
s_nop 3
s_cbranch_vccz Fk_173
global_load_dword v34, v12, s[4:5] sc1
s_add_u32 s100, s100, 1
s_cmp_lt_u32 s100, 0x1000000
s_cbranch_scc1 Fq_170
s_endpgm
Fk_173:
s_mov_b64 exec, -1
Fo_172:
s_barrier
global_load_dwordx4 v[72:75], v21, s[52:53] sc1
global_load_dwordx4 v[76:79], v21, s[52:53] offset:1024 sc1
s_mov_b64 exec, s[60:61]
global_load_dwordx4 v[176:179], v16, s[52:53] sc1
s_mov_b64 exec, -1
global_load_dwordx4 v[80:83], v17, s[54:55] sc1
global_load_dwordx4 v[84:87], v17, s[54:55] offset:256 sc1
global_load_dwordx4 v[88:91], v18, s[54:55] sc1
s_waitcnt vmcnt(3) lgkmcnt(0)
s_branch Sp1_175
Sp_174:
global_load_dwordx4 v[72:75], v21, s[52:53] sc1
global_load_dwordx4 v[76:79], v21, s[52:53] offset:1024 sc1
s_mov_b64 exec, s[60:61]
global_load_dwordx4 v[176:179], v16, s[52:53] sc1
s_mov_b64 exec, -1
s_waitcnt vmcnt(0)
Sp1_175:
v_max3_u32 v30, v72, v74, v76
v_max3_u32 v30, v30, v78, v176
v_max_u32 v30, v30, v178
v_cmp_eq_u32 vcc, -1, v30
s_nop 3
s_cbranch_vccz ok_176
s_add_u32 s100, s100, 1
s_cmp_lt_u32 s100, 0x1000000
s_cbranch_scc1 Sp_174
s_endpgm
ok_176:
v_smfmac_f32_16x16x64_bf16 v[96:99], v[72:75], v[124:131], v5
v_smfmac_f32_16x16x64_bf16 v[100:103], v[72:75], v[140:147], v5
v_smfmac_f32_16x16x64_bf16 v[104:107], v[72:75], v[156:163], v5
v_smfmac_f32_16x16x64_bf16 v[96:99], v[76:79], v[132:139], v5
v_smfmac_f32_16x16x64_bf16 v[100:103], v[76:79], v[148:155], v5
v_smfmac_f32_16x16x64_bf16 v[104:107], v[76:79], v[164:171], v5
s_waitcnt vmcnt(0)
Zp_177:
v_max3_u32 v30, v80, v82, v84
v_max3_u32 v30, v30, v86, v88
v_max_u32 v30, v30, v90
v_cmp_eq_u32 vcc, -1, v30
s_nop 3
s_cbranch_vccz Zo_178
global_load_dwordx4 v[80:83], v17, s[54:55] sc1
global_load_dwordx4 v[84:87], v17, s[54:55] offset:256 sc1
global_load_dwordx4 v[88:91], v18, s[54:55] sc1
s_waitcnt vmcnt(0)
s_add_u32 s100, s100, 1
s_cmp_lt_u32 s100, 0x1000000
s_cbranch_scc1 Zp_177
s_endpgm
Zo_178:
v_mfma_f32_16x16x32_bf16 v[96:99], v[176:179], v[80:83], v[96:99]
v_mfma_f32_16x16x32_bf16 v[100:103], v[176:179], v[84:87], v[100:103]
v_mfma_f32_16x16x32_bf16 v[104:107], v[176:179], v[88:91], v[104:107]
s_nop 6
v_permlane32_swap_b32 v96, v100
v_permlane32_swap_b32 v97, v101
v_permlane32_swap_b32 v98, v102
v_permlane32_swap_b32 v99, v103
v_pk_add_f32 v[96:97], v[96:97], v[100:101]
v_pk_add_f32 v[98:99], v[98:99], v[102:103]
ds_write_b128 v22, v[96:99]
v_mov_b32 v100, v104
v_mov_b32 v101, v105
v_mov_b32 v102, v106
v_mov_b32 v103, v107
v_permlane32_swap_b32 v104, v100
v_permlane32_swap_b32 v105, v101
v_permlane32_swap_b32 v106, v102
v_permlane32_swap_b32 v107, v103
v_pk_add_f32 v[104:105], v[104:105], v[100:101]
v_pk_add_f32 v[106:107], v[106:107], v[102:103]
s_mov_b64 exec, s[64:65]
ds_write_b128 v22, v[104:107] offset:1024
s_mov_b64 exec, -1
s_cmp_lg_u32 s3, 2
s_cbranch_scc1 ew_179
s_mov_b64 exec, 1
global_store_dword v190, v191, s[4:5]
s_mov_b64 exec, -1
ew_179:
s_waitcnt lgkmcnt(0)
s_barrier
s_cmp_eq_u32 s76, 0
s_cbranch_scc1 nfin_180
s_mov_b64 exec, s[74:75]
ds_read_b128 v[36:39], v23 offset:0
ds_read_b128 v[40:43], v23 offset:1536
ds_read_b128 v[44:47], v23 offset:3072
ds_read_b128 v[48:51], v23 offset:4608
s_waitcnt lgkmcnt(2)
v_pk_add_f32 v[36:37], v[36:37], v[40:41]
v_pk_add_f32 v[38:39], v[38:39], v[42:43]
s_waitcnt lgkmcnt(0)
v_pk_add_f32 v[44:45], v[44:45], v[48:49]
v_pk_add_f32 v[46:47], v[46:47], v[50:51]
v_pk_add_f32 v[36:37], v[36:37], v[44:45]
v_pk_add_f32 v[38:39], v[38:39], v[46:47]
v_cvt_pk_bf16_f32 v30, v36, v37
v_cvt_pk_bf16_f32 v31, v38, v39
v_min_u32 v30, s70, v30
global_store_dwordx2 v24, v[30:31], s[34:35]
global_store_dwordx2 v25, v[30:31], s[34:35] sc1
s_mov_b64 exec, -1
s_branch nx_181
nfin_180:
s_cmp_lg_u32 s3, 3
s_cbranch_scc1 nx_181
global_store_dwordx4 v27, v[180:183], s[26:27] sc1
global_store_dwordx4 v26, v[180:183], s[26:27]
s_add_u32 s45, s30, 2
s_min_u32 s45, s45, 63
s_lshl_b32 s46, s45, 7
v_add_u32 v30, s46, v28
uf_182:
global_load_dword v31, v30, s[4:5] sc1
s_waitcnt vmcnt(0)
v_cmp_eq_u32 vcc, 0, v31
s_nop 3
s_cbranch_vccz ok_183
s_add_u32 s100, s100, 1
s_cmp_lt_u32 s100, 0x1000000
s_cbranch_scc1 uf_182
s_endpgm
ok_183:
nx_181:
s_add_u32 s30, s30, 1
s_branch VOstep_110
VOlast_111:
s_waitcnt vmcnt(0)
s_endpgm
L_chain_safe:
s_cmp_ge_u32 s17, 16
s_cbranch_scc1 L_vo_s
s_mov_b32 s60, 0x00ff00ff
s_mov_b32 s61, 0x00ff00ff
s_mov_b32 s62, 0
s_mov_b32 s63, 0x00ff00ff
s_mov_b32 s64, -1
s_mov_b32 s65, 0
s_mov_b32 s72, 0xff00ff00
s_mov_b32 s73, 0xff00ff00
s_mov_b32 s66, 0x3e0293ee
s_mov_b32 s67, 0x3e0293ee
s_mov_b32 s70, 0xfffffffe
s_load_dwordx2 s[8:9], s[0:1], 88
s_load_dwordx2 s[10:11], s[0:1], 96
s_waitcnt lgkmcnt(0)
v_lshrrev_b32 v34, 4, v1
v_lshlrev_b32 v34, 13, v34
v_and_b32 v35, 15, v1
v_lshl_add_u32 v34, v35, 4, v34
s_cmp_lt_u32 s3, 2
s_cselect_b32 s12, s8, s10
s_cselect_b32 s13, s9, s11
s_and_b32 s40, s3, 1
s_lshl_b32 s40, s40, 18
s_lshl_b32 s41, s16, 8
s_add_u32 s40, s40, s41
s_add_u32 s12, s12, s40
s_addc_u32 s13, s13, 0
s_mov_b32 s43, 32768
v_lshrrev_b32 v30, 4, v1
v_mul_u32_u24 v10, 2176, v30
v_bfe_u32 v30, v1, 2, 2
v_lshl_add_u32 v10, v30, 8, v10
v_and_b32 v30, 3, v1
v_lshl_add_u32 v10, v30, 3, v10
s_lshl_b32 s40, s3, 6
v_add_u32 v10, s40, v10
s_add_u32 s40, s12, 0
s_addc_u32 s41, s13, 0
s_mul_i32 s44, s3, 8704
s_add_u32 s44, s44, 0
v_mov_b32 v35, v34
s_add_u32 m0, s44, 0
s_nop 0
global_load_lds_dwordx4 v35, s[40:41]
v_add_u32 v35, s43, v35
s_add_u32 m0, s44, 1088
s_nop 0
global_load_lds_dwordx4 v35, s[40:41]
v_add_u32 v35, s43, v35
s_add_u32 m0, s44, 2176
s_nop 0
global_load_lds_dwordx4 v35, s[40:41]
v_add_u32 v35, s43, v35
s_add_u32 m0, s44, 3264
s_nop 0
global_load_lds_dwordx4 v35, s[40:41]
v_add_u32 v35, s43, v35
s_add_u32 m0, s44, 4352
s_nop 0
global_load_lds_dwordx4 v35, s[40:41]
v_add_u32 v35, s43, v35
s_add_u32 m0, s44, 5440
s_nop 0
global_load_lds_dwordx4 v35, s[40:41]
v_add_u32 v35, s43, v35
s_add_u32 m0, s44, 6528
s_nop 0
global_load_lds_dwordx4 v35, s[40:41]
v_add_u32 v35, s43, v35
s_add_u32 m0, s44, 7616
s_nop 0
global_load_lds_dwordx4 v35, s[40:41]
s_add_u32 s40, s12, 524288
s_addc_u32 s41, s13, 0
s_mul_i32 s44, s3, 8704
s_add_u32 s44, s44, 34816
v_mov_b32 v35, v34
s_add_u32 m0, s44, 0
s_nop 0
global_load_lds_dwordx4 v35, s[40:41]
v_add_u32 v35, s43, v35
s_add_u32 m0, s44, 1088
s_nop 0
global_load_lds_dwordx4 v35, s[40:41]
v_add_u32 v35, s43, v35
s_add_u32 m0, s44, 2176
s_nop 0
global_load_lds_dwordx4 v35, s[40:41]
v_add_u32 v35, s43, v35
s_add_u32 m0, s44, 3264
s_nop 0
global_load_lds_dwordx4 v35, s[40:41]
v_add_u32 v35, s43, v35
s_add_u32 m0, s44, 4352
s_nop 0
global_load_lds_dwordx4 v35, s[40:41]
v_add_u32 v35, s43, v35
s_add_u32 m0, s44, 5440
s_nop 0
global_load_lds_dwordx4 v35, s[40:41]
v_add_u32 v35, s43, v35
s_add_u32 m0, s44, 6528
s_nop 0
global_load_lds_dwordx4 v35, s[40:41]
v_add_u32 v35, s43, v35
s_add_u32 m0, s44, 7616
s_nop 0
global_load_lds_dwordx4 v35, s[40:41]
s_add_u32 s40, s12, 1048576
s_addc_u32 s41, s13, 0
s_mul_i32 s44, s3, 8704
s_add_u32 s44, s44, 69632
v_mov_b32 v35, v34
s_add_u32 m0, s44, 0
s_nop 0
global_load_lds_dwordx4 v35, s[40:41]
v_add_u32 v35, s43, v35
s_add_u32 m0, s44, 1088
s_nop 0
global_load_lds_dwordx4 v35, s[40:41]
v_add_u32 v35, s43, v35
s_add_u32 m0, s44, 2176
s_nop 0
global_load_lds_dwordx4 v35, s[40:41]
v_add_u32 v35, s43, v35
s_add_u32 m0, s44, 3264
s_nop 0
global_load_lds_dwordx4 v35, s[40:41]
v_add_u32 v35, s43, v35
s_add_u32 m0, s44, 4352
s_nop 0
global_load_lds_dwordx4 v35, s[40:41]
v_add_u32 v35, s43, v35
s_add_u32 m0, s44, 5440
s_nop 0
global_load_lds_dwordx4 v35, s[40:41]
v_add_u32 v35, s43, v35
s_add_u32 m0, s44, 6528
s_nop 0
global_load_lds_dwordx4 v35, s[40:41]
v_add_u32 v35, s43, v35
s_add_u32 m0, s44, 7616
s_nop 0
global_load_lds_dwordx4 v35, s[40:41]
s_add_u32 s40, s12, 1572864
s_addc_u32 s41, s13, 0
s_mul_i32 s44, s3, 8704
s_add_u32 s44, s44, 104448
v_mov_b32 v35, v34
s_add_u32 m0, s44, 0
s_nop 0
global_load_lds_dwordx4 v35, s[40:41]
v_add_u32 v35, s43, v35
s_add_u32 m0, s44, 1088
s_nop 0
global_load_lds_dwordx4 v35, s[40:41]
v_add_u32 v35, s43, v35
s_add_u32 m0, s44, 2176
s_nop 0
global_load_lds_dwordx4 v35, s[40:41]
v_add_u32 v35, s43, v35
s_add_u32 m0, s44, 3264
s_nop 0
global_load_lds_dwordx4 v35, s[40:41]
v_add_u32 v35, s43, v35
s_add_u32 m0, s44, 4352
s_nop 0
global_load_lds_dwordx4 v35, s[40:41]
v_add_u32 v35, s43, v35
s_add_u32 m0, s44, 5440
s_nop 0
global_load_lds_dwordx4 v35, s[40:41]
v_add_u32 v35, s43, v35
s_add_u32 m0, s44, 6528
s_nop 0
global_load_lds_dwordx4 v35, s[40:41]
v_add_u32 v35, s43, v35
s_add_u32 m0, s44, 7616
s_nop 0
global_load_lds_dwordx4 v35, s[40:41]
s_cmp_lg_u32 s101, 0
s_cbranch_scc1 arr_184
s_cmp_lg_u32 s99, 0
s_cbranch_scc1 arr_184
s_waitcnt vmcnt(32)
s_barrier
s_cmp_lg_u32 s3, 0
s_cbranch_scc1 arr_184
v_mov_b32 v30, 64
v_mov_b32 v31, 1
s_mov_b64 exec, 1
global_atomic_add v30, v31, s[6:7]
s_mov_b64 exec, -1
arr_184:
s_waitcnt vmcnt(24)
s_barrier
v_add_u32 v33, 0, v10
ds_read_b64_tr_b16 a[0:1], v33 offset:0
ds_read_b64_tr_b16 a[2:3], v33 offset:1088
ds_read_b64_tr_b16 a[4:5], v33 offset:8704
ds_read_b64_tr_b16 a[6:7], v33 offset:9792
ds_read_b64_tr_b16 a[80:81], v33 offset:32
ds_read_b64_tr_b16 a[82:83], v33 offset:1120
ds_read_b64_tr_b16 a[84:85], v33 offset:8736
ds_read_b64_tr_b16 a[86:87], v33 offset:9824
ds_read_b64_tr_b16 a[160:161], v33 offset:17408
ds_read_b64_tr_b16 a[162:163], v33 offset:18496
ds_read_b64_tr_b16 a[164:165], v33 offset:26112
ds_read_b64_tr_b16 a[166:167], v33 offset:27200
ds_read_b64_tr_b16 a[240:241], v33 offset:17440
ds_read_b64_tr_b16 a[242:243], v33 offset:18528
ds_read_b64_tr_b16 a[244:245], v33 offset:26144
ds_read_b64_tr_b16 a[246:247], v33 offset:27232
s_waitcnt lgkmcnt(0)
s_barrier
s_add_u32 s40, s12, 2097152
s_addc_u32 s41, s13, 0
s_mul_i32 s44, s3, 8704
s_add_u32 s44, s44, 0
v_mov_b32 v35, v34
s_add_u32 m0, s44, 0
s_nop 0
global_load_lds_dwordx4 v35, s[40:41]
v_add_u32 v35, s43, v35
s_add_u32 m0, s44, 1088
s_nop 0
global_load_lds_dwordx4 v35, s[40:41]
v_add_u32 v35, s43, v35
s_add_u32 m0, s44, 2176
s_nop 0
global_load_lds_dwordx4 v35, s[40:41]
v_add_u32 v35, s43, v35
s_add_u32 m0, s44, 3264
s_nop 0
global_load_lds_dwordx4 v35, s[40:41]
v_add_u32 v35, s43, v35
s_add_u32 m0, s44, 4352
s_nop 0
global_load_lds_dwordx4 v35, s[40:41]
v_add_u32 v35, s43, v35
s_add_u32 m0, s44, 5440
s_nop 0
global_load_lds_dwordx4 v35, s[40:41]
v_add_u32 v35, s43, v35
s_add_u32 m0, s44, 6528
s_nop 0
global_load_lds_dwordx4 v35, s[40:41]
v_add_u32 v35, s43, v35
s_add_u32 m0, s44, 7616
s_nop 0
global_load_lds_dwordx4 v35, s[40:41]
s_waitcnt vmcnt(24)
s_barrier
v_add_u32 v33, 34816, v10
ds_read_b64_tr_b16 a[8:9], v33 offset:0
ds_read_b64_tr_b16 a[10:11], v33 offset:1088
ds_read_b64_tr_b16 a[12:13], v33 offset:8704
ds_read_b64_tr_b16 a[14:15], v33 offset:9792
ds_read_b64_tr_b16 a[88:89], v33 offset:32
ds_read_b64_tr_b16 a[90:91], v33 offset:1120
ds_read_b64_tr_b16 a[92:93], v33 offset:8736
ds_read_b64_tr_b16 a[94:95], v33 offset:9824
ds_read_b64_tr_b16 a[168:169], v33 offset:17408
ds_read_b64_tr_b16 a[170:171], v33 offset:18496
ds_read_b64_tr_b16 a[172:173], v33 offset:26112
ds_read_b64_tr_b16 a[174:175], v33 offset:27200
ds_read_b64_tr_b16 a[248:249], v33 offset:17440
ds_read_b64_tr_b16 a[250:251], v33 offset:18528
ds_read_b64_tr_b16 a[252:253], v33 offset:26144
ds_read_b64_tr_b16 a[254:255], v33 offset:27232
s_waitcnt lgkmcnt(0)
s_barrier
s_add_u32 s40, s12, 2621440
s_addc_u32 s41, s13, 0
s_mul_i32 s44, s3, 8704
s_add_u32 s44, s44, 34816
v_mov_b32 v35, v34
s_add_u32 m0, s44, 0
s_nop 0
global_load_lds_dwordx4 v35, s[40:41]
v_add_u32 v35, s43, v35
s_add_u32 m0, s44, 1088
s_nop 0
global_load_lds_dwordx4 v35, s[40:41]
v_add_u32 v35, s43, v35
s_add_u32 m0, s44, 2176
s_nop 0
global_load_lds_dwordx4 v35, s[40:41]
v_add_u32 v35, s43, v35
s_add_u32 m0, s44, 3264
s_nop 0
global_load_lds_dwordx4 v35, s[40:41]
v_add_u32 v35, s43, v35
s_add_u32 m0, s44, 4352
s_nop 0
global_load_lds_dwordx4 v35, s[40:41]
v_add_u32 v35, s43, v35
s_add_u32 m0, s44, 5440
s_nop 0
global_load_lds_dwordx4 v35, s[40:41]
v_add_u32 v35, s43, v35
s_add_u32 m0, s44, 6528
s_nop 0
global_load_lds_dwordx4 v35, s[40:41]
v_add_u32 v35, s43, v35
s_add_u32 m0, s44, 7616
s_nop 0
global_load_lds_dwordx4 v35, s[40:41]
s_waitcnt vmcnt(24)
s_barrier
v_add_u32 v33, 69632, v10
ds_read_b64_tr_b16 a[16:17], v33 offset:0
ds_read_b64_tr_b16 a[18:19], v33 offset:1088
ds_read_b64_tr_b16 a[20:21], v33 offset:8704
ds_read_b64_tr_b16 a[22:23], v33 offset:9792
ds_read_b64_tr_b16 a[96:97], v33 offset:32
ds_read_b64_tr_b16 a[98:99], v33 offset:1120
ds_read_b64_tr_b16 a[100:101], v33 offset:8736
ds_read_b64_tr_b16 a[102:103], v33 offset:9824
ds_read_b64_tr_b16 a[176:177], v33 offset:17408
ds_read_b64_tr_b16 a[178:179], v33 offset:18496
ds_read_b64_tr_b16 a[180:181], v33 offset:26112
ds_read_b64_tr_b16 a[182:183], v33 offset:27200
ds_read_b64_tr_b16 v[192:193], v33 offset:17440
ds_read_b64_tr_b16 v[194:195], v33 offset:18528
ds_read_b64_tr_b16 v[196:197], v33 offset:26144
ds_read_b64_tr_b16 v[198:199], v33 offset:27232
s_waitcnt lgkmcnt(0)
s_barrier
s_add_u32 s40, s12, 3145728
s_addc_u32 s41, s13, 0
s_mul_i32 s44, s3, 8704
s_add_u32 s44, s44, 69632
v_mov_b32 v35, v34
s_add_u32 m0, s44, 0
s_nop 0
global_load_lds_dwordx4 v35, s[40:41]
v_add_u32 v35, s43, v35
s_add_u32 m0, s44, 1088
s_nop 0
global_load_lds_dwordx4 v35, s[40:41]
v_add_u32 v35, s43, v35
s_add_u32 m0, s44, 2176
s_nop 0
global_load_lds_dwordx4 v35, s[40:41]
v_add_u32 v35, s43, v35
s_add_u32 m0, s44, 3264
s_nop 0
global_load_lds_dwordx4 v35, s[40:41]
v_add_u32 v35, s43, v35
s_add_u32 m0, s44, 4352
s_nop 0
global_load_lds_dwordx4 v35, s[40:41]
v_add_u32 v35, s43, v35
s_add_u32 m0, s44, 5440
s_nop 0
global_load_lds_dwordx4 v35, s[40:41]
v_add_u32 v35, s43, v35
s_add_u32 m0, s44, 6528
s_nop 0
global_load_lds_dwordx4 v35, s[40:41]
v_add_u32 v35, s43, v35
s_add_u32 m0, s44, 7616
s_nop 0
global_load_lds_dwordx4 v35, s[40:41]
s_waitcnt vmcnt(24)
s_barrier
v_add_u32 v33, 104448, v10
ds_read_b64_tr_b16 a[24:25], v33 offset:0
ds_read_b64_tr_b16 a[26:27], v33 offset:1088
ds_read_b64_tr_b16 a[28:29], v33 offset:8704
ds_read_b64_tr_b16 a[30:31], v33 offset:9792
ds_read_b64_tr_b16 a[104:105], v33 offset:32
ds_read_b64_tr_b16 a[106:107], v33 offset:1120
ds_read_b64_tr_b16 a[108:109], v33 offset:8736
ds_read_b64_tr_b16 a[110:111], v33 offset:9824
ds_read_b64_tr_b16 a[184:185], v33 offset:17408
ds_read_b64_tr_b16 a[186:187], v33 offset:18496
ds_read_b64_tr_b16 a[188:189], v33 offset:26112
ds_read_b64_tr_b16 a[190:191], v33 offset:27200
ds_read_b64_tr_b16 v[200:201], v33 offset:17440
ds_read_b64_tr_b16 v[202:203], v33 offset:18528
ds_read_b64_tr_b16 v[204:205], v33 offset:26144
ds_read_b64_tr_b16 v[206:207], v33 offset:27232
s_waitcnt lgkmcnt(0)
s_barrier
s_add_u32 s40, s12, 3670016
s_addc_u32 s41, s13, 0
s_mul_i32 s44, s3, 8704
s_add_u32 s44, s44, 104448
v_mov_b32 v35, v34
s_add_u32 m0, s44, 0
s_nop 0
global_load_lds_dwordx4 v35, s[40:41]
v_add_u32 v35, s43, v35
s_add_u32 m0, s44, 1088
s_nop 0
global_load_lds_dwordx4 v35, s[40:41]
v_add_u32 v35, s43, v35
s_add_u32 m0, s44, 2176
s_nop 0
global_load_lds_dwordx4 v35, s[40:41]
v_add_u32 v35, s43, v35
s_add_u32 m0, s44, 3264
s_nop 0
global_load_lds_dwordx4 v35, s[40:41]
v_add_u32 v35, s43, v35
s_add_u32 m0, s44, 4352
s_nop 0
global_load_lds_dwordx4 v35, s[40:41]
v_add_u32 v35, s43, v35
s_add_u32 m0, s44, 5440
s_nop 0
global_load_lds_dwordx4 v35, s[40:41]
v_add_u32 v35, s43, v35
s_add_u32 m0, s44, 6528
s_nop 0
global_load_lds_dwordx4 v35, s[40:41]
v_add_u32 v35, s43, v35
s_add_u32 m0, s44, 7616
s_nop 0
global_load_lds_dwordx4 v35, s[40:41]
s_waitcnt vmcnt(24)
s_barrier
v_add_u32 v33, 0, v10
ds_read_b64_tr_b16 a[32:33], v33 offset:0
ds_read_b64_tr_b16 a[34:35], v33 offset:1088
ds_read_b64_tr_b16 a[36:37], v33 offset:8704
ds_read_b64_tr_b16 a[38:39], v33 offset:9792
ds_read_b64_tr_b16 a[112:113], v33 offset:32
ds_read_b64_tr_b16 a[114:115], v33 offset:1120
ds_read_b64_tr_b16 a[116:117], v33 offset:8736
ds_read_b64_tr_b16 a[118:119], v33 offset:9824
ds_read_b64_tr_b16 a[192:193], v33 offset:17408
ds_read_b64_tr_b16 a[194:195], v33 offset:18496
ds_read_b64_tr_b16 a[196:197], v33 offset:26112
ds_read_b64_tr_b16 a[198:199], v33 offset:27200
ds_read_b64_tr_b16 v[208:209], v33 offset:17440
ds_read_b64_tr_b16 v[210:211], v33 offset:18528
ds_read_b64_tr_b16 v[212:213], v33 offset:26144
ds_read_b64_tr_b16 v[214:215], v33 offset:27232
s_waitcnt lgkmcnt(0)
s_barrier
s_add_u32 s40, s12, 4194304
s_addc_u32 s41, s13, 0
s_mul_i32 s44, s3, 8704
s_add_u32 s44, s44, 0
v_mov_b32 v35, v34
s_add_u32 m0, s44, 0
s_nop 0
global_load_lds_dwordx4 v35, s[40:41]
v_add_u32 v35, s43, v35
s_add_u32 m0, s44, 1088
s_nop 0
global_load_lds_dwordx4 v35, s[40:41]
v_add_u32 v35, s43, v35
s_add_u32 m0, s44, 2176
s_nop 0
global_load_lds_dwordx4 v35, s[40:41]
v_add_u32 v35, s43, v35
s_add_u32 m0, s44, 3264
s_nop 0
global_load_lds_dwordx4 v35, s[40:41]
v_add_u32 v35, s43, v35
s_add_u32 m0, s44, 4352
s_nop 0
global_load_lds_dwordx4 v35, s[40:41]
v_add_u32 v35, s43, v35
s_add_u32 m0, s44, 5440
s_nop 0
global_load_lds_dwordx4 v35, s[40:41]
v_add_u32 v35, s43, v35
s_add_u32 m0, s44, 6528
s_nop 0
global_load_lds_dwordx4 v35, s[40:41]
v_add_u32 v35, s43, v35
s_add_u32 m0, s44, 7616
s_nop 0
global_load_lds_dwordx4 v35, s[40:41]
s_waitcnt vmcnt(24)
s_barrier
v_add_u32 v33, 34816, v10
ds_read_b64_tr_b16 a[40:41], v33 offset:0
ds_read_b64_tr_b16 a[42:43], v33 offset:1088
ds_read_b64_tr_b16 a[44:45], v33 offset:8704
ds_read_b64_tr_b16 a[46:47], v33 offset:9792
ds_read_b64_tr_b16 a[120:121], v33 offset:32
ds_read_b64_tr_b16 a[122:123], v33 offset:1120
ds_read_b64_tr_b16 a[124:125], v33 offset:8736
ds_read_b64_tr_b16 a[126:127], v33 offset:9824
ds_read_b64_tr_b16 a[200:201], v33 offset:17408
ds_read_b64_tr_b16 a[202:203], v33 offset:18496
ds_read_b64_tr_b16 a[204:205], v33 offset:26112
ds_read_b64_tr_b16 a[206:207], v33 offset:27200
ds_read_b64_tr_b16 v[216:217], v33 offset:17440
ds_read_b64_tr_b16 v[218:219], v33 offset:18528
ds_read_b64_tr_b16 v[220:221], v33 offset:26144
ds_read_b64_tr_b16 v[222:223], v33 offset:27232
s_waitcnt lgkmcnt(0)
s_barrier
s_add_u32 s40, s12, 4718592
s_addc_u32 s41, s13, 0
s_mul_i32 s44, s3, 8704
s_add_u32 s44, s44, 34816
v_mov_b32 v35, v34
s_add_u32 m0, s44, 0
s_nop 0
global_load_lds_dwordx4 v35, s[40:41]
v_add_u32 v35, s43, v35
s_add_u32 m0, s44, 1088
s_nop 0
global_load_lds_dwordx4 v35, s[40:41]
v_add_u32 v35, s43, v35
s_add_u32 m0, s44, 2176
s_nop 0
global_load_lds_dwordx4 v35, s[40:41]
v_add_u32 v35, s43, v35
s_add_u32 m0, s44, 3264
s_nop 0
global_load_lds_dwordx4 v35, s[40:41]
v_add_u32 v35, s43, v35
s_add_u32 m0, s44, 4352
s_nop 0
global_load_lds_dwordx4 v35, s[40:41]
v_add_u32 v35, s43, v35
s_add_u32 m0, s44, 5440
s_nop 0
global_load_lds_dwordx4 v35, s[40:41]
v_add_u32 v35, s43, v35
s_add_u32 m0, s44, 6528
s_nop 0
global_load_lds_dwordx4 v35, s[40:41]
v_add_u32 v35, s43, v35
s_add_u32 m0, s44, 7616
s_nop 0
global_load_lds_dwordx4 v35, s[40:41]
s_waitcnt vmcnt(24)
s_barrier
v_add_u32 v33, 69632, v10
ds_read_b64_tr_b16 a[48:49], v33 offset:0
ds_read_b64_tr_b16 a[50:51], v33 offset:1088
ds_read_b64_tr_b16 a[52:53], v33 offset:8704
ds_read_b64_tr_b16 a[54:55], v33 offset:9792
ds_read_b64_tr_b16 a[128:129], v33 offset:32
ds_read_b64_tr_b16 a[130:131], v33 offset:1120
ds_read_b64_tr_b16 a[132:133], v33 offset:8736
ds_read_b64_tr_b16 a[134:135], v33 offset:9824
ds_read_b64_tr_b16 a[208:209], v33 offset:17408
ds_read_b64_tr_b16 a[210:211], v33 offset:18496
ds_read_b64_tr_b16 a[212:213], v33 offset:26112
ds_read_b64_tr_b16 a[214:215], v33 offset:27200
ds_read_b64_tr_b16 v[224:225], v33 offset:17440
ds_read_b64_tr_b16 v[226:227], v33 offset:18528
ds_read_b64_tr_b16 v[228:229], v33 offset:26144
ds_read_b64_tr_b16 v[230:231], v33 offset:27232
s_waitcnt lgkmcnt(0)
s_barrier
s_waitcnt vmcnt(16)
s_barrier
v_add_u32 v33, 104448, v10
ds_read_b64_tr_b16 a[56:57], v33 offset:0
ds_read_b64_tr_b16 a[58:59], v33 offset:1088
ds_read_b64_tr_b16 a[60:61], v33 offset:8704
ds_read_b64_tr_b16 a[62:63], v33 offset:9792
ds_read_b64_tr_b16 a[136:137], v33 offset:32
ds_read_b64_tr_b16 a[138:139], v33 offset:1120
ds_read_b64_tr_b16 a[140:141], v33 offset:8736
ds_read_b64_tr_b16 a[142:143], v33 offset:9824
ds_read_b64_tr_b16 a[216:217], v33 offset:17408
ds_read_b64_tr_b16 a[218:219], v33 offset:18496
ds_read_b64_tr_b16 a[220:221], v33 offset:26112
ds_read_b64_tr_b16 a[222:223], v33 offset:27200
ds_read_b64_tr_b16 v[232:233], v33 offset:17440
ds_read_b64_tr_b16 v[234:235], v33 offset:18528
ds_read_b64_tr_b16 v[236:237], v33 offset:26144
ds_read_b64_tr_b16 v[238:239], v33 offset:27232
s_waitcnt lgkmcnt(0)
s_barrier
s_waitcnt vmcnt(8)
s_barrier
v_add_u32 v33, 0, v10
ds_read_b64_tr_b16 a[64:65], v33 offset:0
ds_read_b64_tr_b16 a[66:67], v33 offset:1088
ds_read_b64_tr_b16 a[68:69], v33 offset:8704
ds_read_b64_tr_b16 a[70:71], v33 offset:9792
ds_read_b64_tr_b16 a[144:145], v33 offset:32
ds_read_b64_tr_b16 a[146:147], v33 offset:1120
ds_read_b64_tr_b16 a[148:149], v33 offset:8736
ds_read_b64_tr_b16 a[150:151], v33 offset:9824
ds_read_b64_tr_b16 a[224:225], v33 offset:17408
ds_read_b64_tr_b16 a[226:227], v33 offset:18496
ds_read_b64_tr_b16 a[228:229], v33 offset:26112
ds_read_b64_tr_b16 a[230:231], v33 offset:27200
ds_read_b64_tr_b16 v[240:241], v33 offset:17440
ds_read_b64_tr_b16 v[242:243], v33 offset:18528
ds_read_b64_tr_b16 v[244:245], v33 offset:26144
ds_read_b64_tr_b16 v[246:247], v33 offset:27232
s_waitcnt lgkmcnt(0)
s_barrier
s_waitcnt vmcnt(0)
s_barrier
v_add_u32 v33, 34816, v10
ds_read_b64_tr_b16 a[72:73], v33 offset:0
ds_read_b64_tr_b16 a[74:75], v33 offset:1088
ds_read_b64_tr_b16 a[76:77], v33 offset:8704
ds_read_b64_tr_b16 a[78:79], v33 offset:9792
ds_read_b64_tr_b16 a[152:153], v33 offset:32
ds_read_b64_tr_b16 a[154:155], v33 offset:1120
ds_read_b64_tr_b16 a[156:157], v33 offset:8736
ds_read_b64_tr_b16 a[158:159], v33 offset:9824
ds_read_b64_tr_b16 a[232:233], v33 offset:17408
ds_read_b64_tr_b16 a[234:235], v33 offset:18496
ds_read_b64_tr_b16 a[236:237], v33 offset:26112
ds_read_b64_tr_b16 a[238:239], v33 offset:27200
ds_read_b64_tr_b16 v[248:249], v33 offset:17440
ds_read_b64_tr_b16 v[250:251], v33 offset:18528
ds_read_b64_tr_b16 v[252:253], v33 offset:26144
ds_read_b64_tr_b16 v[254:255], v33 offset:27232
s_waitcnt lgkmcnt(0)
s_barrier
s_cmp_lg_u32 s3, 0
s_cbranch_scc1 cl_185
v_mov_b32 v30, 192
v_mov_b32 v31, 1
s_mov_b64 exec, 1
global_atomic_add v30, v31, s[6:7]
s_mov_b64 exec, -1
cl_185:
v_mov_b32 v30, 64
sc_186:
global_load_dword v31, v30, s[6:7] sc1
s_waitcnt vmcnt(0)
v_readfirstlane_b32 s40, v31
s_cmp_ge_u32 s40, 256
s_nop 2
s_cbranch_scc1 scg_188
s_sleep 4
s_add_u32 s100, s100, 64
s_cmp_lt_u32 s100, 0x1000000
s_cbranch_scc1 sc_186
s_endpgm
scg_188:
s_cmp_lg_u32 s101, 0
s_cbranch_scc1 sco_187
v_and_b32 v30, 7, v1
v_lshlrev_b32 v30, 2, v30
global_load_dword v31, v30, s[6:7] sc1
s_waitcnt vmcnt(0)
v_cmp_ne_u32 vcc, 32, v31
s_nop 3
s_cbranch_vccz sco_187
s_mov_b32 s101, 1
s_lshr_b32 s12, s2, 5
s_and_b32 s17, s2, 31
s_barrier
s_branch L_dispatch
sco_187:
v_and_b32 v30, 15, v1
v_lshrrev_b32 v31, 4, v1
v_lshrrev_b32 v32, 2, v30
v_lshlrev_b32 v32, 4, v32
v_lshrrev_b32 v33, 1, v31
v_lshl_add_u32 v32, v33, 3, v32
v_bfe_u32 v33, v30, 1, 1
v_lshl_add_u32 v32, v33, 2, v32
v_and_b32 v33, 1, v31
v_lshl_add_u32 v32, v33, 1, v32
v_and_b32 v33, 1, v30
v_add_u32 v32, v32, v33
v_lshlrev_b32 v32, 4, v32
s_lshl_b32 s40, s3, 10
s_add_u32 s41, s40, 4096
v_add_u32 v2, s41, v32
v_lshlrev_b32 v4, 4, v1
v_add_u32 v3, s40, v4
s_cmp_lt_u32 s3, 2
s_cselect_b32 s42, 4096, 0
v_add_u32 v184, s42, v2
s_add_u32 s42, s42, 4096
v_add_u32 v185, s42, v3
v_mov_b32 v5, 0x4444
v_mov_b32 v32, 0xeeee
v_cmp_lt_u32 vcc, 7, v30
s_nop 1
v_cndmask_b32 v5, v5, v32, vcc
v_lshrrev_b32 v32, 3, v30
v_and_b32 v33, 1, v31
v_cmp_eq_u32 s[40:41], v32, v33
v_and_b32 v32, 1, v30
v_lshlrev_b32 v32, 4, v32
v_mov_b32 v33, 0x3f80
v_lshlrev_b32 v32, v32, v33
v_cndmask_b32 v32, 0, v32, s[40:41]
v_bfe_u32 v33, v30, 1, 2
v_cmp_gt_u32 s[42:43], 2, v31
v_cmp_eq_u32 vcc, 0, v33
s_nop 1
v_cndmask_b32 v34, 0, v32, vcc
v_cndmask_b32 v6, 0, v34, s[42:43]
v_cndmask_b32 v186, v34, 0, s[42:43]
v_cmp_eq_u32 vcc, 1, v33
s_nop 1
v_cndmask_b32 v34, 0, v32, vcc
v_cndmask_b32 v7, 0, v34, s[42:43]
v_cndmask_b32 v187, v34, 0, s[42:43]
v_cmp_eq_u32 vcc, 2, v33
s_nop 1
v_cndmask_b32 v34, 0, v32, vcc
v_cndmask_b32 v8, 0, v34, s[42:43]
v_cndmask_b32 v188, v34, 0, s[42:43]
v_cmp_eq_u32 vcc, 3, v33
s_nop 1
v_cndmask_b32 v34, 0, v32, vcc
v_cndmask_b32 v9, 0, v34, s[42:43]
v_cndmask_b32 v189, v34, 0, s[42:43]
v_and_b32 v30, 15, v1
v_lshlrev_b32 v30, 2, v30
s_lshl_b32 s40, s15, 7
s_add_u32 s40, s40, 46186496
v_add_u32 v29, s40, v30
v_mov_b32 v30, 21504
v_mov_b32 v32, 0
v_mov_b32 v33, 0
ds_write_b64 v30, v[32:33]
v_mov_b32 v34, 0
v_mov_b32 v35, 0
v_lshlrev_b32 v30, 4, v1
ds_write_b128 v30, v[32:35] offset:21760
s_waitcnt lgkmcnt(0)
s_barrier
s_mul_i32 s18, s15, 10240
s_sub_u32 s19, 1, s15
s_mul_i32 s19, s19, 10240
s_add_u32 s19, s19, 20480
v_and_b32 v30, 15, v1
v_lshrrev_b32 v31, 4, v1
v_lshrrev_b32 v32, 5, v1
v_lshlrev_b32 v32, 4, v32
v_add_u32 v32, v32, v30
s_lshl_b32 s40, s3, 5
v_add_u32 v32, s40, v32
v_lshlrev_b32 v32, 5, v32
v_and_b32 v33, 1, v31
v_lshl_add_u32 v32, v33, 3, v32
v_add_u32 v10, 10240, v32
v_bfe_u32 v32, v1, 2, 2
v_lshl_add_u32 v32, v31, 3, v32
v_lshlrev_b32 v32, 5, v32
v_and_b32 v33, 3, v1
v_lshl_add_u32 v32, v33, 3, v32
v_add_u32 v11, 10240, v32
s_sub_u32 s40, s3, 1
s_and_b32 s40, s40, 1
s_lshl_b32 s40, s40, 8
s_add_u32 s40, s40, 4096
v_lshlrev_b32 v32, 9, v31
v_lshl_add_u32 v32, v30, 4, v32
v_add_u32 v12, s40, v32
v_lshlrev_b32 v32, 3, v31
v_add_u32 v32, v32, v30
v_lshlrev_b32 v32, 4, v32
s_sub_u32 s40, s3, 1
s_and_b32 s40, s40, 1
s_lshl_b32 s40, s40, 3
s_lshl_b32 s41, s14, 9
s_add_u32 s40, s40, s41
s_lshl_b32 s41, s15, 13
s_add_u32 s40, s40, s41
v_add_u32 v13, s40, v32
v_and_b32 v32, 1, v31
v_lshlrev_b32 v32, 3, v32
v_lshl_add_u32 v32, v30, 4, v32
s_lshl_b32 s41, s14, 7
s_lshl_b32 s42, s15, 11
s_add_u32 s41, s41, s42
s_add_u32 s41, s41, 16384
v_add_u32 v32, s41, v32
s_cmp_eq_u32 s3, 0
s_cselect_b64 vcc, -1, 0
v_cndmask_b32 v13, v13, v32, vcc
s_lshl_b32 s40, s14, 7
s_lshl_b32 s42, s15, 11
s_add_u32 s40, s40, s42
s_add_u32 s40, s40, 16384
v_and_b32 v33, 7, v1
v_lshlrev_b32 v33, 4, v33
v_add_u32 v180, s40, v33
s_lshl_b32 s40, s14, 9
s_lshl_b32 s42, s15, 13
s_add_u32 s40, s40, s42
v_and_b32 v33, 31, v1
v_lshlrev_b32 v33, 4, v33
v_add_u32 v181, s40, v33
v_lshlrev_b32 v32, 7, v31
v_lshl_add_u32 v32, v30, 4, v32
v_subrev_u32 v23, 128, v32
v_lshlrev_b32 v32, 4, v30
v_add_u32 v25, 21760, v32
s_lshl_b32 s40, s3, 8
v_add_u32 v24, s40, v25
v_lshlrev_b32 v14, 6, v1
s_lshl_b32 s40, s15, 8
s_lshl_b32 s41, s14, 2
s_add_u32 s40, s40, s41
s_add_u32 s40, s40, 46186752
v_mov_b32 v21, s40
v_mul_u32_u24 v32, 12288, v31
v_lshl_add_u32 v32, v30, 4, v32
s_mul_i32 s40, s15, 196608
s_mul_i32 s41, s14, 768
s_add_u32 s40, s40, s41
s_mul_i32 s41, s3, 49152
s_add_u32 s40, s40, s41
v_add_u32 v15, s40, v32
s_movk_i32 s41, 256
s_cmp_lt_u32 s3, 2
s_cselect_b32 s40, 512, s41
v_add_u32 v16, s40, v15
v_mov_b32 v132, -1
v_mov_b32 v133, -1
v_mov_b32 v134, -1
v_mov_b32 v135, -1
s_cmp_eq_u32 s3, 0
s_cselect_b32 s40, -1, 0
s_mov_b32 s41, 0
v_mov_b32 v32, 0xff800000
v_cndmask_b32 v26, 0, v32, s[40:41]
v_mov_b32 v27, v26
v_mov_b32 v112, -1
v_mov_b32 v113, -1
v_mov_b32 v114, -1
v_mov_b32 v115, -1
s_cmp_eq_u32 s3, 0
s_cselect_b32 s78, s62, s60
s_cselect_b32 s79, s63, s61
s_mov_b32 s30, 0
s_sub_u32 s46, s3, 1
s_cmp_gt_u32 s46, 1
s_cbranch_scc1 nkx_191
nkx_191:
s_add_u32 s44, s30, 4294967295
s_and_b32 s44, s44, 3
s_mul_i32 s44, s44, 40960
s_add_u32 s44, s44, 44040192
s_add_u32 s45, s44, s18
s_add_u32 s36, s4, s45
s_addc_u32 s37, s5, 0
s_add_u32 s45, s44, s19
s_add_u32 s38, s4, s45
s_addc_u32 s39, s5, 0
s_and_b32 s44, s30, 3
s_mul_i32 s44, s44, 20480
s_add_u32 s44, s44, 44236800
s_add_u32 s52, s4, s44
s_addc_u32 s53, s5, 0
v_mov_b32 v96, 0
v_mov_b32 v97, 0
v_mov_b32 v98, 0
v_mov_b32 v99, 0
v_mov_b32 v100, 0
v_mov_b32 v101, 0
v_mov_b32 v102, 0
v_mov_b32 v103, 0
v_mov_b32 v104, 0
v_mov_b32 v105, 0
v_mov_b32 v106, 0
v_mov_b32 v107, 0
v_mov_b32 v108, 0
v_mov_b32 v109, 0
v_mov_b32 v110, 0
v_mov_b32 v111, 0
s_add_u32 s40, s30, 1
v_mov_b32 v22, s40
v_mov_b32 v161, s40
v_mov_b32 v163, s40
s_add_u32 s40, s30, 1
s_cmp_lg_u32 s3, 0
s_cbranch_scc1 Fo_195
s_mov_b64 exec, 0xffff
global_load_dword v31, v29, s[4:5] sc1
s_nop 15
global_load_dword v33, v29, s[4:5] sc1
s_nop 15
global_load_dword v34, v29, s[4:5] sc1
Fq_193:
s_waitcnt vmcnt(2)
v_cmp_gt_u32 vcc, s40, v31
s_nop 3
s_cbranch_vccz Fk_196
global_load_dword v31, v29, s[4:5] sc1
s_waitcnt vmcnt(2)
v_cmp_gt_u32 vcc, s40, v33
s_nop 3
s_cbranch_vccz Fk_196
global_load_dword v33, v29, s[4:5] sc1
s_waitcnt vmcnt(2)
v_cmp_gt_u32 vcc, s40, v34
s_nop 3
s_cbranch_vccz Fk_196
global_load_dword v34, v29, s[4:5] sc1
s_add_u32 s100, s100, 1
s_cmp_lt_u32 s100, 0x1000000
s_cbranch_scc1 Fq_193
s_endpgm
Fk_196:
s_mov_b64 exec, -1
Fo_195:
s_barrier
s_sleep 1
s_sleep 1
nd_197:
global_load_dwordx4 v[36:39], v2, s[36:37] offset:-4096 sc1
global_load_dwordx4 v[40:43], v2, s[36:37] offset:0 sc1
global_load_dwordx4 v[44:47], v184, s[36:37] sc1
s_sleep 1
s_sleep 1
global_load_dwordx4 v[144:147], v2, s[38:39] offset:-4096 sc1
global_load_dwordx4 v[148:151], v2, s[38:39] offset:0 sc1
global_load_dwordx4 v[152:155], v184, s[38:39] sc1
s_waitcnt vmcnt(3)
Gl_198:
v_max3_u32 v30, v36, v38, v40
v_max3_u32 v30, v30, v42, v44
v_max_u32 v30, v30, v46
v_cmp_eq_u32 vcc, -1, v30
s_nop 3
s_cbranch_vccz Glo_199
global_load_dwordx4 v[36:39], v2, s[36:37] offset:-4096 sc1
global_load_dwordx4 v[40:43], v2, s[36:37] offset:0 sc1
global_load_dwordx4 v[44:47], v184, s[36:37] sc1
s_waitcnt vmcnt(0)
s_add_u32 s100, s100, 1
s_cmp_lt_u32 s100, 0x1000000
s_cbranch_scc1 Gl_198
s_endpgm
Glo_199:
v_mfma_f32_16x16x32_bf16 v[56:59], v[36:39], v[6:9], 0
v_mfma_f32_16x16x32_bf16 v[60:63], v[36:39], v[186:189], 0
v_mfma_f32_16x16x32_bf16 v[64:67], v[40:43], v[6:9], 0
v_mfma_f32_16x16x32_bf16 v[68:71], v[40:43], v[186:189], 0
v_mfma_f32_16x16x32_bf16 v[72:75], v[44:47], v[6:9], 0
v_mfma_f32_16x16x32_bf16 v[76:79], v[44:47], v[186:189], 0
s_waitcnt vmcnt(0)
Gr_200:
v_max3_u32 v30, v144, v146, v148
v_max3_u32 v30, v30, v150, v152
v_max_u32 v30, v30, v154
v_cmp_eq_u32 vcc, -1, v30
s_nop 3
s_cbranch_vccz Gro_201
global_load_dwordx4 v[144:147], v2, s[38:39] offset:-4096 sc1
global_load_dwordx4 v[148:151], v2, s[38:39] offset:0 sc1
global_load_dwordx4 v[152:155], v184, s[38:39] sc1
s_waitcnt vmcnt(0)
s_add_u32 s100, s100, 1
s_cmp_lt_u32 s100, 0x1000000
s_cbranch_scc1 Gr_200
s_endpgm
Gro_201:
v_mfma_f32_16x16x32_bf16 v[56:59], v[144:147], v[6:9], v[56:59]
v_mfma_f32_16x16x32_bf16 v[60:63], v[144:147], v[186:189], v[60:63]
v_mfma_f32_16x16x32_bf16 v[64:67], v[148:151], v[6:9], v[64:67]
v_mfma_f32_16x16x32_bf16 v[68:71], v[148:151], v[186:189], v[68:71]
v_mfma_f32_16x16x32_bf16 v[72:75], v[152:155], v[6:9], v[72:75]
v_mfma_f32_16x16x32_bf16 v[76:79], v[152:155], v[186:189], v[76:79]
s_nop 2
v_cvt_pk_bf16_f32 v36, v56, v57
v_cvt_pk_bf16_f32 v37, v58, v59
v_cvt_pk_bf16_f32 v38, v60, v61
v_cvt_pk_bf16_f32 v39, v62, v63
ds_write_b128 v3, v[36:39] offset:0
v_cvt_pk_bf16_f32 v40, v64, v65
v_cvt_pk_bf16_f32 v41, v66, v67
v_cvt_pk_bf16_f32 v42, v68, v69
v_cvt_pk_bf16_f32 v43, v70, v71
ds_write_b128 v3, v[40:43] offset:4096
v_cvt_pk_bf16_f32 v44, v72, v73
v_cvt_pk_bf16_f32 v45, v74, v75
v_cvt_pk_bf16_f32 v46, v76, v77
v_cvt_pk_bf16_f32 v47, v78, v79
ds_write_b128 v185, v[44:47]
s_waitcnt lgkmcnt(0)
Gs_192:
s_barrier
ds_read_b128 v[56:59], v4 offset:0
ds_read_b128 v[60:63], v4 offset:1024
ds_read_b128 v[64:67], v4 offset:2048
ds_read_b128 v[68:71], v4 offset:3072
ds_read_b128 v[72:75], v4 offset:4096
ds_read_b128 v[76:79], v4 offset:5120
ds_read_b128 v[80:83], v4 offset:6144
ds_read_b128 v[84:87], v4 offset:7168
ds_read_b128 v[88:91], v4 offset:8192
ds_read_b128 v[92:95], v4 offset:9216
s_waitcnt lgkmcnt(9)
v_smfmac_f32_16x16x64_bf16 v[96:99], v[56:59], a[0:7], v5
v_smfmac_f32_16x16x64_bf16 v[100:103], v[56:59], a[80:87], v5
v_smfmac_f32_16x16x64_bf16 v[104:107], v[56:59], a[160:167], v5
v_smfmac_f32_16x16x64_bf16 v[108:111], v[56:59], a[240:247], v5
s_waitcnt lgkmcnt(8)
v_smfmac_f32_16x16x64_bf16 v[96:99], v[60:63], a[8:15], v5
v_smfmac_f32_16x16x64_bf16 v[100:103], v[60:63], a[88:95], v5
v_smfmac_f32_16x16x64_bf16 v[104:107], v[60:63], a[168:175], v5
v_smfmac_f32_16x16x64_bf16 v[108:111], v[60:63], a[248:255], v5
s_waitcnt lgkmcnt(7)
v_smfmac_f32_16x16x64_bf16 v[96:99], v[64:67], a[16:23], v5
v_smfmac_f32_16x16x64_bf16 v[100:103], v[64:67], a[96:103], v5
v_smfmac_f32_16x16x64_bf16 v[104:107], v[64:67], a[176:183], v5
v_smfmac_f32_16x16x64_bf16 v[108:111], v[64:67], v[192:199], v5
s_waitcnt lgkmcnt(6)
v_smfmac_f32_16x16x64_bf16 v[96:99], v[68:71], a[24:31], v5
v_smfmac_f32_16x16x64_bf16 v[100:103], v[68:71], a[104:111], v5
v_smfmac_f32_16x16x64_bf16 v[104:107], v[68:71], a[184:191], v5
v_smfmac_f32_16x16x64_bf16 v[108:111], v[68:71], v[200:207], v5
s_waitcnt lgkmcnt(5)
v_smfmac_f32_16x16x64_bf16 v[96:99], v[72:75], a[32:39], v5
v_smfmac_f32_16x16x64_bf16 v[100:103], v[72:75], a[112:119], v5
v_smfmac_f32_16x16x64_bf16 v[104:107], v[72:75], a[192:199], v5
v_smfmac_f32_16x16x64_bf16 v[108:111], v[72:75], v[208:215], v5
s_waitcnt lgkmcnt(0)
v_smfmac_f32_16x16x64_bf16 v[96:99], v[76:79], a[40:47], v5
v_smfmac_f32_16x16x64_bf16 v[100:103], v[76:79], a[120:127], v5
v_smfmac_f32_16x16x64_bf16 v[96:99], v[80:83], a[48:55], v5
v_smfmac_f32_16x16x64_bf16 v[100:103], v[80:83], a[128:135], v5
v_smfmac_f32_16x16x64_bf16 v[96:99], v[84:87], a[56:63], v5
v_smfmac_f32_16x16x64_bf16 v[100:103], v[84:87], a[136:143], v5
v_smfmac_f32_16x16x64_bf16 v[96:99], v[88:91], a[64:71], v5
v_smfmac_f32_16x16x64_bf16 v[100:103], v[88:91], a[144:151], v5
v_smfmac_f32_16x16x64_bf16 v[96:99], v[92:95], a[72:79], v5
v_smfmac_f32_16x16x64_bf16 v[100:103], v[92:95], a[152:159], v5
v_smfmac_f32_16x16x64_bf16 v[104:107], v[76:79], a[200:207], v5
v_smfmac_f32_16x16x64_bf16 v[108:111], v[76:79], v[216:223], v5
v_smfmac_f32_16x16x64_bf16 v[104:107], v[80:83], a[208:215], v5
v_smfmac_f32_16x16x64_bf16 v[108:111], v[80:83], v[224:231], v5
s_nop 3
v_permlane32_swap_b32 v96, v100
v_smfmac_f32_16x16x64_bf16 v[104:107], v[84:87], a[216:223], v5
v_permlane32_swap_b32 v97, v101
v_smfmac_f32_16x16x64_bf16 v[108:111], v[84:87], v[232:239], v5
v_permlane32_swap_b32 v98, v102
v_permlane32_swap_b32 v99, v103
v_smfmac_f32_16x16x64_bf16 v[104:107], v[88:91], a[224:231], v5
v_pk_add_f32 v[96:97], v[96:97], v[100:101]
v_pk_add_f32 v[98:99], v[98:99], v[102:103]
v_smfmac_f32_16x16x64_bf16 v[108:111], v[88:91], v[240:247], v5
v_cvt_pk_bf16_f32 v36, v96, v97
v_cvt_pk_bf16_f32 v37, v98, v99
v_smfmac_f32_16x16x64_bf16 v[104:107], v[92:95], a[232:239], v5
ds_write_b64 v10, v[36:37]
v_smfmac_f32_16x16x64_bf16 v[108:111], v[92:95], v[248:255], v5
s_nop 7
v_permlane32_swap_b32 v104, v108
v_permlane32_swap_b32 v105, v109
v_permlane32_swap_b32 v106, v110
v_permlane32_swap_b32 v107, v111
v_pk_add_f32 v[104:105], v[104:105], v[108:109]
v_pk_add_f32 v[106:107], v[106:107], v[110:111]
v_cvt_pk_bf16_f32 v38, v104, v105
v_cvt_pk_bf16_f32 v39, v106, v107
ds_write_b64 v10, v[38:39] offset:16
s_waitcnt lgkmcnt(0)
s_barrier
s_cmp_eq_u32 s3, 3
s_cbranch_scc1 w3_202
ds_read_b64_tr_b16 v[56:57], v11 offset:0
ds_read_b64_tr_b16 v[58:59], v11 offset:128
ds_read_b64_tr_b16 v[60:61], v11 offset:1024
ds_read_b64_tr_b16 v[62:63], v11 offset:1152
ds_read_b64_tr_b16 v[64:65], v11 offset:2048
ds_read_b64_tr_b16 v[66:67], v11 offset:2176
ds_read_b64_tr_b16 v[68:69], v11 offset:3072
ds_read_b64_tr_b16 v[70:71], v11 offset:3200
s_cmp_lg_u32 s3, 0
s_cbranch_scc1 xs_204
s_waitcnt lgkmcnt(6)
v_mfma_f32_16x16x32_bf16 v[36:39], v[56:59], v[56:59], 0
s_waitcnt lgkmcnt(4)
v_mfma_f32_16x16x32_bf16 v[36:39], v[60:63], v[60:63], v[36:39]
s_waitcnt lgkmcnt(2)
v_mfma_f32_16x16x32_bf16 v[36:39], v[64:67], v[64:67], v[36:39]
s_waitcnt lgkmcnt(0)
v_mfma_f32_16x16x32_bf16 v[36:39], v[68:71], v[68:71], v[36:39]
s_branch sm_205
xs_204:
s_add_u32 s45, s30, 0
s_min_u32 s45, s45, 63
s_lshl_b32 s46, s45, 8
s_lshr_b32 s47, s16, 1
s_add_u32 s47, s47, 16
s_lshl_b32 s47, s47, 2
s_add_u32 s46, s46, s47
s_add_u32 s46, s46, 46137344
v_mov_b32 v32, s46
vf_206:
global_load_dword v33, v32, s[4:5] sc1
s_waitcnt vmcnt(0)
v_cmp_eq_u32 vcc, 0, v33
s_nop 3
s_cbranch_vccz ok_207
s_add_u32 s100, s100, 1
s_cmp_lt_u32 s100, 0x1000000
s_cbranch_scc1 vf_206
s_endpgm
ok_207:
s_lshl_b32 s46, s30, 5
s_add_u32 s46, s46, s16
s_lshl_b32 s46, s46, 13
s_add_u32 s46, s46, 16777216
s_add_u32 s48, s4, s46
s_addc_u32 s49, s5, 0
global_load_dwordx4 v[112:115], v12, s[48:49] offset:-4096 sc1
global_load_dwordx4 v[116:119], v12, s[48:49] offset:-2048 sc1
global_load_dwordx4 v[120:123], v12, s[48:49] offset:0 sc1
global_load_dwordx4 v[124:127], v12, s[48:49] offset:2048 sc1
s_waitcnt vmcnt(0)
s_waitcnt lgkmcnt(6)
v_mfma_f32_16x16x32_bf16 v[36:39], v[112:115], v[56:59], 0
s_waitcnt lgkmcnt(4)
v_mfma_f32_16x16x32_bf16 v[36:39], v[116:119], v[60:63], v[36:39]
s_waitcnt lgkmcnt(2)
v_mfma_f32_16x16x32_bf16 v[36:39], v[120:123], v[64:67], v[36:39]
s_waitcnt lgkmcnt(0)
v_mfma_f32_16x16x32_bf16 v[36:39], v[124:127], v[68:71], v[36:39]
sm_205:
s_nop 7
v_pk_add_f32 v[36:37], v[36:37], v[26:27]
v_pk_add_f32 v[38:39], v[38:39], v[26:27]
v_max3_f32 v160, v36, v37, v38
v_max_f32 v160, v160, v39
v_mov_b32 v34, v160
s_nop 1
v_permlane16_swap_b32 v160, v34
v_max_f32 v160, v160, v34
v_mov_b32 v34, v160
s_nop 1
v_permlane32_swap_b32 v160, v34
v_max_f32 v160, v160, v34
v_pk_mul_f32 v[32:33], v[160:161], s[66:67] op_sel_hi:[0,1]
s_nop 0
v_pk_fma_f32 v[40:41], v[36:37], s[66:67], v[32:33] neg_lo:[0,0,1] neg_hi:[0,0,1]
v_pk_fma_f32 v[42:43], v[38:39], s[66:67], v[32:33] neg_lo:[0,0,1] neg_hi:[0,0,1]
v_exp_f32 v40, v40
v_exp_f32 v41, v41
v_exp_f32 v42, v42
v_exp_f32 v43, v43
s_nop 0
v_pk_add_f32 v[32:33], v[40:41], v[42:43]
v_add_f32 v162, v32, v33
v_mov_b32 v34, v162
s_nop 1
v_permlane16_swap_b32 v162, v34
v_add_f32 v162, v162, v34
v_mov_b32 v34, v162
s_nop 1
v_permlane32_swap_b32 v162, v34
v_add_f32 v162, v162, v34
ds_write_b128 v24, v[160:163]
s_waitcnt lgkmcnt(0)
s_barrier
ds_read_b128 v[44:47], v25 offset:0
ds_read_b128 v[48:51], v25 offset:256
ds_read_b128 v[52:55], v25 offset:512
s_waitcnt lgkmcnt(0)
v_max3_f32 v30, v44, v48, v52
v_mul_f32 v31, s66, v30
v_fma_f32 v44, v44, s66, -v31
v_fma_f32 v48, v48, s66, -v31
v_fma_f32 v52, v52, s66, -v31
v_fma_f32 v32, v160, s66, -v31
v_exp_f32 v44, v44
v_exp_f32 v48, v48
v_exp_f32 v52, v52
v_exp_f32 v32, v32
v_mul_f32 v34, v44, v46
v_fmac_f32 v34, v48, v50
v_fmac_f32 v34, v52, v54
v_rcp_f32 v34, v34
s_nop 0
v_mul_f32 v32, v32, v34
v_pk_mul_f32 v[40:41], v[40:41], v[32:33] op_sel_hi:[1,0]
v_pk_mul_f32 v[42:43], v[42:43], v[32:33] op_sel_hi:[1,0]
v_cvt_pk_bf16_f32 v30, v40, v41
v_cvt_pk_bf16_f32 v31, v42, v43
v_min_u32 v30, s70, v30
s_mov_b64 exec, s[78:79]
global_store_dwordx2 v13, v[30:31], s[52:53] sc1
s_mov_b64 exec, -1
s_branch sh_208
w3_202:
s_cmp_eq_u32 s30, 0
s_cbranch_scc1 nz_210
s_waitcnt vmcnt(0)
s_add_u32 s46, s30, 4294967295
s_lshl_b32 s46, s46, 5
s_add_u32 s46, s46, s16
s_lshl_b32 s46, s46, 2
s_add_u32 s46, s46, 46170112
v_mov_b32 v30, s46
v_mov_b32 v31, 1
global_store_dword v30, v31, s[4:5] sc1
nz_210:
s_sleep 1
s_sleep 1
s_sleep 1
s_sleep 1
s_sleep 1
s_sleep 1
s_mov_b64 exec, 1
global_store_dword v21, v22, s[4:5] sc1
s_mov_b64 exec, -1
s_barrier
s_sleep 1
s_sleep 1
s_sleep 1
s_sleep 1
s_sleep 1
s_sleep 1
ds_read_b64_tr_b16 v[56:57], v11 offset:0
ds_read_b64_tr_b16 v[58:59], v11 offset:128
ds_read_b64_tr_b16 v[60:61], v11 offset:1024
ds_read_b64_tr_b16 v[62:63], v11 offset:1152
ds_read_b64_tr_b16 v[64:65], v11 offset:2048
ds_read_b64_tr_b16 v[66:67], v11 offset:2176
ds_read_b64_tr_b16 v[68:69], v11 offset:3072
ds_read_b64_tr_b16 v[70:71], v11 offset:3200
s_lshl_b32 s46, s30, 5
s_add_u32 s46, s46, s16
s_lshl_b32 s46, s46, 11
s_add_u32 s46, s46, 33554432
s_add_u32 s56, s4, s46
s_addc_u32 s57, s5, 0
s_waitcnt lgkmcnt(0)
s_mov_b64 exec, s[72:73]
global_store_dwordx4 v23, v[56:59], s[56:57] offset:0 sc1
global_store_dwordx4 v23, v[60:63], s[56:57] offset:512 sc1
global_store_dwordx4 v23, v[64:67], s[56:57] offset:1024 sc1
global_store_dwordx4 v23, v[68:71], s[56:57] offset:1536 sc1
s_mov_b64 exec, -1
s_add_u32 s44, s30, 4294967295
s_and_b32 s44, s44, 3
s_mul_i32 s44, s44, 20480
s_add_u32 s44, s44, 44236800
s_add_u32 s58, s4, s44
s_addc_u32 s59, s5, 0
global_store_dwordx4 v180, v[112:115], s[58:59] sc1
global_store_dwordx4 v181, v[112:115], s[58:59] sc1
s_add_u32 s45, s30, 2
s_min_u32 s45, s45, 63
s_lshl_b32 s46, s45, 8
s_lshr_b32 s47, s16, 1
s_add_u32 s47, s47, 16
s_lshl_b32 s47, s47, 2
s_add_u32 s46, s46, s47
s_add_u32 s46, s46, 46137344
v_mov_b32 v32, s46
vf_211:
global_load_dword v33, v32, s[4:5] sc1
s_waitcnt vmcnt(0)
v_cmp_eq_u32 vcc, 0, v33
s_nop 3
s_cbranch_vccz ok_212
s_add_u32 s100, s100, 1
s_cmp_lt_u32 s100, 0x1000000
s_cbranch_scc1 vf_211
s_endpgm
ok_212:
s_add_u32 s46, s30, 0
s_lshl_b32 s46, s46, 5
s_add_u32 s46, s46, s16
s_lshl_b32 s46, s46, 2
s_add_u32 s46, s46, 46161920
v_mov_b32 v30, s46
v_mov_b32 v31, 1
global_store_dword v30, v31, s[4:5] sc1
sh_208:
s_and_b32 s44, s30, 3
s_mul_i32 s44, s44, 393216
s_add_u32 s44, s44, 44367872
s_add_u32 s54, s4, s44
s_addc_u32 s55, s5, 0
s_mul_i32 s44, s30, 393216
s_add_u32 s56, s4, s44
s_addc_u32 s57, s5, 0
s_add_u32 s56, s56, 50331648
s_addc_u32 s57, s57, 0
zc_213:
global_load_dwordx4 v[164:167], v15, s[54:55] sc1
global_load_dwordx4 v[168:171], v15, s[54:55] offset:256 sc1
global_load_dwordx4 v[172:175], v16, s[54:55] sc1
s_waitcnt vmcnt(0)
v_max3_u32 v30, v164, v166, v168
v_max3_u32 v30, v30, v170, v172
v_max_u32 v30, v30, v174
v_cmp_eq_u32 vcc, -1, v30
s_nop 3
s_cbranch_vccz ok_214
s_add_u32 s100, s100, 1
s_cmp_lt_u32 s100, 0x1000000
s_cbranch_scc1 zc_213
s_endpgm
ok_214:
global_store_dwordx4 v15, v[164:167], s[56:57] sc1
global_store_dwordx4 v15, v[168:171], s[56:57] offset:256 sc1
global_store_dwordx4 v16, v[172:175], s[56:57] sc1
s_add_u32 s44, s30, 4294967295
s_and_b32 s44, s44, 3
s_mul_i32 s44, s44, 393216
s_add_u32 s44, s44, 44367872
s_add_u32 s54, s4, s44
s_addc_u32 s55, s5, 0
global_store_dwordx4 v15, v[132:135], s[54:55] sc1
global_store_dwordx4 v15, v[132:135], s[54:55] offset:256 sc1
global_store_dwordx4 v16, v[132:135], s[54:55] sc1
s_add_u32 s30, s30, 1
.p2align 6
QKstep_189:
s_sub_u32 s46, s3, 1
s_cmp_gt_u32 s46, 1
s_cbranch_scc1 nkx_215
s_cmp_lg_u32 s30, 1
s_cbranch_scc1 k1_216
s_add_u32 s45, s30, 0
s_min_u32 s45, s45, 63
s_lshl_b32 s46, s45, 8
s_lshr_b32 s47, s16, 1
s_add_u32 s47, s47, 16
s_lshl_b32 s47, s47, 2
s_add_u32 s46, s46, s47
s_add_u32 s46, s46, 46137344
v_mov_b32 v32, s46
vf_217:
global_load_dword v33, v32, s[4:5] sc1
s_waitcnt vmcnt(0)
v_cmp_eq_u32 vcc, 0, v33
s_nop 3
s_cbranch_vccz ok_218
s_add_u32 s100, s100, 1
s_cmp_lt_u32 s100, 0x1000000
s_cbranch_scc1 vf_217
s_endpgm
ok_218:
k1_216:
s_lshl_b32 s46, s30, 5
s_add_u32 s46, s46, s16
s_lshl_b32 s46, s46, 13
s_add_u32 s46, s46, 16777216
s_add_u32 s48, s4, s46
s_addc_u32 s49, s5, 0
global_load_dwordx4 v[112:115], v12, s[48:49] offset:-4096 sc1
global_load_dwordx4 v[116:119], v12, s[48:49] offset:-2048 sc1
global_load_dwordx4 v[120:123], v12, s[48:49] offset:0 sc1
global_load_dwordx4 v[124:127], v12, s[48:49] offset:2048 sc1
nkx_215:
s_add_u32 s44, s30, 4294967295
s_and_b32 s44, s44, 3
s_mul_i32 s44, s44, 40960
s_add_u32 s44, s44, 44040192
s_add_u32 s45, s44, s18
s_add_u32 s36, s4, s45
s_addc_u32 s37, s5, 0
s_add_u32 s45, s44, s19
s_add_u32 s38, s4, s45
s_addc_u32 s39, s5, 0
s_and_b32 s44, s30, 3
s_mul_i32 s44, s44, 20480
s_add_u32 s44, s44, 44236800
s_add_u32 s52, s4, s44
s_addc_u32 s53, s5, 0
v_mov_b32 v96, 0
v_mov_b32 v97, 0
v_mov_b32 v98, 0
v_mov_b32 v99, 0
v_mov_b32 v100, 0
v_mov_b32 v101, 0
v_mov_b32 v102, 0
v_mov_b32 v103, 0
v_mov_b32 v104, 0
v_mov_b32 v105, 0
v_mov_b32 v106, 0
v_mov_b32 v107, 0
v_mov_b32 v108, 0
v_mov_b32 v109, 0
v_mov_b32 v110, 0
v_mov_b32 v111, 0
s_add_u32 s40, s30, 1
v_mov_b32 v22, s40
v_mov_b32 v161, s40
v_mov_b32 v163, s40
s_add_u32 s40, s30, 1
s_cmp_lg_u32 s3, 0
s_cbranch_scc1 Fo_222
s_mov_b64 exec, 0xffff
global_load_dword v31, v29, s[4:5] sc1
s_nop 15
global_load_dword v33, v29, s[4:5] sc1
s_nop 15
global_load_dword v34, v29, s[4:5] sc1
Fq_220:
s_waitcnt vmcnt(2)
v_cmp_gt_u32 vcc, s40, v31
s_nop 3
s_cbranch_vccz Fk_223
global_load_dword v31, v29, s[4:5] sc1
s_waitcnt vmcnt(2)
v_cmp_gt_u32 vcc, s40, v33
s_nop 3
s_cbranch_vccz Fk_223
global_load_dword v33, v29, s[4:5] sc1
s_waitcnt vmcnt(2)
v_cmp_gt_u32 vcc, s40, v34
s_nop 3
s_cbranch_vccz Fk_223
global_load_dword v34, v29, s[4:5] sc1
s_add_u32 s100, s100, 1
s_cmp_lt_u32 s100, 0x1000000
s_cbranch_scc1 Fq_220
s_endpgm
Fk_223:
s_mov_b64 exec, -1
Fo_222:
s_barrier
s_sleep 1
s_sleep 1
nd_224:
global_load_dwordx4 v[36:39], v2, s[36:37] offset:-4096 sc1
global_load_dwordx4 v[40:43], v2, s[36:37] offset:0 sc1
global_load_dwordx4 v[44:47], v184, s[36:37] sc1
s_sleep 1
s_sleep 1
global_load_dwordx4 v[144:147], v2, s[38:39] offset:-4096 sc1
global_load_dwordx4 v[148:151], v2, s[38:39] offset:0 sc1
global_load_dwordx4 v[152:155], v184, s[38:39] sc1
s_waitcnt vmcnt(3)
Gl_225:
v_max3_u32 v30, v36, v38, v40
v_max3_u32 v30, v30, v42, v44
v_max_u32 v30, v30, v46
v_cmp_eq_u32 vcc, -1, v30
s_nop 3
s_cbranch_vccz Glo_226
global_load_dwordx4 v[36:39], v2, s[36:37] offset:-4096 sc1
global_load_dwordx4 v[40:43], v2, s[36:37] offset:0 sc1
global_load_dwordx4 v[44:47], v184, s[36:37] sc1
s_waitcnt vmcnt(0)
s_add_u32 s100, s100, 1
s_cmp_lt_u32 s100, 0x1000000
s_cbranch_scc1 Gl_225
s_endpgm
Glo_226:
v_mfma_f32_16x16x32_bf16 v[56:59], v[36:39], v[6:9], 0
v_mfma_f32_16x16x32_bf16 v[60:63], v[36:39], v[186:189], 0
v_mfma_f32_16x16x32_bf16 v[64:67], v[40:43], v[6:9], 0
v_mfma_f32_16x16x32_bf16 v[68:71], v[40:43], v[186:189], 0
v_mfma_f32_16x16x32_bf16 v[72:75], v[44:47], v[6:9], 0
v_mfma_f32_16x16x32_bf16 v[76:79], v[44:47], v[186:189], 0
s_waitcnt vmcnt(0)
Gr_227:
v_max3_u32 v30, v144, v146, v148
v_max3_u32 v30, v30, v150, v152
v_max_u32 v30, v30, v154
v_cmp_eq_u32 vcc, -1, v30
s_nop 3
s_cbranch_vccz Gro_228
global_load_dwordx4 v[144:147], v2, s[38:39] offset:-4096 sc1
global_load_dwordx4 v[148:151], v2, s[38:39] offset:0 sc1
global_load_dwordx4 v[152:155], v184, s[38:39] sc1
s_waitcnt vmcnt(0)
s_add_u32 s100, s100, 1
s_cmp_lt_u32 s100, 0x1000000
s_cbranch_scc1 Gr_227
s_endpgm
Gro_228:
v_mfma_f32_16x16x32_bf16 v[56:59], v[144:147], v[6:9], v[56:59]
v_mfma_f32_16x16x32_bf16 v[60:63], v[144:147], v[186:189], v[60:63]
v_mfma_f32_16x16x32_bf16 v[64:67], v[148:151], v[6:9], v[64:67]
v_mfma_f32_16x16x32_bf16 v[68:71], v[148:151], v[186:189], v[68:71]
v_mfma_f32_16x16x32_bf16 v[72:75], v[152:155], v[6:9], v[72:75]
v_mfma_f32_16x16x32_bf16 v[76:79], v[152:155], v[186:189], v[76:79]
s_nop 2
v_cvt_pk_bf16_f32 v36, v56, v57
v_cvt_pk_bf16_f32 v37, v58, v59
v_cvt_pk_bf16_f32 v38, v60, v61
v_cvt_pk_bf16_f32 v39, v62, v63
ds_write_b128 v3, v[36:39] offset:0
v_cvt_pk_bf16_f32 v40, v64, v65
v_cvt_pk_bf16_f32 v41, v66, v67
v_cvt_pk_bf16_f32 v42, v68, v69
v_cvt_pk_bf16_f32 v43, v70, v71
ds_write_b128 v3, v[40:43] offset:4096
v_cvt_pk_bf16_f32 v44, v72, v73
v_cvt_pk_bf16_f32 v45, v74, v75
v_cvt_pk_bf16_f32 v46, v76, v77
v_cvt_pk_bf16_f32 v47, v78, v79
ds_write_b128 v185, v[44:47]
s_waitcnt lgkmcnt(0)
Gs_219:
s_barrier
ds_read_b128 v[56:59], v4 offset:0
ds_read_b128 v[60:63], v4 offset:1024
ds_read_b128 v[64:67], v4 offset:2048
ds_read_b128 v[68:71], v4 offset:3072
ds_read_b128 v[72:75], v4 offset:4096
ds_read_b128 v[76:79], v4 offset:5120
ds_read_b128 v[80:83], v4 offset:6144
ds_read_b128 v[84:87], v4 offset:7168
ds_read_b128 v[88:91], v4 offset:8192
ds_read_b128 v[92:95], v4 offset:9216
s_waitcnt lgkmcnt(9)
v_smfmac_f32_16x16x64_bf16 v[96:99], v[56:59], a[0:7], v5
v_smfmac_f32_16x16x64_bf16 v[100:103], v[56:59], a[80:87], v5
v_smfmac_f32_16x16x64_bf16 v[104:107], v[56:59], a[160:167], v5
v_smfmac_f32_16x16x64_bf16 v[108:111], v[56:59], a[240:247], v5
s_waitcnt lgkmcnt(8)
v_smfmac_f32_16x16x64_bf16 v[96:99], v[60:63], a[8:15], v5
v_smfmac_f32_16x16x64_bf16 v[100:103], v[60:63], a[88:95], v5
v_smfmac_f32_16x16x64_bf16 v[104:107], v[60:63], a[168:175], v5
v_smfmac_f32_16x16x64_bf16 v[108:111], v[60:63], a[248:255], v5
s_waitcnt lgkmcnt(7)
v_smfmac_f32_16x16x64_bf16 v[96:99], v[64:67], a[16:23], v5
v_smfmac_f32_16x16x64_bf16 v[100:103], v[64:67], a[96:103], v5
v_smfmac_f32_16x16x64_bf16 v[104:107], v[64:67], a[176:183], v5
v_smfmac_f32_16x16x64_bf16 v[108:111], v[64:67], v[192:199], v5
s_waitcnt lgkmcnt(6)
v_smfmac_f32_16x16x64_bf16 v[96:99], v[68:71], a[24:31], v5
v_smfmac_f32_16x16x64_bf16 v[100:103], v[68:71], a[104:111], v5
v_smfmac_f32_16x16x64_bf16 v[104:107], v[68:71], a[184:191], v5
v_smfmac_f32_16x16x64_bf16 v[108:111], v[68:71], v[200:207], v5
s_waitcnt lgkmcnt(5)
v_smfmac_f32_16x16x64_bf16 v[96:99], v[72:75], a[32:39], v5
v_smfmac_f32_16x16x64_bf16 v[100:103], v[72:75], a[112:119], v5
v_smfmac_f32_16x16x64_bf16 v[104:107], v[72:75], a[192:199], v5
v_smfmac_f32_16x16x64_bf16 v[108:111], v[72:75], v[208:215], v5
s_waitcnt lgkmcnt(0)
v_smfmac_f32_16x16x64_bf16 v[96:99], v[76:79], a[40:47], v5
v_smfmac_f32_16x16x64_bf16 v[100:103], v[76:79], a[120:127], v5
v_smfmac_f32_16x16x64_bf16 v[96:99], v[80:83], a[48:55], v5
v_smfmac_f32_16x16x64_bf16 v[100:103], v[80:83], a[128:135], v5
v_smfmac_f32_16x16x64_bf16 v[96:99], v[84:87], a[56:63], v5
v_smfmac_f32_16x16x64_bf16 v[100:103], v[84:87], a[136:143], v5
v_smfmac_f32_16x16x64_bf16 v[96:99], v[88:91], a[64:71], v5
v_smfmac_f32_16x16x64_bf16 v[100:103], v[88:91], a[144:151], v5
v_smfmac_f32_16x16x64_bf16 v[96:99], v[92:95], a[72:79], v5
v_smfmac_f32_16x16x64_bf16 v[100:103], v[92:95], a[152:159], v5
v_smfmac_f32_16x16x64_bf16 v[104:107], v[76:79], a[200:207], v5
v_smfmac_f32_16x16x64_bf16 v[108:111], v[76:79], v[216:223], v5
v_smfmac_f32_16x16x64_bf16 v[104:107], v[80:83], a[208:215], v5
v_smfmac_f32_16x16x64_bf16 v[108:111], v[80:83], v[224:231], v5
s_nop 3
v_permlane32_swap_b32 v96, v100
v_smfmac_f32_16x16x64_bf16 v[104:107], v[84:87], a[216:223], v5
v_permlane32_swap_b32 v97, v101
v_smfmac_f32_16x16x64_bf16 v[108:111], v[84:87], v[232:239], v5
v_permlane32_swap_b32 v98, v102
v_permlane32_swap_b32 v99, v103
v_smfmac_f32_16x16x64_bf16 v[104:107], v[88:91], a[224:231], v5
v_pk_add_f32 v[96:97], v[96:97], v[100:101]
v_pk_add_f32 v[98:99], v[98:99], v[102:103]
v_smfmac_f32_16x16x64_bf16 v[108:111], v[88:91], v[240:247], v5
v_cvt_pk_bf16_f32 v36, v96, v97
v_cvt_pk_bf16_f32 v37, v98, v99
v_smfmac_f32_16x16x64_bf16 v[104:107], v[92:95], a[232:239], v5
ds_write_b64 v10, v[36:37]
v_smfmac_f32_16x16x64_bf16 v[108:111], v[92:95], v[248:255], v5
s_nop 7
v_permlane32_swap_b32 v104, v108
v_permlane32_swap_b32 v105, v109
v_permlane32_swap_b32 v106, v110
v_permlane32_swap_b32 v107, v111
v_pk_add_f32 v[104:105], v[104:105], v[108:109]
v_pk_add_f32 v[106:107], v[106:107], v[110:111]
v_cvt_pk_bf16_f32 v38, v104, v105
v_cvt_pk_bf16_f32 v39, v106, v107
ds_write_b64 v10, v[38:39] offset:16
s_waitcnt lgkmcnt(0)
s_barrier
s_cmp_eq_u32 s30, 63
s_cbranch_scc1 QKlast_190
s_cmp_eq_u32 s3, 3
s_cbranch_scc1 w3_229
ds_read_b64_tr_b16 v[56:57], v11 offset:0
ds_read_b64_tr_b16 v[58:59], v11 offset:128
ds_read_b64_tr_b16 v[60:61], v11 offset:1024
ds_read_b64_tr_b16 v[62:63], v11 offset:1152
ds_read_b64_tr_b16 v[64:65], v11 offset:2048
ds_read_b64_tr_b16 v[66:67], v11 offset:2176
ds_read_b64_tr_b16 v[68:69], v11 offset:3072
ds_read_b64_tr_b16 v[70:71], v11 offset:3200
s_cmp_lg_u32 s3, 0
s_cbranch_scc1 xs_231
s_waitcnt lgkmcnt(6)
v_mfma_f32_16x16x32_bf16 v[36:39], v[56:59], v[56:59], 0
s_waitcnt lgkmcnt(4)
v_mfma_f32_16x16x32_bf16 v[36:39], v[60:63], v[60:63], v[36:39]
s_waitcnt lgkmcnt(2)
v_mfma_f32_16x16x32_bf16 v[36:39], v[64:67], v[64:67], v[36:39]
s_waitcnt lgkmcnt(0)
v_mfma_f32_16x16x32_bf16 v[36:39], v[68:71], v[68:71], v[36:39]
s_branch sm_232
xs_231:
s_waitcnt lgkmcnt(6)
s_nop 3
v_mfma_f32_16x16x32_bf16 v[36:39], v[112:115], v[56:59], 0
s_waitcnt lgkmcnt(4)
v_mfma_f32_16x16x32_bf16 v[36:39], v[116:119], v[60:63], v[36:39]
s_waitcnt lgkmcnt(2)
v_mfma_f32_16x16x32_bf16 v[36:39], v[120:123], v[64:67], v[36:39]
s_waitcnt lgkmcnt(0)
v_mfma_f32_16x16x32_bf16 v[36:39], v[124:127], v[68:71], v[36:39]
sm_232:
s_nop 7
v_pk_add_f32 v[36:37], v[36:37], v[26:27]
v_pk_add_f32 v[38:39], v[38:39], v[26:27]
v_max3_f32 v160, v36, v37, v38
v_max_f32 v160, v160, v39
v_mov_b32 v34, v160
s_nop 1
v_permlane16_swap_b32 v160, v34
v_max_f32 v160, v160, v34
v_mov_b32 v34, v160
s_nop 1
v_permlane32_swap_b32 v160, v34
v_max_f32 v160, v160, v34
v_pk_mul_f32 v[32:33], v[160:161], s[66:67] op_sel_hi:[0,1]
s_nop 0
v_pk_fma_f32 v[40:41], v[36:37], s[66:67], v[32:33] neg_lo:[0,0,1] neg_hi:[0,0,1]
v_pk_fma_f32 v[42:43], v[38:39], s[66:67], v[32:33] neg_lo:[0,0,1] neg_hi:[0,0,1]
v_exp_f32 v40, v40
v_exp_f32 v41, v41
v_exp_f32 v42, v42
v_exp_f32 v43, v43
s_nop 0
v_pk_add_f32 v[32:33], v[40:41], v[42:43]
v_add_f32 v162, v32, v33
v_mov_b32 v34, v162
s_nop 1
v_permlane16_swap_b32 v162, v34
v_add_f32 v162, v162, v34
v_mov_b32 v34, v162
s_nop 1
v_permlane32_swap_b32 v162, v34
v_add_f32 v162, v162, v34
ds_write_b128 v24, v[160:163]
s_waitcnt lgkmcnt(0)
s_barrier
ds_read_b128 v[44:47], v25 offset:0
ds_read_b128 v[48:51], v25 offset:256
ds_read_b128 v[52:55], v25 offset:512
s_waitcnt lgkmcnt(0)
v_max3_f32 v30, v44, v48, v52
v_mul_f32 v31, s66, v30
v_fma_f32 v44, v44, s66, -v31
v_fma_f32 v48, v48, s66, -v31
v_fma_f32 v52, v52, s66, -v31
v_fma_f32 v32, v160, s66, -v31
v_exp_f32 v44, v44
v_exp_f32 v48, v48
v_exp_f32 v52, v52
v_exp_f32 v32, v32
v_mul_f32 v34, v44, v46
v_fmac_f32 v34, v48, v50
v_fmac_f32 v34, v52, v54
v_rcp_f32 v34, v34
s_nop 0
v_mul_f32 v32, v32, v34
v_pk_mul_f32 v[40:41], v[40:41], v[32:33] op_sel_hi:[1,0]
v_pk_mul_f32 v[42:43], v[42:43], v[32:33] op_sel_hi:[1,0]
v_cvt_pk_bf16_f32 v30, v40, v41
v_cvt_pk_bf16_f32 v31, v42, v43
v_min_u32 v30, s70, v30
s_mov_b64 exec, s[78:79]
global_store_dwordx2 v13, v[30:31], s[52:53] sc1
s_mov_b64 exec, -1
s_branch sh_233
w3_229:
s_cmp_eq_u32 s30, 0
s_cbranch_scc1 nz_235
s_waitcnt vmcnt(0)
s_add_u32 s46, s30, 4294967295
s_lshl_b32 s46, s46, 5
s_add_u32 s46, s46, s16
s_lshl_b32 s46, s46, 2
s_add_u32 s46, s46, 46170112
v_mov_b32 v30, s46
v_mov_b32 v31, 1
global_store_dword v30, v31, s[4:5] sc1
nz_235:
s_sleep 1
s_sleep 1
s_sleep 1
s_sleep 1
s_sleep 1
s_sleep 1
s_mov_b64 exec, 1
global_store_dword v21, v22, s[4:5] sc1
s_mov_b64 exec, -1
s_barrier
s_sleep 1
s_sleep 1
s_sleep 1
s_sleep 1
s_sleep 1
s_sleep 1
ds_read_b64_tr_b16 v[56:57], v11 offset:0
ds_read_b64_tr_b16 v[58:59], v11 offset:128
ds_read_b64_tr_b16 v[60:61], v11 offset:1024
ds_read_b64_tr_b16 v[62:63], v11 offset:1152
ds_read_b64_tr_b16 v[64:65], v11 offset:2048
ds_read_b64_tr_b16 v[66:67], v11 offset:2176
ds_read_b64_tr_b16 v[68:69], v11 offset:3072
ds_read_b64_tr_b16 v[70:71], v11 offset:3200
s_lshl_b32 s46, s30, 5
s_add_u32 s46, s46, s16
s_lshl_b32 s46, s46, 11
s_add_u32 s46, s46, 33554432
s_add_u32 s56, s4, s46
s_addc_u32 s57, s5, 0
s_waitcnt lgkmcnt(0)
s_mov_b64 exec, s[72:73]
global_store_dwordx4 v23, v[56:59], s[56:57] offset:0 sc1
global_store_dwordx4 v23, v[60:63], s[56:57] offset:512 sc1
global_store_dwordx4 v23, v[64:67], s[56:57] offset:1024 sc1
global_store_dwordx4 v23, v[68:71], s[56:57] offset:1536 sc1
s_mov_b64 exec, -1
s_add_u32 s44, s30, 4294967295
s_and_b32 s44, s44, 3
s_mul_i32 s44, s44, 20480
s_add_u32 s44, s44, 44236800
s_add_u32 s58, s4, s44
s_addc_u32 s59, s5, 0
global_store_dwordx4 v180, v[112:115], s[58:59] sc1
global_store_dwordx4 v181, v[112:115], s[58:59] sc1
s_add_u32 s45, s30, 2
s_min_u32 s45, s45, 63
s_lshl_b32 s46, s45, 8
s_lshr_b32 s47, s16, 1
s_add_u32 s47, s47, 16
s_lshl_b32 s47, s47, 2
s_add_u32 s46, s46, s47
s_add_u32 s46, s46, 46137344
v_mov_b32 v32, s46
vf_236:
global_load_dword v33, v32, s[4:5] sc1
s_waitcnt vmcnt(0)
v_cmp_eq_u32 vcc, 0, v33
s_nop 3
s_cbranch_vccz ok_237
s_add_u32 s100, s100, 1
s_cmp_lt_u32 s100, 0x1000000
s_cbranch_scc1 vf_236
s_endpgm
ok_237:
s_add_u32 s46, s30, 0
s_lshl_b32 s46, s46, 5
s_add_u32 s46, s46, s16
s_lshl_b32 s46, s46, 2
s_add_u32 s46, s46, 46161920
v_mov_b32 v30, s46
v_mov_b32 v31, 1
global_store_dword v30, v31, s[4:5] sc1
sh_233:
s_and_b32 s44, s30, 3
s_mul_i32 s44, s44, 393216
s_add_u32 s44, s44, 44367872
s_add_u32 s54, s4, s44
s_addc_u32 s55, s5, 0
s_mul_i32 s44, s30, 393216
s_add_u32 s56, s4, s44
s_addc_u32 s57, s5, 0
s_add_u32 s56, s56, 50331648
s_addc_u32 s57, s57, 0
zc_238:
global_load_dwordx4 v[164:167], v15, s[54:55] sc1
global_load_dwordx4 v[168:171], v15, s[54:55] offset:256 sc1
global_load_dwordx4 v[172:175], v16, s[54:55] sc1
s_waitcnt vmcnt(0)
v_max3_u32 v30, v164, v166, v168
v_max3_u32 v30, v30, v170, v172
v_max_u32 v30, v30, v174
v_cmp_eq_u32 vcc, -1, v30
s_nop 3
s_cbranch_vccz ok_239
s_add_u32 s100, s100, 1
s_cmp_lt_u32 s100, 0x1000000
s_cbranch_scc1 zc_238
s_endpgm
ok_239:
global_store_dwordx4 v15, v[164:167], s[56:57] sc1
global_store_dwordx4 v15, v[168:171], s[56:57] offset:256 sc1
global_store_dwordx4 v16, v[172:175], s[56:57] sc1
s_add_u32 s44, s30, 4294967295
s_and_b32 s44, s44, 3
s_mul_i32 s44, s44, 393216
s_add_u32 s44, s44, 44367872
s_add_u32 s54, s4, s44
s_addc_u32 s55, s5, 0
global_store_dwordx4 v15, v[132:135], s[54:55] sc1
global_store_dwordx4 v15, v[132:135], s[54:55] offset:256 sc1
global_store_dwordx4 v16, v[132:135], s[54:55] sc1
s_add_u32 s30, s30, 1
s_branch QKstep_189
QKlast_190:
s_cmp_lg_u32 s3, 3
s_cbranch_scc1 d_240
s_waitcnt vmcnt(0)
s_add_u32 s46, s30, 4294967295
s_lshl_b32 s46, s46, 5
s_add_u32 s46, s46, s16
s_lshl_b32 s46, s46, 2
s_add_u32 s46, s46, 46170112
v_mov_b32 v30, s46
v_mov_b32 v31, 1
global_store_dword v30, v31, s[4:5] sc1
ds_read_b64_tr_b16 v[56:57], v11 offset:0
ds_read_b64_tr_b16 v[58:59], v11 offset:128
ds_read_b64_tr_b16 v[60:61], v11 offset:1024
ds_read_b64_tr_b16 v[62:63], v11 offset:1152
ds_read_b64_tr_b16 v[64:65], v11 offset:2048
ds_read_b64_tr_b16 v[66:67], v11 offset:2176
ds_read_b64_tr_b16 v[68:69], v11 offset:3072
ds_read_b64_tr_b16 v[70:71], v11 offset:3200
s_lshl_b32 s46, s30, 5
s_add_u32 s46, s46, s16
s_lshl_b32 s46, s46, 11
s_add_u32 s46, s46, 33554432
s_add_u32 s56, s4, s46
s_addc_u32 s57, s5, 0
s_waitcnt lgkmcnt(0)
s_mov_b64 exec, s[72:73]
global_store_dwordx4 v23, v[56:59], s[56:57] offset:0 sc1
global_store_dwordx4 v23, v[60:63], s[56:57] offset:512 sc1
global_store_dwordx4 v23, v[64:67], s[56:57] offset:1024 sc1
global_store_dwordx4 v23, v[68:71], s[56:57] offset:1536 sc1
s_mov_b64 exec, -1
s_waitcnt vmcnt(0)
s_add_u32 s46, s30, 0
s_lshl_b32 s46, s46, 5
s_add_u32 s46, s46, s16
s_lshl_b32 s46, s46, 2
s_add_u32 s46, s46, 46161920
v_mov_b32 v30, s46
v_mov_b32 v31, 1
global_store_dword v30, v31, s[4:5] sc1
d_240:
s_and_b32 s44, s30, 3
s_mul_i32 s44, s44, 393216
s_add_u32 s44, s44, 44367872
s_add_u32 s54, s4, s44
s_addc_u32 s55, s5, 0
s_mul_i32 s44, s30, 393216
s_add_u32 s56, s4, s44
s_addc_u32 s57, s5, 0
s_add_u32 s56, s56, 50331648
s_addc_u32 s57, s57, 0
zc_242:
global_load_dwordx4 v[164:167], v15, s[54:55] sc1
global_load_dwordx4 v[168:171], v15, s[54:55] offset:256 sc1
global_load_dwordx4 v[172:175], v16, s[54:55] sc1
s_waitcnt vmcnt(0)
v_max3_u32 v30, v164, v166, v168
v_max3_u32 v30, v30, v170, v172
v_max_u32 v30, v30, v174
v_cmp_eq_u32 vcc, -1, v30
s_nop 3
s_cbranch_vccz ok_243
s_add_u32 s100, s100, 1
s_cmp_lt_u32 s100, 0x1000000
s_cbranch_scc1 zc_242
s_endpgm
ok_243:
global_store_dwordx4 v15, v[164:167], s[56:57] sc1
global_store_dwordx4 v15, v[168:171], s[56:57] offset:256 sc1
global_store_dwordx4 v16, v[172:175], s[56:57] sc1
s_waitcnt vmcnt(0)
s_barrier
s_cmp_lg_u32 s3, 3
s_cbranch_scc1 d2_241
s_add_u32 s46, s30, 0
s_lshl_b32 s46, s46, 5
s_add_u32 s46, s46, s16
s_lshl_b32 s46, s46, 2
s_add_u32 s46, s46, 46170112
v_mov_b32 v30, s46
v_mov_b32 v31, 1
global_store_dword v30, v31, s[4:5] sc1
d2_241:
s_waitcnt vmcnt(0)
s_endpgm
L_vo_s:
s_mov_b32 s60, 0x00ff00ff
s_mov_b32 s61, 0x00ff00ff
s_mov_b32 s62, 0
s_mov_b32 s63, 0x00ff00ff
s_mov_b32 s64, -1
s_mov_b32 s65, 0
s_mov_b32 s72, 0xff00ff00
s_mov_b32 s73, 0xff00ff00
s_mov_b32 s66, 0x3e0293ee
s_mov_b32 s67, 0x3e0293ee
s_mov_b32 s70, 0xfffffffe
s_load_dwordx2 s[8:9], s[0:1], 104
s_load_dwordx2 s[10:11], s[0:1], 112
s_waitcnt lgkmcnt(0)
s_lshl_b32 s40, s3, 18
s_lshl_b32 s41, s16, 8
s_add_u32 s40, s40, s41
s_add_u32 s8, s8, s40
s_addc_u32 s9, s9, 0
s_mul_i32 s40, s16, 163840
s_mul_i32 s41, s3, 40960
s_add_u32 s40, s40, s41
s_add_u32 s10, s10, s40
s_addc_u32 s11, s11, 0
v_lshrrev_b32 v30, 4, v1
v_mul_u32_u24 v10, 2176, v30
v_bfe_u32 v30, v1, 2, 2
v_lshl_add_u32 v10, v30, 8, v10
v_and_b32 v30, 3, v1
v_lshl_add_u32 v10, v30, 3, v10
s_lshl_b32 s40, s3, 6
v_add_u32 v10, s40, v10
s_add_u32 s40, s8, 0
s_addc_u32 s41, s9, 0
s_mov_b32 s43, 32768
v_lshrrev_b32 v34, 4, v1
v_lshlrev_b32 v34, 13, v34
v_and_b32 v35, 15, v1
v_lshl_add_u32 v34, v35, 4, v34
s_mul_i32 s44, s3, 8704
s_add_u32 s44, s44, 0
v_mov_b32 v35, v34
s_add_u32 m0, s44, 0
s_nop 0
global_load_lds_dwordx4 v35, s[40:41]
v_add_u32 v35, s43, v35
s_add_u32 m0, s44, 1088
s_nop 0
global_load_lds_dwordx4 v35, s[40:41]
v_add_u32 v35, s43, v35
s_add_u32 m0, s44, 2176
s_nop 0
global_load_lds_dwordx4 v35, s[40:41]
v_add_u32 v35, s43, v35
s_add_u32 m0, s44, 3264
s_nop 0
global_load_lds_dwordx4 v35, s[40:41]
v_add_u32 v35, s43, v35
s_add_u32 m0, s44, 4352
s_nop 0
global_load_lds_dwordx4 v35, s[40:41]
v_add_u32 v35, s43, v35
s_add_u32 m0, s44, 5440
s_nop 0
global_load_lds_dwordx4 v35, s[40:41]
v_add_u32 v35, s43, v35
s_add_u32 m0, s44, 6528
s_nop 0
global_load_lds_dwordx4 v35, s[40:41]
v_add_u32 v35, s43, v35
s_add_u32 m0, s44, 7616
s_nop 0
global_load_lds_dwordx4 v35, s[40:41]
s_add_u32 s40, s8, 1048576
s_addc_u32 s41, s9, 0
s_mov_b32 s43, 32768
v_lshrrev_b32 v34, 4, v1
v_lshlrev_b32 v34, 13, v34
v_and_b32 v35, 15, v1
v_lshl_add_u32 v34, v35, 4, v34
s_mul_i32 s44, s3, 8704
s_add_u32 s44, s44, 34816
v_mov_b32 v35, v34
s_add_u32 m0, s44, 0
s_nop 0
global_load_lds_dwordx4 v35, s[40:41]
v_add_u32 v35, s43, v35
s_add_u32 m0, s44, 1088
s_nop 0
global_load_lds_dwordx4 v35, s[40:41]
v_add_u32 v35, s43, v35
s_add_u32 m0, s44, 2176
s_nop 0
global_load_lds_dwordx4 v35, s[40:41]
v_add_u32 v35, s43, v35
s_add_u32 m0, s44, 3264
s_nop 0
global_load_lds_dwordx4 v35, s[40:41]
v_add_u32 v35, s43, v35
s_add_u32 m0, s44, 4352
s_nop 0
global_load_lds_dwordx4 v35, s[40:41]
v_add_u32 v35, s43, v35
s_add_u32 m0, s44, 5440
s_nop 0
global_load_lds_dwordx4 v35, s[40:41]
v_add_u32 v35, s43, v35
s_add_u32 m0, s44, 6528
s_nop 0
global_load_lds_dwordx4 v35, s[40:41]
v_add_u32 v35, s43, v35
s_add_u32 m0, s44, 7616
s_nop 0
global_load_lds_dwordx4 v35, s[40:41]
s_add_u32 s40, s8, 2097152
s_addc_u32 s41, s9, 0
s_mov_b32 s43, 32768
v_lshrrev_b32 v34, 4, v1
v_lshlrev_b32 v34, 13, v34
v_and_b32 v35, 15, v1
v_lshl_add_u32 v34, v35, 4, v34
s_mul_i32 s44, s3, 8704
s_add_u32 s44, s44, 69632
v_mov_b32 v35, v34
s_add_u32 m0, s44, 0
s_nop 0
global_load_lds_dwordx4 v35, s[40:41]
v_add_u32 v35, s43, v35
s_add_u32 m0, s44, 1088
s_nop 0
global_load_lds_dwordx4 v35, s[40:41]
v_add_u32 v35, s43, v35
s_add_u32 m0, s44, 2176
s_nop 0
global_load_lds_dwordx4 v35, s[40:41]
v_add_u32 v35, s43, v35
s_add_u32 m0, s44, 3264
s_nop 0
global_load_lds_dwordx4 v35, s[40:41]
v_add_u32 v35, s43, v35
s_add_u32 m0, s44, 4352
s_nop 0
global_load_lds_dwordx4 v35, s[40:41]
v_add_u32 v35, s43, v35
s_add_u32 m0, s44, 5440
s_nop 0
global_load_lds_dwordx4 v35, s[40:41]
v_add_u32 v35, s43, v35
s_add_u32 m0, s44, 6528
s_nop 0
global_load_lds_dwordx4 v35, s[40:41]
v_add_u32 v35, s43, v35
s_add_u32 m0, s44, 7616
s_nop 0
global_load_lds_dwordx4 v35, s[40:41]
s_add_u32 s40, s8, 3145728
s_addc_u32 s41, s9, 0
s_mov_b32 s43, 32768
v_lshrrev_b32 v34, 4, v1
v_lshlrev_b32 v34, 13, v34
v_and_b32 v35, 15, v1
v_lshl_add_u32 v34, v35, 4, v34
s_mul_i32 s44, s3, 8704
s_add_u32 s44, s44, 104448
v_mov_b32 v35, v34
s_add_u32 m0, s44, 0
s_nop 0
global_load_lds_dwordx4 v35, s[40:41]
v_add_u32 v35, s43, v35
s_add_u32 m0, s44, 1088
s_nop 0
global_load_lds_dwordx4 v35, s[40:41]
v_add_u32 v35, s43, v35
s_add_u32 m0, s44, 2176
s_nop 0
global_load_lds_dwordx4 v35, s[40:41]
v_add_u32 v35, s43, v35
s_add_u32 m0, s44, 3264
s_nop 0
global_load_lds_dwordx4 v35, s[40:41]
v_add_u32 v35, s43, v35
s_add_u32 m0, s44, 4352
s_nop 0
global_load_lds_dwordx4 v35, s[40:41]
v_add_u32 v35, s43, v35
s_add_u32 m0, s44, 5440
s_nop 0
global_load_lds_dwordx4 v35, s[40:41]
v_add_u32 v35, s43, v35
s_add_u32 m0, s44, 6528
s_nop 0
global_load_lds_dwordx4 v35, s[40:41]
v_add_u32 v35, s43, v35
s_add_u32 m0, s44, 7616
s_nop 0
global_load_lds_dwordx4 v35, s[40:41]
s_cmp_lg_u32 s101, 0
s_cbranch_scc1 arr_244
s_cmp_lg_u32 s99, 0
s_cbranch_scc1 arr_244
s_waitcnt vmcnt(32)
s_barrier
s_cmp_lg_u32 s3, 0
s_cbranch_scc1 arr_244
v_mov_b32 v30, 64
v_mov_b32 v31, 1
s_mov_b64 exec, 1
global_atomic_add v30, v31, s[6:7]
s_mov_b64 exec, -1
arr_244:
s_waitcnt vmcnt(24)
s_barrier
v_add_u32 v33, 0, v10
ds_read_b64_tr_b16 a[0:1], v33 offset:0
ds_read_b64_tr_b16 a[2:3], v33 offset:1088
ds_read_b64_tr_b16 a[4:5], v33 offset:8704
ds_read_b64_tr_b16 a[6:7], v33 offset:9792
ds_read_b64_tr_b16 a[80:81], v33 offset:32
ds_read_b64_tr_b16 a[82:83], v33 offset:1120
ds_read_b64_tr_b16 a[84:85], v33 offset:8736
ds_read_b64_tr_b16 a[86:87], v33 offset:9824
ds_read_b64_tr_b16 a[8:9], v33 offset:17408
ds_read_b64_tr_b16 a[10:11], v33 offset:18496
ds_read_b64_tr_b16 a[12:13], v33 offset:26112
ds_read_b64_tr_b16 a[14:15], v33 offset:27200
ds_read_b64_tr_b16 a[88:89], v33 offset:17440
ds_read_b64_tr_b16 a[90:91], v33 offset:18528
ds_read_b64_tr_b16 a[92:93], v33 offset:26144
ds_read_b64_tr_b16 a[94:95], v33 offset:27232
s_waitcnt lgkmcnt(0)
s_barrier
s_add_u32 s40, s8, 4194304
s_addc_u32 s41, s9, 0
s_mov_b32 s43, 32768
v_lshrrev_b32 v34, 4, v1
v_lshlrev_b32 v34, 13, v34
v_and_b32 v35, 15, v1
v_lshl_add_u32 v34, v35, 4, v34
s_mul_i32 s44, s3, 8704
s_add_u32 s44, s44, 0
v_mov_b32 v35, v34
s_add_u32 m0, s44, 0
s_nop 0
global_load_lds_dwordx4 v35, s[40:41]
v_add_u32 v35, s43, v35
s_add_u32 m0, s44, 1088
s_nop 0
global_load_lds_dwordx4 v35, s[40:41]
v_add_u32 v35, s43, v35
s_add_u32 m0, s44, 2176
s_nop 0
global_load_lds_dwordx4 v35, s[40:41]
v_add_u32 v35, s43, v35
s_add_u32 m0, s44, 3264
s_nop 0
global_load_lds_dwordx4 v35, s[40:41]
v_add_u32 v35, s43, v35
s_add_u32 m0, s44, 4352
s_nop 0
global_load_lds_dwordx4 v35, s[40:41]
v_add_u32 v35, s43, v35
s_add_u32 m0, s44, 5440
s_nop 0
global_load_lds_dwordx4 v35, s[40:41]
v_add_u32 v35, s43, v35
s_add_u32 m0, s44, 6528
s_nop 0
global_load_lds_dwordx4 v35, s[40:41]
v_add_u32 v35, s43, v35
s_add_u32 m0, s44, 7616
s_nop 0
global_load_lds_dwordx4 v35, s[40:41]
s_waitcnt vmcnt(24)
s_barrier
v_add_u32 v33, 34816, v10
ds_read_b64_tr_b16 a[16:17], v33 offset:0
ds_read_b64_tr_b16 a[18:19], v33 offset:1088
ds_read_b64_tr_b16 a[20:21], v33 offset:8704
ds_read_b64_tr_b16 a[22:23], v33 offset:9792
ds_read_b64_tr_b16 a[96:97], v33 offset:32
ds_read_b64_tr_b16 a[98:99], v33 offset:1120
ds_read_b64_tr_b16 a[100:101], v33 offset:8736
ds_read_b64_tr_b16 a[102:103], v33 offset:9824
ds_read_b64_tr_b16 a[24:25], v33 offset:17408
ds_read_b64_tr_b16 a[26:27], v33 offset:18496
ds_read_b64_tr_b16 a[28:29], v33 offset:26112
ds_read_b64_tr_b16 a[30:31], v33 offset:27200
ds_read_b64_tr_b16 a[104:105], v33 offset:17440
ds_read_b64_tr_b16 a[106:107], v33 offset:18528
ds_read_b64_tr_b16 a[108:109], v33 offset:26144
ds_read_b64_tr_b16 a[110:111], v33 offset:27232
s_waitcnt lgkmcnt(0)
s_barrier
s_add_u32 s40, s10, 0
s_addc_u32 s41, s11, 0
s_mov_b32 s43, 5120
v_lshrrev_b32 v34, 4, v1
v_mul_u32_u24 v34, 1280, v34
v_and_b32 v35, 15, v1
v_lshl_add_u32 v34, v35, 4, v34
s_mul_i32 s44, s3, 8704
s_add_u32 s44, s44, 34816
v_mov_b32 v35, v34
s_add_u32 m0, s44, 0
s_nop 0
global_load_lds_dwordx4 v35, s[40:41]
v_add_u32 v35, s43, v35
s_add_u32 m0, s44, 1088
s_nop 0
global_load_lds_dwordx4 v35, s[40:41]
v_add_u32 v35, s43, v35
s_add_u32 m0, s44, 2176
s_nop 0
global_load_lds_dwordx4 v35, s[40:41]
v_add_u32 v35, s43, v35
s_add_u32 m0, s44, 3264
s_nop 0
global_load_lds_dwordx4 v35, s[40:41]
v_add_u32 v35, s43, v35
s_add_u32 m0, s44, 4352
s_nop 0
global_load_lds_dwordx4 v35, s[40:41]
v_add_u32 v35, s43, v35
s_add_u32 m0, s44, 5440
s_nop 0
global_load_lds_dwordx4 v35, s[40:41]
v_add_u32 v35, s43, v35
s_add_u32 m0, s44, 6528
s_nop 0
global_load_lds_dwordx4 v35, s[40:41]
v_add_u32 v35, s43, v35
s_add_u32 m0, s44, 7616
s_nop 0
global_load_lds_dwordx4 v35, s[40:41]
s_waitcnt vmcnt(24)
s_barrier
v_add_u32 v33, 69632, v10
ds_read_b64_tr_b16 a[32:33], v33 offset:0
ds_read_b64_tr_b16 a[34:35], v33 offset:1088
ds_read_b64_tr_b16 a[36:37], v33 offset:8704
ds_read_b64_tr_b16 a[38:39], v33 offset:9792
ds_read_b64_tr_b16 a[112:113], v33 offset:32
ds_read_b64_tr_b16 a[114:115], v33 offset:1120
ds_read_b64_tr_b16 a[116:117], v33 offset:8736
ds_read_b64_tr_b16 a[118:119], v33 offset:9824
ds_read_b64_tr_b16 a[40:41], v33 offset:17408
ds_read_b64_tr_b16 a[42:43], v33 offset:18496
ds_read_b64_tr_b16 a[44:45], v33 offset:26112
ds_read_b64_tr_b16 a[46:47], v33 offset:27200
ds_read_b64_tr_b16 a[120:121], v33 offset:17440
ds_read_b64_tr_b16 a[122:123], v33 offset:18528
ds_read_b64_tr_b16 a[124:125], v33 offset:26144
ds_read_b64_tr_b16 a[126:127], v33 offset:27232
s_waitcnt lgkmcnt(0)
s_barrier
s_add_u32 s40, s10, 256
s_addc_u32 s41, s11, 0
s_mov_b32 s43, 5120
v_lshrrev_b32 v34, 4, v1
v_mul_u32_u24 v34, 1280, v34
v_and_b32 v35, 15, v1
v_lshl_add_u32 v34, v35, 4, v34
s_mul_i32 s44, s3, 8704
s_add_u32 s44, s44, 69632
v_mov_b32 v35, v34
s_add_u32 m0, s44, 0
s_nop 0
global_load_lds_dwordx4 v35, s[40:41]
v_add_u32 v35, s43, v35
s_add_u32 m0, s44, 1088
s_nop 0
global_load_lds_dwordx4 v35, s[40:41]
v_add_u32 v35, s43, v35
s_add_u32 m0, s44, 2176
s_nop 0
global_load_lds_dwordx4 v35, s[40:41]
v_add_u32 v35, s43, v35
s_add_u32 m0, s44, 3264
s_nop 0
global_load_lds_dwordx4 v35, s[40:41]
v_add_u32 v35, s43, v35
s_add_u32 m0, s44, 4352
s_nop 0
global_load_lds_dwordx4 v35, s[40:41]
v_add_u32 v35, s43, v35
s_add_u32 m0, s44, 5440
s_nop 0
global_load_lds_dwordx4 v35, s[40:41]
v_add_u32 v35, s43, v35
s_add_u32 m0, s44, 6528
s_nop 0
global_load_lds_dwordx4 v35, s[40:41]
v_add_u32 v35, s43, v35
s_add_u32 m0, s44, 7616
s_nop 0
global_load_lds_dwordx4 v35, s[40:41]
s_waitcnt vmcnt(24)
s_barrier
v_add_u32 v33, 104448, v10
ds_read_b64_tr_b16 a[48:49], v33 offset:0
ds_read_b64_tr_b16 a[50:51], v33 offset:1088
ds_read_b64_tr_b16 a[52:53], v33 offset:8704
ds_read_b64_tr_b16 a[54:55], v33 offset:9792
ds_read_b64_tr_b16 a[128:129], v33 offset:32
ds_read_b64_tr_b16 a[130:131], v33 offset:1120
ds_read_b64_tr_b16 a[132:133], v33 offset:8736
ds_read_b64_tr_b16 a[134:135], v33 offset:9824
ds_read_b64_tr_b16 a[56:57], v33 offset:17408
ds_read_b64_tr_b16 a[58:59], v33 offset:18496
ds_read_b64_tr_b16 a[60:61], v33 offset:26112
ds_read_b64_tr_b16 a[62:63], v33 offset:27200
ds_read_b64_tr_b16 a[136:137], v33 offset:17440
ds_read_b64_tr_b16 a[138:139], v33 offset:18528
ds_read_b64_tr_b16 a[140:141], v33 offset:26144
ds_read_b64_tr_b16 a[142:143], v33 offset:27232
s_waitcnt lgkmcnt(0)
s_barrier
s_add_u32 s40, s10, 512
s_addc_u32 s41, s11, 0
s_mov_b32 s43, 5120
v_lshrrev_b32 v34, 4, v1
v_mul_u32_u24 v34, 1280, v34
v_and_b32 v35, 15, v1
v_lshl_add_u32 v34, v35, 4, v34
s_mul_i32 s44, s3, 8704
s_add_u32 s44, s44, 104448
v_mov_b32 v35, v34
s_add_u32 m0, s44, 0
s_nop 0
global_load_lds_dwordx4 v35, s[40:41]
v_add_u32 v35, s43, v35
s_add_u32 m0, s44, 1088
s_nop 0
global_load_lds_dwordx4 v35, s[40:41]
v_add_u32 v35, s43, v35
s_add_u32 m0, s44, 2176
s_nop 0
global_load_lds_dwordx4 v35, s[40:41]
v_add_u32 v35, s43, v35
s_add_u32 m0, s44, 3264
s_nop 0
global_load_lds_dwordx4 v35, s[40:41]
v_add_u32 v35, s43, v35
s_add_u32 m0, s44, 4352
s_nop 0
global_load_lds_dwordx4 v35, s[40:41]
v_add_u32 v35, s43, v35
s_add_u32 m0, s44, 5440
s_nop 0
global_load_lds_dwordx4 v35, s[40:41]
v_add_u32 v35, s43, v35
s_add_u32 m0, s44, 6528
s_nop 0
global_load_lds_dwordx4 v35, s[40:41]
v_add_u32 v35, s43, v35
s_add_u32 m0, s44, 7616
s_nop 0
global_load_lds_dwordx4 v35, s[40:41]
s_waitcnt vmcnt(24)
s_barrier
v_add_u32 v33, 0, v10
ds_read_b64_tr_b16 a[64:65], v33 offset:0
ds_read_b64_tr_b16 a[66:67], v33 offset:1088
ds_read_b64_tr_b16 a[68:69], v33 offset:8704
ds_read_b64_tr_b16 a[70:71], v33 offset:9792
ds_read_b64_tr_b16 a[144:145], v33 offset:32
ds_read_b64_tr_b16 a[146:147], v33 offset:1120
ds_read_b64_tr_b16 a[148:149], v33 offset:8736
ds_read_b64_tr_b16 a[150:151], v33 offset:9824
ds_read_b64_tr_b16 a[72:73], v33 offset:17408
ds_read_b64_tr_b16 a[74:75], v33 offset:18496
ds_read_b64_tr_b16 a[76:77], v33 offset:26112
ds_read_b64_tr_b16 a[78:79], v33 offset:27200
ds_read_b64_tr_b16 a[152:153], v33 offset:17440
ds_read_b64_tr_b16 a[154:155], v33 offset:18528
ds_read_b64_tr_b16 a[156:157], v33 offset:26144
ds_read_b64_tr_b16 a[158:159], v33 offset:27232
s_waitcnt lgkmcnt(0)
s_barrier
s_add_u32 s40, s10, 768
s_addc_u32 s41, s11, 0
s_mov_b32 s43, 5120
v_lshrrev_b32 v34, 4, v1
v_mul_u32_u24 v34, 1280, v34
v_and_b32 v35, 15, v1
v_lshl_add_u32 v34, v35, 4, v34
s_mul_i32 s44, s3, 8704
s_add_u32 s44, s44, 0
v_mov_b32 v35, v34
s_add_u32 m0, s44, 0
s_nop 0
global_load_lds_dwordx4 v35, s[40:41]
v_add_u32 v35, s43, v35
s_add_u32 m0, s44, 1088
s_nop 0
global_load_lds_dwordx4 v35, s[40:41]
v_add_u32 v35, s43, v35
s_add_u32 m0, s44, 2176
s_nop 0
global_load_lds_dwordx4 v35, s[40:41]
v_add_u32 v35, s43, v35
s_add_u32 m0, s44, 3264
s_nop 0
global_load_lds_dwordx4 v35, s[40:41]
v_add_u32 v35, s43, v35
s_add_u32 m0, s44, 4352
s_nop 0
global_load_lds_dwordx4 v35, s[40:41]
v_add_u32 v35, s43, v35
s_add_u32 m0, s44, 5440
s_nop 0
global_load_lds_dwordx4 v35, s[40:41]
v_add_u32 v35, s43, v35
s_add_u32 m0, s44, 6528
s_nop 0
global_load_lds_dwordx4 v35, s[40:41]
v_add_u32 v35, s43, v35
s_add_u32 m0, s44, 7616
s_nop 0
global_load_lds_dwordx4 v35, s[40:41]
s_waitcnt vmcnt(24)
s_barrier
v_add_u32 v33, 34816, v10
ds_read_b64_tr_b16 a[160:161], v33 offset:0
ds_read_b64_tr_b16 a[162:163], v33 offset:1088
ds_read_b64_tr_b16 a[164:165], v33 offset:8704
ds_read_b64_tr_b16 a[166:167], v33 offset:9792
ds_read_b64_tr_b16 a[176:177], v33 offset:32
ds_read_b64_tr_b16 a[178:179], v33 offset:1120
ds_read_b64_tr_b16 a[180:181], v33 offset:8736
ds_read_b64_tr_b16 a[182:183], v33 offset:9824
ds_read_b64_tr_b16 a[168:169], v33 offset:17408
ds_read_b64_tr_b16 a[170:171], v33 offset:18496
ds_read_b64_tr_b16 a[172:173], v33 offset:26112
ds_read_b64_tr_b16 a[174:175], v33 offset:27200
ds_read_b64_tr_b16 a[184:185], v33 offset:17440
ds_read_b64_tr_b16 a[186:187], v33 offset:18528
ds_read_b64_tr_b16 a[188:189], v33 offset:26144
ds_read_b64_tr_b16 a[190:191], v33 offset:27232
s_waitcnt lgkmcnt(0)
s_barrier
s_add_u32 s40, s10, 1024
s_addc_u32 s41, s11, 0
s_mov_b32 s43, 5120
v_lshrrev_b32 v34, 4, v1
v_mul_u32_u24 v34, 1280, v34
v_and_b32 v35, 15, v1
v_lshl_add_u32 v34, v35, 4, v34
s_mul_i32 s44, s3, 8704
s_add_u32 s44, s44, 34816
v_mov_b32 v35, v34
s_add_u32 m0, s44, 0
s_nop 0
global_load_lds_dwordx4 v35, s[40:41]
v_add_u32 v35, s43, v35
s_add_u32 m0, s44, 1088
s_nop 0
global_load_lds_dwordx4 v35, s[40:41]
v_add_u32 v35, s43, v35
s_add_u32 m0, s44, 2176
s_nop 0
global_load_lds_dwordx4 v35, s[40:41]
v_add_u32 v35, s43, v35
s_add_u32 m0, s44, 3264
s_nop 0
global_load_lds_dwordx4 v35, s[40:41]
v_add_u32 v35, s43, v35
s_add_u32 m0, s44, 4352
s_nop 0
global_load_lds_dwordx4 v35, s[40:41]
v_add_u32 v35, s43, v35
s_add_u32 m0, s44, 5440
s_nop 0
global_load_lds_dwordx4 v35, s[40:41]
v_add_u32 v35, s43, v35
s_add_u32 m0, s44, 6528
s_nop 0
global_load_lds_dwordx4 v35, s[40:41]
v_add_u32 v35, s43, v35
s_add_u32 m0, s44, 7616
s_nop 0
global_load_lds_dwordx4 v35, s[40:41]
s_waitcnt vmcnt(24)
s_barrier
v_add_u32 v33, 69632, v10
ds_read_b64_tr_b16 a[192:193], v33 offset:0
ds_read_b64_tr_b16 a[194:195], v33 offset:1088
ds_read_b64_tr_b16 a[196:197], v33 offset:8704
ds_read_b64_tr_b16 a[198:199], v33 offset:9792
ds_read_b64_tr_b16 a[208:209], v33 offset:32
ds_read_b64_tr_b16 a[210:211], v33 offset:1120
ds_read_b64_tr_b16 a[212:213], v33 offset:8736
ds_read_b64_tr_b16 a[214:215], v33 offset:9824
ds_read_b64_tr_b16 a[200:201], v33 offset:17408
ds_read_b64_tr_b16 a[202:203], v33 offset:18496
ds_read_b64_tr_b16 a[204:205], v33 offset:26112
ds_read_b64_tr_b16 a[206:207], v33 offset:27200
ds_read_b64_tr_b16 a[216:217], v33 offset:17440
ds_read_b64_tr_b16 a[218:219], v33 offset:18528
ds_read_b64_tr_b16 a[220:221], v33 offset:26144
ds_read_b64_tr_b16 a[222:223], v33 offset:27232
s_waitcnt lgkmcnt(0)
s_barrier
s_waitcnt vmcnt(16)
s_barrier
v_add_u32 v33, 104448, v10
ds_read_b64_tr_b16 a[224:225], v33 offset:0
ds_read_b64_tr_b16 a[226:227], v33 offset:1088
ds_read_b64_tr_b16 a[228:229], v33 offset:8704
ds_read_b64_tr_b16 a[230:231], v33 offset:9792
ds_read_b64_tr_b16 a[240:241], v33 offset:32
ds_read_b64_tr_b16 a[242:243], v33 offset:1120
ds_read_b64_tr_b16 a[244:245], v33 offset:8736
ds_read_b64_tr_b16 a[246:247], v33 offset:9824
ds_read_b64_tr_b16 a[232:233], v33 offset:17408
ds_read_b64_tr_b16 a[234:235], v33 offset:18496
ds_read_b64_tr_b16 a[236:237], v33 offset:26112
ds_read_b64_tr_b16 a[238:239], v33 offset:27200
ds_read_b64_tr_b16 a[248:249], v33 offset:17440
ds_read_b64_tr_b16 a[250:251], v33 offset:18528
ds_read_b64_tr_b16 a[252:253], v33 offset:26144
ds_read_b64_tr_b16 a[254:255], v33 offset:27232
s_waitcnt lgkmcnt(0)
s_barrier
s_waitcnt vmcnt(8)
s_barrier
v_add_u32 v33, 0, v10
ds_read_b64_tr_b16 v[192:193], v33 offset:0
ds_read_b64_tr_b16 v[194:195], v33 offset:1088
ds_read_b64_tr_b16 v[196:197], v33 offset:8704
ds_read_b64_tr_b16 v[198:199], v33 offset:9792
ds_read_b64_tr_b16 v[208:209], v33 offset:32
ds_read_b64_tr_b16 v[210:211], v33 offset:1120
ds_read_b64_tr_b16 v[212:213], v33 offset:8736
ds_read_b64_tr_b16 v[214:215], v33 offset:9824
ds_read_b64_tr_b16 v[200:201], v33 offset:17408
ds_read_b64_tr_b16 v[202:203], v33 offset:18496
ds_read_b64_tr_b16 v[204:205], v33 offset:26112
ds_read_b64_tr_b16 v[206:207], v33 offset:27200
ds_read_b64_tr_b16 v[216:217], v33 offset:17440
ds_read_b64_tr_b16 v[218:219], v33 offset:18528
ds_read_b64_tr_b16 v[220:221], v33 offset:26144
ds_read_b64_tr_b16 v[222:223], v33 offset:27232
s_waitcnt lgkmcnt(0)
s_barrier
s_waitcnt vmcnt(0)
s_barrier
v_add_u32 v33, 34816, v10
ds_read_b64_tr_b16 v[224:225], v33 offset:0
ds_read_b64_tr_b16 v[226:227], v33 offset:1088
ds_read_b64_tr_b16 v[228:229], v33 offset:8704
ds_read_b64_tr_b16 v[230:231], v33 offset:9792
ds_read_b64_tr_b16 v[240:241], v33 offset:32
ds_read_b64_tr_b16 v[242:243], v33 offset:1120
ds_read_b64_tr_b16 v[244:245], v33 offset:8736
ds_read_b64_tr_b16 v[246:247], v33 offset:9824
ds_read_b64_tr_b16 v[232:233], v33 offset:17408
ds_read_b64_tr_b16 v[234:235], v33 offset:18496
ds_read_b64_tr_b16 v[236:237], v33 offset:26112
ds_read_b64_tr_b16 v[238:239], v33 offset:27200
ds_read_b64_tr_b16 v[248:249], v33 offset:17440
ds_read_b64_tr_b16 v[250:251], v33 offset:18528
ds_read_b64_tr_b16 v[252:253], v33 offset:26144
ds_read_b64_tr_b16 v[254:255], v33 offset:27232
s_waitcnt lgkmcnt(0)
s_barrier
s_cmp_lg_u32 s3, 0
s_cbranch_scc1 cl_245
v_mov_b32 v30, 192
v_mov_b32 v31, 1
s_mov_b64 exec, 1
global_atomic_add v30, v31, s[6:7]
s_mov_b64 exec, -1
cl_245:
v_mov_b32 v30, 64
sc_246:
global_load_dword v31, v30, s[6:7] sc1
s_waitcnt vmcnt(0)
v_readfirstlane_b32 s40, v31
s_cmp_ge_u32 s40, 256
s_nop 2
s_cbranch_scc1 scg_248
s_sleep 4
s_add_u32 s100, s100, 64
s_cmp_lt_u32 s100, 0x1000000
s_cbranch_scc1 sc_246
s_endpgm
scg_248:
s_cmp_lg_u32 s101, 0
s_cbranch_scc1 sco_247
v_and_b32 v30, 7, v1
v_lshlrev_b32 v30, 2, v30
global_load_dword v31, v30, s[6:7] sc1
s_waitcnt vmcnt(0)
v_cmp_ne_u32 vcc, 32, v31
s_nop 3
s_cbranch_vccz sco_247
s_mov_b32 s101, 1
s_lshr_b32 s12, s2, 5
s_and_b32 s17, s2, 31
s_barrier
s_branch L_dispatch
sco_247:
v_and_b32 v30, 15, v1
v_lshrrev_b32 v31, 4, v1
v_lshrrev_b32 v32, 2, v30
v_lshlrev_b32 v32, 4, v32
v_lshrrev_b32 v33, 1, v31
v_lshl_add_u32 v32, v33, 3, v32
v_bfe_u32 v33, v30, 1, 1
v_lshl_add_u32 v32, v33, 2, v32
v_and_b32 v33, 1, v31
v_lshl_add_u32 v32, v33, 1, v32
v_and_b32 v33, 1, v30
v_add_u32 v32, v32, v33
v_lshlrev_b32 v32, 4, v32
s_lshl_b32 s40, s3, 10
s_add_u32 s41, s40, 4096
v_add_u32 v2, s41, v32
v_lshlrev_b32 v4, 4, v1
v_add_u32 v3, s40, v4
s_cmp_lt_u32 s3, 2
s_cselect_b32 s42, 4096, 0
v_add_u32 v184, s42, v2
s_add_u32 s42, s42, 4096
v_add_u32 v185, s42, v3
v_mov_b32 v5, 0x4444
v_mov_b32 v32, 0xeeee
v_cmp_lt_u32 vcc, 7, v30
s_nop 1
v_cndmask_b32 v5, v5, v32, vcc
v_lshrrev_b32 v32, 3, v30
v_and_b32 v33, 1, v31
v_cmp_eq_u32 s[40:41], v32, v33
v_and_b32 v32, 1, v30
v_lshlrev_b32 v32, 4, v32
v_mov_b32 v33, 0x3f80
v_lshlrev_b32 v32, v32, v33
v_cndmask_b32 v32, 0, v32, s[40:41]
v_bfe_u32 v33, v30, 1, 2
v_cmp_gt_u32 s[42:43], 2, v31
v_cmp_eq_u32 vcc, 0, v33
s_nop 1
v_cndmask_b32 v34, 0, v32, vcc
v_cndmask_b32 v6, 0, v34, s[42:43]
v_cndmask_b32 v186, v34, 0, s[42:43]
v_cmp_eq_u32 vcc, 1, v33
s_nop 1
v_cndmask_b32 v34, 0, v32, vcc
v_cndmask_b32 v7, 0, v34, s[42:43]
v_cndmask_b32 v187, v34, 0, s[42:43]
v_cmp_eq_u32 vcc, 2, v33
s_nop 1
v_cndmask_b32 v34, 0, v32, vcc
v_cndmask_b32 v8, 0, v34, s[42:43]
v_cndmask_b32 v188, v34, 0, s[42:43]
v_cmp_eq_u32 vcc, 3, v33
s_nop 1
v_cndmask_b32 v34, 0, v32, vcc
v_cndmask_b32 v9, 0, v34, s[42:43]
v_cndmask_b32 v189, v34, 0, s[42:43]
v_and_b32 v30, 15, v1
v_lshlrev_b32 v30, 2, v30
s_lshl_b32 s40, s15, 7
s_add_u32 s40, s40, 46186496
v_add_u32 v29, s40, v30
v_mov_b32 v30, 21504
v_mov_b32 v32, 0
v_mov_b32 v33, 0
ds_write_b64 v30, v[32:33]
v_mov_b32 v34, 0
v_mov_b32 v35, 0
v_lshlrev_b32 v30, 4, v1
ds_write_b128 v30, v[32:35] offset:21760
s_waitcnt lgkmcnt(0)
s_barrier
s_mul_i32 s18, s15, 10240
s_sub_u32 s19, 1, s15
s_mul_i32 s19, s19, 10240
s_add_u32 s19, s19, 20480
v_and_b32 v30, 15, v1
v_lshrrev_b32 v31, 4, v1
s_lshr_b32 s40, s3, 1
s_lshl_b32 s40, s40, 5
s_and_b32 s41, s3, 1
s_lshl_b32 s41, s41, 4
s_add_u32 s40, s40, s41
v_lshrrev_b32 v32, 5, v1
v_lshlrev_b32 v32, 3, v32
v_add_u32 v32, s40, v32
v_lshrrev_b32 v33, 2, v30
v_lshl_add_u32 v32, v33, 1, v32
v_and_b32 v33, 1, v30
v_add_u32 v32, v32, v33
v_lshlrev_b32 v32, 5, v32
v_bfe_u32 v33, v30, 1, 1
v_lshl_add_u32 v32, v33, 4, v32
v_and_b32 v33, 1, v31
v_lshl_add_u32 v32, v33, 3, v32
v_add_u32 v10, 10240, v32
v_bfe_u32 v32, v1, 2, 2
v_lshl_add_u32 v32, v31, 3, v32
v_lshlrev_b32 v32, 5, v32
v_and_b32 v33, 3, v1
v_lshl_add_u32 v32, v33, 3, v32
v_add_u32 v11, 10240, v32
v_lshrrev_b32 v32, 5, v1
s_lshl_b32 s40, s3, 1
v_add_u32 v32, s40, v32
v_mul_u32_u24 v32, 12288, v32
s_mul_i32 s40, s15, 196608
s_mul_i32 s41, s14, 768
s_add_u32 s40, s40, s41
v_add_u32 v32, s40, v32
v_lshl_add_u32 v32, v30, 4, v32
v_and_b32 v33, 1, v31
v_lshl_add_u32 v13, v33, 3, v32
v_add_u32 v14, 98304, v13
v_and_b32 v32, 15, v1
v_lshlrev_b32 v32, 2, v32
s_lshl_b32 s40, s15, 8
s_add_u32 s40, s40, 46186752
v_add_u32 v12, s40, v32
v_lshlrev_b32 v15, 4, v1
s_lshl_b32 s40, s15, 13
s_lshl_b32 s41, s3, 11
s_add_u32 s40, s40, s41
v_add_u32 v21, s40, v15
s_lshl_b32 s40, s15, 11
s_lshl_b32 s41, s3, 9
s_add_u32 s40, s40, s41
s_add_u32 s40, s40, 16384
v_lshlrev_b32 v32, 7, v31
v_lshl_add_u32 v32, v30, 4, v32
v_add_u32 v16, s40, v32
s_mul_i32 s40, s15, 196608
s_mul_i32 s41, s14, 12288
s_add_u32 s40, s40, s41
s_mul_i32 s41, s3, 3072
s_add_u32 s40, s40, s41
v_mul_u32_u24 v32, 768, v31
v_lshl_add_u32 v32, v30, 4, v32
v_add_u32 v17, s40, v32
s_movk_i32 s41, 256
s_cmp_lt_u32 s14, 8
s_cselect_b32 s40, 512, s41
v_add_u32 v18, s40, v17
s_mul_i32 s41, s3, 12288
s_add_u32 s41, s41, 40960
v_add_u32 v19, s41, v15
v_add_u32 v20, 49152, v19
s_mul_i32 s40, s3, 1536
s_add_u32 s40, s40, 14848
v_add_u32 v22, s40, v15
s_cmp_lt_u32 s14, 8
s_cselect_b32 s40, 3, 2
s_mov_b32 s77, s40
v_cmp_gt_u32 vcc, s40, v31
s_nop 1
v_cndmask_b32 v33, 0, v31, vcc
v_lshlrev_b32 v33, 4, v33
v_add_u32 v33, s14, v33
v_lshlrev_b32 v33, 4, v33
v_add_u32 v33, v33, v30
v_lshlrev_b32 v33, 4, v33
v_add_u32 v26, s18, v33
v_add_u32 v27, 20480, v26
s_lshl_b32 s40, s15, 7
s_lshl_b32 s41, s14, 2
s_add_u32 s40, s40, s41
s_add_u32 s40, s40, 46186496
v_mov_b32 v190, s40
v_and_b32 v32, 15, v1
v_lshlrev_b32 v32, 2, v32
s_lshl_b32 s40, s15, 6
s_add_u32 s40, s40, 46153728
v_add_u32 v28, s40, v32
v_lshrrev_b32 v30, 5, v0
v_bfe_u32 v31, v0, 1, 4
v_and_b32 v32, 1, v0
v_lshlrev_b32 v33, 5, v30
v_lshl_add_u32 v33, v32, 4, v33
v_add_u32 v33, v33, v31
v_lshlrev_b32 v33, 4, v33
v_add_u32 v23, 14848, v33
v_lshlrev_b32 v33, 4, v30
v_add_u32 v33, s14, v33
v_lshlrev_b32 v33, 4, v33
v_add_u32 v33, v33, v31
v_lshlrev_b32 v33, 4, v33
v_lshl_add_u32 v33, v32, 3, v33
v_add_u32 v24, s18, v33
v_add_u32 v25, 20480, v24
v_mov_b32 v176, 0
v_mov_b32 v177, 0
v_mov_b32 v178, 0
v_mov_b32 v179, 0
v_mov_b32 v180, -1
v_mov_b32 v181, -1
v_mov_b32 v182, -1
v_mov_b32 v183, -1
s_cmp_eq_u32 s3, 0
s_cselect_b32 s74, -1, 0
s_cselect_b32 s75, -1, 0
s_cmp_eq_u32 s3, 1
s_cselect_b32 s40, 1, 0
s_cmp_lt_u32 s14, 8
s_cselect_b32 s41, 1, 0
s_and_b32 s40, s40, s41
s_cmp_eq_u32 s40, 1
s_cselect_b32 s74, -1, s74
s_or_b32 s76, s74, s75
s_mul_i32 s33, s15, 786432
s_mul_i32 s40, s14, 49152
s_add_u32 s33, s33, s40
s_mul_i32 s40, s3, 12288
s_add_u32 s33, s33, s40
s_add_u32 s71, s40, 40960
s_load_dwordx2 s[8:9], s[0:1], 80
s_add_u32 s34, s4, 44163072
s_addc_u32 s35, s5, 0
s_waitcnt lgkmcnt(0)
s_cmp_eq_u32 s76, 0
s_cbranch_scc1 Pinit_249
s_mov_b64 exec, s[74:75]
v_subrev_u32 v30, s18, v24
v_lshrrev_b32 v30, 4, v30
v_lshlrev_b32 v30, 1, v30
v_and_b32 v31, 1, v0
v_mul_u32_u24 v31, 5120, v31
v_add_u32 v30, v30, v31
v_mov_b32 v32, 0
v_mov_b32 v33, 0
s_cmp_lg_u32 s15, 0
s_cbranch_scc1 Pz_250
global_load_ushort v32, v30, s[8:9]
global_load_ushort v34, v30, s[8:9] offset:1280
global_load_ushort v33, v30, s[8:9] offset:2560
global_load_ushort v35, v30, s[8:9] offset:3840
s_waitcnt vmcnt(0)
v_lshl_or_b32 v32, v34, 16, v32
v_lshl_or_b32 v33, v35, 16, v33
v_min_u32 v32, s70, v32
Pz_250:
global_store_dwordx2 v24, v[32:33], s[34:35] sc1
global_store_dwordx2 v25, v[32:33], s[34:35] sc1
v_mov_b32 v34, 1
global_store_dword v190, v34, s[4:5] sc1
s_mov_b64 exec, -1
Pinit_249:
s_mov_b32 s30, 0
s_add_u32 s44, s30, 4294967295
s_and_b32 s44, s44, 3
s_mul_i32 s44, s44, 40960
s_add_u32 s44, s44, 44040192
s_add_u32 s45, s44, s18
s_add_u32 s36, s4, s45
s_addc_u32 s37, s5, 0
s_add_u32 s45, s44, s19
s_add_u32 s38, s4, s45
s_addc_u32 s39, s5, 0
v_mov_b32 v96, 0
v_mov_b32 v97, 0
v_mov_b32 v98, 0
v_mov_b32 v99, 0
v_mov_b32 v100, 0
v_mov_b32 v101, 0
v_mov_b32 v102, 0
v_mov_b32 v103, 0
s_and_b32 s44, s30, 3
s_mul_i32 s44, s44, 393216
s_add_u32 s44, s44, 44367872
s_add_u32 s54, s4, s44
s_addc_u32 s55, s5, 0
s_and_b32 s44, s30, 3
s_mul_i32 s44, s44, 20480
s_add_u32 s44, s44, 44236800
s_add_u32 s52, s4, s44
s_addc_u32 s53, s5, 0
s_and_b32 s44, s30, 3
s_mul_i32 s44, s44, 40960
s_add_u32 s44, s44, 44040192
s_add_u32 s34, s4, s44
s_addc_u32 s35, s5, 0
s_add_u32 s44, s30, 4294967294
s_and_b32 s44, s44, 3
s_mul_i32 s44, s44, 40960
s_add_u32 s44, s44, 44040192
s_add_u32 s26, s4, s44
s_addc_u32 s27, s5, 0
s_add_u32 s40, s30, 2
v_mov_b32 v191, s40
s_add_u32 s45, s30, 1
s_min_u32 s45, s45, 63
s_mul_i32 s44, s45, 1572864
s_add_u32 s44, s44, s33
s_add_u32 s28, s4, s44
s_addc_u32 s29, s5, 0
s_add_u32 s28, s28, 75497472
s_addc_u32 s29, s29, 0
s_and_b32 s46, s45, 1
s_mul_i32 s46, s46, 49152
s_add_u32 s32, s46, s71
s_cmp_eq_u32 s3, 3
s_cbranch_scc1 nd_254
s_sleep 1
s_sleep 1
s_sleep 1
nd_254:
global_load_dwordx4 v[36:39], v2, s[36:37] offset:-4096 sc1
global_load_dwordx4 v[40:43], v2, s[36:37] offset:0 sc1
global_load_dwordx4 v[44:47], v184, s[36:37] sc1
s_sleep 1
s_sleep 1
s_sleep 1
s_sleep 1
s_sleep 1
global_load_dwordx4 v[80:83], v2, s[38:39] offset:-4096 sc1
global_load_dwordx4 v[84:87], v2, s[38:39] offset:0 sc1
global_load_dwordx4 v[88:91], v184, s[38:39] sc1
s_waitcnt vmcnt(3)
Gl_255:
v_max3_u32 v30, v36, v38, v40
v_max3_u32 v30, v30, v42, v44
v_max_u32 v30, v30, v46
v_cmp_eq_u32 vcc, -1, v30
s_nop 3
s_cbranch_vccz Glo_256
global_load_dwordx4 v[36:39], v2, s[36:37] offset:-4096 sc1
global_load_dwordx4 v[40:43], v2, s[36:37] offset:0 sc1
global_load_dwordx4 v[44:47], v184, s[36:37] sc1
s_waitcnt vmcnt(0)
s_add_u32 s100, s100, 1
s_cmp_lt_u32 s100, 0x1000000
s_cbranch_scc1 Gl_255
s_endpgm
Glo_256:
v_mfma_f32_16x16x32_bf16 v[56:59], v[36:39], v[6:9], 0
v_mfma_f32_16x16x32_bf16 v[60:63], v[36:39], v[186:189], 0
v_mfma_f32_16x16x32_bf16 v[64:67], v[40:43], v[6:9], 0
v_mfma_f32_16x16x32_bf16 v[68:71], v[40:43], v[186:189], 0
v_mfma_f32_16x16x32_bf16 v[72:75], v[44:47], v[6:9], 0
v_mfma_f32_16x16x32_bf16 v[76:79], v[44:47], v[186:189], 0
s_waitcnt vmcnt(0)
Gr_257:
v_max3_u32 v30, v80, v82, v84
v_max3_u32 v30, v30, v86, v88
v_max_u32 v30, v30, v90
v_cmp_eq_u32 vcc, -1, v30
s_nop 3
s_cbranch_vccz Gro_258
global_load_dwordx4 v[80:83], v2, s[38:39] offset:-4096 sc1
global_load_dwordx4 v[84:87], v2, s[38:39] offset:0 sc1
global_load_dwordx4 v[88:91], v184, s[38:39] sc1
s_waitcnt vmcnt(0)
s_add_u32 s100, s100, 1
s_cmp_lt_u32 s100, 0x1000000
s_cbranch_scc1 Gr_257
s_endpgm
Gro_258:
v_mfma_f32_16x16x32_bf16 v[56:59], v[80:83], v[6:9], v[56:59]
v_mfma_f32_16x16x32_bf16 v[60:63], v[80:83], v[186:189], v[60:63]
v_mfma_f32_16x16x32_bf16 v[64:67], v[84:87], v[6:9], v[64:67]
v_mfma_f32_16x16x32_bf16 v[68:71], v[84:87], v[186:189], v[68:71]
v_mfma_f32_16x16x32_bf16 v[72:75], v[88:91], v[6:9], v[72:75]
v_mfma_f32_16x16x32_bf16 v[76:79], v[88:91], v[186:189], v[76:79]
s_nop 2
v_cvt_pk_bf16_f32 v36, v56, v57
v_cvt_pk_bf16_f32 v37, v58, v59
v_cvt_pk_bf16_f32 v38, v60, v61
v_cvt_pk_bf16_f32 v39, v62, v63
ds_write_b128 v3, v[36:39] offset:0
v_cvt_pk_bf16_f32 v40, v64, v65
v_cvt_pk_bf16_f32 v41, v66, v67
v_cvt_pk_bf16_f32 v42, v68, v69
v_cvt_pk_bf16_f32 v43, v70, v71
ds_write_b128 v3, v[40:43] offset:4096
v_cvt_pk_bf16_f32 v44, v72, v73
v_cvt_pk_bf16_f32 v45, v74, v75
v_cvt_pk_bf16_f32 v46, v76, v77
v_cvt_pk_bf16_f32 v47, v78, v79
ds_write_b128 v185, v[44:47]
s_waitcnt lgkmcnt(0)
Gs_253:
s_barrier
ds_read_b128 v[56:59], v4 offset:0
ds_read_b128 v[60:63], v4 offset:1024
ds_read_b128 v[64:67], v4 offset:2048
ds_read_b128 v[68:71], v4 offset:3072
ds_read_b128 v[72:75], v4 offset:4096
ds_read_b128 v[76:79], v4 offset:5120
ds_read_b128 v[80:83], v4 offset:6144
ds_read_b128 v[84:87], v4 offset:7168
ds_read_b128 v[88:91], v4 offset:8192
ds_read_b128 v[92:95], v4 offset:9216
s_waitcnt lgkmcnt(9)
v_smfmac_f32_16x16x64_bf16 v[96:99], v[56:59], a[0:7], v5
v_smfmac_f32_16x16x64_bf16 v[100:103], v[56:59], a[80:87], v5
v_mov_b32 v56, 0
v_mov_b32 v57, 0
v_mov_b32 v58, 0
v_mov_b32 v59, 0
s_waitcnt lgkmcnt(8)
v_smfmac_f32_16x16x64_bf16 v[96:99], v[60:63], a[8:15], v5
v_smfmac_f32_16x16x64_bf16 v[100:103], v[60:63], a[88:95], v5
v_mov_b32 v60, 0
v_mov_b32 v61, 0
v_mov_b32 v62, 0
v_mov_b32 v63, 0
s_waitcnt lgkmcnt(7)
v_smfmac_f32_16x16x64_bf16 v[96:99], v[64:67], a[16:23], v5
v_smfmac_f32_16x16x64_bf16 v[100:103], v[64:67], a[96:103], v5
v_mov_b32 v64, 0
v_mov_b32 v65, 0
v_mov_b32 v66, 0
v_mov_b32 v67, 0
s_waitcnt lgkmcnt(6)
v_smfmac_f32_16x16x64_bf16 v[96:99], v[68:71], a[24:31], v5
v_smfmac_f32_16x16x64_bf16 v[100:103], v[68:71], a[104:111], v5
v_mov_b32 v68, 0
v_mov_b32 v69, 0
v_mov_b32 v70, 0
v_mov_b32 v71, 0
s_waitcnt lgkmcnt(5)
v_smfmac_f32_16x16x64_bf16 v[96:99], v[72:75], a[32:39], v5
v_smfmac_f32_16x16x64_bf16 v[100:103], v[72:75], a[112:119], v5
v_mov_b32 v72, 0
v_mov_b32 v73, 0
v_mov_b32 v74, 0
v_mov_b32 v75, 0
s_waitcnt lgkmcnt(4)
v_smfmac_f32_16x16x64_bf16 v[96:99], v[76:79], a[40:47], v5
v_smfmac_f32_16x16x64_bf16 v[100:103], v[76:79], a[120:127], v5
v_mov_b32 v76, 0
v_mov_b32 v77, 0
v_mov_b32 v78, 0
v_mov_b32 v79, 0
s_waitcnt lgkmcnt(3)
v_smfmac_f32_16x16x64_bf16 v[96:99], v[80:83], a[48:55], v5
v_smfmac_f32_16x16x64_bf16 v[100:103], v[80:83], a[128:135], v5
v_mov_b32 v80, 0
v_mov_b32 v81, 0
v_mov_b32 v82, 0
v_mov_b32 v83, 0
s_waitcnt lgkmcnt(2)
v_smfmac_f32_16x16x64_bf16 v[96:99], v[84:87], a[56:63], v5
v_smfmac_f32_16x16x64_bf16 v[100:103], v[84:87], a[136:143], v5
v_mov_b32 v84, 0
v_mov_b32 v85, 0
v_mov_b32 v86, 0
v_mov_b32 v87, 0
s_waitcnt lgkmcnt(1)
v_smfmac_f32_16x16x64_bf16 v[96:99], v[88:91], a[64:71], v5
v_smfmac_f32_16x16x64_bf16 v[100:103], v[88:91], a[144:151], v5
v_mov_b32 v88, 0
v_mov_b32 v89, 0
v_mov_b32 v90, 0
v_mov_b32 v91, 0
s_waitcnt lgkmcnt(0)
v_smfmac_f32_16x16x64_bf16 v[96:99], v[92:95], a[72:79], v5
v_smfmac_f32_16x16x64_bf16 v[100:103], v[92:95], a[152:159], v5
v_mov_b32 v92, 0
v_mov_b32 v93, 0
v_mov_b32 v94, 0
v_mov_b32 v95, 0
s_nop 3
v_permlane32_swap_b32 v96, v100
v_permlane32_swap_b32 v97, v101
v_permlane32_swap_b32 v98, v102
v_permlane32_swap_b32 v99, v103
v_pk_add_f32 v[96:97], v[96:97], v[100:101]
v_pk_add_f32 v[98:99], v[98:99], v[102:103]
v_cvt_pk_bf16_f32 v44, v96, v97
v_cvt_pk_bf16_f32 v45, v98, v99
ds_write_b64 v10, v[44:45]
s_waitcnt lgkmcnt(0)
s_barrier
ds_read_b64_tr_b16 v[36:37], v11 offset:0
ds_read_b64_tr_b16 v[38:39], v11 offset:128
ds_read_b64_tr_b16 v[40:41], v11 offset:1024
ds_read_b64_tr_b16 v[42:43], v11 offset:1152
s_waitcnt lgkmcnt(0)
v_smfmac_f32_16x16x64_bf16 v[56:59], v[36:39], a[160:167], v5
v_smfmac_f32_16x16x64_bf16 v[60:63], v[36:39], a[176:183], v5
v_smfmac_f32_16x16x64_bf16 v[56:59], v[40:43], a[168:175], v5
v_smfmac_f32_16x16x64_bf16 v[60:63], v[40:43], a[184:191], v5
v_smfmac_f32_16x16x64_bf16 v[64:67], v[36:39], a[192:199], v5
v_smfmac_f32_16x16x64_bf16 v[68:71], v[36:39], a[208:215], v5
s_nop 5
v_permlane32_swap_b32 v56, v60
v_permlane32_swap_b32 v57, v61
v_permlane32_swap_b32 v58, v62
v_smfmac_f32_16x16x64_bf16 v[64:67], v[40:43], a[200:207], v5
v_permlane32_swap_b32 v59, v63
v_pk_add_f32 v[56:57], v[56:57], v[60:61]
v_pk_add_f32 v[58:59], v[58:59], v[62:63]
v_smfmac_f32_16x16x64_bf16 v[68:71], v[40:43], a[216:223], v5
v_cvt_pk_bf16_f32 v46, v56, v57
v_cvt_pk_bf16_f32 v47, v58, v59
v_min_u32 v46, s70, v46
global_store_dwordx2 v13, v[46:47], s[54:55] offset:0 sc1
v_smfmac_f32_16x16x64_bf16 v[72:75], v[36:39], a[224:231], v5
v_smfmac_f32_16x16x64_bf16 v[76:79], v[36:39], a[240:247], v5
s_nop 1
v_permlane32_swap_b32 v64, v68
v_permlane32_swap_b32 v65, v69
v_permlane32_swap_b32 v66, v70
v_smfmac_f32_16x16x64_bf16 v[72:75], v[40:43], a[232:239], v5
v_permlane32_swap_b32 v67, v71
v_pk_add_f32 v[64:65], v[64:65], v[68:69]
v_pk_add_f32 v[66:67], v[66:67], v[70:71]
v_smfmac_f32_16x16x64_bf16 v[76:79], v[40:43], a[248:255], v5
v_cvt_pk_bf16_f32 v48, v64, v65
v_cvt_pk_bf16_f32 v49, v66, v67
v_min_u32 v48, s70, v48
global_store_dwordx2 v14, v[48:49], s[54:55] offset:0 sc1
v_smfmac_f32_16x16x64_bf16 v[80:83], v[36:39], v[192:199], v5
v_smfmac_f32_16x16x64_bf16 v[84:87], v[36:39], v[208:215], v5
s_nop 1
v_permlane32_swap_b32 v72, v76
v_permlane32_swap_b32 v73, v77
v_permlane32_swap_b32 v74, v78
v_smfmac_f32_16x16x64_bf16 v[80:83], v[40:43], v[200:207], v5
v_permlane32_swap_b32 v75, v79
v_pk_add_f32 v[72:73], v[72:73], v[76:77]
v_pk_add_f32 v[74:75], v[74:75], v[78:79]
v_smfmac_f32_16x16x64_bf16 v[84:87], v[40:43], v[216:223], v5
v_cvt_pk_bf16_f32 v50, v72, v73
v_cvt_pk_bf16_f32 v51, v74, v75
v_min_u32 v50, s70, v50
global_store_dwordx2 v13, v[50:51], s[54:55] offset:256 sc1
v_smfmac_f32_16x16x64_bf16 v[88:91], v[36:39], v[224:231], v5
v_smfmac_f32_16x16x64_bf16 v[92:95], v[36:39], v[240:247], v5
s_nop 1
v_permlane32_swap_b32 v80, v84
v_permlane32_swap_b32 v81, v85
v_permlane32_swap_b32 v82, v86
v_smfmac_f32_16x16x64_bf16 v[88:91], v[40:43], v[232:239], v5
v_permlane32_swap_b32 v83, v87
v_pk_add_f32 v[80:81], v[80:81], v[84:85]
v_pk_add_f32 v[82:83], v[82:83], v[86:87]
v_smfmac_f32_16x16x64_bf16 v[92:95], v[40:43], v[248:255], v5
v_cvt_pk_bf16_f32 v52, v80, v81
v_cvt_pk_bf16_f32 v53, v82, v83
v_min_u32 v52, s70, v52
global_store_dwordx2 v14, v[52:53], s[54:55] offset:256 sc1
s_nop 3
v_permlane32_swap_b32 v88, v92
v_permlane32_swap_b32 v89, v93
v_permlane32_swap_b32 v90, v94
v_permlane32_swap_b32 v91, v95
v_pk_add_f32 v[88:89], v[88:89], v[92:93]
v_pk_add_f32 v[90:91], v[90:91], v[94:95]
v_cvt_pk_bf16_f32 v54, v88, v89
v_cvt_pk_bf16_f32 v55, v90, v91
v_min_u32 v54, s70, v54
global_store_dwordx2 v13, v[54:55], s[54:55] offset:512 sc1
s_add_u32 s45, s30, 0
s_min_u32 s45, s45, 63
s_lshl_b32 s46, s45, 7
v_add_u32 v30, s46, v28
uf_259:
global_load_dword v31, v30, s[4:5] sc1
s_waitcnt vmcnt(0)
v_cmp_eq_u32 vcc, 0, v31
s_nop 3
s_cbranch_vccz ok_260
s_add_u32 s100, s100, 1
s_cmp_lt_u32 s100, 0x1000000
s_cbranch_scc1 uf_259
s_endpgm
ok_260:
s_add_u32 s45, s30, 0
s_min_u32 s45, s45, 63
s_mul_i32 s44, s45, 1572864
s_add_u32 s44, s44, s33
s_add_u32 s28, s4, s44
s_addc_u32 s29, s5, 0
s_add_u32 s28, s28, 75497472
s_addc_u32 s29, s29, 0
s_and_b32 s46, s45, 1
s_mul_i32 s46, s46, 49152
s_add_u32 s32, s46, s71
s_mov_b32 m0, s32
s_nop 0
global_load_lds_dwordx4 v15, s[28:29] sc1
global_load_lds_dwordx4 v15, s[28:29] offset:1024 sc1
s_cmp_lt_u32 s77, 3
s_cbranch_scc1 dg_262
global_load_lds_dwordx4 v15, s[28:29] offset:2048 sc1
dg_262:
s_add_u32 s28, s28, 3072
s_addc_u32 s29, s29, 0
s_add_u32 s32, s32, 3072
s_mov_b32 m0, s32
s_nop 0
global_load_lds_dwordx4 v15, s[28:29] sc1
global_load_lds_dwordx4 v15, s[28:29] offset:1024 sc1
s_cmp_lt_u32 s77, 3
s_cbranch_scc1 dg_264
global_load_lds_dwordx4 v15, s[28:29] offset:2048 sc1
dg_264:
s_add_u32 s28, s28, 3072
s_addc_u32 s29, s29, 0
s_add_u32 s32, s32, 3072
s_mov_b32 m0, s32
s_nop 0
global_load_lds_dwordx4 v15, s[28:29] sc1
global_load_lds_dwordx4 v15, s[28:29] offset:1024 sc1
s_cmp_lt_u32 s77, 3
s_cbranch_scc1 dg_266
global_load_lds_dwordx4 v15, s[28:29] offset:2048 sc1
dg_266:
s_add_u32 s28, s28, 3072
s_addc_u32 s29, s29, 0
s_add_u32 s32, s32, 3072
s_mov_b32 m0, s32
s_nop 0
global_load_lds_dwordx4 v15, s[28:29] sc1
global_load_lds_dwordx4 v15, s[28:29] offset:1024 sc1
s_cmp_lt_u32 s77, 3
s_cbranch_scc1 dg_268
global_load_lds_dwordx4 v15, s[28:29] offset:2048 sc1
dg_268:
s_add_u32 s28, s28, 3072
s_addc_u32 s29, s29, 0
s_add_u32 s32, s32, 3072
s_waitcnt vmcnt(0)
s_barrier
s_bitcmp1_b32 s30, 0
s_cbranch_scc1 ub1_269
ds_read_b128 v[124:127], v19 offset:0
ds_read_b128 v[140:143], v19 offset:1024
ds_read_b128 v[156:159], v19 offset:2048
ds_read_b128 v[128:131], v19 offset:3072
ds_read_b128 v[144:147], v19 offset:4096
ds_read_b128 v[160:163], v19 offset:5120
ds_read_b128 v[132:135], v19 offset:6144
ds_read_b128 v[148:151], v19 offset:7168
ds_read_b128 v[164:167], v19 offset:8192
ds_read_b128 v[136:139], v19 offset:9216
ds_read_b128 v[152:155], v19 offset:10240
ds_read_b128 v[168:171], v19 offset:11264
s_branch ub2_270
ub1_269:
ds_read_b128 v[124:127], v20 offset:0
ds_read_b128 v[140:143], v20 offset:1024
ds_read_b128 v[156:159], v20 offset:2048
ds_read_b128 v[128:131], v20 offset:3072
ds_read_b128 v[144:147], v20 offset:4096
ds_read_b128 v[160:163], v20 offset:5120
ds_read_b128 v[132:135], v20 offset:6144
ds_read_b128 v[148:151], v20 offset:7168
ds_read_b128 v[164:167], v20 offset:8192
ds_read_b128 v[136:139], v20 offset:9216
ds_read_b128 v[152:155], v20 offset:10240
ds_read_b128 v[168:171], v20 offset:11264
ub2_270:
v_mov_b32 v96, 0
v_mov_b32 v97, 0
v_mov_b32 v98, 0
v_mov_b32 v99, 0
v_mov_b32 v100, 0
v_mov_b32 v101, 0
v_mov_b32 v102, 0
v_mov_b32 v103, 0
v_mov_b32 v104, 0
v_mov_b32 v105, 0
v_mov_b32 v106, 0
v_mov_b32 v107, 0
s_add_u32 s40, s30, 1
s_cmp_lg_u32 s3, 0
s_cbranch_scc1 Fo_273
s_mov_b64 exec, 0xffff
global_load_dword v31, v12, s[4:5] sc1
s_nop 15
global_load_dword v33, v12, s[4:5] sc1
s_nop 15
global_load_dword v34, v12, s[4:5] sc1
Fq_271:
s_waitcnt vmcnt(2)
v_cmp_gt_u32 vcc, s40, v31
s_nop 3
s_cbranch_vccz Fk_274
global_load_dword v31, v12, s[4:5] sc1
s_waitcnt vmcnt(2)
v_cmp_gt_u32 vcc, s40, v33
s_nop 3
s_cbranch_vccz Fk_274
global_load_dword v33, v12, s[4:5] sc1
s_waitcnt vmcnt(2)
v_cmp_gt_u32 vcc, s40, v34
s_nop 3
s_cbranch_vccz Fk_274
global_load_dword v34, v12, s[4:5] sc1
s_add_u32 s100, s100, 1
s_cmp_lt_u32 s100, 0x1000000
s_cbranch_scc1 Fq_271
s_endpgm
Fk_274:
s_mov_b64 exec, -1
Fo_273:
s_barrier
global_load_dwordx4 v[72:75], v21, s[52:53] sc1
global_load_dwordx4 v[76:79], v21, s[52:53] offset:1024 sc1
s_mov_b64 exec, s[60:61]
global_load_dwordx4 v[176:179], v16, s[52:53] sc1
s_mov_b64 exec, -1
global_load_dwordx4 v[80:83], v17, s[54:55] sc1
global_load_dwordx4 v[84:87], v17, s[54:55] offset:256 sc1
global_load_dwordx4 v[88:91], v18, s[54:55] sc1
s_waitcnt vmcnt(3) lgkmcnt(0)
s_branch Sp1_276
Sp_275:
global_load_dwordx4 v[72:75], v21, s[52:53] sc1
global_load_dwordx4 v[76:79], v21, s[52:53] offset:1024 sc1
s_mov_b64 exec, s[60:61]
global_load_dwordx4 v[176:179], v16, s[52:53] sc1
s_mov_b64 exec, -1
s_waitcnt vmcnt(0)
Sp1_276:
v_max3_u32 v30, v72, v74, v76
v_max3_u32 v30, v30, v78, v176
v_max_u32 v30, v30, v178
v_cmp_eq_u32 vcc, -1, v30
s_nop 3
s_cbranch_vccz ok_277
s_add_u32 s100, s100, 1
s_cmp_lt_u32 s100, 0x1000000
s_cbranch_scc1 Sp_275
s_endpgm
ok_277:
v_smfmac_f32_16x16x64_bf16 v[96:99], v[72:75], v[124:131], v5
v_smfmac_f32_16x16x64_bf16 v[100:103], v[72:75], v[140:147], v5
v_smfmac_f32_16x16x64_bf16 v[104:107], v[72:75], v[156:163], v5
v_smfmac_f32_16x16x64_bf16 v[96:99], v[76:79], v[132:139], v5
v_smfmac_f32_16x16x64_bf16 v[100:103], v[76:79], v[148:155], v5
v_smfmac_f32_16x16x64_bf16 v[104:107], v[76:79], v[164:171], v5
s_waitcnt vmcnt(0)
Zp_278:
v_max3_u32 v30, v80, v82, v84
v_max3_u32 v30, v30, v86, v88
v_max_u32 v30, v30, v90
v_cmp_eq_u32 vcc, -1, v30
s_nop 3
s_cbranch_vccz Zo_279
global_load_dwordx4 v[80:83], v17, s[54:55] sc1
global_load_dwordx4 v[84:87], v17, s[54:55] offset:256 sc1
global_load_dwordx4 v[88:91], v18, s[54:55] sc1
s_waitcnt vmcnt(0)
s_add_u32 s100, s100, 1
s_cmp_lt_u32 s100, 0x1000000
s_cbranch_scc1 Zp_278
s_endpgm
Zo_279:
v_mfma_f32_16x16x32_bf16 v[96:99], v[176:179], v[80:83], v[96:99]
v_mfma_f32_16x16x32_bf16 v[100:103], v[176:179], v[84:87], v[100:103]
v_mfma_f32_16x16x32_bf16 v[104:107], v[176:179], v[88:91], v[104:107]
s_nop 6
v_permlane32_swap_b32 v96, v100
v_permlane32_swap_b32 v97, v101
v_permlane32_swap_b32 v98, v102
v_permlane32_swap_b32 v99, v103
v_pk_add_f32 v[96:97], v[96:97], v[100:101]
v_pk_add_f32 v[98:99], v[98:99], v[102:103]
ds_write_b128 v22, v[96:99]
v_mov_b32 v100, v104
v_mov_b32 v101, v105
v_mov_b32 v102, v106
v_mov_b32 v103, v107
v_permlane32_swap_b32 v104, v100
v_permlane32_swap_b32 v105, v101
v_permlane32_swap_b32 v106, v102
v_permlane32_swap_b32 v107, v103
v_pk_add_f32 v[104:105], v[104:105], v[100:101]
v_pk_add_f32 v[106:107], v[106:107], v[102:103]
s_mov_b64 exec, s[64:65]
ds_write_b128 v22, v[104:107] offset:1024
s_mov_b64 exec, -1
s_cmp_lg_u32 s3, 2
s_cbranch_scc1 ew_280
s_mov_b64 exec, 1
global_store_dword v190, v191, s[4:5] sc1
s_mov_b64 exec, -1
ew_280:
s_waitcnt lgkmcnt(0)
s_barrier
s_cmp_eq_u32 s76, 0
s_cbranch_scc1 nfin_281
s_mov_b64 exec, s[74:75]
ds_read_b128 v[36:39], v23 offset:0
ds_read_b128 v[40:43], v23 offset:1536
ds_read_b128 v[44:47], v23 offset:3072
ds_read_b128 v[48:51], v23 offset:4608
s_waitcnt lgkmcnt(2)
v_pk_add_f32 v[36:37], v[36:37], v[40:41]
v_pk_add_f32 v[38:39], v[38:39], v[42:43]
s_waitcnt lgkmcnt(0)
v_pk_add_f32 v[44:45], v[44:45], v[48:49]
v_pk_add_f32 v[46:47], v[46:47], v[50:51]
v_pk_add_f32 v[36:37], v[36:37], v[44:45]
v_pk_add_f32 v[38:39], v[38:39], v[46:47]
v_cvt_pk_bf16_f32 v30, v36, v37
v_cvt_pk_bf16_f32 v31, v38, v39
v_min_u32 v30, s70, v30
global_store_dwordx2 v24, v[30:31], s[34:35] sc1
global_store_dwordx2 v25, v[30:31], s[34:35] sc1
s_mov_b64 exec, -1
s_branch nx_282
nfin_281:
s_cmp_lg_u32 s3, 3
s_cbranch_scc1 nx_282
global_store_dwordx4 v27, v[180:183], s[26:27] sc1
global_store_dwordx4 v26, v[180:183], s[26:27] sc1
s_add_u32 s45, s30, 2
s_min_u32 s45, s45, 63
s_lshl_b32 s46, s45, 7
v_add_u32 v30, s46, v28
uf_283:
global_load_dword v31, v30, s[4:5] sc1
s_waitcnt vmcnt(0)
v_cmp_eq_u32 vcc, 0, v31
s_nop 3
s_cbranch_vccz ok_284
s_add_u32 s100, s100, 1
s_cmp_lt_u32 s100, 0x1000000
s_cbranch_scc1 uf_283
s_endpgm
ok_284:
nx_282:
s_add_u32 s45, s30, 1
s_min_u32 s45, s45, 63
s_lshl_b32 s46, s45, 7
v_add_u32 v30, s46, v28
uf_285:
global_load_dword v31, v30, s[4:5] sc1
s_waitcnt vmcnt(0)
v_cmp_eq_u32 vcc, 0, v31
s_nop 3
s_cbranch_vccz ok_286
s_add_u32 s100, s100, 1
s_cmp_lt_u32 s100, 0x1000000
s_cbranch_scc1 uf_285
s_endpgm
ok_286:
s_add_u32 s45, s30, 1
s_min_u32 s45, s45, 63
s_mul_i32 s44, s45, 1572864
s_add_u32 s44, s44, s33
s_add_u32 s28, s4, s44
s_addc_u32 s29, s5, 0
s_add_u32 s28, s28, 75497472
s_addc_u32 s29, s29, 0
s_and_b32 s46, s45, 1
s_mul_i32 s46, s46, 49152
s_add_u32 s32, s46, s71
s_mov_b32 m0, s32
s_nop 0
global_load_lds_dwordx4 v15, s[28:29] sc1
global_load_lds_dwordx4 v15, s[28:29] offset:1024 sc1
s_cmp_lt_u32 s77, 3
s_cbranch_scc1 dg_288
global_load_lds_dwordx4 v15, s[28:29] offset:2048 sc1
dg_288:
s_add_u32 s28, s28, 3072
s_addc_u32 s29, s29, 0
s_add_u32 s32, s32, 3072
s_mov_b32 m0, s32
s_nop 0
global_load_lds_dwordx4 v15, s[28:29] sc1
global_load_lds_dwordx4 v15, s[28:29] offset:1024 sc1
s_cmp_lt_u32 s77, 3
s_cbranch_scc1 dg_290
global_load_lds_dwordx4 v15, s[28:29] offset:2048 sc1
dg_290:
s_add_u32 s28, s28, 3072
s_addc_u32 s29, s29, 0
s_add_u32 s32, s32, 3072
s_mov_b32 m0, s32
s_nop 0
global_load_lds_dwordx4 v15, s[28:29] sc1
global_load_lds_dwordx4 v15, s[28:29] offset:1024 sc1
s_cmp_lt_u32 s77, 3
s_cbranch_scc1 dg_292
global_load_lds_dwordx4 v15, s[28:29] offset:2048 sc1
dg_292:
s_add_u32 s28, s28, 3072
s_addc_u32 s29, s29, 0
s_add_u32 s32, s32, 3072
s_mov_b32 m0, s32
s_nop 0
global_load_lds_dwordx4 v15, s[28:29] sc1
global_load_lds_dwordx4 v15, s[28:29] offset:1024 sc1
s_cmp_lt_u32 s77, 3
s_cbranch_scc1 dg_294
global_load_lds_dwordx4 v15, s[28:29] offset:2048 sc1
dg_294:
s_add_u32 s28, s28, 3072
s_addc_u32 s29, s29, 0
s_add_u32 s32, s32, 3072
s_add_u32 s30, s30, 1
.p2align 6
VOstep_251:
s_add_u32 s44, s30, 4294967295
s_and_b32 s44, s44, 3
s_mul_i32 s44, s44, 40960
s_add_u32 s44, s44, 44040192
s_add_u32 s45, s44, s18
s_add_u32 s36, s4, s45
s_addc_u32 s37, s5, 0
s_add_u32 s45, s44, s19
s_add_u32 s38, s4, s45
s_addc_u32 s39, s5, 0
v_mov_b32 v96, 0
v_mov_b32 v97, 0
v_mov_b32 v98, 0
v_mov_b32 v99, 0
v_mov_b32 v100, 0
v_mov_b32 v101, 0
v_mov_b32 v102, 0
v_mov_b32 v103, 0
s_and_b32 s44, s30, 3
s_mul_i32 s44, s44, 393216
s_add_u32 s44, s44, 44367872
s_add_u32 s54, s4, s44
s_addc_u32 s55, s5, 0
s_and_b32 s44, s30, 3
s_mul_i32 s44, s44, 20480
s_add_u32 s44, s44, 44236800
s_add_u32 s52, s4, s44
s_addc_u32 s53, s5, 0
s_and_b32 s44, s30, 3
s_mul_i32 s44, s44, 40960
s_add_u32 s44, s44, 44040192
s_add_u32 s34, s4, s44
s_addc_u32 s35, s5, 0
s_add_u32 s44, s30, 4294967294
s_and_b32 s44, s44, 3
s_mul_i32 s44, s44, 40960
s_add_u32 s44, s44, 44040192
s_add_u32 s26, s4, s44
s_addc_u32 s27, s5, 0
s_add_u32 s40, s30, 2
v_mov_b32 v191, s40
s_add_u32 s45, s30, 1
s_min_u32 s45, s45, 63
s_mul_i32 s44, s45, 1572864
s_add_u32 s44, s44, s33
s_add_u32 s28, s4, s44
s_addc_u32 s29, s5, 0
s_add_u32 s28, s28, 75497472
s_addc_u32 s29, s29, 0
s_and_b32 s46, s45, 1
s_mul_i32 s46, s46, 49152
s_add_u32 s32, s46, s71
s_cmp_eq_u32 s3, 3
s_cbranch_scc1 nd_296
s_sleep 1
s_sleep 1
s_sleep 1
nd_296:
global_load_dwordx4 v[36:39], v2, s[36:37] offset:-4096 sc1
global_load_dwordx4 v[40:43], v2, s[36:37] offset:0 sc1
global_load_dwordx4 v[44:47], v184, s[36:37] sc1
s_sleep 1
s_sleep 1
s_sleep 1
s_sleep 1
s_sleep 1
global_load_dwordx4 v[80:83], v2, s[38:39] offset:-4096 sc1
global_load_dwordx4 v[84:87], v2, s[38:39] offset:0 sc1
global_load_dwordx4 v[88:91], v184, s[38:39] sc1
s_waitcnt vmcnt(3)
Gl_297:
v_max3_u32 v30, v36, v38, v40
v_max3_u32 v30, v30, v42, v44
v_max_u32 v30, v30, v46
v_cmp_eq_u32 vcc, -1, v30
s_nop 3
s_cbranch_vccz Glo_298
global_load_dwordx4 v[36:39], v2, s[36:37] offset:-4096 sc1
global_load_dwordx4 v[40:43], v2, s[36:37] offset:0 sc1
global_load_dwordx4 v[44:47], v184, s[36:37] sc1
s_waitcnt vmcnt(0)
s_add_u32 s100, s100, 1
s_cmp_lt_u32 s100, 0x1000000
s_cbranch_scc1 Gl_297
s_endpgm
Glo_298:
v_mfma_f32_16x16x32_bf16 v[56:59], v[36:39], v[6:9], 0
v_mfma_f32_16x16x32_bf16 v[60:63], v[36:39], v[186:189], 0
v_mfma_f32_16x16x32_bf16 v[64:67], v[40:43], v[6:9], 0
v_mfma_f32_16x16x32_bf16 v[68:71], v[40:43], v[186:189], 0
v_mfma_f32_16x16x32_bf16 v[72:75], v[44:47], v[6:9], 0
v_mfma_f32_16x16x32_bf16 v[76:79], v[44:47], v[186:189], 0
s_waitcnt vmcnt(0)
Gr_299:
v_max3_u32 v30, v80, v82, v84
v_max3_u32 v30, v30, v86, v88
v_max_u32 v30, v30, v90
v_cmp_eq_u32 vcc, -1, v30
s_nop 3
s_cbranch_vccz Gro_300
global_load_dwordx4 v[80:83], v2, s[38:39] offset:-4096 sc1
global_load_dwordx4 v[84:87], v2, s[38:39] offset:0 sc1
global_load_dwordx4 v[88:91], v184, s[38:39] sc1
s_waitcnt vmcnt(0)
s_add_u32 s100, s100, 1
s_cmp_lt_u32 s100, 0x1000000
s_cbranch_scc1 Gr_299
s_endpgm
Gro_300:
v_mfma_f32_16x16x32_bf16 v[56:59], v[80:83], v[6:9], v[56:59]
v_mfma_f32_16x16x32_bf16 v[60:63], v[80:83], v[186:189], v[60:63]
v_mfma_f32_16x16x32_bf16 v[64:67], v[84:87], v[6:9], v[64:67]
v_mfma_f32_16x16x32_bf16 v[68:71], v[84:87], v[186:189], v[68:71]
v_mfma_f32_16x16x32_bf16 v[72:75], v[88:91], v[6:9], v[72:75]
v_mfma_f32_16x16x32_bf16 v[76:79], v[88:91], v[186:189], v[76:79]
s_nop 2
v_cvt_pk_bf16_f32 v36, v56, v57
v_cvt_pk_bf16_f32 v37, v58, v59
v_cvt_pk_bf16_f32 v38, v60, v61
v_cvt_pk_bf16_f32 v39, v62, v63
ds_write_b128 v3, v[36:39] offset:0
v_cvt_pk_bf16_f32 v40, v64, v65
v_cvt_pk_bf16_f32 v41, v66, v67
v_cvt_pk_bf16_f32 v42, v68, v69
v_cvt_pk_bf16_f32 v43, v70, v71
ds_write_b128 v3, v[40:43] offset:4096
v_cvt_pk_bf16_f32 v44, v72, v73
v_cvt_pk_bf16_f32 v45, v74, v75
v_cvt_pk_bf16_f32 v46, v76, v77
v_cvt_pk_bf16_f32 v47, v78, v79
ds_write_b128 v185, v[44:47]
s_waitcnt lgkmcnt(0)
Gs_295:
s_barrier
ds_read_b128 v[56:59], v4 offset:0
ds_read_b128 v[60:63], v4 offset:1024
ds_read_b128 v[64:67], v4 offset:2048
ds_read_b128 v[68:71], v4 offset:3072
ds_read_b128 v[72:75], v4 offset:4096
ds_read_b128 v[76:79], v4 offset:5120
ds_read_b128 v[80:83], v4 offset:6144
ds_read_b128 v[84:87], v4 offset:7168
ds_read_b128 v[88:91], v4 offset:8192
ds_read_b128 v[92:95], v4 offset:9216
s_waitcnt lgkmcnt(9)
v_smfmac_f32_16x16x64_bf16 v[96:99], v[56:59], a[0:7], v5
v_smfmac_f32_16x16x64_bf16 v[100:103], v[56:59], a[80:87], v5
v_mov_b32 v56, 0
v_mov_b32 v57, 0
v_mov_b32 v58, 0
v_mov_b32 v59, 0
s_waitcnt lgkmcnt(8)
v_smfmac_f32_16x16x64_bf16 v[96:99], v[60:63], a[8:15], v5
v_smfmac_f32_16x16x64_bf16 v[100:103], v[60:63], a[88:95], v5
v_mov_b32 v60, 0
v_mov_b32 v61, 0
v_mov_b32 v62, 0
v_mov_b32 v63, 0
s_mov_b32 m0, s32
s_nop 0
global_load_lds_dwordx4 v15, s[28:29] sc1
global_load_lds_dwordx4 v15, s[28:29] offset:1024 sc1
s_cmp_lt_u32 s77, 3
s_cbranch_scc1 dg_302
global_load_lds_dwordx4 v15, s[28:29] offset:2048 sc1
dg_302:
s_add_u32 s28, s28, 3072
s_addc_u32 s29, s29, 0
s_add_u32 s32, s32, 3072
s_waitcnt lgkmcnt(7)
v_smfmac_f32_16x16x64_bf16 v[96:99], v[64:67], a[16:23], v5
v_smfmac_f32_16x16x64_bf16 v[100:103], v[64:67], a[96:103], v5
v_mov_b32 v64, 0
v_mov_b32 v65, 0
v_mov_b32 v66, 0
v_mov_b32 v67, 0
s_waitcnt lgkmcnt(6)
v_smfmac_f32_16x16x64_bf16 v[96:99], v[68:71], a[24:31], v5
v_smfmac_f32_16x16x64_bf16 v[100:103], v[68:71], a[104:111], v5
v_mov_b32 v68, 0
v_mov_b32 v69, 0
v_mov_b32 v70, 0
v_mov_b32 v71, 0
s_waitcnt lgkmcnt(5)
v_smfmac_f32_16x16x64_bf16 v[96:99], v[72:75], a[32:39], v5
v_smfmac_f32_16x16x64_bf16 v[100:103], v[72:75], a[112:119], v5
v_mov_b32 v72, 0
v_mov_b32 v73, 0
v_mov_b32 v74, 0
v_mov_b32 v75, 0
s_mov_b32 m0, s32
s_nop 0
global_load_lds_dwordx4 v15, s[28:29] sc1
global_load_lds_dwordx4 v15, s[28:29] offset:1024 sc1
s_cmp_lt_u32 s77, 3
s_cbranch_scc1 dg_304
global_load_lds_dwordx4 v15, s[28:29] offset:2048 sc1
dg_304:
s_add_u32 s28, s28, 3072
s_addc_u32 s29, s29, 0
s_add_u32 s32, s32, 3072
s_waitcnt lgkmcnt(4)
v_smfmac_f32_16x16x64_bf16 v[96:99], v[76:79], a[40:47], v5
v_smfmac_f32_16x16x64_bf16 v[100:103], v[76:79], a[120:127], v5
v_mov_b32 v76, 0
v_mov_b32 v77, 0
v_mov_b32 v78, 0
v_mov_b32 v79, 0
s_waitcnt lgkmcnt(3)
v_smfmac_f32_16x16x64_bf16 v[96:99], v[80:83], a[48:55], v5
v_smfmac_f32_16x16x64_bf16 v[100:103], v[80:83], a[128:135], v5
v_mov_b32 v80, 0
v_mov_b32 v81, 0
v_mov_b32 v82, 0
v_mov_b32 v83, 0
s_waitcnt lgkmcnt(2)
v_smfmac_f32_16x16x64_bf16 v[96:99], v[84:87], a[56:63], v5
v_smfmac_f32_16x16x64_bf16 v[100:103], v[84:87], a[136:143], v5
v_mov_b32 v84, 0
v_mov_b32 v85, 0
v_mov_b32 v86, 0
v_mov_b32 v87, 0
s_mov_b32 m0, s32
s_nop 0
global_load_lds_dwordx4 v15, s[28:29] sc1
global_load_lds_dwordx4 v15, s[28:29] offset:1024 sc1
s_cmp_lt_u32 s77, 3
s_cbranch_scc1 dg_306
global_load_lds_dwordx4 v15, s[28:29] offset:2048 sc1
dg_306:
s_add_u32 s28, s28, 3072
s_addc_u32 s29, s29, 0
s_add_u32 s32, s32, 3072
s_waitcnt lgkmcnt(1)
v_smfmac_f32_16x16x64_bf16 v[96:99], v[88:91], a[64:71], v5
v_smfmac_f32_16x16x64_bf16 v[100:103], v[88:91], a[144:151], v5
v_mov_b32 v88, 0
v_mov_b32 v89, 0
v_mov_b32 v90, 0
v_mov_b32 v91, 0
s_waitcnt lgkmcnt(0)
v_smfmac_f32_16x16x64_bf16 v[96:99], v[92:95], a[72:79], v5
v_smfmac_f32_16x16x64_bf16 v[100:103], v[92:95], a[152:159], v5
v_mov_b32 v92, 0
v_mov_b32 v93, 0
v_mov_b32 v94, 0
v_mov_b32 v95, 0
s_nop 3
v_permlane32_swap_b32 v96, v100
v_permlane32_swap_b32 v97, v101
v_permlane32_swap_b32 v98, v102
v_permlane32_swap_b32 v99, v103
v_pk_add_f32 v[96:97], v[96:97], v[100:101]
v_pk_add_f32 v[98:99], v[98:99], v[102:103]
v_cvt_pk_bf16_f32 v44, v96, v97
v_cvt_pk_bf16_f32 v45, v98, v99
ds_write_b64 v10, v[44:45]
s_waitcnt lgkmcnt(0)
s_barrier
ds_read_b64_tr_b16 v[36:37], v11 offset:0
ds_read_b64_tr_b16 v[38:39], v11 offset:128
ds_read_b64_tr_b16 v[40:41], v11 offset:1024
ds_read_b64_tr_b16 v[42:43], v11 offset:1152
s_waitcnt lgkmcnt(0)
v_smfmac_f32_16x16x64_bf16 v[56:59], v[36:39], a[160:167], v5
v_smfmac_f32_16x16x64_bf16 v[60:63], v[36:39], a[176:183], v5
v_smfmac_f32_16x16x64_bf16 v[56:59], v[40:43], a[168:175], v5
v_smfmac_f32_16x16x64_bf16 v[60:63], v[40:43], a[184:191], v5
s_mov_b32 m0, s32
s_nop 0
global_load_lds_dwordx4 v15, s[28:29] sc1
global_load_lds_dwordx4 v15, s[28:29] offset:1024 sc1
s_cmp_lt_u32 s77, 3
s_cbranch_scc1 dg_308
global_load_lds_dwordx4 v15, s[28:29] offset:2048 sc1
dg_308:
s_add_u32 s28, s28, 3072
s_addc_u32 s29, s29, 0
s_add_u32 s32, s32, 3072
v_smfmac_f32_16x16x64_bf16 v[64:67], v[36:39], a[192:199], v5
v_smfmac_f32_16x16x64_bf16 v[68:71], v[36:39], a[208:215], v5
v_permlane32_swap_b32 v56, v60
v_permlane32_swap_b32 v57, v61
v_permlane32_swap_b32 v58, v62
v_smfmac_f32_16x16x64_bf16 v[64:67], v[40:43], a[200:207], v5
v_permlane32_swap_b32 v59, v63
v_pk_add_f32 v[56:57], v[56:57], v[60:61]
v_pk_add_f32 v[58:59], v[58:59], v[62:63]
v_smfmac_f32_16x16x64_bf16 v[68:71], v[40:43], a[216:223], v5
v_cvt_pk_bf16_f32 v46, v56, v57
v_cvt_pk_bf16_f32 v47, v58, v59
v_min_u32 v46, s70, v46
global_store_dwordx2 v13, v[46:47], s[54:55] offset:0 sc1
v_smfmac_f32_16x16x64_bf16 v[72:75], v[36:39], a[224:231], v5
v_smfmac_f32_16x16x64_bf16 v[76:79], v[36:39], a[240:247], v5
s_nop 1
v_permlane32_swap_b32 v64, v68
v_permlane32_swap_b32 v65, v69
v_permlane32_swap_b32 v66, v70
v_smfmac_f32_16x16x64_bf16 v[72:75], v[40:43], a[232:239], v5
v_permlane32_swap_b32 v67, v71
v_pk_add_f32 v[64:65], v[64:65], v[68:69]
v_pk_add_f32 v[66:67], v[66:67], v[70:71]
v_smfmac_f32_16x16x64_bf16 v[76:79], v[40:43], a[248:255], v5
v_cvt_pk_bf16_f32 v48, v64, v65
v_cvt_pk_bf16_f32 v49, v66, v67
v_min_u32 v48, s70, v48
global_store_dwordx2 v14, v[48:49], s[54:55] offset:0 sc1
v_smfmac_f32_16x16x64_bf16 v[80:83], v[36:39], v[192:199], v5
v_smfmac_f32_16x16x64_bf16 v[84:87], v[36:39], v[208:215], v5
s_nop 1
v_permlane32_swap_b32 v72, v76
v_permlane32_swap_b32 v73, v77
v_permlane32_swap_b32 v74, v78
v_smfmac_f32_16x16x64_bf16 v[80:83], v[40:43], v[200:207], v5
v_permlane32_swap_b32 v75, v79
v_pk_add_f32 v[72:73], v[72:73], v[76:77]
v_pk_add_f32 v[74:75], v[74:75], v[78:79]
v_smfmac_f32_16x16x64_bf16 v[84:87], v[40:43], v[216:223], v5
v_cvt_pk_bf16_f32 v50, v72, v73
v_cvt_pk_bf16_f32 v51, v74, v75
v_min_u32 v50, s70, v50
global_store_dwordx2 v13, v[50:51], s[54:55] offset:256 sc1
v_smfmac_f32_16x16x64_bf16 v[88:91], v[36:39], v[224:231], v5
v_smfmac_f32_16x16x64_bf16 v[92:95], v[36:39], v[240:247], v5
s_nop 1
v_permlane32_swap_b32 v80, v84
v_permlane32_swap_b32 v81, v85
v_permlane32_swap_b32 v82, v86
v_smfmac_f32_16x16x64_bf16 v[88:91], v[40:43], v[232:239], v5
v_permlane32_swap_b32 v83, v87
v_pk_add_f32 v[80:81], v[80:81], v[84:85]
v_pk_add_f32 v[82:83], v[82:83], v[86:87]
v_smfmac_f32_16x16x64_bf16 v[92:95], v[40:43], v[248:255], v5
v_cvt_pk_bf16_f32 v52, v80, v81
v_cvt_pk_bf16_f32 v53, v82, v83
v_min_u32 v52, s70, v52
global_store_dwordx2 v14, v[52:53], s[54:55] offset:256 sc1
s_nop 3
v_permlane32_swap_b32 v88, v92
v_permlane32_swap_b32 v89, v93
v_permlane32_swap_b32 v90, v94
v_permlane32_swap_b32 v91, v95
v_pk_add_f32 v[88:89], v[88:89], v[92:93]
v_pk_add_f32 v[90:91], v[90:91], v[94:95]
v_cvt_pk_bf16_f32 v54, v88, v89
v_cvt_pk_bf16_f32 v55, v90, v91
v_min_u32 v54, s70, v54
global_store_dwordx2 v13, v[54:55], s[54:55] offset:512 sc1
s_cmp_eq_u32 s30, 63
s_cbranch_scc1 VOlast_252
s_bitcmp1_b32 s30, 0
s_cbranch_scc1 ub1_309
ds_read_b128 v[124:127], v19 offset:0
ds_read_b128 v[140:143], v19 offset:1024
ds_read_b128 v[156:159], v19 offset:2048
ds_read_b128 v[128:131], v19 offset:3072
ds_read_b128 v[144:147], v19 offset:4096
ds_read_b128 v[160:163], v19 offset:5120
ds_read_b128 v[132:135], v19 offset:6144
ds_read_b128 v[148:151], v19 offset:7168
ds_read_b128 v[164:167], v19 offset:8192
ds_read_b128 v[136:139], v19 offset:9216
ds_read_b128 v[152:155], v19 offset:10240
ds_read_b128 v[168:171], v19 offset:11264
s_branch ub2_310
ub1_309:
ds_read_b128 v[124:127], v20 offset:0
ds_read_b128 v[140:143], v20 offset:1024
ds_read_b128 v[156:159], v20 offset:2048
ds_read_b128 v[128:131], v20 offset:3072
ds_read_b128 v[144:147], v20 offset:4096
ds_read_b128 v[160:163], v20 offset:5120
ds_read_b128 v[132:135], v20 offset:6144
ds_read_b128 v[148:151], v20 offset:7168
ds_read_b128 v[164:167], v20 offset:8192
ds_read_b128 v[136:139], v20 offset:9216
ds_read_b128 v[152:155], v20 offset:10240
ds_read_b128 v[168:171], v20 offset:11264
ub2_310:
v_mov_b32 v96, 0
v_mov_b32 v97, 0
v_mov_b32 v98, 0
v_mov_b32 v99, 0
v_mov_b32 v100, 0
v_mov_b32 v101, 0
v_mov_b32 v102, 0
v_mov_b32 v103, 0
v_mov_b32 v104, 0
v_mov_b32 v105, 0
v_mov_b32 v106, 0
v_mov_b32 v107, 0
s_add_u32 s40, s30, 1
s_cmp_lg_u32 s3, 0
s_cbranch_scc1 Fo_313
s_mov_b64 exec, 0xffff
global_load_dword v31, v12, s[4:5] sc1
s_nop 15
global_load_dword v33, v12, s[4:5] sc1
s_nop 15
global_load_dword v34, v12, s[4:5] sc1
Fq_311:
s_waitcnt vmcnt(2)
v_cmp_gt_u32 vcc, s40, v31
s_nop 3
s_cbranch_vccz Fk_314
global_load_dword v31, v12, s[4:5] sc1
s_waitcnt vmcnt(2)
v_cmp_gt_u32 vcc, s40, v33
s_nop 3
s_cbranch_vccz Fk_314
global_load_dword v33, v12, s[4:5] sc1
s_waitcnt vmcnt(2)
v_cmp_gt_u32 vcc, s40, v34
s_nop 3
s_cbranch_vccz Fk_314
global_load_dword v34, v12, s[4:5] sc1
s_add_u32 s100, s100, 1
s_cmp_lt_u32 s100, 0x1000000
s_cbranch_scc1 Fq_311
s_endpgm
Fk_314:
s_mov_b64 exec, -1
Fo_313:
s_barrier
global_load_dwordx4 v[72:75], v21, s[52:53] sc1
global_load_dwordx4 v[76:79], v21, s[52:53] offset:1024 sc1
s_mov_b64 exec, s[60:61]
global_load_dwordx4 v[176:179], v16, s[52:53] sc1
s_mov_b64 exec, -1
global_load_dwordx4 v[80:83], v17, s[54:55] sc1
global_load_dwordx4 v[84:87], v17, s[54:55] offset:256 sc1
global_load_dwordx4 v[88:91], v18, s[54:55] sc1
s_waitcnt vmcnt(3) lgkmcnt(0)
s_branch Sp1_316
Sp_315:
global_load_dwordx4 v[72:75], v21, s[52:53] sc1
global_load_dwordx4 v[76:79], v21, s[52:53] offset:1024 sc1
s_mov_b64 exec, s[60:61]
global_load_dwordx4 v[176:179], v16, s[52:53] sc1
s_mov_b64 exec, -1
s_waitcnt vmcnt(0)
Sp1_316:
v_max3_u32 v30, v72, v74, v76
v_max3_u32 v30, v30, v78, v176
v_max_u32 v30, v30, v178
v_cmp_eq_u32 vcc, -1, v30
s_nop 3
s_cbranch_vccz ok_317
s_add_u32 s100, s100, 1
s_cmp_lt_u32 s100, 0x1000000
s_cbranch_scc1 Sp_315
s_endpgm
ok_317:
v_smfmac_f32_16x16x64_bf16 v[96:99], v[72:75], v[124:131], v5
v_smfmac_f32_16x16x64_bf16 v[100:103], v[72:75], v[140:147], v5
v_smfmac_f32_16x16x64_bf16 v[104:107], v[72:75], v[156:163], v5
v_smfmac_f32_16x16x64_bf16 v[96:99], v[76:79], v[132:139], v5
v_smfmac_f32_16x16x64_bf16 v[100:103], v[76:79], v[148:155], v5
v_smfmac_f32_16x16x64_bf16 v[104:107], v[76:79], v[164:171], v5
s_waitcnt vmcnt(0)
Zp_318:
v_max3_u32 v30, v80, v82, v84
v_max3_u32 v30, v30, v86, v88
v_max_u32 v30, v30, v90
v_cmp_eq_u32 vcc, -1, v30
s_nop 3
s_cbranch_vccz Zo_319
global_load_dwordx4 v[80:83], v17, s[54:55] sc1
global_load_dwordx4 v[84:87], v17, s[54:55] offset:256 sc1
global_load_dwordx4 v[88:91], v18, s[54:55] sc1
s_waitcnt vmcnt(0)
s_add_u32 s100, s100, 1
s_cmp_lt_u32 s100, 0x1000000
s_cbranch_scc1 Zp_318
s_endpgm
Zo_319:
v_mfma_f32_16x16x32_bf16 v[96:99], v[176:179], v[80:83], v[96:99]
v_mfma_f32_16x16x32_bf16 v[100:103], v[176:179], v[84:87], v[100:103]
v_mfma_f32_16x16x32_bf16 v[104:107], v[176:179], v[88:91], v[104:107]
s_nop 6
v_permlane32_swap_b32 v96, v100
v_permlane32_swap_b32 v97, v101
v_permlane32_swap_b32 v98, v102
v_permlane32_swap_b32 v99, v103
v_pk_add_f32 v[96:97], v[96:97], v[100:101]
v_pk_add_f32 v[98:99], v[98:99], v[102:103]
ds_write_b128 v22, v[96:99]
v_mov_b32 v100, v104
v_mov_b32 v101, v105
v_mov_b32 v102, v106
v_mov_b32 v103, v107
v_permlane32_swap_b32 v104, v100
v_permlane32_swap_b32 v105, v101
v_permlane32_swap_b32 v106, v102
v_permlane32_swap_b32 v107, v103
v_pk_add_f32 v[104:105], v[104:105], v[100:101]
v_pk_add_f32 v[106:107], v[106:107], v[102:103]
s_mov_b64 exec, s[64:65]
ds_write_b128 v22, v[104:107] offset:1024
s_mov_b64 exec, -1
s_cmp_lg_u32 s3, 2
s_cbranch_scc1 ew_320
s_mov_b64 exec, 1
global_store_dword v190, v191, s[4:5] sc1
s_mov_b64 exec, -1
ew_320:
s_waitcnt lgkmcnt(0)
s_barrier
s_cmp_eq_u32 s76, 0
s_cbranch_scc1 nfin_321
s_mov_b64 exec, s[74:75]
ds_read_b128 v[36:39], v23 offset:0
ds_read_b128 v[40:43], v23 offset:1536
ds_read_b128 v[44:47], v23 offset:3072
ds_read_b128 v[48:51], v23 offset:4608
s_waitcnt lgkmcnt(2)
v_pk_add_f32 v[36:37], v[36:37], v[40:41]
v_pk_add_f32 v[38:39], v[38:39], v[42:43]
s_waitcnt lgkmcnt(0)
v_pk_add_f32 v[44:45], v[44:45], v[48:49]
v_pk_add_f32 v[46:47], v[46:47], v[50:51]
v_pk_add_f32 v[36:37], v[36:37], v[44:45]
v_pk_add_f32 v[38:39], v[38:39], v[46:47]
v_cvt_pk_bf16_f32 v30, v36, v37
v_cvt_pk_bf16_f32 v31, v38, v39
v_min_u32 v30, s70, v30
global_store_dwordx2 v24, v[30:31], s[34:35] sc1
global_store_dwordx2 v25, v[30:31], s[34:35] sc1
s_mov_b64 exec, -1
s_branch nx_322
nfin_321:
s_cmp_lg_u32 s3, 3
s_cbranch_scc1 nx_322
global_store_dwordx4 v27, v[180:183], s[26:27] sc1
global_store_dwordx4 v26, v[180:183], s[26:27] sc1
s_add_u32 s45, s30, 2
s_min_u32 s45, s45, 63
s_lshl_b32 s46, s45, 7
v_add_u32 v30, s46, v28
uf_323:
global_load_dword v31, v30, s[4:5] sc1
s_waitcnt vmcnt(0)
v_cmp_eq_u32 vcc, 0, v31
s_nop 3
s_cbranch_vccz ok_324
s_add_u32 s100, s100, 1
s_cmp_lt_u32 s100, 0x1000000
s_cbranch_scc1 uf_323
s_endpgm
ok_324:
nx_322:
s_add_u32 s30, s30, 1
s_branch VOstep_251
VOlast_252:
s_waitcnt vmcnt(0)
s_endpgm
L_exit:
s_endpgm
.section .rodata,"a"
.p2align 6
.amdhsa_kernel concat_heads__ssm_conv_s4__memory_aug_recurrent_mem_tr__prompt_kernel
  .amdhsa_next_free_vgpr 512
  .amdhsa_next_free_sgpr 102
  .amdhsa_accum_offset 256
  .amdhsa_group_segment_fixed_size 0
  .amdhsa_kernarg_size 152
  .amdhsa_user_sgpr_count 2
  .amdhsa_user_sgpr_kernarg_segment_ptr 1
  .amdhsa_system_sgpr_workgroup_id_x 1
.end_amdhsa_kernel
```
